```python
import torch

def _softmax(x, axis=-1):
    return torch.softmax(x, dim=axis)
def _gelu(x):
    return torch.nn.functional.gelu(x, approximate="tanh")
def _silu(x):
    return torch.nn.functional.silu(x)
def _sigmoid(x):
    return torch.sigmoid(x)
def _layernorm(x, axis=-1, eps=1e-5):
    m = x.mean(dim=axis, keepdim=True)
    v = x.var(dim=axis, keepdim=True, unbiased=False)
    return (x - m) / torch.sqrt(v + eps)
def _scatter_add(tgt, idx, src, axis=0):
    return tgt.clone().index_add_(axis, idx, src)
def _segment_sum(src, seg, n):
    out = torch.zeros((n,) + src.shape[1:], dtype=src.dtype)
    return out.index_add_(0, seg, src)
def _pad(x, pw):
    flat = tuple(v for pair in reversed(pw) for v in pair)
    return torch.nn.functional.pad(x, flat)

kernel_name = 'recurrent_scan__mha_block_cached__mixer_token_mlp__prompt'

def setup_inputs():

    _w = (lambda a: (lambda t: t.to(torch.bfloat16) if t.is_floating_point() else t)(torch.as_tensor(a)))
    def _A_setup():
        B, Sq, D = 1, 2048, 640
        H, Sk, Dh = 32, 2048, 128
        return {
            "x": _w((lambda *s: torch.randn(*s, dtype=torch.bfloat16) * 0.1)(B, Sq, D)),
            "k_cache": _w((lambda *s: torch.randn(*s, dtype=torch.bfloat16) * 0.8)(B, H, Sk, Dh)),
            "v_cache": _w((lambda *s: torch.randn(*s, dtype=torch.bfloat16) * 3.2)(B, H, Sk, Dh)),
            "wq": _w((lambda *s: torch.randn(*s, dtype=torch.bfloat16) * 0.8)(D, H * Dh) * (D ** -0.5)),
            "wo": _w((lambda *s: torch.randn(*s, dtype=torch.bfloat16) * 3.2)(H * Dh, D) * ((H * Dh) ** -0.5)),
        }
    _A_in = _A_setup()

    def _B_setup():
        B, S, D, F = 1, 2048, 640, 1728
        return {
            "x": _w((lambda *s: torch.randn(*s, dtype=torch.bfloat16) * 0.1)(B, S, D)),
            "w1": _w((lambda *s: torch.randn(*s, dtype=torch.bfloat16) * 3.2)(S, F) * (S ** -0.5)),
            "b1": _w((lambda *s: torch.randn(*s, dtype=torch.bfloat16) * 3.2)(F) * 0.02),
            "w2": _w((lambda *s: torch.randn(*s, dtype=torch.bfloat16) * 3.2)(F, S) * (F ** -0.5)),
            "b2": _w((lambda *s: torch.randn(*s, dtype=torch.bfloat16) * 3.2)(S) * 0.02),
        }
    _B_in = _B_setup()

    return {
        "A_x": _A_in["x"],
        "A_k_cache": _A_in["k_cache"],
        "A_v_cache": _A_in["v_cache"],
        "A_wq": _A_in["wq"],
        "A_wo": _A_in["wo"],
        "B_x": _B_in["x"],
        "B_w1": _B_in["w1"],
        "B_b1": _B_in["b1"],
        "B_w2": _B_in["w2"],
        "B_b2": _B_in["b2"],
    }

def reference(A_x, A_k_cache, A_v_cache, A_wq, A_wo, B_x, B_w1, B_b1, B_w2, B_b2):
    def _A_ref(x, k_cache, v_cache, wq, wo):
        B, Sq, D = x.shape
        H, Dh = 32, 128
        q = (lambda x, *d: x.permute(*d))((x @ wq).reshape(B, Sq, H, Dh), 0, 2, 1, 3)
        scores = torch.einsum("bhqd,bhkd->bhqk", q, k_cache) * (Dh ** -0.5)
        p = _softmax(scores, axis=-1)
        o = torch.einsum("bhqk,bhkd->bhqd", p, v_cache)
        return (lambda x, *d: x.permute(*d))(o, 0, 2, 1, 3).reshape(B, Sq, H * Dh) @ wo

    def _B_ref(x, w1, b1, w2, b2):
        B, S, D = x.shape
        h = _layernorm(x, axis=-1)
        u = torch.einsum("bsd,sf->bdf", h, w1) + b1
        u = _gelu(u)
        y = torch.einsum("bdf,fs->bds", u, w2) + b2
        return (lambda x, *d: x.permute(*d))(y, 0, 2, 1)

    x = A_x
    xn = _layernorm(x, axis=-1)
    s = _A_ref(xn, A_k_cache, A_v_cache, A_wq, A_wo)
    g = _silu(_B_ref(xn, B_w1, B_b1, B_w2, B_b2))
    return x + s * g
```

```asm
; @launch grid=(256,1,1) block=(256,1,1) lds=163840
.amdgcn_target "amdgcn-amd-amdhsa--gfx950"
.text
.globl recurrent_scan__mha_block_cached__mixer_token_mlp__prompt_kernel
.p2align 8
.type recurrent_scan__mha_block_cached__mixer_token_mlp__prompt_kernel,@function
recurrent_scan__mha_block_cached__mixer_token_mlp__prompt_kernel:
s_cmp_ge_u32 s2, 256
s_cbranch_scc1 K_exit
s_load_dwordx2 s[36:37], s[0:1], 0
s_load_dwordx2 s[60:61], s[0:1], 88
s_load_dwordx2 s[12:13], s[0:1], 24
s_load_dwordx2 s[16:17], s[0:1], 96
s_load_dwordx2 s[4:5], s[0:1], 8
s_load_dwordx2 s[8:9], s[0:1], 16
s_load_dwordx2 s[32:33], s[0:1], 32
s_getpc_b64 s[72:73]
K_pc:
v_and_b32 v1, 63, v0
v_lshrrev_b32 v17, 6, v0
s_mov_b32 s74, K_last-K_pc
v_readfirstlane_b32 s44, v17
s_mov_b32 s75, 0x20000
s_lshr_b32 s51, s2, 3
v_lshlrev_b32 v98, 7, v1
s_cmp_lt_u32 s44, 2
s_cbranch_scc1 K_nocp
s_lshl_b32 s49, s51, 1
s_add_u32 s49, s49, s44
s_and_b32 s49, s49, 15
s_lshl_b32 s49, s49, 13
buffer_load_dword v25, v98, s[72:75], s49 offen
K_nocp:
s_and_b32 s81, s2, 7
s_lshr_b32 s52, s51, 3
s_and_b32 s80, s51, 7
s_lshl_b32 s53, s52, 3
s_add_u32 s53, s53, s81
s_lshl_b32 s54, s80, 5
s_add_u32 s83, s53, s54
v_lshrrev_b32 v96, 5, v0
v_and_b32 v97, 31, v0
s_lshr_b32 s54, s83, 2
s_lshl_b32 s54, s54, 5
s_and_b32 s55, s83, 3
s_lshl_b32 s55, s55, 2
s_add_u32 s54, s54, s55
v_and_b32 v98, 3, v96
v_lshrrev_b32 v99, 2, v96
v_lshl_add_u32 v98, v99, 4, v98
v_add_u32 v98, s54, v98
v_mul_u32_u24 v98, 1280, v98
v_lshl_add_u32 v98, v97, 3, v98
s_mov_b32 s38, 2621440
s_mov_b32 s39, 0x20000
s_mov_b32 s62, 256
s_mov_b32 s63, 0x20000
v_mov_b32 v182, 0
s_memrealtime s[90:91]
s_waitcnt lgkmcnt(0)
buffer_load_dwordx2 v[100:101], v98, s[36:39], 0 offen offset:0
buffer_load_dwordx2 v[102:103], v98, s[36:39], 0 offen offset:256
buffer_load_dwordx2 v[104:105], v98, s[36:39], 0 offen offset:512
buffer_load_dwordx2 v[106:107], v98, s[36:39], 0 offen offset:768
buffer_load_dwordx2 v[108:109], v98, s[36:39], 0 offen offset:1024
s_lshl_b32 s48, s2, 2
s_add_u32 s48, s48, s44
s_cmp_lg_u32 s48, 1
s_cbranch_scc1 K_notag
s_or_b32 s90, s90, 1
v_mov_b32 v183, s90
s_mov_b64 exec, 1
buffer_store_dword v183, v182, s[60:63], 0 offen sc1
s_mov_b64 exec, -1
K_notag:
s_lshl_b32 s50, s81, 2
s_add_u32 s50, s50, s52
s_lshl_b32 s56, s50, 8
s_sub_u32 s14, 5242880, s56
s_mov_b32 s15, 0x20000
s_add_u32 s12, s12, s56
s_addc_u32 s13, s13, 0
s_cmp_lt_u32 s44, 2
s_cbranch_scc1 K_nopf
v_lshrrev_b32 v98, 1, v1
v_and_b32 v99, 1, v1
v_lshlrev_b32 v99, 7, v99
v_lshl_add_u32 v98, v98, 17, v99
s_lshl_b32 s48, s80, 1
s_add_u32 s48, s48, s44
s_sub_u32 s48, s48, 2
s_lshl_b32 s48, s48, 13
buffer_load_dword v25, v98, s[12:15], s48 offen
s_add_u32 s48, s48, 4194304
buffer_load_dword v25, v98, s[12:15], s48 offen
K_nopf:
s_load_dwordx2 s[20:21], s[0:1], 48
s_load_dwordx2 s[24:25], s[0:1], 56
s_load_dwordx2 s[28:29], s[0:1], 64
s_load_dwordx2 s[64:65], s[0:1], 72
s_load_dwordx2 s[68:69], s[0:1], 80
s_mov_b32 s18, 67108864
s_mov_b32 s19, 0x20000
s_mov_b32 s45, 0
s_lshr_b32 s48, s2, 5
s_lshr_b32 s53, s81, 1
s_mul_i32 s53, s53, 7
s_add_u32 s53, s53, s48
s_cmp_lt_u32 s48, 7
s_cselect_b32 s78, 1, 0
s_cmp_lt_u32 s53, 27
s_cselect_b32 s78, s78, 0
s_and_b32 s48, s81, 1
s_lshl_b32 s48, s48, 2
s_and_b32 s82, s80, 3
s_add_u32 s82, s82, s48
s_lshl_b32 s82, s82, 5
s_add_u32 s82, s82, s53
s_cmp_eq_u32 s78, 0
s_cselect_b32 s58, 8, 0
s_cmp_lg_u32 s44, 0
s_cselect_b32 s58, -1, s58
s_mov_b32 s49, 0xffff0000
v_mul_u32_u24 v176, 1280, v96
v_lshl_add_u32 v176, v97, 3, v176
v_add_u32 v176, 131072, v176
v_and_b32 v184, 3, v1
v_bfe_u32 v185, v1, 2, 2
v_bfe_u32 v186, v1, 4, 1
v_lshrrev_b32 v187, 5, v1
v_lshl_add_u32 v177, v186, 2, v184
v_mul_u32_u24 v177, 1280, v177
v_lshl_add_u32 v177, v187, 6, v177
v_lshl_add_u32 v177, v185, 3, v177
v_add_u32 v177, 131072, v177
s_lshr_b32 s54, s83, 2
s_lshl_b32 s54, s54, 1
v_add_u32 v178, s54, v186
v_mul_u32_u24 v178, 20, v178
v_add_u32 v178, v178, v187
v_lshlrev_b32 v178, 6, v178
v_lshl_add_u32 v178, v185, 4, v178
v_add_u32 v178, v178, v184
v_add_u32 v178, s55, v178
v_lshlrev_b32 v178, 4, v178
v_lshrrev_b32 v188, 4, v1
v_and_b32 v189, 15, v1
v_lshlrev_b32 v190, 1, v188
v_xor_b32 v189, v189, v190
v_lshlrev_b32 v189, 4, v189
v_lshl_add_u32 v17, v188, 13, v189
v_xor_b32 v18, 128, v17
s_lshl_b32 s46, s44, 17
s_lshl_b32 s40, s44, 12
s_lshl_b32 s52, s50, 19
s_add_u32 s4, s4, s52
s_addc_u32 s5, s5, 0
s_add_u32 s8, s8, s52
s_addc_u32 s9, s9, 0
s_mov_b32 s6, 524288
s_mov_b32 s7, 0x20000
s_mov_b32 s10, 524288
s_mov_b32 s11, 0x20000
s_mov_b32 s34, 5242880
s_mov_b32 s35, 0x20000
s_mov_b32 s22, 7077888
s_mov_b32 s23, 0x20000
s_mov_b32 s26, 3456
s_mov_b32 s27, 0x20000
s_mov_b32 s30, 7077888
s_mov_b32 s31, 0x20000
s_mov_b32 s66, 4096
s_mov_b32 s67, 0x20000
s_mov_b32 s70, 2621440
s_mov_b32 s71, 0x20000
s_lshr_b32 s3, s2, 3
s_lshl_b32 s3, s3, 2
s_add_u32 s3, s3, s44
s_lshl_b32 s3, s3, 10
s_and_b32 s3, s3, 0xffff
s_add_u32 s3, s3, K_tail-K_pc
s_branch K_al
.p2align 12
K_al:
s_cmp_lt_u32 s44, 2
s_cbranch_scc1 K_w0
s_waitcnt vmcnt(2)
s_branch K_w1
K_w0:
s_waitcnt vmcnt(0)
K_w1:
buffer_load_dword v183, v182, s[60:63], 0 offen sc1
v_lshlrev_b32 v110, 16, v100
v_and_b32 v111, s49, v100
v_lshlrev_b32 v112, 16, v101
v_and_b32 v113, s49, v101
v_lshlrev_b32 v114, 16, v102
v_and_b32 v115, s49, v102
v_lshlrev_b32 v116, 16, v103
v_and_b32 v117, s49, v103
v_lshlrev_b32 v118, 16, v104
v_and_b32 v119, s49, v104
v_lshlrev_b32 v120, 16, v105
v_and_b32 v121, s49, v105
v_lshlrev_b32 v122, 16, v106
v_and_b32 v123, s49, v106
v_lshlrev_b32 v124, 16, v107
v_and_b32 v125, s49, v107
v_lshlrev_b32 v126, 16, v108
v_and_b32 v127, s49, v108
v_lshlrev_b32 v128, 16, v109
v_and_b32 v129, s49, v109
v_pk_add_f32 v[170:171], v[110:111], v[112:113]
v_pk_add_f32 v[170:171], v[170:171], v[114:115]
v_pk_add_f32 v[170:171], v[170:171], v[116:117]
v_pk_add_f32 v[170:171], v[170:171], v[118:119]
v_pk_add_f32 v[170:171], v[170:171], v[120:121]
v_pk_add_f32 v[170:171], v[170:171], v[122:123]
v_pk_add_f32 v[170:171], v[170:171], v[124:125]
v_pk_add_f32 v[170:171], v[170:171], v[126:127]
v_pk_add_f32 v[170:171], v[170:171], v[128:129]
v_add_f32 v170, v170, v171
s_nop 1
v_add_f32_dpp v170, v170, v170 row_ror:8 row_mask:0xf bank_mask:0xf
s_nop 1
v_add_f32_dpp v170, v170, v170 row_ror:4 row_mask:0xf bank_mask:0xf
s_nop 1
v_add_f32_dpp v170, v170, v170 row_ror:2 row_mask:0xf bank_mask:0xf
s_nop 1
v_add_f32_dpp v170, v170, v170 row_ror:1 row_mask:0xf bank_mask:0xf
v_mov_b32 v174, v170
s_nop 1
v_permlane16_swap_b32 v174, v170
s_nop 1
v_add_f32 v170, v170, v174
v_mul_f32 v170, 0xbacccccd, v170
v_pk_add_f32 v[130:131], v[110:111], v[170:171] op_sel_hi:[1,0]
v_pk_add_f32 v[132:133], v[112:113], v[170:171] op_sel_hi:[1,0]
v_pk_add_f32 v[134:135], v[114:115], v[170:171] op_sel_hi:[1,0]
v_pk_add_f32 v[136:137], v[116:117], v[170:171] op_sel_hi:[1,0]
v_pk_add_f32 v[138:139], v[118:119], v[170:171] op_sel_hi:[1,0]
v_pk_add_f32 v[140:141], v[120:121], v[170:171] op_sel_hi:[1,0]
v_pk_add_f32 v[142:143], v[122:123], v[170:171] op_sel_hi:[1,0]
v_pk_add_f32 v[144:145], v[124:125], v[170:171] op_sel_hi:[1,0]
v_pk_add_f32 v[146:147], v[126:127], v[170:171] op_sel_hi:[1,0]
v_pk_add_f32 v[148:149], v[128:129], v[170:171] op_sel_hi:[1,0]
v_pk_mul_f32 v[172:173], v[130:131], v[130:131]
v_pk_fma_f32 v[172:173], v[132:133], v[132:133], v[172:173]
v_pk_fma_f32 v[172:173], v[134:135], v[134:135], v[172:173]
v_pk_fma_f32 v[172:173], v[136:137], v[136:137], v[172:173]
v_pk_fma_f32 v[172:173], v[138:139], v[138:139], v[172:173]
v_pk_fma_f32 v[172:173], v[140:141], v[140:141], v[172:173]
v_pk_fma_f32 v[172:173], v[142:143], v[142:143], v[172:173]
v_pk_fma_f32 v[172:173], v[144:145], v[144:145], v[172:173]
v_pk_fma_f32 v[172:173], v[146:147], v[146:147], v[172:173]
v_pk_fma_f32 v[172:173], v[148:149], v[148:149], v[172:173]
v_add_f32 v172, v172, v173
s_nop 1
v_add_f32_dpp v172, v172, v172 row_ror:8 row_mask:0xf bank_mask:0xf
s_nop 1
v_add_f32_dpp v172, v172, v172 row_ror:4 row_mask:0xf bank_mask:0xf
s_nop 1
v_add_f32_dpp v172, v172, v172 row_ror:2 row_mask:0xf bank_mask:0xf
s_nop 1
v_add_f32_dpp v172, v172, v172 row_ror:1 row_mask:0xf bank_mask:0xf
v_mov_b32 v174, v172
s_nop 1
v_permlane16_swap_b32 v174, v172
s_nop 1
v_add_f32 v172, v172, v174
v_mul_f32 v172, 0x3acccccd, v172
v_cvt_pk_bf16_f32 v170, v170, v170
v_and_b32 v170, 0xffff0000, v170
v_cvt_pk_bf16_f32 v172, v172, v172
v_and_b32 v172, 0xffff0000, v172
v_add_f32 v172, 0x3727c5ac, v172
v_cvt_pk_bf16_f32 v172, v172, v172
v_and_b32 v172, 0xffff0000, v172
v_sqrt_f32 v172, v172
s_nop 0
v_cvt_pk_bf16_f32 v172, v172, v172
v_and_b32 v172, 0xffff0000, v172
v_rcp_f32 v172, v172
v_pk_add_f32 v[130:131], v[110:111], v[170:171] op_sel_hi:[1,0]
v_pk_add_f32 v[132:133], v[112:113], v[170:171] op_sel_hi:[1,0]
v_pk_add_f32 v[134:135], v[114:115], v[170:171] op_sel_hi:[1,0]
v_pk_add_f32 v[136:137], v[116:117], v[170:171] op_sel_hi:[1,0]
v_pk_add_f32 v[138:139], v[118:119], v[170:171] op_sel_hi:[1,0]
v_pk_add_f32 v[140:141], v[120:121], v[170:171] op_sel_hi:[1,0]
v_pk_add_f32 v[142:143], v[122:123], v[170:171] op_sel_hi:[1,0]
v_pk_add_f32 v[144:145], v[124:125], v[170:171] op_sel_hi:[1,0]
v_pk_add_f32 v[146:147], v[126:127], v[170:171] op_sel_hi:[1,0]
v_pk_add_f32 v[148:149], v[128:129], v[170:171] op_sel_hi:[1,0]
v_cvt_pk_bf16_f32 v150, v130, v131
v_cvt_pk_bf16_f32 v151, v132, v133
v_cvt_pk_bf16_f32 v152, v134, v135
v_cvt_pk_bf16_f32 v153, v136, v137
v_cvt_pk_bf16_f32 v154, v138, v139
v_cvt_pk_bf16_f32 v155, v140, v141
v_cvt_pk_bf16_f32 v156, v142, v143
v_cvt_pk_bf16_f32 v157, v144, v145
v_cvt_pk_bf16_f32 v158, v146, v147
v_cvt_pk_bf16_f32 v159, v148, v149
v_lshlrev_b32 v130, 16, v150
v_and_b32 v131, s49, v150
v_lshlrev_b32 v132, 16, v151
v_and_b32 v133, s49, v151
v_lshlrev_b32 v134, 16, v152
v_and_b32 v135, s49, v152
v_lshlrev_b32 v136, 16, v153
v_and_b32 v137, s49, v153
v_lshlrev_b32 v138, 16, v154
v_and_b32 v139, s49, v154
v_lshlrev_b32 v140, 16, v155
v_and_b32 v141, s49, v155
v_lshlrev_b32 v142, 16, v156
v_and_b32 v143, s49, v156
v_lshlrev_b32 v144, 16, v157
v_and_b32 v145, s49, v157
v_lshlrev_b32 v146, 16, v158
v_and_b32 v147, s49, v158
v_lshlrev_b32 v148, 16, v159
v_and_b32 v149, s49, v159
v_mul_f32 v174, 0x3e0293ee, v172
v_pk_mul_f32 v[110:111], v[130:131], v[174:175] op_sel_hi:[1,0]
v_pk_mul_f32 v[112:113], v[132:133], v[174:175] op_sel_hi:[1,0]
v_pk_mul_f32 v[114:115], v[134:135], v[174:175] op_sel_hi:[1,0]
v_pk_mul_f32 v[116:117], v[136:137], v[174:175] op_sel_hi:[1,0]
v_pk_mul_f32 v[118:119], v[138:139], v[174:175] op_sel_hi:[1,0]
v_pk_mul_f32 v[120:121], v[140:141], v[174:175] op_sel_hi:[1,0]
v_pk_mul_f32 v[122:123], v[142:143], v[174:175] op_sel_hi:[1,0]
v_pk_mul_f32 v[124:125], v[144:145], v[174:175] op_sel_hi:[1,0]
v_pk_mul_f32 v[126:127], v[146:147], v[174:175] op_sel_hi:[1,0]
v_pk_mul_f32 v[128:129], v[148:149], v[174:175] op_sel_hi:[1,0]
v_cvt_pk_bf16_f32 v150, v110, v111
v_cvt_pk_bf16_f32 v151, v112, v113
v_cvt_pk_bf16_f32 v152, v114, v115
v_cvt_pk_bf16_f32 v153, v116, v117
v_cvt_pk_bf16_f32 v154, v118, v119
v_cvt_pk_bf16_f32 v155, v120, v121
v_cvt_pk_bf16_f32 v156, v122, v123
v_cvt_pk_bf16_f32 v157, v124, v125
v_cvt_pk_bf16_f32 v158, v126, v127
v_cvt_pk_bf16_f32 v159, v128, v129
s_waitcnt lgkmcnt(0)
ds_write_b64 v176, v[150:151] offset:0
ds_write_b64 v176, v[152:153] offset:256
ds_write_b64 v176, v[154:155] offset:512
ds_write_b64 v176, v[156:157] offset:768
ds_write_b64 v176, v[158:159] offset:1024
s_waitcnt lgkmcnt(0)
s_barrier
s_cmp_lg_u32 s44, 0
s_cbranch_scc1 K_noxs
ds_read2_b64 v[184:187], v177 offset0:0 offset1:4
ds_read2_b64 v[188:191], v177 offset0:16 offset1:20
ds_read2_b64 v[192:195], v177 offset0:32 offset1:36
ds_read2_b64 v[196:199], v177 offset0:48 offset1:52
ds_read2_b64 v[200:203], v177 offset0:64 offset1:68
ds_read2_b64 v[204:207], v177 offset0:80 offset1:84
ds_read2_b64 v[208:211], v177 offset0:96 offset1:100
ds_read2_b64 v[212:215], v177 offset0:112 offset1:116
ds_read2_b64 v[216:219], v177 offset0:128 offset1:132
ds_read2_b64 v[220:223], v177 offset0:144 offset1:148
s_mov_b32 s54, 0
s_waitcnt lgkmcnt(9)
buffer_store_dwordx4 v[184:187], v178, s[16:19], s54 offen offset:0 sc1
s_waitcnt lgkmcnt(8)
buffer_store_dwordx4 v[188:191], v178, s[16:19], s54 offen offset:2048 sc1
s_mov_b32 s54, 4096
s_waitcnt lgkmcnt(7)
buffer_store_dwordx4 v[192:195], v178, s[16:19], s54 offen offset:0 sc1
s_waitcnt lgkmcnt(6)
buffer_store_dwordx4 v[196:199], v178, s[16:19], s54 offen offset:2048 sc1
s_mov_b32 s54, 8192
s_waitcnt lgkmcnt(5)
buffer_store_dwordx4 v[200:203], v178, s[16:19], s54 offen offset:0 sc1
s_waitcnt lgkmcnt(4)
buffer_store_dwordx4 v[204:207], v178, s[16:19], s54 offen offset:2048 sc1
s_mov_b32 s54, 12288
s_waitcnt lgkmcnt(3)
buffer_store_dwordx4 v[208:211], v178, s[16:19], s54 offen offset:0 sc1
s_waitcnt lgkmcnt(2)
buffer_store_dwordx4 v[212:215], v178, s[16:19], s54 offen offset:2048 sc1
s_mov_b32 s54, 16384
s_waitcnt lgkmcnt(1)
buffer_store_dwordx4 v[216:219], v178, s[16:19], s54 offen offset:0 sc1
s_waitcnt lgkmcnt(0)
buffer_store_dwordx4 v[220:223], v178, s[16:19], s54 offen offset:2048 sc1
K_noxs:
K_start:
v_lshrrev_b32 v66, 2, v1
v_and_b32 v67, 7, v66
v_lshlrev_b32 v67, 1, v67
v_and_b32 v68, 3, v1
v_xor_b32 v69, v67, v68
v_lshlrev_b32 v69, 4, v69
v_lshl_add_u32 v32, v66, 8, v69
v_xor_b32 v33, 64, v32
v_xor_b32 v34, 128, v32
v_xor_b32 v35, 192, v32
v_add_u32 v19, 65536, v32
v_add_u32 v20, 65536, v33
v_add_u32 v21, 65536, v34
v_add_u32 v22, 65536, v35
v_min_u32 v73, 7, v1
v_lshlrev_b32 v73, 7, v73
s_lshl_b32 s56, s80, 12
s_add_u32 s56, s56, 14680064
v_add_u32 v73, s56, v73
s_lshl_b32 s56, s44, 10
v_add_u32 v73, s56, v73
v_bfe_u32 v89, v1, 2, 2
v_mul_u32_u24 v89, 1280, v89
v_lshrrev_b32 v64, 4, v1
s_lshl_b32 s54, s44, 2
v_add_u32 v64, s54, v64
v_lshl_add_u32 v89, v64, 5, v89
v_lshl_add_u32 v89, v68, 3, v89
v_add_u32 v89, 131072, v89
v_mul_u32_u24 v88, 65536, v64
v_and_b32 v65, 15, v1
v_lshl_add_u32 v88, v65, 4, v88
s_lshl_b32 s55, s80, 4
s_add_u32 s55, s55, s54
s_mul_i32 s47, s55, 20480
v_lshlrev_b32 v23, 4, v1
s_nop 0
s_add_u32 m0, s40, 98304
s_lshl_b32 s50, s81, 2
s_lshr_b32 s52, s2, 6
s_add_u32 s50, s50, s52
s_add_u32 s48, s46, 0
buffer_load_dwordx4 v17, s[12:15], s48 offen offset:0 lds
s_mov_b32 s41, s40
s_mov_b32 s42, s40
s_mul_i32 s57, s55, 135424
s_add_u32 s48, s46, 31744
buffer_load_dwordx4 v18, s[12:15], s48 offen offset:1024 lds
s_lshl_b32 s54, s50, 12
s_add_u32 s57, s57, s54
s_add_u32 s57, s57, 16777216
s_add_u32 s48, s46, 63488
buffer_load_dwordx4 v17, s[12:15], s48 offen offset:2048 lds
s_lshl_b32 s59, s2, 2
s_add_u32 s59, s59, s44
s_lshl_b32 s54, s50, 2
s_add_u32 s48, s46, 95232
buffer_load_dwordx4 v18, s[12:15], s48 offen offset:3072 lds
s_add_u32 s54, s54, s44
s_mul_i32 s76, s54, 40960
s_mul_i32 s53, s80, 160
s_cmp_lg_u32 s44, 1
s_cbranch_scc1 K_hop1
s_mov_b64 exec, 0
s_branch K_pg0
K_back0:
s_mov_b64 exec, -1
K_hop1:
s_add_u32 m0, s40, 114688
s_add_u32 s76, s76, s53
s_mul_i32 s77, s80, 677120
s_lshl_b32 s54, s54, 10
s_add_u32 s48, s46, 524288
buffer_load_dwordx4 v17, s[12:15], s48 offen offset:0 lds
s_add_u32 s77, s77, s54
s_add_u32 s77, s77, 8388608
s_mul_i32 s59, s59, 7168
s_add_u32 s48, s46, 556032
buffer_load_dwordx4 v18, s[12:15], s48 offen offset:1024 lds
s_lshl_b32 s50, s83, 8
s_add_u32 s50, s50, 2621440
s_cmp_lg_u32 s45, 0
s_cselect_b32 s50, 67108864, s50
s_add_u32 s48, s46, 587776
buffer_load_dwordx4 v17, s[12:15], s48 offen offset:2048 lds
s_add_u32 s51, s50, 1048576
s_add_u32 s52, s50, 2097152
s_cmp_ge_u32 s44, 2
s_cselect_b32 s52, 67108864, s52
s_add_u32 s48, s46, 619520
buffer_load_dwordx4 v18, s[12:15], s48 offen offset:3072 lds
v_bfe_u32 v68, v1, 1, 1
v_xor_b32 v68, v67, v68
v_lshlrev_b32 v68, 4, v68
s_bitcmp1_b32 s58, 0
s_cbranch_scc1 Lw0_1
s_waitcnt vmcnt(8)
v_cmp_eq_u32 vcc, 0, v183
s_cbranch_vccz Lspun_3
s_mov_b32 s56, 0x40000
Lspin_2:
buffer_load_dword v183, v182, s[60:63], 0 offen sc1
s_waitcnt vmcnt(0)
v_cmp_eq_u32 vcc, 0, v183
s_cbranch_vccz Lspun_3
s_sleep 1
s_sub_u32 s56, s56, 1
s_cmp_lg_u32 s56, 0
s_cbranch_scc1 Lspin_2
Lspun_3:
v_readfirstlane_b32 s88, v183
s_nop 1
s_bitcmp1_b32 s58, 0
s_cbranch_scc1 Lsig_4
s_bitset1_b32 s58, 0
v_mov_b32 v99, s83
v_mov_b32 v98, s88
v_lshlrev_b32 v99, 7, v99
v_add_u32 v99, 14680064, v99
s_mov_b64 exec, 1
buffer_store_dword v98, v99, s[16:19], 0 offen sc1
s_mov_b64 exec, -1
Lsig_4:
Lw0_1:
s_add_u32 m0, s40, 0
v_lshl_add_u32 v68, v66, 8, v68
v_and_b32 v69, 1, v1
v_lshl_add_u32 v68, v69, 3, v68
s_add_u32 s48, s46, 1048576
buffer_load_dwordx4 v17, s[12:15], s48 offen offset:0 lds
v_add_u32 v6, 65536, v68
v_xor_b32 v7, 32, v6
v_xor_b32 v8, 64, v6
s_add_u32 s48, s46, 1080320
buffer_load_dwordx4 v18, s[12:15], s48 offen offset:1024 lds
v_xor_b32 v9, 96, v6
v_xor_b32 v10, 128, v6
v_xor_b32 v11, 160, v6
s_add_u32 s48, s46, 1112064
buffer_load_dwordx4 v17, s[12:15], s48 offen offset:2048 lds
v_xor_b32 v12, 192, v6
v_xor_b32 v13, 224, v6
v_and_b32 v64, 15, v1
s_add_u32 s48, s46, 1143808
buffer_load_dwordx4 v18, s[12:15], s48 offen offset:3072 lds
v_lshrrev_b32 v65, 4, v1
v_and_b32 v66, 7, v1
v_lshlrev_b32 v24, 7, v66
s_cmp_lg_u32 s44, 2
s_cbranch_scc1 K_hop2
s_mov_b64 exec, 0
s_branch K_pg1
K_back1:
s_mov_b64 exec, -1
K_hop2:
s_add_u32 m0, s40, 16384
v_lshlrev_b32 v66, 1, v66
v_xor_b32 v66, v66, v65
v_lshlrev_b32 v66, 4, v66
s_add_u32 s48, s46, 1572864
buffer_load_dwordx4 v17, s[12:15], s48 offen offset:0 lds
v_lshl_add_u32 v2, v64, 8, v66
v_xor_b32 v3, 64, v2
v_xor_b32 v4, 128, v2
s_add_u32 s48, s46, 1604608
buffer_load_dwordx4 v18, s[12:15], s48 offen offset:1024 lds
v_xor_b32 v5, 192, v2
v_lshlrev_b32 v66, 1, v65
v_xor_b32 v66, v66, v64
s_add_u32 s48, s46, 1636352
buffer_load_dwordx4 v17, s[12:15], s48 offen offset:2048 lds
v_lshlrev_b32 v66, 4, v66
v_lshl_add_u32 v14, v65, 8, v66
v_xor_b32 v15, 128, v14
s_add_u32 s48, s46, 1668096
buffer_load_dwordx4 v18, s[12:15], s48 offen offset:3072 lds
v_mov_b32 v70, 0x3f803f80
v_cmp_gt_u32 vcc, 2, v64
v_mov_b32 v71, 0x44444444
v_mov_b32 v72, 0xeeeeeeee
v_cndmask_b32 v28, 0, v70, vcc
v_cmp_eq_u32 vcc, 1, v69
v_mov_b32 v29, v28
v_mov_b32 v30, v28
v_mov_b32 v31, v28
v_cndmask_b32 v16, v71, v72, vcc
s_add_u32 m0, s40, 32768
v_add_u32 v64, 0, v1
v_mul_u32_u24 v65, 6554, v64
v_lshrrev_b32 v65, 16, v65
s_add_u32 s48, s46, 2097152
buffer_load_dwordx4 v17, s[12:15], s48 offen offset:0 lds
v_mul_u32_u24 v66, 10, v65
v_sub_u32 v64, v64, v66
v_mul_u32_u24 v65, 1280, v65
s_add_u32 s48, s46, 2128896
buffer_load_dwordx4 v18, s[12:15], s48 offen offset:1024 lds
v_lshl_add_u32 v36, v64, 4, v65
v_add_u32 v64, 64, v1
v_mul_u32_u24 v65, 6554, v64
s_add_u32 s48, s46, 2160640
buffer_load_dwordx4 v17, s[12:15], s48 offen offset:2048 lds
v_lshrrev_b32 v65, 16, v65
v_mul_u32_u24 v66, 10, v65
v_sub_u32 v64, v64, v66
s_add_u32 s48, s46, 2192384
buffer_load_dwordx4 v18, s[12:15], s48 offen offset:3072 lds
v_mul_u32_u24 v65, 1280, v65
v_lshl_add_u32 v37, v64, 4, v65
v_add_u32 v64, 128, v1
s_cmp_lg_u32 s44, 3
s_cbranch_scc1 K_hop3
s_mov_b64 exec, 0
s_branch K_pg2
K_back2:
s_mov_b64 exec, -1
K_hop3:
s_add_u32 m0, s40, 49152
v_mul_u32_u24 v65, 6554, v64
v_lshrrev_b32 v65, 16, v65
v_mul_u32_u24 v66, 10, v65
s_add_u32 s48, s46, 2621440
buffer_load_dwordx4 v17, s[12:15], s48 offen offset:0 lds
v_sub_u32 v64, v64, v66
v_mul_u32_u24 v65, 1280, v65
v_lshl_add_u32 v38, v64, 4, v65
s_add_u32 s48, s46, 2653184
buffer_load_dwordx4 v18, s[12:15], s48 offen offset:1024 lds
v_add_u32 v64, 192, v1
v_mul_u32_u24 v65, 6554, v64
v_lshrrev_b32 v65, 16, v65
s_add_u32 s48, s46, 2684928
buffer_load_dwordx4 v17, s[12:15], s48 offen offset:2048 lds
v_mul_u32_u24 v66, 10, v65
v_sub_u32 v64, v64, v66
v_mul_u32_u24 v65, 1280, v65
s_add_u32 s48, s46, 2716672
buffer_load_dwordx4 v18, s[12:15], s48 offen offset:3072 lds
v_lshl_add_u32 v39, v64, 4, v65
v_add_u32 v64, 256, v1
v_mul_u32_u24 v65, 6554, v64
s_add_u32 m0, s40, 65536
v_lshrrev_b32 v65, 16, v65
v_mul_u32_u24 v66, 10, v65
v_sub_u32 v64, v64, v66
s_add_u32 s48, s46, 3145728
buffer_load_dwordx4 v17, s[12:15], s48 offen offset:0 lds
v_mul_u32_u24 v65, 1280, v65
v_lshl_add_u32 v40, v64, 4, v65
s_add_u32 s48, s46, 3177472
buffer_load_dwordx4 v18, s[12:15], s48 offen offset:1024 lds
s_add_u32 s48, s46, 3209216
buffer_load_dwordx4 v17, s[12:15], s48 offen offset:2048 lds
s_add_u32 s48, s46, 3240960
buffer_load_dwordx4 v18, s[12:15], s48 offen offset:3072 lds
s_add_u32 m0, s40, 81920
s_add_u32 s48, s46, 3670016
buffer_load_dwordx4 v17, s[12:15], s48 offen offset:0 lds
s_add_u32 s48, s46, 3701760
buffer_load_dwordx4 v18, s[12:15], s48 offen offset:1024 lds
s_add_u32 s48, s46, 3733504
buffer_load_dwordx4 v17, s[12:15], s48 offen offset:2048 lds
buffer_load_dword v74, v73, s[16:19], 0 offen sc1
s_add_u32 s48, s46, 3765248
buffer_load_dwordx4 v18, s[12:15], s48 offen offset:3072 lds
s_mov_b32 s53, 0xffff0000
v_min_u32 v176, 141312, v176
v_max_u32 v176, 131072, v176
v_and_b32 v176, -8, v176
v_pk_mul_f32 v[130:131], v[130:131], v[172:173] op_sel_hi:[1,0]
v_pk_mul_f32 v[132:133], v[132:133], v[172:173] op_sel_hi:[1,0]
v_pk_mul_f32 v[134:135], v[134:135], v[172:173] op_sel_hi:[1,0]
v_pk_mul_f32 v[136:137], v[136:137], v[172:173] op_sel_hi:[1,0]
v_pk_mul_f32 v[138:139], v[138:139], v[172:173] op_sel_hi:[1,0]
v_pk_mul_f32 v[140:141], v[140:141], v[172:173] op_sel_hi:[1,0]
v_pk_mul_f32 v[142:143], v[142:143], v[172:173] op_sel_hi:[1,0]
v_pk_mul_f32 v[144:145], v[144:145], v[172:173] op_sel_hi:[1,0]
v_pk_mul_f32 v[146:147], v[146:147], v[172:173] op_sel_hi:[1,0]
v_pk_mul_f32 v[148:149], v[148:149], v[172:173] op_sel_hi:[1,0]
v_cvt_pk_bf16_f32 v160, v130, v131
v_cvt_pk_bf16_f32 v161, v132, v133
v_cvt_pk_bf16_f32 v162, v134, v135
v_cvt_pk_bf16_f32 v163, v136, v137
v_cvt_pk_bf16_f32 v164, v138, v139
v_cvt_pk_bf16_f32 v165, v140, v141
v_cvt_pk_bf16_f32 v166, v142, v143
v_cvt_pk_bf16_f32 v167, v144, v145
v_cvt_pk_bf16_f32 v168, v146, v147
v_cvt_pk_bf16_f32 v169, v148, v149
v_lshlrev_b32 v110, 16, v160
v_and_b32 v111, s53, v160
v_lshlrev_b32 v112, 16, v161
v_and_b32 v113, s53, v161
v_lshlrev_b32 v114, 16, v162
v_and_b32 v115, s53, v162
v_lshlrev_b32 v116, 16, v163
v_and_b32 v117, s53, v163
v_lshlrev_b32 v118, 16, v164
v_and_b32 v119, s53, v164
v_lshlrev_b32 v120, 16, v165
v_and_b32 v121, s53, v165
v_lshlrev_b32 v122, 16, v166
v_and_b32 v123, s53, v166
v_lshlrev_b32 v124, 16, v167
v_and_b32 v125, s53, v167
v_lshlrev_b32 v126, 16, v168
v_and_b32 v127, s53, v168
v_lshlrev_b32 v128, 16, v169
v_and_b32 v129, s53, v169
v_pk_add_f32 v[170:171], v[110:111], v[112:113]
v_pk_add_f32 v[170:171], v[170:171], v[114:115]
v_pk_add_f32 v[170:171], v[170:171], v[116:117]
v_pk_add_f32 v[170:171], v[170:171], v[118:119]
v_pk_add_f32 v[170:171], v[170:171], v[120:121]
v_pk_add_f32 v[170:171], v[170:171], v[122:123]
v_pk_add_f32 v[170:171], v[170:171], v[124:125]
v_pk_add_f32 v[170:171], v[170:171], v[126:127]
v_pk_add_f32 v[170:171], v[170:171], v[128:129]
v_add_f32 v170, v170, v171
s_nop 1
v_add_f32_dpp v170, v170, v170 row_ror:8 row_mask:0xf bank_mask:0xf
s_nop 1
v_add_f32_dpp v170, v170, v170 row_ror:4 row_mask:0xf bank_mask:0xf
s_nop 1
v_add_f32_dpp v170, v170, v170 row_ror:2 row_mask:0xf bank_mask:0xf
s_nop 1
v_add_f32_dpp v170, v170, v170 row_ror:1 row_mask:0xf bank_mask:0xf
v_mov_b32 v174, v170
s_nop 1
v_permlane16_swap_b32 v174, v170
s_nop 1
v_add_f32 v170, v170, v174
v_mul_f32 v170, 0xbacccccd, v170
v_pk_add_f32 v[130:131], v[110:111], v[170:171] op_sel_hi:[1,0]
v_pk_add_f32 v[132:133], v[112:113], v[170:171] op_sel_hi:[1,0]
v_pk_add_f32 v[134:135], v[114:115], v[170:171] op_sel_hi:[1,0]
v_pk_add_f32 v[136:137], v[116:117], v[170:171] op_sel_hi:[1,0]
v_pk_add_f32 v[138:139], v[118:119], v[170:171] op_sel_hi:[1,0]
v_pk_add_f32 v[140:141], v[120:121], v[170:171] op_sel_hi:[1,0]
v_pk_add_f32 v[142:143], v[122:123], v[170:171] op_sel_hi:[1,0]
v_pk_add_f32 v[144:145], v[124:125], v[170:171] op_sel_hi:[1,0]
v_pk_add_f32 v[146:147], v[126:127], v[170:171] op_sel_hi:[1,0]
v_pk_add_f32 v[148:149], v[128:129], v[170:171] op_sel_hi:[1,0]
v_pk_mul_f32 v[172:173], v[130:131], v[130:131]
v_pk_fma_f32 v[172:173], v[132:133], v[132:133], v[172:173]
v_pk_fma_f32 v[172:173], v[134:135], v[134:135], v[172:173]
v_pk_fma_f32 v[172:173], v[136:137], v[136:137], v[172:173]
v_pk_fma_f32 v[172:173], v[138:139], v[138:139], v[172:173]
v_pk_fma_f32 v[172:173], v[140:141], v[140:141], v[172:173]
v_pk_fma_f32 v[172:173], v[142:143], v[142:143], v[172:173]
v_pk_fma_f32 v[172:173], v[144:145], v[144:145], v[172:173]
v_pk_fma_f32 v[172:173], v[146:147], v[146:147], v[172:173]
v_pk_fma_f32 v[172:173], v[148:149], v[148:149], v[172:173]
v_add_f32 v172, v172, v173
s_nop 1
v_add_f32_dpp v172, v172, v172 row_ror:8 row_mask:0xf bank_mask:0xf
s_nop 1
v_add_f32_dpp v172, v172, v172 row_ror:4 row_mask:0xf bank_mask:0xf
s_nop 1
v_add_f32_dpp v172, v172, v172 row_ror:2 row_mask:0xf bank_mask:0xf
s_nop 1
v_add_f32_dpp v172, v172, v172 row_ror:1 row_mask:0xf bank_mask:0xf
v_mov_b32 v174, v172
s_nop 1
v_permlane16_swap_b32 v174, v172
s_nop 1
v_add_f32 v172, v172, v174
v_mul_f32 v172, 0x3acccccd, v172
v_cvt_pk_bf16_f32 v170, v170, v170
v_and_b32 v170, 0xffff0000, v170
s_waitcnt vmcnt(1)
s_cmp_lg_u32 s45, 0
s_cbranch_scc1 Ltag_5
v_cmp_eq_u32 vcc, 0, v183
s_cbranch_vccz Lspun_7
s_mov_b32 s56, 0x40000
Lspin_6:
buffer_load_dword v183, v182, s[60:63], 0 offen sc1
s_waitcnt vmcnt(0)
v_cmp_eq_u32 vcc, 0, v183
s_cbranch_vccz Lspun_7
s_sleep 1
s_sub_u32 s56, s56, 1
s_cmp_lg_u32 s56, 0
s_cbranch_scc1 Lspin_6
Lspun_7:
v_readfirstlane_b32 s88, v183
s_nop 1
Ltag_5:
v_cmp_ne_u32 vcc, s88, v74
s_cbranch_vccz Lspun_9
s_mov_b32 s56, 0x40000
Lspin_8:
buffer_load_dword v74, v73, s[16:19], 0 offen sc1
s_waitcnt vmcnt(0)
v_cmp_ne_u32 vcc, s88, v74
s_cbranch_vccz Lspun_9
s_sleep 1
s_sub_u32 s56, s56, 1
s_cmp_lg_u32 s56, 0
s_cbranch_scc1 Lspin_8
Lspun_9:
s_add_u32 s49, s47, 0
buffer_load_dwordx4 a[0:3], v23, s[16:19], s49 offen sc1
buffer_load_dwordx4 a[4:7], v23, s[16:19], s49 offen offset:1024 sc1
s_add_u32 s49, s47, 20480
buffer_load_dwordx4 a[8:11], v23, s[16:19], s49 offen sc1
buffer_load_dwordx4 a[12:15], v23, s[16:19], s49 offen offset:1024 sc1
s_add_u32 s49, s47, 40960
buffer_load_dwordx4 a[16:19], v23, s[16:19], s49 offen sc1
buffer_load_dwordx4 a[20:23], v23, s[16:19], s49 offen offset:1024 sc1
s_add_u32 s49, s47, 61440
buffer_load_dwordx4 a[24:27], v23, s[16:19], s49 offen sc1
buffer_load_dwordx4 a[28:31], v23, s[16:19], s49 offen offset:1024 sc1
v_cvt_pk_bf16_f32 v172, v172, v172
v_and_b32 v172, 0xffff0000, v172
v_add_f32 v172, 0x3727c5ac, v172
v_cvt_pk_bf16_f32 v172, v172, v172
v_and_b32 v172, 0xffff0000, v172
v_sqrt_f32 v172, v172
s_nop 0
s_add_u32 s49, s47, 2048
buffer_load_dwordx4 a[32:35], v23, s[16:19], s49 offen sc1
v_cvt_pk_bf16_f32 v172, v172, v172
v_and_b32 v172, 0xffff0000, v172
v_rcp_f32 v172, v172
v_pk_add_f32 v[130:131], v[110:111], v[170:171] op_sel_hi:[1,0]
v_pk_add_f32 v[132:133], v[112:113], v[170:171] op_sel_hi:[1,0]
v_pk_add_f32 v[134:135], v[114:115], v[170:171] op_sel_hi:[1,0]
v_pk_add_f32 v[136:137], v[116:117], v[170:171] op_sel_hi:[1,0]
v_pk_add_f32 v[138:139], v[118:119], v[170:171] op_sel_hi:[1,0]
buffer_load_dwordx4 a[36:39], v23, s[16:19], s49 offen offset:1024 sc1
v_pk_add_f32 v[140:141], v[120:121], v[170:171] op_sel_hi:[1,0]
v_pk_add_f32 v[142:143], v[122:123], v[170:171] op_sel_hi:[1,0]
v_pk_add_f32 v[144:145], v[124:125], v[170:171] op_sel_hi:[1,0]
v_pk_add_f32 v[146:147], v[126:127], v[170:171] op_sel_hi:[1,0]
v_pk_add_f32 v[148:149], v[128:129], v[170:171] op_sel_hi:[1,0]
v_cvt_pk_bf16_f32 v160, v130, v131
v_cvt_pk_bf16_f32 v161, v132, v133
v_cvt_pk_bf16_f32 v162, v134, v135
s_add_u32 s49, s47, 22528
buffer_load_dwordx4 a[40:43], v23, s[16:19], s49 offen sc1
v_cvt_pk_bf16_f32 v163, v136, v137
v_cvt_pk_bf16_f32 v164, v138, v139
v_cvt_pk_bf16_f32 v165, v140, v141
v_cvt_pk_bf16_f32 v166, v142, v143
v_cvt_pk_bf16_f32 v167, v144, v145
v_cvt_pk_bf16_f32 v168, v146, v147
v_cvt_pk_bf16_f32 v169, v148, v149
v_lshlrev_b32 v130, 16, v160
buffer_load_dwordx4 a[44:47], v23, s[16:19], s49 offen offset:1024 sc1
v_and_b32 v131, s53, v160
v_lshlrev_b32 v132, 16, v161
v_and_b32 v133, s53, v161
v_lshlrev_b32 v134, 16, v162
v_and_b32 v135, s53, v162
v_lshlrev_b32 v136, 16, v163
v_and_b32 v137, s53, v163
v_lshlrev_b32 v138, 16, v164
s_add_u32 s49, s47, 43008
buffer_load_dwordx4 a[48:51], v23, s[16:19], s49 offen sc1
v_and_b32 v139, s53, v164
v_lshlrev_b32 v140, 16, v165
v_and_b32 v141, s53, v165
v_lshlrev_b32 v142, 16, v166
K_pg0:
s_cbranch_execz K_pg3
v_and_b32 v143, s53, v166
v_lshlrev_b32 v144, 16, v167
v_and_b32 v145, s53, v167
v_lshlrev_b32 v146, 16, v168
buffer_load_dwordx4 a[52:55], v23, s[16:19], s49 offen offset:1024 sc1
v_and_b32 v147, s53, v168
v_lshlrev_b32 v148, 16, v169
v_and_b32 v149, s53, v169
v_pk_mul_f32 v[130:131], v[130:131], v[172:173] op_sel_hi:[1,0]
v_pk_mul_f32 v[132:133], v[132:133], v[172:173] op_sel_hi:[1,0]
v_pk_mul_f32 v[134:135], v[134:135], v[172:173] op_sel_hi:[1,0]
v_pk_mul_f32 v[136:137], v[136:137], v[172:173] op_sel_hi:[1,0]
v_pk_mul_f32 v[138:139], v[138:139], v[172:173] op_sel_hi:[1,0]
s_add_u32 s49, s47, 63488
buffer_load_dwordx4 a[56:59], v23, s[16:19], s49 offen sc1
v_pk_mul_f32 v[140:141], v[140:141], v[172:173] op_sel_hi:[1,0]
v_pk_mul_f32 v[142:143], v[142:143], v[172:173] op_sel_hi:[1,0]
v_pk_mul_f32 v[144:145], v[144:145], v[172:173] op_sel_hi:[1,0]
v_pk_mul_f32 v[146:147], v[146:147], v[172:173] op_sel_hi:[1,0]
v_pk_mul_f32 v[148:149], v[148:149], v[172:173] op_sel_hi:[1,0]
v_cvt_pk_bf16_f32 v160, v130, v131
v_cvt_pk_bf16_f32 v161, v132, v133
v_cvt_pk_bf16_f32 v162, v134, v135
buffer_load_dwordx4 a[60:63], v23, s[16:19], s49 offen offset:1024 sc1
v_cvt_pk_bf16_f32 v163, v136, v137
v_cvt_pk_bf16_f32 v164, v138, v139
v_cvt_pk_bf16_f32 v165, v140, v141
v_cvt_pk_bf16_f32 v166, v142, v143
v_cvt_pk_bf16_f32 v167, v144, v145
v_cvt_pk_bf16_f32 v168, v146, v147
v_cvt_pk_bf16_f32 v169, v148, v149
s_barrier
ds_read_b64_tr_b16 a[128:129], v19 offset:32768
ds_read_b64_tr_b16 a[130:131], v19 offset:36864
ds_read_b64_tr_b16 a[132:133], v19 offset:40960
ds_read_b64_tr_b16 a[134:135], v19 offset:45056
ds_read_b64_tr_b16 a[136:137], v19 offset:32776
ds_read_b64_tr_b16 a[138:139], v19 offset:36872
ds_read_b64_tr_b16 a[140:141], v19 offset:40968
ds_read_b64_tr_b16 a[142:143], v19 offset:45064
ds_write_b64 v176, v[160:161] offset:0
ds_write_b64 v176, v[162:163] offset:256
ds_write_b64 v176, v[164:165] offset:512
ds_write_b64 v176, v[166:167] offset:768
ds_write_b64 v176, v[168:169] offset:1024
s_waitcnt vmcnt(8) lgkmcnt(9)
v_mfma_f32_16x16x32_bf16 v[96:99], a[128:131], a[0:3], 0
ds_read_b64_tr_b16 a[144:145], v20 offset:32768
s_add_u32 s49, s47, 4096
buffer_load_dwordx4 a[64:67], v23, s[16:19], s49 offen sc1
v_mfma_f32_16x16x32_bf16 v[96:99], a[132:135], a[4:7], v[96:99]
ds_read_b64_tr_b16 a[146:147], v20 offset:36864
v_mfma_f32_16x16x32_bf16 v[100:103], a[132:135], a[12:15], 0
ds_read_b64_tr_b16 a[148:149], v20 offset:40960
v_mfma_f32_16x16x32_bf16 v[100:103], a[128:131], a[8:11], v[100:103]
ds_read_b64_tr_b16 a[150:151], v20 offset:45056
v_mfma_f32_16x16x32_bf16 v[104:107], a[128:131], a[16:19], 0
ds_read_b64_tr_b16 a[152:153], v20 offset:32776
v_mfma_f32_16x16x32_bf16 v[104:107], a[132:135], a[20:23], v[104:107]
ds_read_b64_tr_b16 a[154:155], v20 offset:36872
v_mfma_f32_16x16x32_bf16 v[108:111], a[132:135], a[28:31], 0
ds_read_b64_tr_b16 a[156:157], v20 offset:40968
buffer_load_dwordx4 a[68:71], v23, s[16:19], s49 offen offset:1024 sc1
v_mfma_f32_16x16x32_bf16 v[108:111], a[128:131], a[24:27], v[108:111]
ds_read_b64_tr_b16 a[158:159], v20 offset:45064
s_waitcnt lgkmcnt(13)
v_mfma_f32_16x16x32_bf16 v[124:127], a[136:139], a[24:27], 0
ds_read_b64_tr_b16 a[160:161], v21 offset:32768
v_mfma_f32_16x16x32_bf16 v[124:127], a[140:143], a[28:31], v[124:127]
ds_read_b64_tr_b16 a[162:163], v21 offset:36864
v_mfma_f32_16x16x32_bf16 v[120:123], a[140:143], a[20:23], 0
ds_read_b64_tr_b16 a[164:165], v21 offset:40960
v_mfma_f32_16x16x32_bf16 v[120:123], a[136:139], a[16:19], v[120:123]
ds_read_b64_tr_b16 a[166:167], v21 offset:45056
v_mfma_f32_16x16x32_bf16 v[116:119], a[136:139], a[8:11], 0
ds_read_b64_tr_b16 a[168:169], v21 offset:32776
s_add_u32 s49, s47, 24576
buffer_load_dwordx4 a[72:75], v23, s[16:19], s49 offen sc1
v_mfma_f32_16x16x32_bf16 v[116:119], a[140:143], a[12:15], v[116:119]
ds_read_b64_tr_b16 a[170:171], v21 offset:36872
v_mfma_f32_16x16x32_bf16 v[112:115], a[140:143], a[4:7], 0
ds_read_b64_tr_b16 a[172:173], v21 offset:40968
v_mfma_f32_16x16x32_bf16 v[112:115], a[136:139], a[0:3], v[112:115]
ds_read_b64_tr_b16 a[174:175], v21 offset:45064
s_waitcnt lgkmcnt(8)
v_mfma_f32_16x16x32_bf16 v[128:131], a[144:147], a[0:3], 0
ds_read_b64_tr_b16 a[176:177], v22 offset:32768
v_mfma_f32_16x16x32_bf16 v[128:131], a[148:151], a[4:7], v[128:131]
ds_read_b64_tr_b16 a[178:179], v22 offset:36864
v_mfma_f32_16x16x32_bf16 v[132:135], a[148:151], a[12:15], 0
ds_read_b64_tr_b16 a[180:181], v22 offset:40960
buffer_load_dwordx4 a[76:79], v23, s[16:19], s49 offen offset:1024 sc1
v_mfma_f32_16x16x32_bf16 v[132:135], a[144:147], a[8:11], v[132:135]
ds_read_b64_tr_b16 a[182:183], v22 offset:45056
v_mfma_f32_16x16x32_bf16 v[136:139], a[144:147], a[16:19], 0
ds_read_b64_tr_b16 a[184:185], v22 offset:32776
v_mfma_f32_16x16x32_bf16 v[136:139], a[148:151], a[20:23], v[136:139]
ds_read_b64_tr_b16 a[186:187], v22 offset:36872
v_mfma_f32_16x16x32_bf16 v[140:143], a[148:151], a[28:31], 0
ds_read_b64_tr_b16 a[188:189], v22 offset:40968
v_mfma_f32_16x16x32_bf16 v[140:143], a[144:147], a[24:27], v[140:143]
ds_read_b64_tr_b16 a[190:191], v22 offset:45064
v_mfma_f32_16x16x32_bf16 v[156:159], a[152:155], a[24:27], 0
ds_read_b64_tr_b16 a[192:193], v19 offset:49152
s_add_u32 s49, s47, 45056
buffer_load_dwordx4 a[80:83], v23, s[16:19], s49 offen sc1
v_mfma_f32_16x16x32_bf16 v[156:159], a[156:159], a[28:31], v[156:159]
ds_read_b64_tr_b16 a[194:195], v19 offset:53248
v_mfma_f32_16x16x32_bf16 v[152:155], a[156:159], a[20:23], 0
ds_read_b64_tr_b16 a[196:197], v19 offset:57344
v_mfma_f32_16x16x32_bf16 v[152:155], a[152:155], a[16:19], v[152:155]
ds_read_b64_tr_b16 a[198:199], v19 offset:61440
v_mfma_f32_16x16x32_bf16 v[148:151], a[152:155], a[8:11], 0
ds_read_b64_tr_b16 a[200:201], v19 offset:49160
v_mfma_f32_16x16x32_bf16 v[148:151], a[156:159], a[12:15], v[148:151]
ds_read_b64_tr_b16 a[202:203], v19 offset:53256
v_mfma_f32_16x16x32_bf16 v[144:147], a[156:159], a[4:7], 0
ds_read_b64_tr_b16 a[204:205], v19 offset:57352
v_mfma_f32_16x16x32_bf16 v[144:147], a[152:155], a[0:3], v[144:147]
ds_read_b64_tr_b16 a[206:207], v19 offset:61448
buffer_load_dwordx4 a[84:87], v23, s[16:19], s49 offen offset:1024 sc1
s_waitcnt lgkmcnt(8)
v_mfma_f32_16x16x32_bf16 v[160:163], a[160:163], a[0:3], 0
ds_read_b64_tr_b16 a[208:209], v20 offset:49152
v_mfma_f32_16x16x32_bf16 v[160:163], a[164:167], a[4:7], v[160:163]
ds_read_b64_tr_b16 a[210:211], v20 offset:53248
v_mfma_f32_16x16x32_bf16 v[164:167], a[164:167], a[12:15], 0
ds_read_b64_tr_b16 a[212:213], v20 offset:57344
v_mfma_f32_16x16x32_bf16 v[164:167], a[160:163], a[8:11], v[164:167]
ds_read_b64_tr_b16 a[214:215], v20 offset:61440
v_mfma_f32_16x16x32_bf16 v[168:171], a[160:163], a[16:19], 0
ds_read_b64_tr_b16 a[216:217], v20 offset:49160
v_mfma_f32_16x16x32_bf16 v[168:171], a[164:167], a[20:23], v[168:171]
ds_read_b64_tr_b16 a[218:219], v20 offset:53256
s_add_u32 s49, s47, 65536
buffer_load_dwordx4 a[88:91], v23, s[16:19], s49 offen sc1
v_mfma_f32_16x16x32_bf16 v[172:175], a[164:167], a[28:31], 0
ds_read_b64_tr_b16 a[220:221], v20 offset:57352
v_mfma_f32_16x16x32_bf16 v[172:175], a[160:163], a[24:27], v[172:175]
ds_read_b64_tr_b16 a[222:223], v20 offset:61448
v_mfma_f32_16x16x32_bf16 v[188:191], a[168:171], a[24:27], 0
ds_read_b64_tr_b16 a[224:225], v21 offset:49152
v_mfma_f32_16x16x32_bf16 v[188:191], a[172:175], a[28:31], v[188:191]
ds_read_b64_tr_b16 a[226:227], v21 offset:53248
v_mfma_f32_16x16x32_bf16 v[184:187], a[172:175], a[20:23], 0
ds_read_b64_tr_b16 a[228:229], v21 offset:57344
v_mfma_f32_16x16x32_bf16 v[184:187], a[168:171], a[16:19], v[184:187]
ds_read_b64_tr_b16 a[230:231], v21 offset:61440
buffer_load_dwordx4 a[92:95], v23, s[16:19], s49 offen offset:1024 sc1
v_mfma_f32_16x16x32_bf16 v[180:183], a[168:171], a[8:11], 0
ds_read_b64_tr_b16 a[232:233], v21 offset:49160
v_mfma_f32_16x16x32_bf16 v[180:183], a[172:175], a[12:15], v[180:183]
ds_read_b64_tr_b16 a[234:235], v21 offset:53256
v_mfma_f32_16x16x32_bf16 v[176:179], a[172:175], a[4:7], 0
ds_read_b64_tr_b16 a[236:237], v21 offset:57352
v_mfma_f32_16x16x32_bf16 v[176:179], a[168:171], a[0:3], v[176:179]
ds_read_b64_tr_b16 a[238:239], v21 offset:61448
v_mfma_f32_16x16x32_bf16 v[192:195], a[176:179], a[0:3], 0
ds_read_b64_tr_b16 a[240:241], v22 offset:49152
v_mfma_f32_16x16x32_bf16 v[192:195], a[180:183], a[4:7], v[192:195]
ds_read_b64_tr_b16 a[242:243], v22 offset:53248
s_add_u32 s49, s47, 6144
buffer_load_dwordx4 a[96:99], v23, s[16:19], s49 offen sc1
v_mfma_f32_16x16x32_bf16 v[196:199], a[180:183], a[12:15], 0
ds_read_b64_tr_b16 a[244:245], v22 offset:57344
v_mfma_f32_16x16x32_bf16 v[196:199], a[176:179], a[8:11], v[196:199]
ds_read_b64_tr_b16 a[246:247], v22 offset:61440
v_mfma_f32_16x16x32_bf16 v[200:203], a[176:179], a[16:19], 0
ds_read_b64_tr_b16 a[248:249], v22 offset:49160
v_mfma_f32_16x16x32_bf16 v[200:203], a[180:183], a[20:23], v[200:203]
ds_read_b64_tr_b16 a[250:251], v22 offset:53256
v_mfma_f32_16x16x32_bf16 v[204:207], a[180:183], a[28:31], 0
ds_read_b64_tr_b16 a[252:253], v22 offset:57352
v_mfma_f32_16x16x32_bf16 v[204:207], a[176:179], a[24:27], v[204:207]
ds_read_b64_tr_b16 a[254:255], v22 offset:61448
buffer_load_dwordx4 a[100:103], v23, s[16:19], s49 offen offset:1024 sc1
v_mfma_f32_16x16x32_bf16 v[220:223], a[184:187], a[24:27], 0
v_mfma_f32_16x16x32_bf16 v[220:223], a[188:191], a[28:31], v[220:223]
v_mfma_f32_16x16x32_bf16 v[216:219], a[188:191], a[20:23], 0
v_mfma_f32_16x16x32_bf16 v[216:219], a[184:187], a[16:19], v[216:219]
v_mfma_f32_16x16x32_bf16 v[212:215], a[184:187], a[8:11], 0
v_mfma_f32_16x16x32_bf16 v[212:215], a[188:191], a[12:15], v[212:215]
v_mfma_f32_16x16x32_bf16 v[208:211], a[188:191], a[4:7], 0
v_mfma_f32_16x16x32_bf16 v[208:211], a[184:187], a[0:3], v[208:211]
s_waitcnt vmcnt(10) lgkmcnt(0)
s_barrier
v_mfma_f32_16x16x32_bf16 v[96:99], a[192:195], a[32:35], v[96:99]
ds_read_b64_tr_b16 a[128:129], v32 offset:0
v_mfma_f32_16x16x32_bf16 v[96:99], a[196:199], a[36:39], v[96:99]
ds_read_b64_tr_b16 a[130:131], v32 offset:4096
v_mfma_f32_16x16x32_bf16 v[100:103], a[196:199], a[44:47], v[100:103]
s_add_u32 m0, s40, 98304
v_mfma_f32_16x16x32_bf16 v[100:103], a[192:195], a[40:43], v[100:103]
ds_read_b64_tr_b16 a[132:133], v32 offset:8192
v_mfma_f32_16x16x32_bf16 v[104:107], a[192:195], a[48:51], v[104:107]
s_add_u32 s48, s46, 4194304
buffer_load_dwordx4 v17, s[12:15], s48 offen offset:0 lds
v_mfma_f32_16x16x32_bf16 v[104:107], a[196:199], a[52:55], v[104:107]
ds_read_b64_tr_b16 a[134:135], v32 offset:12288
v_mfma_f32_16x16x32_bf16 v[108:111], a[196:199], a[60:63], v[108:111]
s_add_u32 s48, s46, 4226048
buffer_load_dwordx4 v18, s[12:15], s48 offen offset:1024 lds
v_mfma_f32_16x16x32_bf16 v[108:111], a[192:195], a[56:59], v[108:111]
ds_read_b64_tr_b16 a[136:137], v32 offset:8
v_mfma_f32_16x16x32_bf16 v[124:127], a[200:203], a[56:59], v[124:127]
ds_read_b64_tr_b16 a[138:139], v32 offset:4104
v_mfma_f32_16x16x32_bf16 v[124:127], a[204:207], a[60:63], v[124:127]
v_mfma_f32_16x16x32_bf16 v[120:123], a[204:207], a[52:55], v[120:123]
ds_read_b64_tr_b16 a[140:141], v32 offset:8200
v_mfma_f32_16x16x32_bf16 v[120:123], a[200:203], a[48:51], v[120:123]
s_add_u32 s48, s46, 4257792
buffer_load_dwordx4 v17, s[12:15], s48 offen offset:2048 lds
v_mfma_f32_16x16x32_bf16 v[116:119], a[200:203], a[40:43], v[116:119]
ds_read_b64_tr_b16 a[142:143], v32 offset:12296
v_mfma_f32_16x16x32_bf16 v[116:119], a[204:207], a[44:47], v[116:119]
s_add_u32 s48, s46, 4289536
buffer_load_dwordx4 v18, s[12:15], s48 offen offset:3072 lds
v_mfma_f32_16x16x32_bf16 v[112:115], a[204:207], a[36:39], v[112:115]
ds_read_b64_tr_b16 a[144:145], v33 offset:0
v_mfma_f32_16x16x32_bf16 v[112:115], a[200:203], a[32:35], v[112:115]
ds_read_b64_tr_b16 a[146:147], v33 offset:4096
v_mfma_f32_16x16x32_bf16 v[128:131], a[208:211], a[32:35], v[128:131]
v_mfma_f32_16x16x32_bf16 v[128:131], a[212:215], a[36:39], v[128:131]
ds_read_b64_tr_b16 a[148:149], v33 offset:8192
v_mfma_f32_16x16x32_bf16 v[132:135], a[212:215], a[44:47], v[132:135]
s_add_u32 s49, s47, 26624
buffer_load_dwordx4 a[104:107], v23, s[16:19], s49 offen sc1
v_mfma_f32_16x16x32_bf16 v[132:135], a[208:211], a[40:43], v[132:135]
ds_read_b64_tr_b16 a[150:151], v33 offset:12288
v_mfma_f32_16x16x32_bf16 v[136:139], a[208:211], a[48:51], v[136:139]
buffer_load_dwordx4 a[108:111], v23, s[16:19], s49 offen offset:1024 sc1
v_mfma_f32_16x16x32_bf16 v[136:139], a[212:215], a[52:55], v[136:139]
ds_read_b64_tr_b16 a[152:153], v33 offset:8
v_mfma_f32_16x16x32_bf16 v[140:143], a[212:215], a[60:63], v[140:143]
ds_read_b64_tr_b16 a[154:155], v33 offset:4104
v_mfma_f32_16x16x32_bf16 v[140:143], a[208:211], a[56:59], v[140:143]
v_mfma_f32_16x16x32_bf16 v[156:159], a[216:219], a[56:59], v[156:159]
ds_read_b64_tr_b16 a[156:157], v33 offset:8200
v_mfma_f32_16x16x32_bf16 v[156:159], a[220:223], a[60:63], v[156:159]
s_add_u32 s49, s47, 47104
buffer_load_dwordx4 a[112:115], v23, s[16:19], s49 offen sc1
v_mfma_f32_16x16x32_bf16 v[152:155], a[220:223], a[52:55], v[152:155]
ds_read_b64_tr_b16 a[158:159], v33 offset:12296
v_mfma_f32_16x16x32_bf16 v[152:155], a[216:219], a[48:51], v[152:155]
buffer_load_dwordx4 a[116:119], v23, s[16:19], s49 offen offset:1024 sc1
v_mfma_f32_16x16x32_bf16 v[148:151], a[216:219], a[40:43], v[148:151]
ds_read_b64_tr_b16 a[160:161], v34 offset:0
v_mfma_f32_16x16x32_bf16 v[148:151], a[220:223], a[44:47], v[148:151]
ds_read_b64_tr_b16 a[162:163], v34 offset:4096
v_mfma_f32_16x16x32_bf16 v[144:147], a[220:223], a[36:39], v[144:147]
s_add_u32 s49, s47, 67584
buffer_load_dwordx4 a[120:123], v23, s[16:19], s49 offen sc1
v_mfma_f32_16x16x32_bf16 v[144:147], a[216:219], a[32:35], v[144:147]
ds_read_b64_tr_b16 a[164:165], v34 offset:8192
v_mfma_f32_16x16x32_bf16 v[160:163], a[224:227], a[32:35], v[160:163]
v_mfma_f32_16x16x32_bf16 v[160:163], a[228:231], a[36:39], v[160:163]
ds_read_b64_tr_b16 a[166:167], v34 offset:12288
v_mfma_f32_16x16x32_bf16 v[164:167], a[228:231], a[44:47], v[164:167]
buffer_load_dwordx4 a[124:127], v23, s[16:19], s49 offen offset:1024 sc1
v_mfma_f32_16x16x32_bf16 v[164:167], a[224:227], a[40:43], v[164:167]
ds_read_b64_tr_b16 a[168:169], v34 offset:8
v_mfma_f32_16x16x32_bf16 v[168:171], a[224:227], a[48:51], v[168:171]
ds_read_b64_tr_b16 a[170:171], v34 offset:4104
v_mfma_f32_16x16x32_bf16 v[168:171], a[228:231], a[52:55], v[168:171]
s_add_u32 s49, s47, 8192
buffer_load_dwordx4 a[0:3], v23, s[16:19], s49 offen sc1
v_mfma_f32_16x16x32_bf16 v[172:175], a[228:231], a[60:63], v[172:175]
ds_read_b64_tr_b16 a[172:173], v34 offset:8200
v_mfma_f32_16x16x32_bf16 v[172:175], a[224:227], a[56:59], v[172:175]
v_mfma_f32_16x16x32_bf16 v[188:191], a[232:235], a[56:59], v[188:191]
ds_read_b64_tr_b16 a[174:175], v34 offset:12296
v_mfma_f32_16x16x32_bf16 v[188:191], a[236:239], a[60:63], v[188:191]
buffer_load_dwordx4 a[4:7], v23, s[16:19], s49 offen offset:1024 sc1
v_mfma_f32_16x16x32_bf16 v[184:187], a[236:239], a[52:55], v[184:187]
ds_read_b64_tr_b16 a[176:177], v35 offset:0
v_mfma_f32_16x16x32_bf16 v[184:187], a[232:235], a[48:51], v[184:187]
ds_read_b64_tr_b16 a[178:179], v35 offset:4096
v_mfma_f32_16x16x32_bf16 v[180:183], a[232:235], a[40:43], v[180:183]
s_add_u32 s49, s47, 28672
buffer_load_dwordx4 a[8:11], v23, s[16:19], s49 offen sc1
v_mfma_f32_16x16x32_bf16 v[180:183], a[236:239], a[44:47], v[180:183]
ds_read_b64_tr_b16 a[180:181], v35 offset:8192
v_mfma_f32_16x16x32_bf16 v[176:179], a[236:239], a[36:39], v[176:179]
v_mfma_f32_16x16x32_bf16 v[176:179], a[232:235], a[32:35], v[176:179]
ds_read_b64_tr_b16 a[182:183], v35 offset:12288
v_mfma_f32_16x16x32_bf16 v[192:195], a[240:243], a[32:35], v[192:195]
buffer_load_dwordx4 a[12:15], v23, s[16:19], s49 offen offset:1024 sc1
v_mfma_f32_16x16x32_bf16 v[192:195], a[244:247], a[36:39], v[192:195]
ds_read_b64_tr_b16 a[184:185], v35 offset:8
v_mfma_f32_16x16x32_bf16 v[196:199], a[244:247], a[44:47], v[196:199]
ds_read_b64_tr_b16 a[186:187], v35 offset:4104
v_mfma_f32_16x16x32_bf16 v[196:199], a[240:243], a[40:43], v[196:199]
ds_read_b64_tr_b16 v[76:77], v89 offset:0
v_mfma_f32_16x16x32_bf16 v[200:203], a[240:243], a[48:51], v[200:203]
ds_read_b64_tr_b16 a[188:189], v35 offset:8200
v_mfma_f32_16x16x32_bf16 v[200:203], a[244:247], a[52:55], v[200:203]
ds_read_b64_tr_b16 v[78:79], v89 offset:5120
v_mfma_f32_16x16x32_bf16 v[204:207], a[244:247], a[60:63], v[204:207]
ds_read_b64_tr_b16 a[190:191], v35 offset:12296
v_mfma_f32_16x16x32_bf16 v[204:207], a[240:243], a[56:59], v[204:207]
v_mfma_f32_16x16x32_bf16 v[220:223], a[248:251], a[56:59], v[220:223]
ds_read_b64_tr_b16 v[80:81], v89 offset:512
v_mfma_f32_16x16x32_bf16 v[220:223], a[252:255], a[60:63], v[220:223]
ds_read_b64_tr_b16 v[82:83], v89 offset:5632
v_mfma_f32_16x16x32_bf16 v[216:219], a[252:255], a[52:55], v[216:219]
v_mfma_f32_16x16x32_bf16 v[216:219], a[248:251], a[48:51], v[216:219]
ds_read_b64_tr_b16 v[84:85], v89 offset:1024
v_mfma_f32_16x16x32_bf16 v[212:215], a[248:251], a[40:43], v[212:215]
ds_read_b64_tr_b16 v[86:87], v89 offset:6144
v_mfma_f32_16x16x32_bf16 v[212:215], a[252:255], a[44:47], v[212:215]
v_mfma_f32_16x16x32_bf16 v[208:211], a[252:255], a[36:39], v[208:211]
v_mfma_f32_16x16x32_bf16 v[208:211], a[248:251], a[32:35], v[208:211]
s_waitcnt vmcnt(16) lgkmcnt(0)
v_mfma_f32_16x16x32_bf16 v[96:99], a[128:131], a[64:67], v[96:99]
ds_read_b64_tr_b16 a[192:193], v32 offset:16384
v_mfma_f32_16x16x32_bf16 v[96:99], a[132:135], a[68:71], v[96:99]
ds_read_b64_tr_b16 a[194:195], v32 offset:20480
v_mfma_f32_16x16x32_bf16 v[100:103], a[132:135], a[76:79], v[100:103]
s_add_u32 m0, s40, 114688
v_mfma_f32_16x16x32_bf16 v[100:103], a[128:131], a[72:75], v[100:103]
ds_read_b64_tr_b16 a[196:197], v32 offset:24576
v_mfma_f32_16x16x32_bf16 v[104:107], a[128:131], a[80:83], v[104:107]
s_add_u32 s48, s46, 4718592
buffer_load_dwordx4 v17, s[12:15], s48 offen offset:0 lds
v_mfma_f32_16x16x32_bf16 v[104:107], a[132:135], a[84:87], v[104:107]
ds_read_b64_tr_b16 a[198:199], v32 offset:28672
v_mfma_f32_16x16x32_bf16 v[108:111], a[132:135], a[92:95], v[108:111]
v_mfma_f32_16x16x32_bf16 v[108:111], a[128:131], a[88:91], v[108:111]
ds_read_b64_tr_b16 a[200:201], v32 offset:16392
v_mfma_f32_16x16x32_bf16 v[124:127], a[136:139], a[88:91], v[124:127]
ds_read_b64_tr_b16 a[202:203], v32 offset:20488
v_mfma_f32_16x16x32_bf16 v[124:127], a[140:143], a[92:95], v[124:127]
s_add_u32 s48, s46, 4750336
buffer_load_dwordx4 v18, s[12:15], s48 offen offset:1024 lds
v_mfma_f32_16x16x32_bf16 v[120:123], a[140:143], a[84:87], v[120:123]
ds_read_b64_tr_b16 a[204:205], v32 offset:24584
v_mfma_f32_16x16x32_bf16 v[120:123], a[136:139], a[80:83], v[120:123]
v_mfma_f32_16x16x32_bf16 v[116:119], a[136:139], a[72:75], v[116:119]
ds_read_b64_tr_b16 a[206:207], v32 offset:28680
v_mfma_f32_16x16x32_bf16 v[116:119], a[140:143], a[76:79], v[116:119]
s_add_u32 s48, s46, 4782080
buffer_load_dwordx4 v17, s[12:15], s48 offen offset:2048 lds
v_mfma_f32_16x16x32_bf16 v[112:115], a[140:143], a[68:71], v[112:115]
ds_read_b64_tr_b16 a[208:209], v33 offset:16384
v_mfma_f32_16x16x32_bf16 v[112:115], a[136:139], a[64:67], v[112:115]
ds_read_b64_tr_b16 a[210:211], v33 offset:20480
v_mfma_f32_16x16x32_bf16 v[128:131], a[144:147], a[64:67], v[128:131]
v_mfma_f32_16x16x32_bf16 v[128:131], a[148:151], a[68:71], v[128:131]
ds_read_b64_tr_b16 a[212:213], v33 offset:24576
v_mfma_f32_16x16x32_bf16 v[132:135], a[148:151], a[76:79], v[132:135]
s_add_u32 s48, s46, 4813824
buffer_load_dwordx4 v18, s[12:15], s48 offen offset:3072 lds
v_mfma_f32_16x16x32_bf16 v[132:135], a[144:147], a[72:75], v[132:135]
ds_read_b64_tr_b16 a[214:215], v33 offset:28672
v_mfma_f32_16x16x32_bf16 v[136:139], a[144:147], a[80:83], v[136:139]
v_mfma_f32_16x16x32_bf16 v[136:139], a[148:151], a[84:87], v[136:139]
ds_read_b64_tr_b16 a[216:217], v33 offset:16392
v_mfma_f32_16x16x32_bf16 v[140:143], a[148:151], a[92:95], v[140:143]
ds_read_b64_tr_b16 a[218:219], v33 offset:20488
v_mfma_f32_16x16x32_bf16 v[140:143], a[144:147], a[88:91], v[140:143]
s_add_u32 s49, s47, 49152
buffer_load_dwordx4 a[16:19], v23, s[16:19], s49 offen sc1
v_mfma_f32_16x16x32_bf16 v[156:159], a[152:155], a[88:91], v[156:159]
ds_read_b64_tr_b16 a[220:221], v33 offset:24584
v_mfma_f32_16x16x32_bf16 v[156:159], a[156:159], a[92:95], v[156:159]
v_mfma_f32_16x16x32_bf16 v[152:155], a[156:159], a[84:87], v[152:155]
ds_read_b64_tr_b16 a[222:223], v33 offset:28680
v_mfma_f32_16x16x32_bf16 v[152:155], a[152:155], a[80:83], v[152:155]
buffer_load_dwordx4 a[20:23], v23, s[16:19], s49 offen offset:1024 sc1
v_mfma_f32_16x16x32_bf16 v[148:151], a[152:155], a[72:75], v[148:151]
ds_read_b64_tr_b16 a[224:225], v34 offset:16384
v_mfma_f32_16x16x32_bf16 v[148:151], a[156:159], a[76:79], v[148:151]
ds_read_b64_tr_b16 a[226:227], v34 offset:20480
v_mfma_f32_16x16x32_bf16 v[144:147], a[156:159], a[68:71], v[144:147]
v_mfma_f32_16x16x32_bf16 v[144:147], a[152:155], a[64:67], v[144:147]
ds_read_b64_tr_b16 a[228:229], v34 offset:24576
v_mfma_f32_16x16x32_bf16 v[160:163], a[160:163], a[64:67], v[160:163]
s_add_u32 s49, s47, 69632
buffer_load_dwordx4 a[24:27], v23, s[16:19], s49 offen sc1
v_mfma_f32_16x16x32_bf16 v[160:163], a[164:167], a[68:71], v[160:163]
ds_read_b64_tr_b16 a[230:231], v34 offset:28672
v_mfma_f32_16x16x32_bf16 v[164:167], a[164:167], a[76:79], v[164:167]
v_mfma_f32_16x16x32_bf16 v[164:167], a[160:163], a[72:75], v[164:167]
ds_read_b64_tr_b16 a[232:233], v34 offset:16392
v_mfma_f32_16x16x32_bf16 v[168:171], a[160:163], a[80:83], v[168:171]
ds_read_b64_tr_b16 a[234:235], v34 offset:20488
v_mfma_f32_16x16x32_bf16 v[168:171], a[164:167], a[84:87], v[168:171]
buffer_load_dwordx4 a[28:31], v23, s[16:19], s49 offen offset:1024 sc1
v_mfma_f32_16x16x32_bf16 v[172:175], a[164:167], a[92:95], v[172:175]
ds_read_b64_tr_b16 a[236:237], v34 offset:24584
v_mfma_f32_16x16x32_bf16 v[172:175], a[160:163], a[88:91], v[172:175]
s_add_u32 s49, s47, 10240
buffer_load_dwordx4 a[32:35], v23, s[16:19], s49 offen sc1
v_mfma_f32_16x16x32_bf16 v[188:191], a[168:171], a[88:91], v[188:191]
ds_read_b64_tr_b16 a[238:239], v34 offset:28680
v_mfma_f32_16x16x32_bf16 v[188:191], a[172:175], a[92:95], v[188:191]
v_mfma_f32_16x16x32_bf16 v[184:187], a[172:175], a[84:87], v[184:187]
ds_read_b64_tr_b16 a[240:241], v35 offset:16384
v_mfma_f32_16x16x32_bf16 v[184:187], a[168:171], a[80:83], v[184:187]
ds_read_b64_tr_b16 a[242:243], v35 offset:20480
v_mfma_f32_16x16x32_bf16 v[180:183], a[168:171], a[72:75], v[180:183]
buffer_load_dwordx4 a[36:39], v23, s[16:19], s49 offen offset:1024 sc1
v_mfma_f32_16x16x32_bf16 v[180:183], a[172:175], a[76:79], v[180:183]
ds_read_b64_tr_b16 a[244:245], v35 offset:24576
v_mfma_f32_16x16x32_bf16 v[176:179], a[172:175], a[68:71], v[176:179]
v_mfma_f32_16x16x32_bf16 v[176:179], a[168:171], a[64:67], v[176:179]
ds_read_b64_tr_b16 a[246:247], v35 offset:28672
v_mfma_f32_16x16x32_bf16 v[192:195], a[176:179], a[64:67], v[192:195]
s_add_u32 s49, s47, 30720
buffer_load_dwordx4 a[40:43], v23, s[16:19], s49 offen sc1
v_mfma_f32_16x16x32_bf16 v[192:195], a[180:183], a[68:71], v[192:195]
ds_read_b64_tr_b16 a[248:249], v35 offset:16392
v_mfma_f32_16x16x32_bf16 v[196:199], a[180:183], a[76:79], v[196:199]
ds_read_b64_tr_b16 a[250:251], v35 offset:20488
v_mfma_f32_16x16x32_bf16 v[196:199], a[176:179], a[72:75], v[196:199]
v_mfma_f32_16x16x32_bf16 v[200:203], a[176:179], a[80:83], v[200:203]
ds_read_b64_tr_b16 a[252:253], v35 offset:24584
v_mfma_f32_16x16x32_bf16 v[200:203], a[180:183], a[84:87], v[200:203]
buffer_load_dwordx4 a[44:47], v23, s[16:19], s49 offen offset:1024 sc1
v_mfma_f32_16x16x32_bf16 v[204:207], a[180:183], a[92:95], v[204:207]
ds_read_b64_tr_b16 a[254:255], v35 offset:28680
v_mfma_f32_16x16x32_bf16 v[204:207], a[176:179], a[88:91], v[204:207]
v_mfma_f32_16x16x32_bf16 v[220:223], a[184:187], a[88:91], v[220:223]
s_add_u32 s49, s47, 51200
buffer_load_dwordx4 a[48:51], v23, s[16:19], s49 offen sc1
v_mfma_f32_16x16x32_bf16 v[220:223], a[188:191], a[92:95], v[220:223]
v_mfma_f32_16x16x32_bf16 v[216:219], a[188:191], a[84:87], v[216:219]
buffer_load_dwordx4 a[52:55], v23, s[16:19], s49 offen offset:1024 sc1
v_mfma_f32_16x16x32_bf16 v[216:219], a[184:187], a[80:83], v[216:219]
v_mfma_f32_16x16x32_bf16 v[212:215], a[184:187], a[72:75], v[212:215]
buffer_store_dwordx4 v[76:79], v88, s[16:19], s50 offen sc1
v_mfma_f32_16x16x32_bf16 v[212:215], a[188:191], a[76:79], v[212:215]
v_mfma_f32_16x16x32_bf16 v[208:211], a[188:191], a[68:71], v[208:211]
v_mfma_f32_16x16x32_bf16 v[208:211], a[184:187], a[64:67], v[208:211]
s_waitcnt vmcnt(19) lgkmcnt(0)
v_mfma_f32_16x16x32_bf16 v[96:99], a[192:195], a[96:99], v[96:99]
ds_read_b64_tr_b16 a[128:129], v32 offset:32768
v_mfma_f32_16x16x32_bf16 v[96:99], a[196:199], a[100:103], v[96:99]
ds_read_b64_tr_b16 a[130:131], v32 offset:36864
v_mfma_f32_16x16x32_bf16 v[100:103], a[196:199], a[108:111], v[100:103]
s_add_u32 s49, s47, 71680
buffer_load_dwordx4 a[56:59], v23, s[16:19], s49 offen sc1
v_mfma_f32_16x16x32_bf16 v[100:103], a[192:195], a[104:107], v[100:103]
ds_read_b64_tr_b16 a[132:133], v32 offset:40960
v_mfma_f32_16x16x32_bf16 v[104:107], a[192:195], a[112:115], v[104:107]
v_mfma_f32_16x16x32_bf16 v[104:107], a[196:199], a[116:119], v[104:107]
ds_read_b64_tr_b16 a[134:135], v32 offset:45056
v_mfma_f32_16x16x32_bf16 v[108:111], a[196:199], a[124:127], v[108:111]
buffer_load_dwordx4 a[60:63], v23, s[16:19], s49 offen offset:1024 sc1
v_mfma_f32_16x16x32_bf16 v[108:111], a[192:195], a[120:123], v[108:111]
ds_read_b64_tr_b16 a[136:137], v32 offset:32776
v_mfma_f32_16x16x32_bf16 v[124:127], a[200:203], a[120:123], v[124:127]
ds_read_b64_tr_b16 a[138:139], v32 offset:36872
v_mfma_f32_16x16x32_bf16 v[124:127], a[204:207], a[124:127], v[124:127]
v_mfma_f32_16x16x32_bf16 v[120:123], a[204:207], a[116:119], v[120:123]
ds_read_b64_tr_b16 a[140:141], v32 offset:40968
v_mfma_f32_16x16x32_bf16 v[120:123], a[200:203], a[112:115], v[120:123]
v_mfma_f32_16x16x32_bf16 v[116:119], a[200:203], a[104:107], v[116:119]
ds_read_b64_tr_b16 a[142:143], v32 offset:45064
v_mfma_f32_16x16x32_bf16 v[116:119], a[204:207], a[108:111], v[116:119]
s_add_u32 s49, s47, 12288
buffer_load_dwordx4 a[64:67], v23, s[16:19], s49 offen sc1
v_mfma_f32_16x16x32_bf16 v[112:115], a[204:207], a[100:103], v[112:115]
ds_read_b64_tr_b16 a[144:145], v33 offset:32768
v_mfma_f32_16x16x32_bf16 v[112:115], a[200:203], a[96:99], v[112:115]
ds_read_b64_tr_b16 a[146:147], v33 offset:36864
v_mfma_f32_16x16x32_bf16 v[128:131], a[208:211], a[96:99], v[128:131]
v_mfma_f32_16x16x32_bf16 v[128:131], a[212:215], a[100:103], v[128:131]
ds_read_b64_tr_b16 a[148:149], v33 offset:40960
v_mfma_f32_16x16x32_bf16 v[132:135], a[212:215], a[108:111], v[132:135]
buffer_load_dwordx4 a[68:71], v23, s[16:19], s49 offen offset:1024 sc1
v_mfma_f32_16x16x32_bf16 v[132:135], a[208:211], a[104:107], v[132:135]
ds_read_b64_tr_b16 a[150:151], v33 offset:45056
v_mfma_f32_16x16x32_bf16 v[136:139], a[208:211], a[112:115], v[136:139]
v_mfma_f32_16x16x32_bf16 v[136:139], a[212:215], a[116:119], v[136:139]
ds_read_b64_tr_b16 a[152:153], v33 offset:32776
v_mfma_f32_16x16x32_bf16 v[140:143], a[212:215], a[124:127], v[140:143]
ds_read_b64_tr_b16 a[154:155], v33 offset:36872
v_mfma_f32_16x16x32_bf16 v[140:143], a[208:211], a[120:123], v[140:143]
v_mfma_f32_16x16x32_bf16 v[156:159], a[216:219], a[120:123], v[156:159]
ds_read_b64_tr_b16 a[156:157], v33 offset:40968
v_mfma_f32_16x16x32_bf16 v[156:159], a[220:223], a[124:127], v[156:159]
s_add_u32 s49, s47, 32768
buffer_load_dwordx4 a[72:75], v23, s[16:19], s49 offen sc1
v_mfma_f32_16x16x32_bf16 v[152:155], a[220:223], a[116:119], v[152:155]
ds_read_b64_tr_b16 a[158:159], v33 offset:45064
v_mfma_f32_16x16x32_bf16 v[152:155], a[216:219], a[112:115], v[152:155]
v_mfma_f32_16x16x32_bf16 v[148:151], a[216:219], a[104:107], v[148:151]
ds_read_b64_tr_b16 a[160:161], v34 offset:32768
v_mfma_f32_16x16x32_bf16 v[148:151], a[220:223], a[108:111], v[148:151]
ds_read_b64_tr_b16 a[162:163], v34 offset:36864
v_mfma_f32_16x16x32_bf16 v[144:147], a[220:223], a[100:103], v[144:147]
buffer_load_dwordx4 a[76:79], v23, s[16:19], s49 offen offset:1024 sc1
v_mfma_f32_16x16x32_bf16 v[144:147], a[216:219], a[96:99], v[144:147]
ds_read_b64_tr_b16 a[164:165], v34 offset:40960
v_mfma_f32_16x16x32_bf16 v[160:163], a[224:227], a[96:99], v[160:163]
v_mfma_f32_16x16x32_bf16 v[160:163], a[228:231], a[100:103], v[160:163]
ds_read_b64_tr_b16 a[166:167], v34 offset:45056
v_mfma_f32_16x16x32_bf16 v[164:167], a[228:231], a[108:111], v[164:167]
v_mfma_f32_16x16x32_bf16 v[164:167], a[224:227], a[104:107], v[164:167]
ds_read_b64_tr_b16 a[168:169], v34 offset:32776
v_mfma_f32_16x16x32_bf16 v[168:171], a[224:227], a[112:115], v[168:171]
ds_read_b64_tr_b16 a[170:171], v34 offset:36872
v_mfma_f32_16x16x32_bf16 v[168:171], a[228:231], a[116:119], v[168:171]
s_add_u32 s49, s47, 53248
buffer_load_dwordx4 a[80:83], v23, s[16:19], s49 offen sc1
v_mfma_f32_16x16x32_bf16 v[172:175], a[228:231], a[124:127], v[172:175]
ds_read_b64_tr_b16 a[172:173], v34 offset:40968
v_mfma_f32_16x16x32_bf16 v[172:175], a[224:227], a[120:123], v[172:175]
v_mfma_f32_16x16x32_bf16 v[188:191], a[232:235], a[120:123], v[188:191]
ds_read_b64_tr_b16 a[174:175], v34 offset:45064
v_mfma_f32_16x16x32_bf16 v[188:191], a[236:239], a[124:127], v[188:191]
buffer_load_dwordx4 a[84:87], v23, s[16:19], s49 offen offset:1024 sc1
v_mfma_f32_16x16x32_bf16 v[184:187], a[236:239], a[116:119], v[184:187]
ds_read_b64_tr_b16 a[176:177], v35 offset:32768
v_mfma_f32_16x16x32_bf16 v[184:187], a[232:235], a[112:115], v[184:187]
ds_read_b64_tr_b16 a[178:179], v35 offset:36864
v_mfma_f32_16x16x32_bf16 v[180:183], a[232:235], a[104:107], v[180:183]
v_mfma_f32_16x16x32_bf16 v[180:183], a[236:239], a[108:111], v[180:183]
ds_read_b64_tr_b16 a[180:181], v35 offset:40960
K_pg1:
s_cbranch_execz K_pg4
v_mfma_f32_16x16x32_bf16 v[176:179], a[236:239], a[100:103], v[176:179]
v_mfma_f32_16x16x32_bf16 v[176:179], a[232:235], a[96:99], v[176:179]
ds_read_b64_tr_b16 a[182:183], v35 offset:45056
v_mfma_f32_16x16x32_bf16 v[192:195], a[240:243], a[96:99], v[192:195]
s_add_u32 s49, s47, 73728
buffer_load_dwordx4 a[88:91], v23, s[16:19], s49 offen sc1
v_mfma_f32_16x16x32_bf16 v[192:195], a[244:247], a[100:103], v[192:195]
ds_read_b64_tr_b16 a[184:185], v35 offset:32776
v_mfma_f32_16x16x32_bf16 v[196:199], a[244:247], a[108:111], v[196:199]
ds_read_b64_tr_b16 a[186:187], v35 offset:36872
v_mfma_f32_16x16x32_bf16 v[196:199], a[240:243], a[104:107], v[196:199]
v_mfma_f32_16x16x32_bf16 v[200:203], a[240:243], a[112:115], v[200:203]
ds_read_b64_tr_b16 a[188:189], v35 offset:40968
v_mfma_f32_16x16x32_bf16 v[200:203], a[244:247], a[116:119], v[200:203]
buffer_load_dwordx4 a[92:95], v23, s[16:19], s49 offen offset:1024 sc1
v_mfma_f32_16x16x32_bf16 v[204:207], a[244:247], a[124:127], v[204:207]
ds_read_b64_tr_b16 a[190:191], v35 offset:45064
v_mfma_f32_16x16x32_bf16 v[204:207], a[240:243], a[120:123], v[204:207]
v_mfma_f32_16x16x32_bf16 v[220:223], a[248:251], a[120:123], v[220:223]
v_mfma_f32_16x16x32_bf16 v[220:223], a[252:255], a[124:127], v[220:223]
buffer_store_dwordx4 v[80:83], v88, s[16:19], s51 offen sc1
v_mfma_f32_16x16x32_bf16 v[216:219], a[252:255], a[116:119], v[216:219]
v_mfma_f32_16x16x32_bf16 v[216:219], a[248:251], a[112:115], v[216:219]
buffer_store_dwordx4 v[84:87], v88, s[16:19], s52 offen sc1
v_mfma_f32_16x16x32_bf16 v[212:215], a[248:251], a[104:107], v[212:215]
v_mfma_f32_16x16x32_bf16 v[212:215], a[252:255], a[108:111], v[212:215]
v_mfma_f32_16x16x32_bf16 v[208:211], a[252:255], a[100:103], v[208:211]
v_mfma_f32_16x16x32_bf16 v[208:211], a[248:251], a[96:99], v[208:211]
s_waitcnt vmcnt(19) lgkmcnt(0)
s_barrier
v_mfma_f32_16x16x32_bf16 v[96:99], a[128:131], a[0:3], v[96:99]
ds_read_b64_tr_b16 a[192:193], v32 offset:49152
v_mov_b32 v240, 0
v_mfma_f32_16x16x32_bf16 v[96:99], a[132:135], a[4:7], v[96:99]
ds_read_b64_tr_b16 a[194:195], v32 offset:53248
v_mov_b32 v241, 0
v_mfma_f32_16x16x32_bf16 v[100:103], a[132:135], a[12:15], v[100:103]
s_add_u32 s49, s47, 14336
buffer_load_dwordx4 a[96:99], v23, s[16:19], s49 offen sc1
v_mfma_f32_16x16x32_bf16 v[100:103], a[128:131], a[8:11], v[100:103]
ds_read_b64_tr_b16 a[196:197], v32 offset:57344
v_mov_b32 v242, 0
v_mfma_f32_16x16x32_bf16 v[104:107], a[128:131], a[16:19], v[104:107]
v_mfma_f32_16x16x32_bf16 v[104:107], a[132:135], a[20:23], v[104:107]
ds_read_b64_tr_b16 a[198:199], v32 offset:61440
v_mov_b32 v243, 0
v_mfma_f32_16x16x32_bf16 v[108:111], a[132:135], a[28:31], v[108:111]
buffer_load_dwordx4 a[100:103], v23, s[16:19], s49 offen offset:1024 sc1
v_mfma_f32_16x16x32_bf16 v[108:111], a[128:131], a[24:27], v[108:111]
ds_read_b64_tr_b16 a[200:201], v32 offset:49160
v_mov_b32 v244, 0
v_mfma_f32_16x16x32_bf16 v[124:127], a[136:139], a[24:27], v[124:127]
ds_read_b64_tr_b16 a[202:203], v32 offset:53256
v_mov_b32 v245, 0
v_mfma_f32_16x16x32_bf16 v[124:127], a[140:143], a[28:31], v[124:127]
v_mfma_f32_16x16x32_bf16 v[120:123], a[140:143], a[20:23], v[120:123]
ds_read_b64_tr_b16 a[204:205], v32 offset:57352
v_mov_b32 v246, 0
v_mfma_f32_16x16x32_bf16 v[120:123], a[136:139], a[16:19], v[120:123]
s_add_u32 s49, s47, 34816
buffer_load_dwordx4 a[104:107], v23, s[16:19], s49 offen sc1
v_mfma_f32_16x16x32_bf16 v[116:119], a[136:139], a[8:11], v[116:119]
ds_read_b64_tr_b16 a[206:207], v32 offset:61448
v_mov_b32 v247, 0
v_mfma_f32_16x16x32_bf16 v[116:119], a[140:143], a[12:15], v[116:119]
v_mfma_f32_16x16x32_bf16 v[112:115], a[140:143], a[4:7], v[112:115]
ds_read_b64_tr_b16 a[208:209], v33 offset:49152
v_mov_b32 v248, 0
v_mfma_f32_16x16x32_bf16 v[112:115], a[136:139], a[0:3], v[112:115]
ds_read_b64_tr_b16 a[210:211], v33 offset:53248
v_mov_b32 v249, 0
v_mfma_f32_16x16x32_bf16 v[128:131], a[144:147], a[0:3], v[128:131]
buffer_load_dwordx4 a[108:111], v23, s[16:19], s49 offen offset:1024 sc1
v_mfma_f32_16x16x32_bf16 v[128:131], a[148:151], a[4:7], v[128:131]
ds_read_b64_tr_b16 a[212:213], v33 offset:57344
v_mov_b32 v250, 0
v_mfma_f32_16x16x32_bf16 v[132:135], a[148:151], a[12:15], v[132:135]
v_mfma_f32_16x16x32_bf16 v[132:135], a[144:147], a[8:11], v[132:135]
ds_read_b64_tr_b16 a[214:215], v33 offset:61440
v_mov_b32 v251, 0
v_mfma_f32_16x16x32_bf16 v[136:139], a[144:147], a[16:19], v[136:139]
v_mfma_f32_16x16x32_bf16 v[136:139], a[148:151], a[20:23], v[136:139]
ds_read_b64_tr_b16 a[216:217], v33 offset:49160
v_mov_b32 v252, 0
v_mfma_f32_16x16x32_bf16 v[140:143], a[148:151], a[28:31], v[140:143]
ds_read_b64_tr_b16 a[218:219], v33 offset:53256
v_mov_b32 v253, 0
v_mfma_f32_16x16x32_bf16 v[140:143], a[144:147], a[24:27], v[140:143]
s_add_u32 s49, s47, 55296
buffer_load_dwordx4 a[112:115], v23, s[16:19], s49 offen sc1
v_mfma_f32_16x16x32_bf16 v[156:159], a[152:155], a[24:27], v[156:159]
ds_read_b64_tr_b16 a[220:221], v33 offset:57352
v_mov_b32 v254, 0
v_mfma_f32_16x16x32_bf16 v[156:159], a[156:159], a[28:31], v[156:159]
v_mfma_f32_16x16x32_bf16 v[152:155], a[156:159], a[20:23], v[152:155]
ds_read_b64_tr_b16 a[222:223], v33 offset:61448
v_mov_b32 v255, 0
v_mfma_f32_16x16x32_bf16 v[152:155], a[152:155], a[16:19], v[152:155]
buffer_load_dwordx4 a[116:119], v23, s[16:19], s49 offen offset:1024 sc1
v_mfma_f32_16x16x32_bf16 v[148:151], a[152:155], a[8:11], v[148:151]
ds_read_b64_tr_b16 a[224:225], v34 offset:49152
v_and_b32 v26, 7, v1
v_mfma_f32_16x16x32_bf16 v[148:151], a[156:159], a[12:15], v[148:151]
ds_read_b64_tr_b16 a[226:227], v34 offset:53248
v_min_u32 v27, 6, v26
v_mfma_f32_16x16x32_bf16 v[144:147], a[156:159], a[4:7], v[144:147]
v_mfma_f32_16x16x32_bf16 v[144:147], a[152:155], a[0:3], v[144:147]
ds_read_b64_tr_b16 a[228:229], v34 offset:57344
v_lshlrev_b32 v27, 7, v27
v_mfma_f32_16x16x32_bf16 v[160:163], a[160:163], a[0:3], v[160:163]
s_add_u32 s49, s47, 75776
buffer_load_dwordx4 a[120:123], v23, s[16:19], s49 offen sc1
v_mfma_f32_16x16x32_bf16 v[160:163], a[164:167], a[4:7], v[160:163]
ds_read_b64_tr_b16 a[230:231], v34 offset:61440
v_lshrrev_b32 v17, 3, v1
v_mfma_f32_16x16x32_bf16 v[164:167], a[164:167], a[12:15], v[164:167]
v_mfma_f32_16x16x32_bf16 v[164:167], a[160:163], a[8:11], v[164:167]
ds_read_b64_tr_b16 a[232:233], v34 offset:49160
v_mul_u32_u24 v17, 3456, v17
v_mfma_f32_16x16x32_bf16 v[168:171], a[160:163], a[16:19], v[168:171]
ds_read_b64_tr_b16 a[234:235], v34 offset:53256
v_add_u32 v27, v27, v17
v_mfma_f32_16x16x32_bf16 v[168:171], a[164:167], a[20:23], v[168:171]
v_mfma_f32_16x16x32_bf16 v[172:175], a[164:167], a[28:31], v[172:175]
ds_read_b64_tr_b16 a[236:237], v34 offset:57352
v_lshlrev_b32 v26, 4, v26
v_mfma_f32_16x16x32_bf16 v[172:175], a[160:163], a[24:27], v[172:175]
buffer_load_dwordx4 a[124:127], v23, s[16:19], s49 offen offset:1024 sc1
v_mfma_f32_16x16x32_bf16 v[188:191], a[168:171], a[24:27], v[188:191]
ds_read_b64_tr_b16 a[238:239], v34 offset:61448
v_add_u32 v26, 64, v26
v_mfma_f32_16x16x32_bf16 v[188:191], a[172:175], a[28:31], v[188:191]
v_mfma_f32_16x16x32_bf16 v[184:187], a[172:175], a[20:23], v[184:187]
ds_read_b64_tr_b16 a[240:241], v35 offset:49152
v_mfma_f32_16x16x32_bf16 v[184:187], a[168:171], a[16:19], v[184:187]
ds_read_b64_tr_b16 a[242:243], v35 offset:53248
v_mfma_f32_16x16x32_bf16 v[180:183], a[168:171], a[8:11], v[180:183]
s_add_u32 m0, s40, 0
v_mfma_f32_16x16x32_bf16 v[180:183], a[172:175], a[12:15], v[180:183]
ds_read_b64_tr_b16 a[244:245], v35 offset:57344
v_mfma_f32_16x16x32_bf16 v[176:179], a[172:175], a[4:7], v[176:179]
v_mfma_f32_16x16x32_bf16 v[176:179], a[168:171], a[0:3], v[176:179]
ds_read_b64_tr_b16 a[246:247], v35 offset:61440
v_mfma_f32_16x16x32_bf16 v[192:195], a[176:179], a[0:3], v[192:195]
buffer_load_dwordx4 v14, s[4:7], s41 offen offset:0 lds
v_mfma_f32_16x16x32_bf16 v[192:195], a[180:183], a[4:7], v[192:195]
ds_read_b64_tr_b16 a[248:249], v35 offset:49160
v_mfma_f32_16x16x32_bf16 v[196:199], a[180:183], a[12:15], v[196:199]
ds_read_b64_tr_b16 a[250:251], v35 offset:53256
v_mfma_f32_16x16x32_bf16 v[196:199], a[176:179], a[8:11], v[196:199]
v_mfma_f32_16x16x32_bf16 v[200:203], a[176:179], a[16:19], v[200:203]
ds_read_b64_tr_b16 a[252:253], v35 offset:57352
v_mfma_f32_16x16x32_bf16 v[200:203], a[180:183], a[20:23], v[200:203]
v_mfma_f32_16x16x32_bf16 v[204:207], a[180:183], a[28:31], v[204:207]
ds_read_b64_tr_b16 a[254:255], v35 offset:61448
v_mfma_f32_16x16x32_bf16 v[204:207], a[176:179], a[24:27], v[204:207]
buffer_load_dwordx4 v15, s[4:7], s41 offen offset:1024 lds
v_mfma_f32_16x16x32_bf16 v[220:223], a[184:187], a[24:27], v[220:223]
v_mfma_f32_16x16x32_bf16 v[220:223], a[188:191], a[28:31], v[220:223]
buffer_load_dwordx4 v14, s[4:7], s41 offen offset:2048 lds
v_mfma_f32_16x16x32_bf16 v[216:219], a[188:191], a[20:23], v[216:219]
v_mfma_f32_16x16x32_bf16 v[216:219], a[184:187], a[16:19], v[216:219]
buffer_load_dwordx4 v15, s[4:7], s41 offen offset:3072 lds
s_add_u32 s41, s41, 16384
v_mfma_f32_16x16x32_bf16 v[212:215], a[184:187], a[8:11], v[212:215]
v_mfma_f32_16x16x32_bf16 v[212:215], a[188:191], a[12:15], v[212:215]
v_mfma_f32_16x16x32_bf16 v[208:211], a[188:191], a[4:7], v[208:211]
v_mfma_f32_16x16x32_bf16 v[208:211], a[184:187], a[0:3], v[208:211]
s_waitcnt vmcnt(22) lgkmcnt(0)
v_mfma_f32_16x16x32_bf16 v[96:99], a[192:195], a[32:35], v[96:99]
ds_read_b64_tr_b16 a[128:129], v19 offset:0
v_mfma_f32_16x16x32_bf16 v[96:99], a[196:199], a[36:39], v[96:99]
ds_read_b64_tr_b16 a[130:131], v19 offset:4096
v_mfma_f32_16x16x32_bf16 v[100:103], a[196:199], a[44:47], v[100:103]
s_add_u32 s49, s47, 16384
buffer_load_dwordx4 a[0:3], v23, s[16:19], s49 offen sc1
v_mfma_f32_16x16x32_bf16 v[100:103], a[192:195], a[40:43], v[100:103]
ds_read_b64_tr_b16 a[132:133], v19 offset:8192
v_mfma_f32_16x16x32_bf16 v[104:107], a[192:195], a[48:51], v[104:107]
v_mfma_f32_16x16x32_bf16 v[104:107], a[196:199], a[52:55], v[104:107]
ds_read_b64_tr_b16 a[134:135], v19 offset:12288
v_mfma_f32_16x16x32_bf16 v[108:111], a[196:199], a[60:63], v[108:111]
buffer_load_dwordx4 a[4:7], v23, s[16:19], s49 offen offset:1024 sc1
v_mfma_f32_16x16x32_bf16 v[108:111], a[192:195], a[56:59], v[108:111]
ds_read_b64_tr_b16 a[136:137], v19 offset:8
v_mfma_f32_16x16x32_bf16 v[124:127], a[200:203], a[56:59], v[124:127]
ds_read_b64_tr_b16 a[138:139], v19 offset:4104
v_mfma_f32_16x16x32_bf16 v[124:127], a[204:207], a[60:63], v[124:127]
v_mfma_f32_16x16x32_bf16 v[120:123], a[204:207], a[52:55], v[120:123]
ds_read_b64_tr_b16 a[140:141], v19 offset:8200
v_mfma_f32_16x16x32_bf16 v[120:123], a[200:203], a[48:51], v[120:123]
s_add_u32 s49, s47, 36864
buffer_load_dwordx4 a[8:11], v23, s[16:19], s49 offen sc1
v_mfma_f32_16x16x32_bf16 v[116:119], a[200:203], a[40:43], v[116:119]
ds_read_b64_tr_b16 a[142:143], v19 offset:12296
v_mfma_f32_16x16x32_bf16 v[116:119], a[204:207], a[44:47], v[116:119]
v_mfma_f32_16x16x32_bf16 v[112:115], a[204:207], a[36:39], v[112:115]
ds_read_b64_tr_b16 a[144:145], v20 offset:0
v_mfma_f32_16x16x32_bf16 v[112:115], a[200:203], a[32:35], v[112:115]
ds_read_b64_tr_b16 a[146:147], v20 offset:4096
v_mfma_f32_16x16x32_bf16 v[128:131], a[208:211], a[32:35], v[128:131]
buffer_load_dwordx4 a[12:15], v23, s[16:19], s49 offen offset:1024 sc1
v_mfma_f32_16x16x32_bf16 v[128:131], a[212:215], a[36:39], v[128:131]
ds_read_b64_tr_b16 a[148:149], v20 offset:8192
v_mfma_f32_16x16x32_bf16 v[132:135], a[212:215], a[44:47], v[132:135]
v_mfma_f32_16x16x32_bf16 v[132:135], a[208:211], a[40:43], v[132:135]
ds_read_b64_tr_b16 a[150:151], v20 offset:12288
v_mfma_f32_16x16x32_bf16 v[136:139], a[208:211], a[48:51], v[136:139]
v_mfma_f32_16x16x32_bf16 v[136:139], a[212:215], a[52:55], v[136:139]
ds_read_b64_tr_b16 a[152:153], v20 offset:8
v_mfma_f32_16x16x32_bf16 v[140:143], a[212:215], a[60:63], v[140:143]
ds_read_b64_tr_b16 a[154:155], v20 offset:4104
v_mfma_f32_16x16x32_bf16 v[140:143], a[208:211], a[56:59], v[140:143]
s_add_u32 s49, s47, 57344
buffer_load_dwordx4 a[16:19], v23, s[16:19], s49 offen sc1
v_mfma_f32_16x16x32_bf16 v[156:159], a[216:219], a[56:59], v[156:159]
ds_read_b64_tr_b16 a[156:157], v20 offset:8200
v_mfma_f32_16x16x32_bf16 v[156:159], a[220:223], a[60:63], v[156:159]
v_mfma_f32_16x16x32_bf16 v[152:155], a[220:223], a[52:55], v[152:155]
ds_read_b64_tr_b16 a[158:159], v20 offset:12296
v_mfma_f32_16x16x32_bf16 v[152:155], a[216:219], a[48:51], v[152:155]
buffer_load_dwordx4 a[20:23], v23, s[16:19], s49 offen offset:1024 sc1
v_mfma_f32_16x16x32_bf16 v[148:151], a[216:219], a[40:43], v[148:151]
ds_read_b64_tr_b16 a[160:161], v21 offset:0
v_mfma_f32_16x16x32_bf16 v[148:151], a[220:223], a[44:47], v[148:151]
ds_read_b64_tr_b16 a[162:163], v21 offset:4096
v_mfma_f32_16x16x32_bf16 v[144:147], a[220:223], a[36:39], v[144:147]
v_mfma_f32_16x16x32_bf16 v[144:147], a[216:219], a[32:35], v[144:147]
ds_read_b64_tr_b16 a[164:165], v21 offset:8192
v_mfma_f32_16x16x32_bf16 v[160:163], a[224:227], a[32:35], v[160:163]
s_add_u32 s49, s47, 77824
buffer_load_dwordx4 a[24:27], v23, s[16:19], s49 offen sc1
v_mfma_f32_16x16x32_bf16 v[160:163], a[228:231], a[36:39], v[160:163]
ds_read_b64_tr_b16 a[166:167], v21 offset:12288
v_mfma_f32_16x16x32_bf16 v[164:167], a[228:231], a[44:47], v[164:167]
v_mfma_f32_16x16x32_bf16 v[164:167], a[224:227], a[40:43], v[164:167]
ds_read_b64_tr_b16 a[168:169], v21 offset:8
v_mfma_f32_16x16x32_bf16 v[168:171], a[224:227], a[48:51], v[168:171]
ds_read_b64_tr_b16 a[170:171], v21 offset:4104
v_mfma_f32_16x16x32_bf16 v[168:171], a[228:231], a[52:55], v[168:171]
v_mfma_f32_16x16x32_bf16 v[172:175], a[228:231], a[60:63], v[172:175]
ds_read_b64_tr_b16 a[172:173], v21 offset:8200
v_mfma_f32_16x16x32_bf16 v[172:175], a[224:227], a[56:59], v[172:175]
buffer_load_dwordx4 a[28:31], v23, s[16:19], s49 offen offset:1024 sc1
v_mfma_f32_16x16x32_bf16 v[188:191], a[232:235], a[56:59], v[188:191]
ds_read_b64_tr_b16 a[174:175], v21 offset:12296
v_mfma_f32_16x16x32_bf16 v[188:191], a[236:239], a[60:63], v[188:191]
v_mfma_f32_16x16x32_bf16 v[184:187], a[236:239], a[52:55], v[184:187]
ds_read_b64_tr_b16 a[176:177], v22 offset:0
v_mfma_f32_16x16x32_bf16 v[184:187], a[232:235], a[48:51], v[184:187]
ds_read_b64_tr_b16 a[178:179], v22 offset:4096
v_mfma_f32_16x16x32_bf16 v[180:183], a[232:235], a[40:43], v[180:183]
s_add_u32 m0, s40, 16384
v_mfma_f32_16x16x32_bf16 v[180:183], a[236:239], a[44:47], v[180:183]
ds_read_b64_tr_b16 a[180:181], v22 offset:8192
v_mfma_f32_16x16x32_bf16 v[176:179], a[236:239], a[36:39], v[176:179]
v_mfma_f32_16x16x32_bf16 v[176:179], a[232:235], a[32:35], v[176:179]
ds_read_b64_tr_b16 a[182:183], v22 offset:12288
v_mfma_f32_16x16x32_bf16 v[192:195], a[240:243], a[32:35], v[192:195]
buffer_load_dwordx4 v14, s[4:7], s41 offen offset:0 lds
v_mfma_f32_16x16x32_bf16 v[192:195], a[244:247], a[36:39], v[192:195]
ds_read_b64_tr_b16 a[184:185], v22 offset:8
v_mfma_f32_16x16x32_bf16 v[196:199], a[244:247], a[44:47], v[196:199]
ds_read_b64_tr_b16 a[186:187], v22 offset:4104
v_mfma_f32_16x16x32_bf16 v[196:199], a[240:243], a[40:43], v[196:199]
v_mfma_f32_16x16x32_bf16 v[200:203], a[240:243], a[48:51], v[200:203]
ds_read_b64_tr_b16 a[188:189], v22 offset:8200
v_mfma_f32_16x16x32_bf16 v[200:203], a[244:247], a[52:55], v[200:203]
v_mfma_f32_16x16x32_bf16 v[204:207], a[244:247], a[60:63], v[204:207]
ds_read_b64_tr_b16 a[190:191], v22 offset:12296
v_mfma_f32_16x16x32_bf16 v[204:207], a[240:243], a[56:59], v[204:207]
buffer_load_dwordx4 v15, s[4:7], s41 offen offset:1024 lds
v_mfma_f32_16x16x32_bf16 v[220:223], a[248:251], a[56:59], v[220:223]
v_mfma_f32_16x16x32_bf16 v[220:223], a[252:255], a[60:63], v[220:223]
buffer_load_dwordx4 v14, s[4:7], s41 offen offset:2048 lds
v_mfma_f32_16x16x32_bf16 v[216:219], a[252:255], a[52:55], v[216:219]
v_mfma_f32_16x16x32_bf16 v[216:219], a[248:251], a[48:51], v[216:219]
buffer_load_dwordx4 v15, s[4:7], s41 offen offset:3072 lds
s_add_u32 s41, s41, 16384
v_mfma_f32_16x16x32_bf16 v[212:215], a[248:251], a[40:43], v[212:215]
v_mfma_f32_16x16x32_bf16 v[212:215], a[252:255], a[44:47], v[212:215]
v_mfma_f32_16x16x32_bf16 v[208:211], a[252:255], a[36:39], v[208:211]
v_mfma_f32_16x16x32_bf16 v[208:211], a[248:251], a[32:35], v[208:211]
s_waitcnt vmcnt(26) lgkmcnt(0)
v_mfma_f32_16x16x32_bf16 v[96:99], a[128:131], a[64:67], v[96:99]
ds_read_b64_tr_b16 a[192:193], v19 offset:16384
v_min_u32 v17, 39, v1
v_mfma_f32_16x16x32_bf16 v[96:99], a[132:135], a[68:71], v[96:99]
ds_read_b64_tr_b16 a[194:195], v19 offset:20480
v_lshlrev_b32 v17, 7, v17
v_mfma_f32_16x16x32_bf16 v[100:103], a[132:135], a[76:79], v[100:103]
s_add_u32 s49, s47, 18432
buffer_load_dwordx4 a[32:35], v23, s[16:19], s49 offen sc1
v_mfma_f32_16x16x32_bf16 v[100:103], a[128:131], a[72:75], v[100:103]
ds_read_b64_tr_b16 a[196:197], v19 offset:24576
v_lshrrev_b32 v25, 2, v1
v_mfma_f32_16x16x32_bf16 v[104:107], a[128:131], a[80:83], v[104:107]
v_mfma_f32_16x16x32_bf16 v[104:107], a[132:135], a[84:87], v[104:107]
ds_read_b64_tr_b16 a[198:199], v19 offset:28672
v_mul_u32_u24 v25, 160, v25
v_mfma_f32_16x16x32_bf16 v[108:111], a[132:135], a[92:95], v[108:111]
buffer_load_dwordx4 a[36:39], v23, s[16:19], s49 offen offset:1024 sc1
v_mfma_f32_16x16x32_bf16 v[108:111], a[128:131], a[88:91], v[108:111]
ds_read_b64_tr_b16 a[200:201], v19 offset:16392
v_and_b32 v18, 3, v1
v_mfma_f32_16x16x32_bf16 v[124:127], a[136:139], a[88:91], v[124:127]
ds_read_b64_tr_b16 a[202:203], v19 offset:20488
v_lshl_add_u32 v25, v18, 3, v25
v_mfma_f32_16x16x32_bf16 v[124:127], a[140:143], a[92:95], v[124:127]
v_mfma_f32_16x16x32_bf16 v[120:123], a[140:143], a[84:87], v[120:123]
ds_read_b64_tr_b16 a[204:205], v19 offset:24584
s_lshl_b32 s53, s44, 13
v_mfma_f32_16x16x32_bf16 v[120:123], a[136:139], a[80:83], v[120:123]
s_add_u32 s49, s47, 38912
buffer_load_dwordx4 a[40:43], v23, s[16:19], s49 offen sc1
v_mfma_f32_16x16x32_bf16 v[116:119], a[136:139], a[72:75], v[116:119]
ds_read_b64_tr_b16 a[206:207], v19 offset:28680
s_add_u32 s53, s53, 131072
v_mfma_f32_16x16x32_bf16 v[116:119], a[140:143], a[76:79], v[116:119]
v_mfma_f32_16x16x32_bf16 v[112:115], a[140:143], a[68:71], v[112:115]
ds_read_b64_tr_b16 a[208:209], v20 offset:16384
v_add_u32 v25, s53, v25
v_mfma_f32_16x16x32_bf16 v[112:115], a[136:139], a[64:67], v[112:115]
ds_read_b64_tr_b16 a[210:211], v20 offset:20480
s_lshr_b32 s53, s2, 3
v_mfma_f32_16x16x32_bf16 v[128:131], a[144:147], a[64:67], v[128:131]
buffer_load_dwordx4 a[44:47], v23, s[16:19], s49 offen offset:1024 sc1
v_mfma_f32_16x16x32_bf16 v[128:131], a[148:151], a[68:71], v[128:131]
ds_read_b64_tr_b16 a[212:213], v20 offset:24576
s_lshl_b32 s53, s53, 2
v_mfma_f32_16x16x32_bf16 v[132:135], a[148:151], a[76:79], v[132:135]
v_mfma_f32_16x16x32_bf16 v[132:135], a[144:147], a[72:75], v[132:135]
ds_read_b64_tr_b16 a[214:215], v20 offset:28672
s_add_u32 s53, s53, s44
v_mfma_f32_16x16x32_bf16 v[136:139], a[144:147], a[80:83], v[136:139]
v_mfma_f32_16x16x32_bf16 v[136:139], a[148:151], a[84:87], v[136:139]
ds_read_b64_tr_b16 a[216:217], v20 offset:16392
s_mul_i32 s79, s53, 55296
v_mfma_f32_16x16x32_bf16 v[140:143], a[148:151], a[92:95], v[140:143]
ds_read_b64_tr_b16 a[218:219], v20 offset:20488
s_lshr_b32 s54, s81, 1
v_mfma_f32_16x16x32_bf16 v[140:143], a[144:147], a[88:91], v[140:143]
s_add_u32 s49, s47, 59392
buffer_load_dwordx4 a[48:51], v23, s[16:19], s49 offen sc1
v_mfma_f32_16x16x32_bf16 v[156:159], a[152:155], a[88:91], v[156:159]
ds_read_b64_tr_b16 a[220:221], v20 offset:24584
s_mul_i32 s54, s54, 896
v_mfma_f32_16x16x32_bf16 v[156:159], a[156:159], a[92:95], v[156:159]
v_mfma_f32_16x16x32_bf16 v[152:155], a[156:159], a[84:87], v[152:155]
ds_read_b64_tr_b16 a[222:223], v20 offset:28680
s_add_u32 s79, s79, s54
v_mfma_f32_16x16x32_bf16 v[152:155], a[152:155], a[80:83], v[152:155]
buffer_load_dwordx4 a[52:55], v23, s[16:19], s49 offen offset:1024 sc1
v_mfma_f32_16x16x32_bf16 v[148:151], a[152:155], a[72:75], v[148:151]
ds_read_b64_tr_b16 a[224:225], v21 offset:16384
s_add_u32 s79, s79, 165888
v_mfma_f32_16x16x32_bf16 v[148:151], a[156:159], a[76:79], v[148:151]
ds_read_b64_tr_b16 a[226:227], v21 offset:20480
s_mul_i32 s101, s53, 10240
v_mfma_f32_16x16x32_bf16 v[144:147], a[156:159], a[68:71], v[144:147]
v_mfma_f32_16x16x32_bf16 v[144:147], a[152:155], a[64:67], v[144:147]
ds_read_b64_tr_b16 a[228:229], v21 offset:24576
s_and_b32 s54, s81, 1
v_mfma_f32_16x16x32_bf16 v[160:163], a[160:163], a[64:67], v[160:163]
s_add_u32 s49, s47, 79872
buffer_load_dwordx4 a[56:59], v23, s[16:19], s49 offen sc1
v_mfma_f32_16x16x32_bf16 v[160:163], a[164:167], a[68:71], v[160:163]
ds_read_b64_tr_b16 a[230:231], v21 offset:28672
s_mul_i32 s54, s54, 1310720
v_mfma_f32_16x16x32_bf16 v[164:167], a[164:167], a[76:79], v[164:167]
v_mfma_f32_16x16x32_bf16 v[164:167], a[160:163], a[72:75], v[164:167]
ds_read_b64_tr_b16 a[232:233], v21 offset:16392
s_add_u32 s101, s101, s54
v_mfma_f32_16x16x32_bf16 v[168:171], a[160:163], a[80:83], v[168:171]
ds_read_b64_tr_b16 a[234:235], v21 offset:20488
s_add_u32 s101, s101, 2657280
v_mfma_f32_16x16x32_bf16 v[168:171], a[164:167], a[84:87], v[168:171]
v_mfma_f32_16x16x32_bf16 v[172:175], a[164:167], a[92:95], v[172:175]
ds_read_b64_tr_b16 a[236:237], v21 offset:24584
v_mfma_f32_16x16x32_bf16 v[172:175], a[160:163], a[88:91], v[172:175]
buffer_load_dwordx4 a[60:63], v23, s[16:19], s49 offen offset:1024 sc1
v_mfma_f32_16x16x32_bf16 v[188:191], a[168:171], a[88:91], v[188:191]
ds_read_b64_tr_b16 a[238:239], v21 offset:28680
v_mfma_f32_16x16x32_bf16 v[188:191], a[172:175], a[92:95], v[188:191]
v_mfma_f32_16x16x32_bf16 v[184:187], a[172:175], a[84:87], v[184:187]
ds_read_b64_tr_b16 a[240:241], v22 offset:16384
v_mfma_f32_16x16x32_bf16 v[184:187], a[168:171], a[80:83], v[184:187]
ds_read_b64_tr_b16 a[242:243], v22 offset:20480
v_mfma_f32_16x16x32_bf16 v[180:183], a[168:171], a[72:75], v[180:183]
s_add_u32 m0, s40, 32768
v_mfma_f32_16x16x32_bf16 v[180:183], a[172:175], a[76:79], v[180:183]
ds_read_b64_tr_b16 a[244:245], v22 offset:24576
v_mfma_f32_16x16x32_bf16 v[176:179], a[172:175], a[68:71], v[176:179]
v_mfma_f32_16x16x32_bf16 v[176:179], a[168:171], a[64:67], v[176:179]
ds_read_b64_tr_b16 a[246:247], v22 offset:28672
v_mfma_f32_16x16x32_bf16 v[192:195], a[176:179], a[64:67], v[192:195]
buffer_load_dwordx4 v14, s[4:7], s41 offen offset:0 lds
v_mfma_f32_16x16x32_bf16 v[192:195], a[180:183], a[68:71], v[192:195]
ds_read_b64_tr_b16 a[248:249], v22 offset:16392
v_mfma_f32_16x16x32_bf16 v[196:199], a[180:183], a[76:79], v[196:199]
ds_read_b64_tr_b16 a[250:251], v22 offset:20488
v_mfma_f32_16x16x32_bf16 v[196:199], a[176:179], a[72:75], v[196:199]
v_mfma_f32_16x16x32_bf16 v[200:203], a[176:179], a[80:83], v[200:203]
ds_read_b64_tr_b16 a[252:253], v22 offset:24584
v_mfma_f32_16x16x32_bf16 v[200:203], a[180:183], a[84:87], v[200:203]
v_mfma_f32_16x16x32_bf16 v[204:207], a[180:183], a[92:95], v[204:207]
ds_read_b64_tr_b16 a[254:255], v22 offset:28680
v_mfma_f32_16x16x32_bf16 v[204:207], a[176:179], a[88:91], v[204:207]
buffer_load_dwordx4 v15, s[4:7], s41 offen offset:1024 lds
v_mfma_f32_16x16x32_bf16 v[220:223], a[184:187], a[88:91], v[220:223]
v_mfma_f32_16x16x32_bf16 v[220:223], a[188:191], a[92:95], v[220:223]
buffer_load_dwordx4 v14, s[4:7], s41 offen offset:2048 lds
v_mfma_f32_16x16x32_bf16 v[216:219], a[188:191], a[84:87], v[216:219]
v_mfma_f32_16x16x32_bf16 v[216:219], a[184:187], a[80:83], v[216:219]
buffer_load_dwordx4 v15, s[4:7], s41 offen offset:3072 lds
s_add_u32 s41, s41, 16384
v_mfma_f32_16x16x32_bf16 v[212:215], a[184:187], a[72:75], v[212:215]
v_mfma_f32_16x16x32_bf16 v[212:215], a[188:191], a[76:79], v[212:215]
v_mfma_f32_16x16x32_bf16 v[208:211], a[188:191], a[68:71], v[208:211]
v_mfma_f32_16x16x32_bf16 v[208:211], a[184:187], a[64:67], v[208:211]
s_waitcnt vmcnt(28) lgkmcnt(0)
s_barrier
v_mfma_f32_16x16x32_bf16 v[96:99], a[192:195], a[96:99], v[96:99]
ds_read_b64_tr_b16 a[128:129], v19 offset:32768
v_mfma_f32_16x16x32_bf16 v[96:99], a[196:199], a[100:103], v[96:99]
ds_read_b64_tr_b16 a[130:131], v19 offset:36864
v_mfma_f32_16x16x32_bf16 v[100:103], a[196:199], a[108:111], v[100:103]
s_lshl_b32 s48, s44, 13
s_add_u32 m0, s48, 131072
v_mfma_f32_16x16x32_bf16 v[100:103], a[192:195], a[104:107], v[100:103]
ds_read_b64_tr_b16 a[132:133], v19 offset:40960
v_mfma_f32_16x16x32_bf16 v[104:107], a[192:195], a[112:115], v[104:107]
v_mfma_f32_16x16x32_bf16 v[104:107], a[196:199], a[116:119], v[104:107]
ds_read_b64_tr_b16 a[134:135], v19 offset:45056
v_mfma_f32_16x16x32_bf16 v[108:111], a[196:199], a[124:127], v[108:111]
v_mfma_f32_16x16x32_bf16 v[108:111], a[192:195], a[120:123], v[108:111]
ds_read_b64_tr_b16 a[136:137], v19 offset:32776
v_mfma_f32_16x16x32_bf16 v[124:127], a[200:203], a[120:123], v[124:127]
ds_read_b64_tr_b16 a[138:139], v19 offset:36872
v_mfma_f32_16x16x32_bf16 v[124:127], a[204:207], a[124:127], v[124:127]
buffer_load_dwordx4 v36, s[32:35], s76 offen lds
v_mfma_f32_16x16x32_bf16 v[120:123], a[204:207], a[116:119], v[120:123]
ds_read_b64_tr_b16 a[140:141], v19 offset:40968
v_mfma_f32_16x16x32_bf16 v[120:123], a[200:203], a[112:115], v[120:123]
v_mfma_f32_16x16x32_bf16 v[116:119], a[200:203], a[104:107], v[116:119]
ds_read_b64_tr_b16 a[142:143], v19 offset:45064
v_mfma_f32_16x16x32_bf16 v[116:119], a[204:207], a[108:111], v[116:119]
v_mfma_f32_16x16x32_bf16 v[112:115], a[204:207], a[100:103], v[112:115]
ds_read_b64_tr_b16 a[144:145], v20 offset:32768
v_mfma_f32_16x16x32_bf16 v[112:115], a[200:203], a[96:99], v[112:115]
ds_read_b64_tr_b16 a[146:147], v20 offset:36864
v_mfma_f32_16x16x32_bf16 v[128:131], a[208:211], a[96:99], v[128:131]
s_lshl_b32 s48, s44, 13
s_add_u32 m0, s48, 132096
v_mfma_f32_16x16x32_bf16 v[128:131], a[212:215], a[100:103], v[128:131]
ds_read_b64_tr_b16 a[148:149], v20 offset:40960
v_mfma_f32_16x16x32_bf16 v[132:135], a[212:215], a[108:111], v[132:135]
v_mfma_f32_16x16x32_bf16 v[132:135], a[208:211], a[104:107], v[132:135]
ds_read_b64_tr_b16 a[150:151], v20 offset:45056
v_mfma_f32_16x16x32_bf16 v[136:139], a[208:211], a[112:115], v[136:139]
v_mfma_f32_16x16x32_bf16 v[136:139], a[212:215], a[116:119], v[136:139]
ds_read_b64_tr_b16 a[152:153], v20 offset:32776
v_mfma_f32_16x16x32_bf16 v[140:143], a[212:215], a[124:127], v[140:143]
ds_read_b64_tr_b16 a[154:155], v20 offset:36872
v_mfma_f32_16x16x32_bf16 v[140:143], a[208:211], a[120:123], v[140:143]
buffer_load_dwordx4 v37, s[32:35], s76 offen lds
v_mfma_f32_16x16x32_bf16 v[156:159], a[216:219], a[120:123], v[156:159]
ds_read_b64_tr_b16 a[156:157], v20 offset:40968
v_mfma_f32_16x16x32_bf16 v[156:159], a[220:223], a[124:127], v[156:159]
v_mfma_f32_16x16x32_bf16 v[152:155], a[220:223], a[116:119], v[152:155]
ds_read_b64_tr_b16 a[158:159], v20 offset:45064
v_mfma_f32_16x16x32_bf16 v[152:155], a[216:219], a[112:115], v[152:155]
v_mfma_f32_16x16x32_bf16 v[148:151], a[216:219], a[104:107], v[148:151]
ds_read_b64_tr_b16 a[160:161], v21 offset:32768
v_mfma_f32_16x16x32_bf16 v[148:151], a[220:223], a[108:111], v[148:151]
ds_read_b64_tr_b16 a[162:163], v21 offset:36864
v_mfma_f32_16x16x32_bf16 v[144:147], a[220:223], a[100:103], v[144:147]
s_lshl_b32 s48, s44, 13
s_add_u32 m0, s48, 133120
v_mfma_f32_16x16x32_bf16 v[144:147], a[216:219], a[96:99], v[144:147]
ds_read_b64_tr_b16 a[164:165], v21 offset:40960
v_mfma_f32_16x16x32_bf16 v[160:163], a[224:227], a[96:99], v[160:163]
v_mfma_f32_16x16x32_bf16 v[160:163], a[228:231], a[100:103], v[160:163]
ds_read_b64_tr_b16 a[166:167], v21 offset:45056
v_mfma_f32_16x16x32_bf16 v[164:167], a[228:231], a[108:111], v[164:167]
v_mfma_f32_16x16x32_bf16 v[164:167], a[224:227], a[104:107], v[164:167]
ds_read_b64_tr_b16 a[168:169], v21 offset:32776
v_mfma_f32_16x16x32_bf16 v[168:171], a[224:227], a[112:115], v[168:171]
ds_read_b64_tr_b16 a[170:171], v21 offset:36872
v_mfma_f32_16x16x32_bf16 v[168:171], a[228:231], a[116:119], v[168:171]
buffer_load_dwordx4 v38, s[32:35], s76 offen lds
v_mfma_f32_16x16x32_bf16 v[172:175], a[228:231], a[124:127], v[172:175]
ds_read_b64_tr_b16 a[172:173], v21 offset:40968
v_mfma_f32_16x16x32_bf16 v[172:175], a[224:227], a[120:123], v[172:175]
v_mfma_f32_16x16x32_bf16 v[188:191], a[232:235], a[120:123], v[188:191]
ds_read_b64_tr_b16 a[174:175], v21 offset:45064
v_mfma_f32_16x16x32_bf16 v[188:191], a[236:239], a[124:127], v[188:191]
v_mfma_f32_16x16x32_bf16 v[184:187], a[236:239], a[116:119], v[184:187]
ds_read_b64_tr_b16 a[176:177], v22 offset:32768
v_mfma_f32_16x16x32_bf16 v[184:187], a[232:235], a[112:115], v[184:187]
ds_read_b64_tr_b16 a[178:179], v22 offset:36864
v_mfma_f32_16x16x32_bf16 v[180:183], a[232:235], a[104:107], v[180:183]
s_lshl_b32 s48, s44, 13
s_add_u32 m0, s48, 134144
v_mfma_f32_16x16x32_bf16 v[180:183], a[236:239], a[108:111], v[180:183]
ds_read_b64_tr_b16 a[180:181], v22 offset:40960
v_mfma_f32_16x16x32_bf16 v[176:179], a[236:239], a[100:103], v[176:179]
v_mfma_f32_16x16x32_bf16 v[176:179], a[232:235], a[96:99], v[176:179]
ds_read_b64_tr_b16 a[182:183], v22 offset:45056
v_mfma_f32_16x16x32_bf16 v[192:195], a[240:243], a[96:99], v[192:195]
v_mfma_f32_16x16x32_bf16 v[192:195], a[244:247], a[100:103], v[192:195]
ds_read_b64_tr_b16 a[184:185], v22 offset:32776
v_mfma_f32_16x16x32_bf16 v[196:199], a[244:247], a[108:111], v[196:199]
ds_read_b64_tr_b16 a[186:187], v22 offset:36872
v_mfma_f32_16x16x32_bf16 v[196:199], a[240:243], a[104:107], v[196:199]
buffer_load_dwordx4 v39, s[32:35], s76 offen lds
v_mfma_f32_16x16x32_bf16 v[200:203], a[240:243], a[112:115], v[200:203]
ds_read_b64_tr_b16 a[188:189], v22 offset:40968
v_mfma_f32_16x16x32_bf16 v[200:203], a[244:247], a[116:119], v[200:203]
v_mfma_f32_16x16x32_bf16 v[204:207], a[244:247], a[124:127], v[204:207]
ds_read_b64_tr_b16 a[190:191], v22 offset:45064
v_mfma_f32_16x16x32_bf16 v[204:207], a[240:243], a[120:123], v[204:207]
v_mfma_f32_16x16x32_bf16 v[220:223], a[248:251], a[120:123], v[220:223]
s_lshl_b32 s48, s44, 13
s_add_u32 m0, s48, 135168
v_mfma_f32_16x16x32_bf16 v[220:223], a[252:255], a[124:127], v[220:223]
v_mfma_f32_16x16x32_bf16 v[216:219], a[252:255], a[116:119], v[216:219]
v_mfma_f32_16x16x32_bf16 v[216:219], a[248:251], a[112:115], v[216:219]
buffer_load_dwordx4 v40, s[32:35], s76 offen lds
v_mfma_f32_16x16x32_bf16 v[212:215], a[248:251], a[104:107], v[212:215]
v_mfma_f32_16x16x32_bf16 v[212:215], a[252:255], a[108:111], v[212:215]
v_mfma_f32_16x16x32_bf16 v[208:211], a[252:255], a[100:103], v[208:211]
v_mfma_f32_16x16x32_bf16 v[208:211], a[248:251], a[96:99], v[208:211]
s_waitcnt vmcnt(21) lgkmcnt(0)
v_mfma_f32_16x16x32_bf16 v[96:99], a[128:131], a[0:3], v[96:99]
ds_read_b64_tr_b16 a[192:193], v19 offset:49152
K_pg2:
s_cbranch_execz K_pg5
v_mfma_f32_16x16x32_bf16 v[96:99], a[132:135], a[4:7], v[96:99]
ds_read_b64_tr_b16 a[194:195], v19 offset:53248
v_mfma_f32_16x16x32_bf16 v[100:103], a[132:135], a[12:15], v[100:103]
s_add_u32 m0, s40, 65536
v_mfma_f32_16x16x32_bf16 v[100:103], a[128:131], a[8:11], v[100:103]
ds_read_b64_tr_b16 a[196:197], v19 offset:57344
v_mfma_f32_16x16x32_bf16 v[104:107], a[128:131], a[16:19], v[104:107]
v_mfma_f32_16x16x32_bf16 v[104:107], a[132:135], a[20:23], v[104:107]
ds_read_b64_tr_b16 a[198:199], v19 offset:61440
v_mfma_f32_16x16x32_bf16 v[108:111], a[132:135], a[28:31], v[108:111]
v_mfma_f32_16x16x32_bf16 v[108:111], a[128:131], a[24:27], v[108:111]
ds_read_b64_tr_b16 a[200:201], v19 offset:49160
v_mfma_f32_16x16x32_bf16 v[124:127], a[136:139], a[24:27], v[124:127]
ds_read_b64_tr_b16 a[202:203], v19 offset:53256
v_mfma_f32_16x16x32_bf16 v[124:127], a[140:143], a[28:31], v[124:127]
buffer_load_dwordx4 v14, s[8:11], s42 offen offset:0 lds
v_mfma_f32_16x16x32_bf16 v[120:123], a[140:143], a[20:23], v[120:123]
ds_read_b64_tr_b16 a[204:205], v19 offset:57352
v_mfma_f32_16x16x32_bf16 v[120:123], a[136:139], a[16:19], v[120:123]
v_mfma_f32_16x16x32_bf16 v[116:119], a[136:139], a[8:11], v[116:119]
ds_read_b64_tr_b16 a[206:207], v19 offset:61448
v_mfma_f32_16x16x32_bf16 v[116:119], a[140:143], a[12:15], v[116:119]
v_mfma_f32_16x16x32_bf16 v[112:115], a[140:143], a[4:7], v[112:115]
ds_read_b64_tr_b16 a[208:209], v20 offset:49152
v_mfma_f32_16x16x32_bf16 v[112:115], a[136:139], a[0:3], v[112:115]
ds_read_b64_tr_b16 a[210:211], v20 offset:53248
v_mfma_f32_16x16x32_bf16 v[128:131], a[144:147], a[0:3], v[128:131]
buffer_load_dwordx4 v15, s[8:11], s42 offen offset:1024 lds
v_mfma_f32_16x16x32_bf16 v[128:131], a[148:151], a[4:7], v[128:131]
ds_read_b64_tr_b16 a[212:213], v20 offset:57344
v_mfma_f32_16x16x32_bf16 v[132:135], a[148:151], a[12:15], v[132:135]
v_mfma_f32_16x16x32_bf16 v[132:135], a[144:147], a[8:11], v[132:135]
ds_read_b64_tr_b16 a[214:215], v20 offset:61440
v_mfma_f32_16x16x32_bf16 v[136:139], a[144:147], a[16:19], v[136:139]
v_mfma_f32_16x16x32_bf16 v[136:139], a[148:151], a[20:23], v[136:139]
ds_read_b64_tr_b16 a[216:217], v20 offset:49160
v_mfma_f32_16x16x32_bf16 v[140:143], a[148:151], a[28:31], v[140:143]
ds_read_b64_tr_b16 a[218:219], v20 offset:53256
v_mfma_f32_16x16x32_bf16 v[140:143], a[144:147], a[24:27], v[140:143]
buffer_load_dwordx4 v14, s[8:11], s42 offen offset:2048 lds
v_mfma_f32_16x16x32_bf16 v[156:159], a[152:155], a[24:27], v[156:159]
ds_read_b64_tr_b16 a[220:221], v20 offset:57352
v_mfma_f32_16x16x32_bf16 v[156:159], a[156:159], a[28:31], v[156:159]
v_mfma_f32_16x16x32_bf16 v[152:155], a[156:159], a[20:23], v[152:155]
ds_read_b64_tr_b16 a[222:223], v20 offset:61448
v_mfma_f32_16x16x32_bf16 v[152:155], a[152:155], a[16:19], v[152:155]
v_mfma_f32_16x16x32_bf16 v[148:151], a[152:155], a[8:11], v[148:151]
ds_read_b64_tr_b16 a[224:225], v21 offset:49152
v_mfma_f32_16x16x32_bf16 v[148:151], a[156:159], a[12:15], v[148:151]
ds_read_b64_tr_b16 a[226:227], v21 offset:53248
v_mfma_f32_16x16x32_bf16 v[144:147], a[156:159], a[4:7], v[144:147]
buffer_load_dwordx4 v15, s[8:11], s42 offen offset:3072 lds
s_add_u32 s42, s42, 16384
v_mfma_f32_16x16x32_bf16 v[144:147], a[152:155], a[0:3], v[144:147]
ds_read_b64_tr_b16 a[228:229], v21 offset:57344
v_mfma_f32_16x16x32_bf16 v[160:163], a[160:163], a[0:3], v[160:163]
v_mfma_f32_16x16x32_bf16 v[160:163], a[164:167], a[4:7], v[160:163]
ds_read_b64_tr_b16 a[230:231], v21 offset:61440
v_mfma_f32_16x16x32_bf16 v[164:167], a[164:167], a[12:15], v[164:167]
v_mfma_f32_16x16x32_bf16 v[164:167], a[160:163], a[8:11], v[164:167]
ds_read_b64_tr_b16 a[232:233], v21 offset:49160
v_mfma_f32_16x16x32_bf16 v[168:171], a[160:163], a[16:19], v[168:171]
ds_read_b64_tr_b16 a[234:235], v21 offset:53256
v_mfma_f32_16x16x32_bf16 v[168:171], a[164:167], a[20:23], v[168:171]
s_add_u32 m0, s40, 49152
v_mfma_f32_16x16x32_bf16 v[172:175], a[164:167], a[28:31], v[172:175]
ds_read_b64_tr_b16 a[236:237], v21 offset:57352
v_mfma_f32_16x16x32_bf16 v[172:175], a[160:163], a[24:27], v[172:175]
v_mfma_f32_16x16x32_bf16 v[188:191], a[168:171], a[24:27], v[188:191]
ds_read_b64_tr_b16 a[238:239], v21 offset:61448
v_mfma_f32_16x16x32_bf16 v[188:191], a[172:175], a[28:31], v[188:191]
v_mfma_f32_16x16x32_bf16 v[184:187], a[172:175], a[20:23], v[184:187]
ds_read_b64_tr_b16 a[240:241], v22 offset:49152
v_mfma_f32_16x16x32_bf16 v[184:187], a[168:171], a[16:19], v[184:187]
ds_read_b64_tr_b16 a[242:243], v22 offset:53248
v_mfma_f32_16x16x32_bf16 v[180:183], a[168:171], a[8:11], v[180:183]
buffer_load_dwordx4 v14, s[4:7], s41 offen offset:0 lds
v_mfma_f32_16x16x32_bf16 v[180:183], a[172:175], a[12:15], v[180:183]
ds_read_b64_tr_b16 a[244:245], v22 offset:57344
v_mfma_f32_16x16x32_bf16 v[176:179], a[172:175], a[4:7], v[176:179]
v_mfma_f32_16x16x32_bf16 v[176:179], a[168:171], a[0:3], v[176:179]
ds_read_b64_tr_b16 a[246:247], v22 offset:61440
v_mfma_f32_16x16x32_bf16 v[192:195], a[176:179], a[0:3], v[192:195]
v_mfma_f32_16x16x32_bf16 v[192:195], a[180:183], a[4:7], v[192:195]
ds_read_b64_tr_b16 a[248:249], v22 offset:49160
v_mfma_f32_16x16x32_bf16 v[196:199], a[180:183], a[12:15], v[196:199]
ds_read_b64_tr_b16 a[250:251], v22 offset:53256
v_mfma_f32_16x16x32_bf16 v[196:199], a[176:179], a[8:11], v[196:199]
buffer_load_dwordx4 v15, s[4:7], s41 offen offset:1024 lds
v_mfma_f32_16x16x32_bf16 v[200:203], a[176:179], a[16:19], v[200:203]
ds_read_b64_tr_b16 a[252:253], v22 offset:57352
v_mfma_f32_16x16x32_bf16 v[200:203], a[180:183], a[20:23], v[200:203]
v_mfma_f32_16x16x32_bf16 v[204:207], a[180:183], a[28:31], v[204:207]
ds_read_b64_tr_b16 a[254:255], v22 offset:61448
v_mfma_f32_16x16x32_bf16 v[204:207], a[176:179], a[24:27], v[204:207]
v_mfma_f32_16x16x32_bf16 v[220:223], a[184:187], a[24:27], v[220:223]
buffer_load_dwordx4 v14, s[4:7], s41 offen offset:2048 lds
v_mfma_f32_16x16x32_bf16 v[220:223], a[188:191], a[28:31], v[220:223]
v_mfma_f32_16x16x32_bf16 v[216:219], a[188:191], a[20:23], v[216:219]
v_mfma_f32_16x16x32_bf16 v[216:219], a[184:187], a[16:19], v[216:219]
buffer_load_dwordx4 v15, s[4:7], s41 offen offset:3072 lds
s_add_u32 s41, s41, 16384
v_mfma_f32_16x16x32_bf16 v[212:215], a[184:187], a[8:11], v[212:215]
v_mfma_f32_16x16x32_bf16 v[212:215], a[188:191], a[12:15], v[212:215]
v_mfma_f32_16x16x32_bf16 v[208:211], a[188:191], a[4:7], v[208:211]
v_mfma_f32_16x16x32_bf16 v[208:211], a[184:187], a[0:3], v[208:211]
s_mov_b32 s100, 0x07060302
s_waitcnt vmcnt(25)
s_waitcnt vmcnt(17) lgkmcnt(0)
s_barrier
v_mfma_f32_16x16x32_bf16 v[96:99], a[192:195], a[32:35], v[96:99]
ds_read_b128 a[128:131], v2 offset:0
v_mfma_f32_16x16x32_bf16 v[96:99], a[196:199], a[36:39], v[96:99]
ds_read_b128 a[132:135], v3 offset:0
v_mfma_f32_16x16x32_bf16 v[112:115], a[204:207], a[36:39], v[112:115]
ds_read_b128 a[136:139], v4 offset:0
v_mfma_f32_16x16x32_bf16 v[112:115], a[200:203], a[32:35], v[112:115]
ds_read_b128 a[140:143], v5 offset:0
v_mfma_f32_16x16x32_bf16 v[128:131], a[208:211], a[32:35], v[128:131]
ds_read_b128 a[144:147], v2 offset:4096
v_mfma_f32_16x16x32_bf16 v[128:131], a[212:215], a[36:39], v[128:131]
ds_read_b128 a[148:151], v3 offset:4096
v_mfma_f32_16x16x32_bf16 v[144:147], a[220:223], a[36:39], v[144:147]
ds_read_b128 a[152:155], v4 offset:4096
v_mfma_f32_16x16x32_bf16 v[144:147], a[216:219], a[32:35], v[144:147]
ds_read_b128 a[156:159], v5 offset:4096
v_mfma_f32_16x16x32_bf16 v[160:163], a[224:227], a[32:35], v[160:163]
ds_read_b128 a[160:163], v2 offset:8192
v_mfma_f32_16x16x32_bf16 v[160:163], a[228:231], a[36:39], v[160:163]
ds_read_b128 a[164:167], v3 offset:8192
v_cvt_pk_bf16_f32 v32, v96, v97
v_mfma_f32_16x16x32_bf16 v[176:179], a[236:239], a[36:39], v[176:179]
ds_read_b128 a[168:171], v4 offset:8192
v_cvt_pk_bf16_f32 v33, v98, v99
v_mfma_f32_16x16x32_bf16 v[176:179], a[232:235], a[32:35], v[176:179]
ds_read_b128 a[172:175], v5 offset:8192
v_cvt_pk_bf16_f32 v34, v112, v113
v_mfma_f32_16x16x32_bf16 v[192:195], a[240:243], a[32:35], v[192:195]
ds_read_b128 a[176:179], v2 offset:12288
v_cvt_pk_bf16_f32 v35, v114, v115
v_mfma_f32_16x16x32_bf16 v[192:195], a[244:247], a[36:39], v[192:195]
ds_read_b128 a[180:183], v3 offset:12288
v_cvt_pk_bf16_f32 v36, v128, v129
v_mfma_f32_16x16x32_bf16 v[208:211], a[252:255], a[36:39], v[208:211]
ds_read_b128 a[184:187], v4 offset:12288
v_cvt_pk_bf16_f32 v37, v130, v131
v_mfma_f32_16x16x32_bf16 v[208:211], a[248:251], a[32:35], v[208:211]
ds_read_b128 a[188:191], v5 offset:12288
v_cvt_pk_bf16_f32 v38, v144, v145
v_mfma_f32_16x16x32_bf16 v[100:103], a[192:195], a[40:43], v[100:103]
ds_read_b128 a[64:67], v2 offset:16384
v_cvt_pk_bf16_f32 v39, v146, v147
v_mfma_f32_16x16x32_bf16 v[100:103], a[196:199], a[44:47], v[100:103]
ds_read_b128 a[68:71], v3 offset:16384
v_cvt_pk_bf16_f32 v40, v160, v161
v_mfma_f32_16x16x32_bf16 v[116:119], a[204:207], a[44:47], v[116:119]
ds_read_b128 a[72:75], v4 offset:16384
v_cvt_pk_bf16_f32 v41, v162, v163
v_mfma_f32_16x16x32_bf16 v[116:119], a[200:203], a[40:43], v[116:119]
ds_read_b128 a[76:79], v5 offset:16384
v_cvt_pk_bf16_f32 v42, v176, v177
v_mfma_f32_16x16x32_bf16 v[132:135], a[208:211], a[40:43], v[132:135]
ds_read_b128 a[80:83], v2 offset:20480
v_cvt_pk_bf16_f32 v43, v178, v179
v_mfma_f32_16x16x32_bf16 v[132:135], a[212:215], a[44:47], v[132:135]
ds_read_b128 a[84:87], v3 offset:20480
v_cvt_pk_bf16_f32 v44, v192, v193
v_mfma_f32_16x16x32_bf16 v[148:151], a[220:223], a[44:47], v[148:151]
ds_read_b128 a[88:91], v4 offset:20480
v_cvt_pk_bf16_f32 v45, v194, v195
v_mfma_f32_16x16x32_bf16 v[148:151], a[216:219], a[40:43], v[148:151]
ds_read_b128 a[92:95], v5 offset:20480
v_cvt_pk_bf16_f32 v46, v208, v209
v_mfma_f32_16x16x32_bf16 v[164:167], a[224:227], a[40:43], v[164:167]
ds_read_b128 a[96:99], v2 offset:24576
v_cvt_pk_bf16_f32 v47, v210, v211
v_mfma_f32_16x16x32_bf16 v[164:167], a[228:231], a[44:47], v[164:167]
ds_read_b128 a[100:103], v3 offset:24576
v_cvt_pk_bf16_f32 v48, v100, v101
v_mfma_f32_16x16x32_bf16 v[180:183], a[236:239], a[44:47], v[180:183]
ds_read_b128 a[104:107], v4 offset:24576
v_cvt_pk_bf16_f32 v49, v102, v103
v_mfma_f32_16x16x32_bf16 v[180:183], a[232:235], a[40:43], v[180:183]
ds_read_b128 a[108:111], v5 offset:24576
v_cvt_pk_bf16_f32 v50, v116, v117
v_mfma_f32_16x16x32_bf16 v[196:199], a[240:243], a[40:43], v[196:199]
ds_read_b128 a[112:115], v2 offset:28672
v_cvt_pk_bf16_f32 v51, v118, v119
v_mfma_f32_16x16x32_bf16 v[196:199], a[244:247], a[44:47], v[196:199]
ds_read_b128 a[116:119], v3 offset:28672
v_cvt_pk_bf16_f32 v52, v132, v133
v_mfma_f32_16x16x32_bf16 v[212:215], a[252:255], a[44:47], v[212:215]
ds_read_b128 a[120:123], v4 offset:28672
v_cvt_pk_bf16_f32 v53, v134, v135
v_mfma_f32_16x16x32_bf16 v[212:215], a[248:251], a[40:43], v[212:215]
ds_read_b128 a[124:127], v5 offset:28672
s_waitcnt lgkmcnt(15)
v_cvt_pk_bf16_f32 v54, v148, v149
v_mfma_f32_16x16x32_bf16 v[96:99], a[128:131], v[32:35], 0
s_add_u32 m0, s40, 81920
v_cvt_pk_bf16_f32 v55, v150, v151
v_mfma_f32_16x16x32_bf16 v[96:99], a[132:135], v[36:39], v[96:99]
v_cvt_pk_bf16_f32 v56, v164, v165
v_mfma_f32_16x16x32_bf16 v[96:99], a[136:139], v[40:43], v[96:99]
buffer_load_dwordx4 v14, s[8:11], s42 offen offset:0 lds
v_cvt_pk_bf16_f32 v57, v166, v167
v_mfma_f32_16x16x32_bf16 v[96:99], a[140:143], v[44:47], v[96:99]
v_cvt_pk_bf16_f32 v58, v180, v181
v_mfma_f32_16x16x32_bf16 v[104:107], a[192:195], a[48:51], v[104:107]
buffer_load_dwordx4 v15, s[8:11], s42 offen offset:1024 lds
v_cvt_pk_bf16_f32 v59, v182, v183
v_mfma_f32_16x16x32_bf16 v[104:107], a[196:199], a[52:55], v[104:107]
v_cvt_pk_bf16_f32 v60, v196, v197
v_mfma_f32_16x16x32_bf16 v[120:123], a[204:207], a[52:55], v[120:123]
buffer_load_dwordx4 v14, s[8:11], s42 offen offset:2048 lds
v_cvt_pk_bf16_f32 v61, v198, v199
v_mfma_f32_16x16x32_bf16 v[120:123], a[200:203], a[48:51], v[120:123]
v_cvt_pk_bf16_f32 v62, v212, v213
v_mfma_f32_16x16x32_bf16 v[136:139], a[208:211], a[48:51], v[136:139]
buffer_load_dwordx4 v15, s[8:11], s42 offen offset:3072 lds
s_add_u32 s42, s42, 16384
v_cvt_pk_bf16_f32 v63, v214, v215
v_mfma_f32_16x16x32_bf16 v[136:139], a[212:215], a[52:55], v[136:139]
s_waitcnt lgkmcnt(0)
s_barrier
v_mfma_f32_16x16x32_bf16 v[152:155], a[220:223], a[52:55], v[152:155]
v_mfma_f32_16x16x32_bf16 v[152:155], a[216:219], a[48:51], v[152:155]
s_add_u32 m0, s40, 0
v_max3_f32 v224, v96, v97, v98
v_mfma_f32_16x16x32_bf16 v[168:171], a[224:227], a[48:51], v[168:171]
v_max_f32 v224, v224, v99
v_mfma_f32_16x16x32_bf16 v[168:171], a[228:231], a[52:55], v[168:171]
v_mov_b32 v225, v224
v_cvt_pk_bf16_f32 v64, v104, v105
v_mfma_f32_16x16x32_bf16 v[184:187], a[236:239], a[52:55], v[184:187]
v_cvt_pk_bf16_f32 v65, v106, v107
v_mfma_f32_16x16x32_bf16 v[184:187], a[232:235], a[48:51], v[184:187]
buffer_load_dwordx4 v14, s[4:7], s41 offen offset:0 lds
v_permlane16_swap_b32 v225, v224
v_cvt_pk_bf16_f32 v66, v120, v121
v_mfma_f32_16x16x32_bf16 v[200:203], a[240:243], a[48:51], v[200:203]
v_cvt_pk_bf16_f32 v67, v122, v123
v_mfma_f32_16x16x32_bf16 v[200:203], a[244:247], a[52:55], v[200:203]
v_max_f32 v224, v224, v225
v_cvt_pk_bf16_f32 v68, v136, v137
v_mfma_f32_16x16x32_bf16 v[216:219], a[252:255], a[52:55], v[216:219]
v_mov_b32 v225, v224
v_cvt_pk_bf16_f32 v69, v138, v139
v_mfma_f32_16x16x32_bf16 v[216:219], a[248:251], a[48:51], v[216:219]
buffer_load_dwordx4 v15, s[4:7], s41 offen offset:1024 lds
v_cvt_pk_bf16_f32 v70, v152, v153
v_mfma_f32_16x16x32_bf16 v[100:103], a[128:131], v[48:51], 0
v_permlane32_swap_b32 v225, v224
v_cvt_pk_bf16_f32 v71, v154, v155
v_mfma_f32_16x16x32_bf16 v[100:103], a[132:135], v[52:55], v[100:103]
v_cvt_pk_bf16_f32 v72, v168, v169
v_mfma_f32_16x16x32_bf16 v[100:103], a[136:139], v[56:59], v[100:103]
v_max_f32 v224, v224, v225
v_cvt_pk_bf16_f32 v73, v170, v171
v_mfma_f32_16x16x32_bf16 v[100:103], a[140:143], v[60:63], v[100:103]
buffer_load_dwordx4 v14, s[4:7], s41 offen offset:2048 lds
v_sub_f32 v224, 0, v224
v_cvt_pk_bf16_f32 v74, v184, v185
v_mfma_f32_16x16x32_bf16 v[108:111], a[192:195], a[56:59], v[108:111]
v_mov_b32 v225, v224
v_cvt_pk_bf16_f32 v75, v186, v187
v_mfma_f32_16x16x32_bf16 v[108:111], a[196:199], a[60:63], v[108:111]
v_mov_b32 v226, v224
v_cvt_pk_bf16_f32 v76, v200, v201
v_mfma_f32_16x16x32_bf16 v[124:127], a[204:207], a[60:63], v[124:127]
v_mov_b32 v227, v224
v_cvt_pk_bf16_f32 v77, v202, v203
v_mfma_f32_16x16x32_bf16 v[124:127], a[200:203], a[56:59], v[124:127]
buffer_load_dwordx4 v15, s[4:7], s41 offen offset:3072 lds
s_add_u32 s41, s41, 16384
v_cvt_pk_bf16_f32 v78, v216, v217
v_mfma_f32_16x16x32_bf16 v[140:143], a[208:211], a[56:59], v[140:143]
v_cvt_pk_bf16_f32 v79, v218, v219
v_mfma_f32_16x16x32_bf16 v[140:143], a[212:215], a[60:63], v[140:143]
v_mfma_f32_16x16x32_bf16 v[156:159], a[220:223], a[60:63], v[156:159]
v_mfma_f32_16x16x32_bf16 v[156:159], a[216:219], a[56:59], v[156:159]
s_add_u32 m0, s40, 98304
v_max3_f32 v228, v100, v101, v102
v_mfma_f32_16x16x32_bf16 v[172:175], a[224:227], a[56:59], v[172:175]
v_max_f32 v228, v228, v103
v_mfma_f32_16x16x32_bf16 v[172:175], a[228:231], a[60:63], v[172:175]
v_mov_b32 v229, v228
v_cvt_pk_bf16_f32 v80, v108, v109
v_mfma_f32_16x16x32_bf16 v[188:191], a[236:239], a[60:63], v[188:191]
v_cvt_pk_bf16_f32 v81, v110, v111
v_mfma_f32_16x16x32_bf16 v[188:191], a[232:235], a[56:59], v[188:191]
buffer_load_dwordx4 v14, s[8:11], s42 offen offset:0 lds
v_permlane16_swap_b32 v229, v228
v_cvt_pk_bf16_f32 v82, v124, v125
v_mfma_f32_16x16x32_bf16 v[204:207], a[240:243], a[56:59], v[204:207]
v_cvt_pk_bf16_f32 v83, v126, v127
v_mfma_f32_16x16x32_bf16 v[204:207], a[244:247], a[60:63], v[204:207]
v_max_f32 v228, v228, v229
v_cvt_pk_bf16_f32 v84, v140, v141
v_mfma_f32_16x16x32_bf16 v[220:223], a[252:255], a[60:63], v[220:223]
v_mov_b32 v229, v228
v_cvt_pk_bf16_f32 v85, v142, v143
v_mfma_f32_16x16x32_bf16 v[220:223], a[248:251], a[56:59], v[220:223]
buffer_load_dwordx4 v15, s[8:11], s42 offen offset:1024 lds
v_cvt_pk_bf16_f32 v86, v156, v157
v_mfma_f32_16x16x32_bf16 v[104:107], a[128:131], v[64:67], 0
v_permlane32_swap_b32 v229, v228
v_cvt_pk_bf16_f32 v87, v158, v159
v_mfma_f32_16x16x32_bf16 v[104:107], a[132:135], v[68:71], v[104:107]
v_cvt_pk_bf16_f32 v88, v172, v173
v_mfma_f32_16x16x32_bf16 v[104:107], a[136:139], v[72:75], v[104:107]
v_max_f32 v228, v228, v229
v_cvt_pk_bf16_f32 v89, v174, v175
v_mfma_f32_16x16x32_bf16 v[104:107], a[140:143], v[76:79], v[104:107]
buffer_load_dwordx4 v14, s[8:11], s42 offen offset:2048 lds
v_sub_f32 v228, 0, v228
v_cvt_pk_bf16_f32 v90, v188, v189
v_mfma_f32_16x16x32_bf16 v[96:99], a[128:131], v[32:35], v[224:227]
v_mov_b32 v229, v228
v_cvt_pk_bf16_f32 v91, v190, v191
v_mfma_f32_16x16x32_bf16 v[96:99], a[132:135], v[36:39], v[96:99]
v_mov_b32 v230, v228
v_cvt_pk_bf16_f32 v92, v204, v205
v_mfma_f32_16x16x32_bf16 v[96:99], a[136:139], v[40:43], v[96:99]
v_mov_b32 v231, v228
v_cvt_pk_bf16_f32 v93, v206, v207
v_mfma_f32_16x16x32_bf16 v[96:99], a[140:143], v[44:47], v[96:99]
buffer_load_dwordx4 v15, s[8:11], s42 offen offset:3072 lds
s_add_u32 s42, s42, 16384
v_cvt_pk_bf16_f32 v94, v220, v221
v_mfma_f32_16x16x32_bf16 v[112:115], a[144:147], v[32:35], v[224:227]
v_cvt_pk_bf16_f32 v95, v222, v223
v_mfma_f32_16x16x32_bf16 v[112:115], a[148:151], v[36:39], v[112:115]
v_mfma_f32_16x16x32_bf16 v[112:115], a[152:155], v[40:43], v[112:115]
v_mfma_f32_16x16x32_bf16 v[112:115], a[156:159], v[44:47], v[112:115]
v_max3_f32 v232, v104, v105, v106
v_mfma_f32_16x16x32_bf16 v[128:131], a[160:163], v[32:35], v[224:227]
v_max_f32 v232, v232, v107
v_mfma_f32_16x16x32_bf16 v[128:131], a[164:167], v[36:39], v[128:131]
v_mov_b32 v233, v232
v_mfma_f32_16x16x32_bf16 v[128:131], a[168:171], v[40:43], v[128:131]
v_mfma_f32_16x16x32_bf16 v[128:131], a[172:175], v[44:47], v[128:131]
v_permlane16_swap_b32 v233, v232
v_mfma_f32_16x16x32_bf16 v[144:147], a[176:179], v[32:35], v[224:227]
v_exp_f32 v96, v96
v_mfma_f32_16x16x32_bf16 v[144:147], a[180:183], v[36:39], v[144:147]
v_max_f32 v232, v232, v233
v_mfma_f32_16x16x32_bf16 v[144:147], a[184:187], v[40:43], v[144:147]
v_mov_b32 v233, v232
v_mfma_f32_16x16x32_bf16 v[144:147], a[188:191], v[44:47], v[144:147]
v_exp_f32 v97, v97
v_mfma_f32_16x16x32_bf16 v[108:111], a[128:131], v[80:83], 0
v_permlane32_swap_b32 v233, v232
v_cvt_pk_bf16_f32 v160, v96, v97
v_mfma_f32_16x16x32_bf16 v[108:111], a[132:135], v[84:87], v[108:111]
v_exp_f32 v98, v98
v_mfma_f32_16x16x32_bf16 v[108:111], a[136:139], v[88:91], v[108:111]
v_max_f32 v232, v232, v233
v_mfma_f32_16x16x32_bf16 v[108:111], a[140:143], v[92:95], v[108:111]
v_sub_f32 v232, 0, v232
v_mfma_f32_16x16x32_bf16 v[100:103], a[128:131], v[48:51], v[228:231]
v_mov_b32 v233, v232
v_mfma_f32_16x16x32_bf16 v[100:103], a[132:135], v[52:55], v[100:103]
v_mov_b32 v234, v232
v_mfma_f32_16x16x32_bf16 v[100:103], a[136:139], v[56:59], v[100:103]
v_mov_b32 v235, v232
v_mfma_f32_16x16x32_bf16 v[100:103], a[140:143], v[60:63], v[100:103]
v_exp_f32 v99, v99
v_mfma_f32_16x16x32_bf16 v[116:119], a[144:147], v[48:51], v[228:231]
v_exp_f32 v112, v112
v_mfma_f32_16x16x32_bf16 v[116:119], a[148:151], v[52:55], v[116:119]
v_exp_f32 v113, v113
v_mfma_f32_16x16x32_bf16 v[116:119], a[152:155], v[56:59], v[116:119]
v_cvt_pk_bf16_f32 v161, v98, v99
v_cvt_pk_bf16_f32 v162, v112, v113
v_mfma_f32_16x16x32_bf16 v[116:119], a[156:159], v[60:63], v[116:119]
v_max3_f32 v236, v108, v109, v110
v_mfma_f32_16x16x32_bf16 v[132:135], a[160:163], v[48:51], v[228:231]
v_max_f32 v236, v236, v111
v_mfma_f32_16x16x32_bf16 v[132:135], a[164:167], v[52:55], v[132:135]
v_mov_b32 v237, v236
v_mfma_f32_16x16x32_bf16 v[132:135], a[168:171], v[56:59], v[132:135]
v_exp_f32 v114, v114
v_mfma_f32_16x16x32_bf16 v[132:135], a[172:175], v[60:63], v[132:135]
v_permlane16_swap_b32 v237, v236
v_mfma_f32_16x16x32_bf16 v[148:151], a[176:179], v[48:51], v[228:231]
v_exp_f32 v115, v115
v_mfma_f32_16x16x32_bf16 v[148:151], a[180:183], v[52:55], v[148:151]
v_max_f32 v236, v236, v237
v_cvt_pk_bf16_f32 v163, v114, v115
v_mfma_f32_16x16x32_bf16 v[148:151], a[184:187], v[56:59], v[148:151]
v_mov_b32 v237, v236
v_mfma_f32_16x16x32_bf16 v[148:151], a[188:191], v[60:63], v[148:151]
v_exp_f32 v128, v128
v_mfma_f32_16x16x32_bf16 v[104:107], a[128:131], v[64:67], v[232:235]
v_permlane32_swap_b32 v237, v236
v_mfma_f32_16x16x32_bf16 v[104:107], a[132:135], v[68:71], v[104:107]
v_exp_f32 v129, v129
v_mfma_f32_16x16x32_bf16 v[104:107], a[136:139], v[72:75], v[104:107]
v_max_f32 v236, v236, v237
v_cvt_pk_bf16_f32 v164, v128, v129
v_mfma_f32_16x16x32_bf16 v[104:107], a[140:143], v[76:79], v[104:107]
v_sub_f32 v236, 0, v236
v_mfma_f32_16x16x32_bf16 v[120:123], a[144:147], v[64:67], v[232:235]
v_mov_b32 v237, v236
v_mfma_f32_16x16x32_bf16 v[120:123], a[148:151], v[68:71], v[120:123]
v_mov_b32 v238, v236
v_mfma_f32_16x16x32_bf16 v[120:123], a[152:155], v[72:75], v[120:123]
v_mov_b32 v239, v236
v_mfma_f32_16x16x32_bf16 v[120:123], a[156:159], v[76:79], v[120:123]
v_exp_f32 v130, v130
v_mfma_f32_16x16x32_bf16 v[136:139], a[160:163], v[64:67], v[232:235]
v_exp_f32 v131, v131
v_mfma_f32_16x16x32_bf16 v[136:139], a[164:167], v[68:71], v[136:139]
v_exp_f32 v144, v144
v_mfma_f32_16x16x32_bf16 v[136:139], a[168:171], v[72:75], v[136:139]
v_exp_f32 v145, v145
v_mfma_f32_16x16x32_bf16 v[136:139], a[172:175], v[76:79], v[136:139]
v_cvt_pk_bf16_f32 v165, v130, v131
v_cvt_pk_bf16_f32 v166, v144, v145
v_mfma_f32_16x16x32_bf16 v[152:155], a[176:179], v[64:67], v[232:235]
v_exp_f32 v146, v146
v_mfma_f32_16x16x32_bf16 v[152:155], a[180:183], v[68:71], v[152:155]
v_exp_f32 v147, v147
v_mfma_f32_16x16x32_bf16 v[152:155], a[184:187], v[72:75], v[152:155]
v_exp_f32 v100, v100
v_mfma_f32_16x16x32_bf16 v[152:155], a[188:191], v[76:79], v[152:155]
v_exp_f32 v101, v101
v_mfma_f32_16x16x32_bf16 v[108:111], a[128:131], v[80:83], v[236:239]
v_cvt_pk_bf16_f32 v167, v146, v147
v_cvt_pk_bf16_f32 v168, v100, v101
v_mfma_f32_16x16x32_bf16 v[108:111], a[132:135], v[84:87], v[108:111]
v_exp_f32 v102, v102
v_mfma_f32_16x16x32_bf16 v[108:111], a[136:139], v[88:91], v[108:111]
v_exp_f32 v103, v103
v_mfma_f32_16x16x32_bf16 v[108:111], a[140:143], v[92:95], v[108:111]
v_exp_f32 v116, v116
v_mfma_f32_16x16x32_bf16 v[124:127], a[144:147], v[80:83], v[236:239]
v_exp_f32 v117, v117
v_mfma_f32_16x16x32_bf16 v[124:127], a[148:151], v[84:87], v[124:127]
v_cvt_pk_bf16_f32 v169, v102, v103
v_cvt_pk_bf16_f32 v170, v116, v117
v_mfma_f32_16x16x32_bf16 v[124:127], a[152:155], v[88:91], v[124:127]
v_exp_f32 v118, v118
v_mfma_f32_16x16x32_bf16 v[124:127], a[156:159], v[92:95], v[124:127]
v_exp_f32 v119, v119
v_mfma_f32_16x16x32_bf16 v[140:143], a[160:163], v[80:83], v[236:239]
v_exp_f32 v132, v132
v_mfma_f32_16x16x32_bf16 v[140:143], a[164:167], v[84:87], v[140:143]
v_exp_f32 v133, v133
v_mfma_f32_16x16x32_bf16 v[140:143], a[168:171], v[88:91], v[140:143]
v_cvt_pk_bf16_f32 v171, v118, v119
v_cvt_pk_bf16_f32 v172, v132, v133
v_mfma_f32_16x16x32_bf16 v[140:143], a[172:175], v[92:95], v[140:143]
v_exp_f32 v134, v134
v_mfma_f32_16x16x32_bf16 v[156:159], a[176:179], v[80:83], v[236:239]
v_exp_f32 v135, v135
v_mfma_f32_16x16x32_bf16 v[156:159], a[180:183], v[84:87], v[156:159]
v_exp_f32 v148, v148
v_mfma_f32_16x16x32_bf16 v[156:159], a[184:187], v[88:91], v[156:159]
v_exp_f32 v149, v149
v_mfma_f32_16x16x32_bf16 v[156:159], a[188:191], v[92:95], v[156:159]
v_cvt_pk_bf16_f32 v173, v134, v135
v_cvt_pk_bf16_f32 v174, v148, v149
v_exp_f32 v150, v150
v_exp_f32 v151, v151
v_exp_f32 v104, v104
v_exp_f32 v105, v105
v_exp_f32 v106, v106
v_exp_f32 v107, v107
v_exp_f32 v120, v120
v_exp_f32 v121, v121
v_exp_f32 v122, v122
v_exp_f32 v123, v123
v_exp_f32 v136, v136
v_exp_f32 v137, v137
v_exp_f32 v138, v138
v_exp_f32 v139, v139
v_exp_f32 v152, v152
v_exp_f32 v153, v153
v_exp_f32 v154, v154
v_exp_f32 v155, v155
v_exp_f32 v108, v108
v_exp_f32 v109, v109
v_exp_f32 v110, v110
v_exp_f32 v111, v111
v_exp_f32 v124, v124
v_exp_f32 v125, v125
v_exp_f32 v126, v126
v_exp_f32 v127, v127
v_exp_f32 v140, v140
v_exp_f32 v141, v141
v_exp_f32 v142, v142
v_exp_f32 v143, v143
v_exp_f32 v156, v156
v_cvt_pk_bf16_f32 v175, v150, v151
v_cvt_pk_bf16_f32 v176, v104, v105
v_cvt_pk_bf16_f32 v177, v106, v107
v_cvt_pk_bf16_f32 v178, v120, v121
v_cvt_pk_bf16_f32 v179, v122, v123
v_cvt_pk_bf16_f32 v180, v136, v137
v_cvt_pk_bf16_f32 v181, v138, v139
v_cvt_pk_bf16_f32 v182, v152, v153
v_cvt_pk_bf16_f32 v183, v154, v155
v_cvt_pk_bf16_f32 v184, v108, v109
v_cvt_pk_bf16_f32 v185, v110, v111
v_cvt_pk_bf16_f32 v186, v124, v125
v_cvt_pk_bf16_f32 v187, v126, v127
v_cvt_pk_bf16_f32 v188, v140, v141
v_cvt_pk_bf16_f32 v189, v142, v143
s_waitcnt vmcnt(16)
s_barrier
s_cmp_lg_u32 s45, 0
s_cbranch_scc1 K_truemax
K_it0:
v_mfma_f32_16x16x32_bf16 v[96:99], a[64:67], v[32:35], v[224:227]
v_exp_f32 v157, v157
v_mfma_f32_16x16x32_bf16 v[96:99], a[68:71], v[36:39], v[96:99]
ds_read_b64_tr_b16 a[192:193], v6 offset:0
v_cvt_pk_bf16_f32 v190, v156, v157
v_mfma_f32_16x16x32_bf16 v[96:99], a[72:75], v[40:43], v[96:99]
v_exp_f32 v158, v158
v_mfma_f32_16x16x32_bf16 v[96:99], a[76:79], v[44:47], v[96:99]
ds_read_b64_tr_b16 a[194:195], v6 offset:4096
ds_read_b64_tr_b16 a[128:129], v25 offset:0
v_mfma_f32_16x16x32_bf16 v[100:103], a[76:79], v[60:63], v[228:231]
v_exp_f32 v159, v159
v_mfma_f32_16x16x32_bf16 v[100:103], a[72:75], v[56:59], v[100:103]
ds_read_b64_tr_b16 a[196:197], v6 offset:8192
v_cvt_pk_bf16_f32 v191, v158, v159
v_mfma_f32_16x16x32_bf16 v[100:103], a[68:71], v[52:55], v[100:103]
s_add_u32 m0, s40, 16384
ds_read_b64_tr_b16 a[130:131], v25 offset:2560
ds_read_b64_tr_b16 a[132:133], v25 offset:32
v_mfma_f32_16x16x32_bf16 v[100:103], a[64:67], v[48:51], v[100:103]
ds_read_b64_tr_b16 a[198:199], v6 offset:12288
ds_read_b64_tr_b16 a[134:135], v25 offset:2592
v_mfma_f32_16x16x32_bf16 v[104:107], a[64:67], v[64:67], v[232:235]
s_sub_u32 s101, s101, 5120
ds_read_b64_tr_b16 a[136:137], v25 offset:64
ds_read_b64_tr_b16 a[138:139], v25 offset:2624
v_mfma_f32_16x16x32_bf16 v[104:107], a[68:71], v[68:71], v[104:107]
ds_read_b64_tr_b16 a[200:201], v7 offset:0
ds_read_b64_tr_b16 a[140:141], v25 offset:96
v_mfma_f32_16x16x32_bf16 v[104:107], a[72:75], v[72:75], v[104:107]
v_exp_f32 v96, v96
v_mfma_f32_16x16x32_bf16 v[104:107], a[76:79], v[76:79], v[104:107]
ds_read_b64_tr_b16 a[202:203], v7 offset:4096
ds_read_b64_tr_b16 a[142:143], v25 offset:2656
v_mfma_f32_16x16x32_bf16 v[108:111], a[76:79], v[92:95], v[236:239]
v_exp_f32 v97, v97
v_mfma_f32_16x16x32_bf16 v[108:111], a[72:75], v[88:91], v[108:111]
ds_read_b64_tr_b16 a[204:205], v7 offset:8192
v_cvt_pk_bf16_f32 v192, v96, v97
v_mfma_f32_16x16x32_bf16 v[108:111], a[68:71], v[84:87], v[108:111]
v_exp_f32 v98, v98
v_mfma_f32_16x16x32_bf16 v[108:111], a[64:67], v[80:83], v[108:111]
ds_read_b64_tr_b16 a[206:207], v7 offset:12288
ds_read_b64_tr_b16 a[144:145], v25 offset:128
v_mfma_f32_16x16x32_bf16 v[112:115], a[80:83], v[32:35], v[224:227]
v_exp_f32 v99, v99
v_mfma_f32_16x16x32_bf16 v[112:115], a[84:87], v[36:39], v[112:115]
ds_read_b64_tr_b16 a[208:209], v8 offset:0
v_cvt_pk_bf16_f32 v193, v98, v99
v_mfma_f32_16x16x32_bf16 v[112:115], a[88:91], v[40:43], v[112:115]
v_exp_f32 v100, v100
v_mfma_f32_16x16x32_bf16 v[112:115], a[92:95], v[44:47], v[112:115]
ds_read_b64_tr_b16 a[210:211], v8 offset:4096
ds_read_b64_tr_b16 a[146:147], v25 offset:2688
v_mfma_f32_16x16x32_bf16 v[116:119], a[92:95], v[60:63], v[228:231]
v_exp_f32 v101, v101
v_mfma_f32_16x16x32_bf16 v[116:119], a[88:91], v[56:59], v[116:119]
ds_read_b64_tr_b16 a[212:213], v8 offset:8192
v_cvt_pk_bf16_f32 v200, v100, v101
v_mfma_f32_16x16x32_bf16 v[116:119], a[84:87], v[52:55], v[116:119]
K_pg3:
s_cbranch_execz K_pg6
v_exp_f32 v102, v102
v_mfma_f32_16x16x32_bf16 v[116:119], a[80:83], v[48:51], v[116:119]
ds_read_b64_tr_b16 a[214:215], v8 offset:12288
s_waitcnt lgkmcnt(2)
v_mfma_f32_16x16x32_bf16 v[120:123], a[80:83], v[64:67], v[232:235]
v_exp_f32 v103, v103
v_mfma_f32_16x16x32_bf16 v[120:123], a[84:87], v[68:71], v[120:123]
ds_read_b64_tr_b16 a[216:217], v9 offset:0
v_cvt_pk_bf16_f32 v201, v102, v103
v_mfma_f32_16x16x32_bf16 v[120:123], a[88:91], v[72:75], v[120:123]
v_exp_f32 v104, v104
v_mfma_f32_16x16x32_bf16 v[120:123], a[92:95], v[76:79], v[120:123]
ds_read_b64_tr_b16 a[218:219], v9 offset:4096
buffer_store_dwordx4 a[128:131], v23, s[16:19], s77 offen sc1
v_mfma_f32_16x16x32_bf16 v[124:127], a[92:95], v[92:95], v[236:239]
v_exp_f32 v105, v105
v_mfma_f32_16x16x32_bf16 v[124:127], a[88:91], v[88:91], v[124:127]
ds_read_b64_tr_b16 a[220:221], v9 offset:8192
v_cvt_pk_bf16_f32 v208, v104, v105
v_mfma_f32_16x16x32_bf16 v[124:127], a[84:87], v[84:87], v[124:127]
v_exp_f32 v106, v106
v_mfma_f32_16x16x32_bf16 v[124:127], a[80:83], v[80:83], v[124:127]
ds_read_b64_tr_b16 a[222:223], v9 offset:12288
s_add_u32 s77, s77, 135424
v_mfma_f32_16x16x32_bf16 v[128:131], a[96:99], v[32:35], v[224:227]
v_exp_f32 v107, v107
v_mfma_f32_16x16x32_bf16 v[128:131], a[100:103], v[36:39], v[128:131]
ds_read_b64_tr_b16 a[224:225], v10 offset:0
v_cvt_pk_bf16_f32 v209, v106, v107
v_mfma_f32_16x16x32_bf16 v[128:131], a[104:107], v[40:43], v[128:131]
v_exp_f32 v108, v108
v_mfma_f32_16x16x32_bf16 v[128:131], a[108:111], v[44:47], v[128:131]
ds_read_b64_tr_b16 a[226:227], v10 offset:4096
buffer_store_dwordx4 a[132:135], v23, s[16:19], s77 offen sc1
v_mfma_f32_16x16x32_bf16 v[132:135], a[108:111], v[60:63], v[228:231]
v_exp_f32 v109, v109
v_mfma_f32_16x16x32_bf16 v[132:135], a[104:107], v[56:59], v[132:135]
ds_read_b64_tr_b16 a[228:229], v10 offset:8192
v_cvt_pk_bf16_f32 v216, v108, v109
v_mfma_f32_16x16x32_bf16 v[132:135], a[100:103], v[52:55], v[132:135]
v_exp_f32 v110, v110
v_mfma_f32_16x16x32_bf16 v[132:135], a[96:99], v[48:51], v[132:135]
ds_read_b64_tr_b16 a[230:231], v10 offset:12288
s_add_u32 s77, s77, 135424
v_mfma_f32_16x16x32_bf16 v[136:139], a[96:99], v[64:67], v[232:235]
v_exp_f32 v111, v111
v_mfma_f32_16x16x32_bf16 v[136:139], a[100:103], v[68:71], v[136:139]
ds_read_b64_tr_b16 a[232:233], v11 offset:0
v_cvt_pk_bf16_f32 v217, v110, v111
v_mfma_f32_16x16x32_bf16 v[136:139], a[104:107], v[72:75], v[136:139]
v_exp_f32 v112, v112
v_mfma_f32_16x16x32_bf16 v[136:139], a[108:111], v[76:79], v[136:139]
ds_read_b64_tr_b16 a[234:235], v11 offset:4096
buffer_store_dwordx4 a[136:139], v23, s[16:19], s77 offen sc1
v_mfma_f32_16x16x32_bf16 v[140:143], a[108:111], v[92:95], v[236:239]
v_exp_f32 v113, v113
v_mfma_f32_16x16x32_bf16 v[140:143], a[104:107], v[88:91], v[140:143]
ds_read_b64_tr_b16 a[236:237], v11 offset:8192
v_cvt_pk_bf16_f32 v194, v112, v113
v_mfma_f32_16x16x32_bf16 v[140:143], a[100:103], v[84:87], v[140:143]
v_exp_f32 v114, v114
v_mfma_f32_16x16x32_bf16 v[140:143], a[96:99], v[80:83], v[140:143]
ds_read_b64_tr_b16 a[238:239], v11 offset:12288
s_add_u32 s77, s77, 135424
v_mfma_f32_16x16x32_bf16 v[144:147], a[112:115], v[32:35], v[224:227]
v_exp_f32 v115, v115
v_mfma_f32_16x16x32_bf16 v[144:147], a[116:119], v[36:39], v[144:147]
ds_read_b64_tr_b16 a[240:241], v12 offset:0
v_cvt_pk_bf16_f32 v195, v114, v115
v_mfma_f32_16x16x32_bf16 v[144:147], a[120:123], v[40:43], v[144:147]
v_exp_f32 v116, v116
v_mfma_f32_16x16x32_bf16 v[144:147], a[124:127], v[44:47], v[144:147]
ds_read_b64_tr_b16 a[242:243], v12 offset:4096
buffer_store_dwordx4 a[140:143], v23, s[16:19], s77 offen sc1
v_mfma_f32_16x16x32_bf16 v[148:151], a[124:127], v[60:63], v[228:231]
v_exp_f32 v117, v117
v_mfma_f32_16x16x32_bf16 v[148:151], a[120:123], v[56:59], v[148:151]
ds_read_b64_tr_b16 a[244:245], v12 offset:8192
v_cvt_pk_bf16_f32 v202, v116, v117
v_mfma_f32_16x16x32_bf16 v[148:151], a[116:119], v[52:55], v[148:151]
v_exp_f32 v118, v118
v_mfma_f32_16x16x32_bf16 v[148:151], a[112:115], v[48:51], v[148:151]
ds_read_b64_tr_b16 a[246:247], v12 offset:12288
s_add_u32 s77, s77, 135424
v_mfma_f32_16x16x32_bf16 v[152:155], a[112:115], v[64:67], v[232:235]
v_exp_f32 v119, v119
v_mfma_f32_16x16x32_bf16 v[152:155], a[116:119], v[68:71], v[152:155]
ds_read_b64_tr_b16 a[248:249], v13 offset:0
v_cvt_pk_bf16_f32 v203, v118, v119
v_mfma_f32_16x16x32_bf16 v[152:155], a[120:123], v[72:75], v[152:155]
v_exp_f32 v120, v120
v_mfma_f32_16x16x32_bf16 v[152:155], a[124:127], v[76:79], v[152:155]
ds_read_b64_tr_b16 a[250:251], v13 offset:4096
buffer_store_dwordx4 a[144:147], v23, s[16:19], s77 offen sc1
v_mfma_f32_16x16x32_bf16 v[156:159], a[124:127], v[92:95], v[236:239]
v_exp_f32 v121, v121
v_mfma_f32_16x16x32_bf16 v[156:159], a[120:123], v[88:91], v[156:159]
ds_read_b64_tr_b16 a[252:253], v13 offset:8192
v_cvt_pk_bf16_f32 v210, v120, v121
v_mfma_f32_16x16x32_bf16 v[156:159], a[116:119], v[84:87], v[156:159]
v_exp_f32 v122, v122
v_mfma_f32_16x16x32_bf16 v[156:159], a[112:115], v[80:83], v[156:159]
ds_read_b64_tr_b16 a[254:255], v13 offset:12288
s_waitcnt lgkmcnt(8)
v_mfma_f32_16x16x32_bf16 a[0:3], v[160:163], a[192:195], 0
v_exp_f32 v123, v123
v_mfma_f32_16x16x32_bf16 a[0:3], v[164:167], a[196:199], a[0:3]
ds_read_b128 a[128:131], v2 offset:32768
v_cvt_pk_bf16_f32 v211, v122, v123
v_mfma_f32_16x16x32_bf16 a[4:7], v[172:175], a[196:199], 0
v_exp_f32 v124, v124
v_mfma_f32_16x16x32_bf16 a[4:7], v[168:171], a[192:195], a[4:7]
buffer_load_dwordx4 v14, s[4:7], s41 offen offset:0 lds
v_mfma_f32_16x16x32_bf16 a[8:11], v[176:179], a[192:195], 0
v_exp_f32 v125, v125
v_mfma_f32_16x16x32_bf16 a[8:11], v[180:183], a[196:199], a[8:11]
ds_read_b128 a[132:135], v3 offset:32768
v_cvt_pk_bf16_f32 v218, v124, v125
v_mfma_f32_16x16x32_bf16 a[12:15], v[188:191], a[196:199], 0
v_exp_f32 v126, v126
v_mfma_f32_16x16x32_bf16 a[12:15], v[184:187], a[192:195], a[12:15]
ds_read_b128 a[136:139], v4 offset:32768
v_mfma_f32_16x16x32_bf16 a[28:31], v[184:187], a[200:203], 0
v_exp_f32 v127, v127
v_mfma_f32_16x16x32_bf16 a[28:31], v[188:191], a[204:207], a[28:31]
ds_read_b128 a[140:143], v5 offset:32768
v_cvt_pk_bf16_f32 v219, v126, v127
v_mfma_f32_16x16x32_bf16 a[24:27], v[180:183], a[204:207], 0
v_exp_f32 v128, v128
v_mfma_f32_16x16x32_bf16 a[24:27], v[176:179], a[200:203], a[24:27]
buffer_load_dwordx4 v15, s[4:7], s41 offen offset:1024 lds
s_waitcnt lgkmcnt(4)
v_mfma_f32_16x16x32_bf16 a[20:23], v[168:171], a[200:203], 0
v_exp_f32 v129, v129
v_mfma_f32_16x16x32_bf16 a[20:23], v[172:175], a[204:207], a[20:23]
ds_read_b128 a[144:147], v2 offset:36864
v_cvt_pk_bf16_f32 v196, v128, v129
v_mfma_f32_16x16x32_bf16 a[16:19], v[164:167], a[204:207], 0
v_exp_f32 v130, v130
v_mfma_f32_16x16x32_bf16 a[16:19], v[160:163], a[200:203], a[16:19]
ds_read_b128 a[148:151], v3 offset:36864
v_mfma_f32_16x16x32_bf16 a[32:35], v[160:163], a[208:211], 0
v_exp_f32 v131, v131
v_mfma_f32_16x16x32_bf16 a[32:35], v[164:167], a[212:215], a[32:35]
ds_read_b128 a[152:155], v4 offset:36864
v_cvt_pk_bf16_f32 v197, v130, v131
v_mfma_f32_16x16x32_bf16 a[36:39], v[172:175], a[212:215], 0
v_exp_f32 v132, v132
v_mfma_f32_16x16x32_bf16 a[36:39], v[168:171], a[208:211], a[36:39]
buffer_load_dwordx4 v14, s[4:7], s41 offen offset:2048 lds
v_mfma_f32_16x16x32_bf16 a[40:43], v[176:179], a[208:211], 0
v_exp_f32 v133, v133
v_mfma_f32_16x16x32_bf16 a[40:43], v[180:183], a[212:215], a[40:43]
ds_read_b128 a[156:159], v5 offset:36864
v_cvt_pk_bf16_f32 v204, v132, v133
v_mfma_f32_16x16x32_bf16 a[44:47], v[188:191], a[212:215], 0
v_exp_f32 v134, v134
v_mfma_f32_16x16x32_bf16 a[44:47], v[184:187], a[208:211], a[44:47]
ds_read_b128 a[160:163], v2 offset:40960
v_mfma_f32_16x16x32_bf16 a[60:63], v[184:187], a[216:219], 0
v_exp_f32 v135, v135
v_mfma_f32_16x16x32_bf16 a[60:63], v[188:191], a[220:223], a[60:63]
ds_read_b128 a[164:167], v3 offset:40960
v_cvt_pk_bf16_f32 v205, v134, v135
v_mfma_f32_16x16x32_bf16 a[56:59], v[180:183], a[220:223], 0
v_exp_f32 v136, v136
v_mfma_f32_16x16x32_bf16 a[56:59], v[176:179], a[216:219], a[56:59]
buffer_load_dwordx4 v15, s[4:7], s41 offen offset:3072 lds
s_add_u32 s41, s41, 16384
v_mfma_f32_16x16x32_bf16 a[52:55], v[168:171], a[216:219], 0
v_exp_f32 v137, v137
v_mfma_f32_16x16x32_bf16 a[52:55], v[172:175], a[220:223], a[52:55]
ds_read_b128 a[168:171], v4 offset:40960
v_cvt_pk_bf16_f32 v212, v136, v137
v_mfma_f32_16x16x32_bf16 a[48:51], v[164:167], a[220:223], 0
v_exp_f32 v138, v138
v_mfma_f32_16x16x32_bf16 a[48:51], v[160:163], a[216:219], a[48:51]
ds_read_b128 a[172:175], v5 offset:40960
s_add_u32 m0, s40, 114688
v_mfma_f32_16x16x32_bf16 a[64:67], v[160:163], a[224:227], 0
v_exp_f32 v139, v139
v_mfma_f32_16x16x32_bf16 a[64:67], v[164:167], a[228:231], a[64:67]
ds_read_b128 a[176:179], v2 offset:45056
v_cvt_pk_bf16_f32 v213, v138, v139
v_mfma_f32_16x16x32_bf16 a[68:71], v[172:175], a[228:231], 0
v_exp_f32 v140, v140
v_mfma_f32_16x16x32_bf16 a[68:71], v[168:171], a[224:227], a[68:71]
buffer_load_dwordx4 v14, s[8:11], s42 offen offset:0 lds
v_mfma_f32_16x16x32_bf16 a[72:75], v[176:179], a[224:227], 0
v_exp_f32 v141, v141
v_mfma_f32_16x16x32_bf16 a[72:75], v[180:183], a[228:231], a[72:75]
ds_read_b128 a[180:183], v3 offset:45056
v_cvt_pk_bf16_f32 v220, v140, v141
v_mfma_f32_16x16x32_bf16 a[76:79], v[188:191], a[228:231], 0
v_exp_f32 v142, v142
v_mfma_f32_16x16x32_bf16 a[76:79], v[184:187], a[224:227], a[76:79]
ds_read_b128 a[184:187], v4 offset:45056
v_mfma_f32_16x16x32_bf16 a[92:95], v[184:187], a[232:235], 0
v_exp_f32 v143, v143
v_mfma_f32_16x16x32_bf16 a[92:95], v[188:191], a[236:239], a[92:95]
ds_read_b128 a[188:191], v5 offset:45056
v_cvt_pk_bf16_f32 v221, v142, v143
v_mfma_f32_16x16x32_bf16 a[88:91], v[180:183], a[236:239], 0
v_exp_f32 v144, v144
v_mfma_f32_16x16x32_bf16 a[88:91], v[176:179], a[232:235], a[88:91]
buffer_load_dwordx4 v15, s[8:11], s42 offen offset:1024 lds
v_mfma_f32_16x16x32_bf16 a[84:87], v[168:171], a[232:235], 0
v_exp_f32 v145, v145
v_mfma_f32_16x16x32_bf16 a[84:87], v[172:175], a[236:239], a[84:87]
v_cvt_pk_bf16_f32 v198, v144, v145
v_mfma_f32_16x16x32_bf16 a[80:83], v[164:167], a[236:239], 0
v_exp_f32 v146, v146
v_mfma_f32_16x16x32_bf16 a[80:83], v[160:163], a[232:235], a[80:83]
buffer_load_dword v18, v24, s[28:31], s59 offen
v_mfma_f32_16x16x32_bf16 a[96:99], v[160:163], a[240:243], 0
v_exp_f32 v147, v147
v_mfma_f32_16x16x32_bf16 a[96:99], v[164:167], a[244:247], a[96:99]
v_cvt_pk_bf16_f32 v199, v146, v147
v_mfma_f32_16x16x32_bf16 a[100:103], v[172:175], a[244:247], 0
v_exp_f32 v148, v148
v_mfma_f32_16x16x32_bf16 a[100:103], v[168:171], a[240:243], a[100:103]
buffer_load_dwordx4 v14, s[8:11], s42 offen offset:2048 lds
v_mfma_f32_16x16x32_bf16 a[104:107], v[176:179], a[240:243], 0
v_exp_f32 v149, v149
v_mfma_f32_16x16x32_bf16 a[104:107], v[180:183], a[244:247], a[104:107]
v_cvt_pk_bf16_f32 v206, v148, v149
v_mfma_f32_16x16x32_bf16 a[108:111], v[188:191], a[244:247], 0
v_exp_f32 v150, v150
v_mfma_f32_16x16x32_bf16 a[108:111], v[184:187], a[240:243], a[108:111]
buffer_load_dword v18, v24, s[36:39], s59 offen
s_add_u32 s59, s59, 1024
v_mfma_f32_16x16x32_bf16 a[124:127], v[184:187], a[248:251], 0
v_exp_f32 v151, v151
v_mfma_f32_16x16x32_bf16 a[124:127], v[188:191], a[252:255], a[124:127]
s_mov_b32 s56, 67108864
v_cvt_pk_bf16_f32 v207, v150, v151
v_mfma_f32_16x16x32_bf16 a[120:123], v[180:183], a[252:255], 0
v_exp_f32 v152, v152
v_mfma_f32_16x16x32_bf16 a[120:123], v[176:179], a[248:251], a[120:123]
buffer_load_dwordx4 v15, s[8:11], s42 offen offset:3072 lds
s_add_u32 s42, s42, 16384
v_mfma_f32_16x16x32_bf16 a[116:119], v[168:171], a[248:251], 0
v_exp_f32 v153, v153
v_mfma_f32_16x16x32_bf16 a[116:119], v[172:175], a[252:255], a[116:119]
buffer_load_dword v18, v17, s[16:19], s56 offen
v_cvt_pk_bf16_f32 v214, v152, v153
v_mfma_f32_16x16x32_bf16 a[112:115], v[164:167], a[252:255], 0
s_waitcnt vmcnt(11)
v_exp_f32 v154, v154
v_mfma_f32_16x16x32_bf16 a[112:115], v[160:163], a[248:251], a[112:115]
s_waitcnt vmcnt(24) lgkmcnt(0)
s_barrier
v_smfmac_f32_16x16x64_bf16 v[240:243], v[28:31], v[160:167], v16
v_exp_f32 v155, v155
v_smfmac_f32_16x16x64_bf16 v[244:247], v[28:31], v[168:175], v16
v_cvt_pk_bf16_f32 v215, v154, v155
v_smfmac_f32_16x16x64_bf16 v[248:251], v[28:31], v[176:183], v16
v_exp_f32 v156, v156
v_smfmac_f32_16x16x64_bf16 v[252:255], v[28:31], v[184:191], v16
s_bitcmp1_b32 s58, 1
s_cbranch_scc1 Lsig_10
s_bitset1_b32 s58, 1
v_mov_b32 v22, s80
v_mov_b32 v21, 1
v_lshlrev_b32 v22, 4, v22
s_mov_b64 exec, 1
buffer_atomic_add v21, v22, s[60:63], 0 offen offset:64 sc1
s_mov_b64 exec, -1
Lsig_10:
s_mov_b32 s43, 7
s_mov_b32 s54, s57
s_nop 0
s_nop 0
s_nop 0
s_nop 0
s_nop 0
s_nop 0
s_nop 0
s_nop 0
s_nop 0
K_loop:
v_mfma_f32_16x16x32_bf16 v[96:99], a[128:131], v[32:35], v[224:227]
v_exp_f32 v157, v157
v_mfma_f32_16x16x32_bf16 v[96:99], a[132:135], v[36:39], v[96:99]
ds_read_b64_tr_b16 a[192:193], v6 offset:16384
v_cvt_pk_bf16_f32 v222, v156, v157
v_mfma_f32_16x16x32_bf16 v[96:99], a[136:139], v[40:43], v[96:99]
v_exp_f32 v158, v158
v_mfma_f32_16x16x32_bf16 v[96:99], a[140:143], v[44:47], v[96:99]
ds_read_b64_tr_b16 a[194:195], v6 offset:20480
v_mfma_f32_16x16x32_bf16 v[100:103], a[140:143], v[60:63], v[228:231]
v_exp_f32 v159, v159
v_mfma_f32_16x16x32_bf16 v[100:103], a[136:139], v[56:59], v[100:103]
ds_read_b64_tr_b16 a[196:197], v6 offset:24576
v_cvt_pk_bf16_f32 v223, v158, v159
v_mfma_f32_16x16x32_bf16 v[100:103], a[132:135], v[52:55], v[100:103]
s_add_u32 m0, s40, 32768
s_cmp_le_u32 s43, 3
s_cselect_b32 s56, 0, 256
v_mfma_f32_16x16x32_bf16 v[100:103], a[128:131], v[48:51], v[100:103]
ds_read_b64_tr_b16 a[198:199], v6 offset:28672
v_mfma_f32_16x16x32_bf16 v[104:107], a[128:131], v[64:67], v[232:235]
buffer_load_dword v20, v26, s[60:63], s56 offen sc1
v_mfma_f32_16x16x32_bf16 v[104:107], a[132:135], v[68:71], v[104:107]
ds_read_b64_tr_b16 a[200:201], v7 offset:16384
v_mfma_f32_16x16x32_bf16 v[104:107], a[136:139], v[72:75], v[104:107]
v_exp_f32 v96, v96
v_mfma_f32_16x16x32_bf16 v[104:107], a[140:143], v[76:79], v[104:107]
ds_read_b64_tr_b16 a[202:203], v7 offset:20480
v_mfma_f32_16x16x32_bf16 v[108:111], a[140:143], v[92:95], v[236:239]
v_exp_f32 v97, v97
v_mfma_f32_16x16x32_bf16 v[108:111], a[136:139], v[88:91], v[108:111]
ds_read_b64_tr_b16 a[204:205], v7 offset:24576
v_cvt_pk_bf16_f32 v160, v96, v97
v_mfma_f32_16x16x32_bf16 v[108:111], a[132:135], v[84:87], v[108:111]
v_exp_f32 v98, v98
v_mfma_f32_16x16x32_bf16 v[108:111], a[128:131], v[80:83], v[108:111]
ds_read_b64_tr_b16 a[206:207], v7 offset:28672
v_mfma_f32_16x16x32_bf16 v[112:115], a[144:147], v[32:35], v[224:227]
v_exp_f32 v99, v99
v_mfma_f32_16x16x32_bf16 v[112:115], a[148:151], v[36:39], v[112:115]
ds_read_b64_tr_b16 a[208:209], v8 offset:16384
v_cvt_pk_bf16_f32 v161, v98, v99
v_mfma_f32_16x16x32_bf16 v[112:115], a[152:155], v[40:43], v[112:115]
v_exp_f32 v100, v100
v_mfma_f32_16x16x32_bf16 v[112:115], a[156:159], v[44:47], v[112:115]
ds_read_b64_tr_b16 a[210:211], v8 offset:20480
v_mfma_f32_16x16x32_bf16 v[116:119], a[156:159], v[60:63], v[228:231]
v_exp_f32 v101, v101
v_mfma_f32_16x16x32_bf16 v[116:119], a[152:155], v[56:59], v[116:119]
ds_read_b64_tr_b16 a[212:213], v8 offset:24576
v_cvt_pk_bf16_f32 v168, v100, v101
v_mfma_f32_16x16x32_bf16 v[116:119], a[148:151], v[52:55], v[116:119]
v_exp_f32 v102, v102
v_mfma_f32_16x16x32_bf16 v[116:119], a[144:147], v[48:51], v[116:119]
ds_read_b64_tr_b16 a[214:215], v8 offset:28672
v_mfma_f32_16x16x32_bf16 v[120:123], a[144:147], v[64:67], v[232:235]
v_exp_f32 v103, v103
v_mfma_f32_16x16x32_bf16 v[120:123], a[148:151], v[68:71], v[120:123]
ds_read_b64_tr_b16 a[216:217], v9 offset:16384
v_cvt_pk_bf16_f32 v169, v102, v103
v_mfma_f32_16x16x32_bf16 v[120:123], a[152:155], v[72:75], v[120:123]
v_exp_f32 v104, v104
v_mfma_f32_16x16x32_bf16 v[120:123], a[156:159], v[76:79], v[120:123]
ds_read_b64_tr_b16 a[218:219], v9 offset:20480
v_mfma_f32_16x16x32_bf16 v[124:127], a[156:159], v[92:95], v[236:239]
v_exp_f32 v105, v105
v_mfma_f32_16x16x32_bf16 v[124:127], a[152:155], v[88:91], v[124:127]
ds_read_b64_tr_b16 a[220:221], v9 offset:24576
v_cvt_pk_bf16_f32 v176, v104, v105
v_mfma_f32_16x16x32_bf16 v[124:127], a[148:151], v[84:87], v[124:127]
v_exp_f32 v106, v106
v_mfma_f32_16x16x32_bf16 v[124:127], a[144:147], v[80:83], v[124:127]
ds_read_b64_tr_b16 a[222:223], v9 offset:28672
v_mfma_f32_16x16x32_bf16 v[128:131], a[160:163], v[32:35], v[224:227]
v_exp_f32 v107, v107
v_mfma_f32_16x16x32_bf16 v[128:131], a[164:167], v[36:39], v[128:131]
ds_read_b64_tr_b16 a[224:225], v10 offset:16384
v_cvt_pk_bf16_f32 v177, v106, v107
v_mfma_f32_16x16x32_bf16 v[128:131], a[168:171], v[40:43], v[128:131]
v_exp_f32 v108, v108
v_mfma_f32_16x16x32_bf16 v[128:131], a[172:175], v[44:47], v[128:131]
ds_read_b64_tr_b16 a[226:227], v10 offset:20480
v_mfma_f32_16x16x32_bf16 v[132:135], a[172:175], v[60:63], v[228:231]
v_exp_f32 v109, v109
v_mfma_f32_16x16x32_bf16 v[132:135], a[168:171], v[56:59], v[132:135]
ds_read_b64_tr_b16 a[228:229], v10 offset:24576
v_cvt_pk_bf16_f32 v184, v108, v109
v_mfma_f32_16x16x32_bf16 v[132:135], a[164:167], v[52:55], v[132:135]
v_exp_f32 v110, v110
v_mfma_f32_16x16x32_bf16 v[132:135], a[160:163], v[48:51], v[132:135]
ds_read_b64_tr_b16 a[230:231], v10 offset:28672
v_mfma_f32_16x16x32_bf16 v[136:139], a[160:163], v[64:67], v[232:235]
v_exp_f32 v111, v111
v_mfma_f32_16x16x32_bf16 v[136:139], a[164:167], v[68:71], v[136:139]
ds_read_b64_tr_b16 a[232:233], v11 offset:16384
v_cvt_pk_bf16_f32 v185, v110, v111
v_mfma_f32_16x16x32_bf16 v[136:139], a[168:171], v[72:75], v[136:139]
v_exp_f32 v112, v112
v_mfma_f32_16x16x32_bf16 v[136:139], a[172:175], v[76:79], v[136:139]
ds_read_b64_tr_b16 a[234:235], v11 offset:20480
v_mfma_f32_16x16x32_bf16 v[140:143], a[172:175], v[92:95], v[236:239]
v_exp_f32 v113, v113
v_mfma_f32_16x16x32_bf16 v[140:143], a[168:171], v[88:91], v[140:143]
ds_read_b64_tr_b16 a[236:237], v11 offset:24576
v_cvt_pk_bf16_f32 v162, v112, v113
v_mfma_f32_16x16x32_bf16 v[140:143], a[164:167], v[84:87], v[140:143]
v_exp_f32 v114, v114
v_mfma_f32_16x16x32_bf16 v[140:143], a[160:163], v[80:83], v[140:143]
ds_read_b64_tr_b16 a[238:239], v11 offset:28672
v_mfma_f32_16x16x32_bf16 v[144:147], a[176:179], v[32:35], v[224:227]
v_exp_f32 v115, v115
v_mfma_f32_16x16x32_bf16 v[144:147], a[180:183], v[36:39], v[144:147]
ds_read_b64_tr_b16 a[240:241], v12 offset:16384
v_cvt_pk_bf16_f32 v163, v114, v115
v_mfma_f32_16x16x32_bf16 v[144:147], a[184:187], v[40:43], v[144:147]
v_exp_f32 v116, v116
v_mfma_f32_16x16x32_bf16 v[144:147], a[188:191], v[44:47], v[144:147]
ds_read_b64_tr_b16 a[242:243], v12 offset:20480
v_mfma_f32_16x16x32_bf16 v[148:151], a[188:191], v[60:63], v[228:231]
v_exp_f32 v117, v117
v_mfma_f32_16x16x32_bf16 v[148:151], a[184:187], v[56:59], v[148:151]
ds_read_b64_tr_b16 a[244:245], v12 offset:24576
v_cvt_pk_bf16_f32 v170, v116, v117
v_mfma_f32_16x16x32_bf16 v[148:151], a[180:183], v[52:55], v[148:151]
v_exp_f32 v118, v118
v_mfma_f32_16x16x32_bf16 v[148:151], a[176:179], v[48:51], v[148:151]
ds_read_b64_tr_b16 a[246:247], v12 offset:28672
v_mfma_f32_16x16x32_bf16 v[152:155], a[176:179], v[64:67], v[232:235]
v_exp_f32 v119, v119
v_mfma_f32_16x16x32_bf16 v[152:155], a[180:183], v[68:71], v[152:155]
ds_read_b64_tr_b16 a[248:249], v13 offset:16384
v_cvt_pk_bf16_f32 v171, v118, v119
v_mfma_f32_16x16x32_bf16 v[152:155], a[184:187], v[72:75], v[152:155]
v_exp_f32 v120, v120
v_mfma_f32_16x16x32_bf16 v[152:155], a[188:191], v[76:79], v[152:155]
ds_read_b64_tr_b16 a[250:251], v13 offset:20480
v_mfma_f32_16x16x32_bf16 v[156:159], a[188:191], v[92:95], v[236:239]
v_exp_f32 v121, v121
v_mfma_f32_16x16x32_bf16 v[156:159], a[184:187], v[88:91], v[156:159]
ds_read_b64_tr_b16 a[252:253], v13 offset:24576
v_cvt_pk_bf16_f32 v178, v120, v121
v_mfma_f32_16x16x32_bf16 v[156:159], a[180:183], v[84:87], v[156:159]
v_exp_f32 v122, v122
v_mfma_f32_16x16x32_bf16 v[156:159], a[176:179], v[80:83], v[156:159]
ds_read_b64_tr_b16 a[254:255], v13 offset:28672
s_waitcnt lgkmcnt(8)
v_mfma_f32_16x16x32_bf16 a[0:3], v[192:195], a[192:195], a[0:3]
v_exp_f32 v123, v123
v_mfma_f32_16x16x32_bf16 a[0:3], v[196:199], a[196:199], a[0:3]
ds_read_b128 a[128:131], v2 offset:49152
v_cvt_pk_bf16_f32 v179, v122, v123
v_mfma_f32_16x16x32_bf16 a[4:7], v[204:207], a[196:199], a[4:7]
v_exp_f32 v124, v124
v_mfma_f32_16x16x32_bf16 a[4:7], v[200:203], a[192:195], a[4:7]
buffer_load_dwordx4 v14, s[4:7], s41 offen offset:0 lds
v_mfma_f32_16x16x32_bf16 a[8:11], v[208:211], a[192:195], a[8:11]
v_exp_f32 v125, v125
v_mfma_f32_16x16x32_bf16 a[8:11], v[212:215], a[196:199], a[8:11]
ds_read_b128 a[132:135], v3 offset:49152
v_cvt_pk_bf16_f32 v186, v124, v125
v_mfma_f32_16x16x32_bf16 a[12:15], v[220:223], a[196:199], a[12:15]
v_exp_f32 v126, v126
v_mfma_f32_16x16x32_bf16 a[12:15], v[216:219], a[192:195], a[12:15]
ds_read_b128 a[136:139], v4 offset:49152
v_mfma_f32_16x16x32_bf16 a[28:31], v[216:219], a[200:203], a[28:31]
v_exp_f32 v127, v127
v_mfma_f32_16x16x32_bf16 a[28:31], v[220:223], a[204:207], a[28:31]
ds_read_b128 a[140:143], v5 offset:49152
v_cvt_pk_bf16_f32 v187, v126, v127
v_mfma_f32_16x16x32_bf16 a[24:27], v[212:215], a[204:207], a[24:27]
v_exp_f32 v128, v128
v_mfma_f32_16x16x32_bf16 a[24:27], v[208:211], a[200:203], a[24:27]
buffer_load_dwordx4 v15, s[4:7], s41 offen offset:1024 lds
s_waitcnt lgkmcnt(4)
v_mfma_f32_16x16x32_bf16 a[20:23], v[200:203], a[200:203], a[20:23]
v_exp_f32 v129, v129
v_mfma_f32_16x16x32_bf16 a[20:23], v[204:207], a[204:207], a[20:23]
ds_read_b128 a[144:147], v2 offset:53248
v_cvt_pk_bf16_f32 v164, v128, v129
v_mfma_f32_16x16x32_bf16 a[16:19], v[196:199], a[204:207], a[16:19]
v_exp_f32 v130, v130
v_mfma_f32_16x16x32_bf16 a[16:19], v[192:195], a[200:203], a[16:19]
ds_read_b128 a[148:151], v3 offset:53248
v_mfma_f32_16x16x32_bf16 a[32:35], v[192:195], a[208:211], a[32:35]
v_exp_f32 v131, v131
v_mfma_f32_16x16x32_bf16 a[32:35], v[196:199], a[212:215], a[32:35]
ds_read_b128 a[152:155], v4 offset:53248
v_cvt_pk_bf16_f32 v165, v130, v131
v_mfma_f32_16x16x32_bf16 a[36:39], v[204:207], a[212:215], a[36:39]
v_exp_f32 v132, v132
v_mfma_f32_16x16x32_bf16 a[36:39], v[200:203], a[208:211], a[36:39]
buffer_load_dwordx4 v14, s[4:7], s41 offen offset:2048 lds
v_mfma_f32_16x16x32_bf16 a[40:43], v[208:211], a[208:211], a[40:43]
v_exp_f32 v133, v133
v_mfma_f32_16x16x32_bf16 a[40:43], v[212:215], a[212:215], a[40:43]
ds_read_b128 a[156:159], v5 offset:53248
v_cvt_pk_bf16_f32 v172, v132, v133
v_mfma_f32_16x16x32_bf16 a[44:47], v[220:223], a[212:215], a[44:47]
v_exp_f32 v134, v134
v_mfma_f32_16x16x32_bf16 a[44:47], v[216:219], a[208:211], a[44:47]
ds_read_b128 a[160:163], v2 offset:57344
v_mfma_f32_16x16x32_bf16 a[60:63], v[216:219], a[216:219], a[60:63]
v_exp_f32 v135, v135
v_mfma_f32_16x16x32_bf16 a[60:63], v[220:223], a[220:223], a[60:63]
ds_read_b128 a[164:167], v3 offset:57344
v_cvt_pk_bf16_f32 v173, v134, v135
v_mfma_f32_16x16x32_bf16 a[56:59], v[212:215], a[220:223], a[56:59]
v_exp_f32 v136, v136
v_mfma_f32_16x16x32_bf16 a[56:59], v[208:211], a[216:219], a[56:59]
buffer_load_dwordx4 v15, s[4:7], s41 offen offset:3072 lds
s_add_u32 s41, s41, 16384
v_mfma_f32_16x16x32_bf16 a[52:55], v[200:203], a[216:219], a[52:55]
v_exp_f32 v137, v137
v_mfma_f32_16x16x32_bf16 a[52:55], v[204:207], a[220:223], a[52:55]
ds_read_b128 a[168:171], v4 offset:57344
v_cvt_pk_bf16_f32 v180, v136, v137
v_mfma_f32_16x16x32_bf16 a[48:51], v[196:199], a[220:223], a[48:51]
v_exp_f32 v138, v138
v_mfma_f32_16x16x32_bf16 a[48:51], v[192:195], a[216:219], a[48:51]
ds_read_b128 a[172:175], v5 offset:57344
s_add_u32 m0, s40, 65536
v_mfma_f32_16x16x32_bf16 a[64:67], v[192:195], a[224:227], a[64:67]
v_exp_f32 v139, v139
v_mfma_f32_16x16x32_bf16 a[64:67], v[196:199], a[228:231], a[64:67]
ds_read_b128 a[176:179], v2 offset:61440
v_cvt_pk_bf16_f32 v181, v138, v139
v_mfma_f32_16x16x32_bf16 a[68:71], v[204:207], a[228:231], a[68:71]
v_exp_f32 v140, v140
v_mfma_f32_16x16x32_bf16 a[68:71], v[200:203], a[224:227], a[68:71]
buffer_load_dwordx4 v14, s[8:11], s42 offen offset:0 lds
v_mfma_f32_16x16x32_bf16 a[72:75], v[208:211], a[224:227], a[72:75]
v_exp_f32 v141, v141
v_mfma_f32_16x16x32_bf16 a[72:75], v[212:215], a[228:231], a[72:75]
ds_read_b128 a[180:183], v3 offset:61440
v_cvt_pk_bf16_f32 v188, v140, v141
v_mfma_f32_16x16x32_bf16 a[76:79], v[220:223], a[228:231], a[76:79]
v_exp_f32 v142, v142
v_mfma_f32_16x16x32_bf16 a[76:79], v[216:219], a[224:227], a[76:79]
ds_read_b128 a[184:187], v4 offset:61440
v_mfma_f32_16x16x32_bf16 a[92:95], v[216:219], a[232:235], a[92:95]
v_exp_f32 v143, v143
v_mfma_f32_16x16x32_bf16 a[92:95], v[220:223], a[236:239], a[92:95]
ds_read_b128 a[188:191], v5 offset:61440
v_cvt_pk_bf16_f32 v189, v142, v143
v_mfma_f32_16x16x32_bf16 a[88:91], v[212:215], a[236:239], a[88:91]
v_exp_f32 v144, v144
v_mfma_f32_16x16x32_bf16 a[88:91], v[208:211], a[232:235], a[88:91]
buffer_load_dwordx4 v15, s[8:11], s42 offen offset:1024 lds
v_mfma_f32_16x16x32_bf16 a[84:87], v[200:203], a[232:235], a[84:87]
v_exp_f32 v145, v145
v_mfma_f32_16x16x32_bf16 a[84:87], v[204:207], a[236:239], a[84:87]
v_cvt_pk_bf16_f32 v166, v144, v145
v_mfma_f32_16x16x32_bf16 a[80:83], v[196:199], a[236:239], a[80:83]
v_exp_f32 v146, v146
v_mfma_f32_16x16x32_bf16 a[80:83], v[192:195], a[232:235], a[80:83]
s_cmp_le_u32 s43, 2
s_cselect_b32 s56, s79, 16777216
v_mfma_f32_16x16x32_bf16 a[96:99], v[192:195], a[240:243], a[96:99]
v_exp_f32 v147, v147
v_mfma_f32_16x16x32_bf16 a[96:99], v[196:199], a[244:247], a[96:99]
v_cvt_pk_bf16_f32 v167, v146, v147
v_mfma_f32_16x16x32_bf16 a[100:103], v[204:207], a[244:247], a[100:103]
v_exp_f32 v148, v148
v_mfma_f32_16x16x32_bf16 a[100:103], v[200:203], a[240:243], a[100:103]
buffer_load_dwordx4 v14, s[8:11], s42 offen offset:2048 lds
v_mfma_f32_16x16x32_bf16 a[104:107], v[208:211], a[240:243], a[104:107]
v_exp_f32 v149, v149
v_mfma_f32_16x16x32_bf16 a[104:107], v[212:215], a[244:247], a[104:107]
v_cvt_pk_bf16_f32 v174, v148, v149
v_mfma_f32_16x16x32_bf16 a[108:111], v[220:223], a[244:247], a[108:111]
v_exp_f32 v150, v150
v_mfma_f32_16x16x32_bf16 a[108:111], v[216:219], a[240:243], a[108:111]
buffer_load_dword v18, v27, s[20:23], s56 offen
s_sub_u32 s79, s79, 27648
v_mfma_f32_16x16x32_bf16 a[124:127], v[216:219], a[248:251], a[124:127]
v_exp_f32 v151, v151
v_mfma_f32_16x16x32_bf16 a[124:127], v[220:223], a[252:255], a[124:127]
v_cvt_pk_bf16_f32 v175, v150, v151
v_mfma_f32_16x16x32_bf16 a[120:123], v[212:215], a[252:255], a[120:123]
v_exp_f32 v152, v152
v_mfma_f32_16x16x32_bf16 a[120:123], v[208:211], a[248:251], a[120:123]
buffer_load_dwordx4 v15, s[8:11], s42 offen offset:3072 lds
s_add_u32 s42, s42, 16384
v_mfma_f32_16x16x32_bf16 a[116:119], v[200:203], a[248:251], a[116:119]
v_exp_f32 v153, v153
v_mfma_f32_16x16x32_bf16 a[116:119], v[204:207], a[252:255], a[116:119]
v_cvt_pk_bf16_f32 v182, v152, v153
v_mfma_f32_16x16x32_bf16 a[112:115], v[196:199], a[252:255], a[112:115]
v_exp_f32 v154, v154
v_mfma_f32_16x16x32_bf16 a[112:115], v[192:195], a[248:251], a[112:115]
s_waitcnt vmcnt(21) lgkmcnt(0)
s_barrier
v_smfmac_f32_16x16x64_bf16 v[240:243], v[28:31], v[192:199], v16
v_exp_f32 v155, v155
v_smfmac_f32_16x16x64_bf16 v[244:247], v[28:31], v[200:207], v16
v_cvt_pk_bf16_f32 v183, v154, v155
v_smfmac_f32_16x16x64_bf16 v[248:251], v[28:31], v[208:215], v16
v_exp_f32 v156, v156
v_smfmac_f32_16x16x64_bf16 v[252:255], v[28:31], v[216:223], v16
v_mfma_f32_16x16x32_bf16 v[96:99], a[128:131], v[32:35], v[224:227]
v_exp_f32 v157, v157
v_mfma_f32_16x16x32_bf16 v[96:99], a[132:135], v[36:39], v[96:99]
ds_read_b64_tr_b16 a[192:193], v6 offset:32768
v_cvt_pk_bf16_f32 v190, v156, v157
v_mfma_f32_16x16x32_bf16 v[96:99], a[136:139], v[40:43], v[96:99]
v_exp_f32 v158, v158
v_mfma_f32_16x16x32_bf16 v[96:99], a[140:143], v[44:47], v[96:99]
ds_read_b64_tr_b16 a[194:195], v6 offset:36864
K_pg4:
s_cbranch_execz K_pg7
v_mfma_f32_16x16x32_bf16 v[100:103], a[140:143], v[60:63], v[228:231]
v_exp_f32 v159, v159
v_mfma_f32_16x16x32_bf16 v[100:103], a[136:139], v[56:59], v[100:103]
ds_read_b64_tr_b16 a[196:197], v6 offset:40960
v_cvt_pk_bf16_f32 v191, v158, v159
v_mfma_f32_16x16x32_bf16 v[100:103], a[132:135], v[52:55], v[100:103]
s_add_u32 m0, s40, 49152
v_mfma_f32_16x16x32_bf16 v[100:103], a[128:131], v[48:51], v[100:103]
ds_read_b64_tr_b16 a[198:199], v6 offset:45056
v_mfma_f32_16x16x32_bf16 v[104:107], a[128:131], v[64:67], v[232:235]
v_mfma_f32_16x16x32_bf16 v[104:107], a[132:135], v[68:71], v[104:107]
ds_read_b64_tr_b16 a[200:201], v7 offset:32768
v_mfma_f32_16x16x32_bf16 v[104:107], a[136:139], v[72:75], v[104:107]
v_exp_f32 v96, v96
v_mfma_f32_16x16x32_bf16 v[104:107], a[140:143], v[76:79], v[104:107]
ds_read_b64_tr_b16 a[202:203], v7 offset:36864
v_mfma_f32_16x16x32_bf16 v[108:111], a[140:143], v[92:95], v[236:239]
v_exp_f32 v97, v97
v_mfma_f32_16x16x32_bf16 v[108:111], a[136:139], v[88:91], v[108:111]
ds_read_b64_tr_b16 a[204:205], v7 offset:40960
v_cvt_pk_bf16_f32 v192, v96, v97
v_mfma_f32_16x16x32_bf16 v[108:111], a[132:135], v[84:87], v[108:111]
v_exp_f32 v98, v98
v_mfma_f32_16x16x32_bf16 v[108:111], a[128:131], v[80:83], v[108:111]
ds_read_b64_tr_b16 a[206:207], v7 offset:45056
v_mfma_f32_16x16x32_bf16 v[112:115], a[144:147], v[32:35], v[224:227]
v_exp_f32 v99, v99
v_mfma_f32_16x16x32_bf16 v[112:115], a[148:151], v[36:39], v[112:115]
ds_read_b64_tr_b16 a[208:209], v8 offset:32768
v_cvt_pk_bf16_f32 v193, v98, v99
v_mfma_f32_16x16x32_bf16 v[112:115], a[152:155], v[40:43], v[112:115]
v_exp_f32 v100, v100
v_mfma_f32_16x16x32_bf16 v[112:115], a[156:159], v[44:47], v[112:115]
ds_read_b64_tr_b16 a[210:211], v8 offset:36864
v_mfma_f32_16x16x32_bf16 v[116:119], a[156:159], v[60:63], v[228:231]
v_exp_f32 v101, v101
v_mfma_f32_16x16x32_bf16 v[116:119], a[152:155], v[56:59], v[116:119]
ds_read_b64_tr_b16 a[212:213], v8 offset:40960
v_cvt_pk_bf16_f32 v200, v100, v101
v_mfma_f32_16x16x32_bf16 v[116:119], a[148:151], v[52:55], v[116:119]
v_exp_f32 v102, v102
v_mfma_f32_16x16x32_bf16 v[116:119], a[144:147], v[48:51], v[116:119]
ds_read_b64_tr_b16 a[214:215], v8 offset:45056
v_mfma_f32_16x16x32_bf16 v[120:123], a[144:147], v[64:67], v[232:235]
v_exp_f32 v103, v103
v_mfma_f32_16x16x32_bf16 v[120:123], a[148:151], v[68:71], v[120:123]
ds_read_b64_tr_b16 a[216:217], v9 offset:32768
v_cvt_pk_bf16_f32 v201, v102, v103
v_mfma_f32_16x16x32_bf16 v[120:123], a[152:155], v[72:75], v[120:123]
v_exp_f32 v104, v104
v_mfma_f32_16x16x32_bf16 v[120:123], a[156:159], v[76:79], v[120:123]
ds_read_b64_tr_b16 a[218:219], v9 offset:36864
v_mfma_f32_16x16x32_bf16 v[124:127], a[156:159], v[92:95], v[236:239]
v_exp_f32 v105, v105
v_mfma_f32_16x16x32_bf16 v[124:127], a[152:155], v[88:91], v[124:127]
ds_read_b64_tr_b16 a[220:221], v9 offset:40960
v_cvt_pk_bf16_f32 v208, v104, v105
v_mfma_f32_16x16x32_bf16 v[124:127], a[148:151], v[84:87], v[124:127]
v_exp_f32 v106, v106
v_mfma_f32_16x16x32_bf16 v[124:127], a[144:147], v[80:83], v[124:127]
ds_read_b64_tr_b16 a[222:223], v9 offset:45056
v_mfma_f32_16x16x32_bf16 v[128:131], a[160:163], v[32:35], v[224:227]
v_exp_f32 v107, v107
v_mfma_f32_16x16x32_bf16 v[128:131], a[164:167], v[36:39], v[128:131]
ds_read_b64_tr_b16 a[224:225], v10 offset:32768
v_cvt_pk_bf16_f32 v209, v106, v107
v_mfma_f32_16x16x32_bf16 v[128:131], a[168:171], v[40:43], v[128:131]
v_exp_f32 v108, v108
v_mfma_f32_16x16x32_bf16 v[128:131], a[172:175], v[44:47], v[128:131]
ds_read_b64_tr_b16 a[226:227], v10 offset:36864
v_mfma_f32_16x16x32_bf16 v[132:135], a[172:175], v[60:63], v[228:231]
v_exp_f32 v109, v109
v_mfma_f32_16x16x32_bf16 v[132:135], a[168:171], v[56:59], v[132:135]
ds_read_b64_tr_b16 a[228:229], v10 offset:40960
v_cvt_pk_bf16_f32 v216, v108, v109
v_mfma_f32_16x16x32_bf16 v[132:135], a[164:167], v[52:55], v[132:135]
v_exp_f32 v110, v110
v_mfma_f32_16x16x32_bf16 v[132:135], a[160:163], v[48:51], v[132:135]
ds_read_b64_tr_b16 a[230:231], v10 offset:45056
v_mfma_f32_16x16x32_bf16 v[136:139], a[160:163], v[64:67], v[232:235]
v_exp_f32 v111, v111
v_mfma_f32_16x16x32_bf16 v[136:139], a[164:167], v[68:71], v[136:139]
ds_read_b64_tr_b16 a[232:233], v11 offset:32768
v_cvt_pk_bf16_f32 v217, v110, v111
v_mfma_f32_16x16x32_bf16 v[136:139], a[168:171], v[72:75], v[136:139]
v_exp_f32 v112, v112
v_mfma_f32_16x16x32_bf16 v[136:139], a[172:175], v[76:79], v[136:139]
ds_read_b64_tr_b16 a[234:235], v11 offset:36864
v_mfma_f32_16x16x32_bf16 v[140:143], a[172:175], v[92:95], v[236:239]
v_exp_f32 v113, v113
v_mfma_f32_16x16x32_bf16 v[140:143], a[168:171], v[88:91], v[140:143]
ds_read_b64_tr_b16 a[236:237], v11 offset:40960
v_cvt_pk_bf16_f32 v194, v112, v113
v_mfma_f32_16x16x32_bf16 v[140:143], a[164:167], v[84:87], v[140:143]
v_exp_f32 v114, v114
v_mfma_f32_16x16x32_bf16 v[140:143], a[160:163], v[80:83], v[140:143]
ds_read_b64_tr_b16 a[238:239], v11 offset:45056
v_mfma_f32_16x16x32_bf16 v[144:147], a[176:179], v[32:35], v[224:227]
v_exp_f32 v115, v115
v_mfma_f32_16x16x32_bf16 v[144:147], a[180:183], v[36:39], v[144:147]
ds_read_b64_tr_b16 a[240:241], v12 offset:32768
v_cvt_pk_bf16_f32 v195, v114, v115
v_mfma_f32_16x16x32_bf16 v[144:147], a[184:187], v[40:43], v[144:147]
v_exp_f32 v116, v116
v_mfma_f32_16x16x32_bf16 v[144:147], a[188:191], v[44:47], v[144:147]
ds_read_b64_tr_b16 a[242:243], v12 offset:36864
v_mfma_f32_16x16x32_bf16 v[148:151], a[188:191], v[60:63], v[228:231]
v_exp_f32 v117, v117
v_mfma_f32_16x16x32_bf16 v[148:151], a[184:187], v[56:59], v[148:151]
ds_read_b64_tr_b16 a[244:245], v12 offset:40960
v_cvt_pk_bf16_f32 v202, v116, v117
v_mfma_f32_16x16x32_bf16 v[148:151], a[180:183], v[52:55], v[148:151]
v_exp_f32 v118, v118
v_mfma_f32_16x16x32_bf16 v[148:151], a[176:179], v[48:51], v[148:151]
ds_read_b64_tr_b16 a[246:247], v12 offset:45056
v_mfma_f32_16x16x32_bf16 v[152:155], a[176:179], v[64:67], v[232:235]
v_exp_f32 v119, v119
v_mfma_f32_16x16x32_bf16 v[152:155], a[180:183], v[68:71], v[152:155]
ds_read_b64_tr_b16 a[248:249], v13 offset:32768
v_cvt_pk_bf16_f32 v203, v118, v119
v_mfma_f32_16x16x32_bf16 v[152:155], a[184:187], v[72:75], v[152:155]
v_exp_f32 v120, v120
v_mfma_f32_16x16x32_bf16 v[152:155], a[188:191], v[76:79], v[152:155]
ds_read_b64_tr_b16 a[250:251], v13 offset:36864
v_mfma_f32_16x16x32_bf16 v[156:159], a[188:191], v[92:95], v[236:239]
v_exp_f32 v121, v121
v_mfma_f32_16x16x32_bf16 v[156:159], a[184:187], v[88:91], v[156:159]
ds_read_b64_tr_b16 a[252:253], v13 offset:40960
v_cvt_pk_bf16_f32 v210, v120, v121
v_mfma_f32_16x16x32_bf16 v[156:159], a[180:183], v[84:87], v[156:159]
v_exp_f32 v122, v122
v_mfma_f32_16x16x32_bf16 v[156:159], a[176:179], v[80:83], v[156:159]
ds_read_b64_tr_b16 a[254:255], v13 offset:45056
s_waitcnt lgkmcnt(8)
v_mfma_f32_16x16x32_bf16 a[0:3], v[160:163], a[192:195], a[0:3]
v_exp_f32 v123, v123
v_mfma_f32_16x16x32_bf16 a[0:3], v[164:167], a[196:199], a[0:3]
ds_read_b128 a[128:131], v2 offset:0
v_cvt_pk_bf16_f32 v211, v122, v123
v_mfma_f32_16x16x32_bf16 a[4:7], v[172:175], a[196:199], a[4:7]
v_exp_f32 v124, v124
v_mfma_f32_16x16x32_bf16 a[4:7], v[168:171], a[192:195], a[4:7]
buffer_load_dwordx4 v14, s[4:7], s41 offen offset:0 lds
v_mfma_f32_16x16x32_bf16 a[8:11], v[176:179], a[192:195], a[8:11]
v_exp_f32 v125, v125
v_mfma_f32_16x16x32_bf16 a[8:11], v[180:183], a[196:199], a[8:11]
ds_read_b128 a[132:135], v3 offset:0
v_cvt_pk_bf16_f32 v218, v124, v125
v_mfma_f32_16x16x32_bf16 a[12:15], v[188:191], a[196:199], a[12:15]
v_exp_f32 v126, v126
v_mfma_f32_16x16x32_bf16 a[12:15], v[184:187], a[192:195], a[12:15]
ds_read_b128 a[136:139], v4 offset:0
v_mfma_f32_16x16x32_bf16 a[28:31], v[184:187], a[200:203], a[28:31]
v_exp_f32 v127, v127
v_mfma_f32_16x16x32_bf16 a[28:31], v[188:191], a[204:207], a[28:31]
ds_read_b128 a[140:143], v5 offset:0
v_cvt_pk_bf16_f32 v219, v126, v127
v_mfma_f32_16x16x32_bf16 a[24:27], v[180:183], a[204:207], a[24:27]
v_exp_f32 v128, v128
v_mfma_f32_16x16x32_bf16 a[24:27], v[176:179], a[200:203], a[24:27]
buffer_load_dwordx4 v15, s[4:7], s41 offen offset:1024 lds
s_waitcnt lgkmcnt(4)
v_mfma_f32_16x16x32_bf16 a[20:23], v[168:171], a[200:203], a[20:23]
v_exp_f32 v129, v129
v_mfma_f32_16x16x32_bf16 a[20:23], v[172:175], a[204:207], a[20:23]
ds_read_b128 a[144:147], v2 offset:4096
v_cvt_pk_bf16_f32 v196, v128, v129
v_mfma_f32_16x16x32_bf16 a[16:19], v[164:167], a[204:207], a[16:19]
v_exp_f32 v130, v130
v_mfma_f32_16x16x32_bf16 a[16:19], v[160:163], a[200:203], a[16:19]
ds_read_b128 a[148:151], v3 offset:4096
v_mfma_f32_16x16x32_bf16 a[32:35], v[160:163], a[208:211], a[32:35]
v_exp_f32 v131, v131
v_mfma_f32_16x16x32_bf16 a[32:35], v[164:167], a[212:215], a[32:35]
ds_read_b128 a[152:155], v4 offset:4096
v_cvt_pk_bf16_f32 v197, v130, v131
v_mfma_f32_16x16x32_bf16 a[36:39], v[172:175], a[212:215], a[36:39]
v_exp_f32 v132, v132
v_mfma_f32_16x16x32_bf16 a[36:39], v[168:171], a[208:211], a[36:39]
buffer_load_dwordx4 v14, s[4:7], s41 offen offset:2048 lds
v_mfma_f32_16x16x32_bf16 a[40:43], v[176:179], a[208:211], a[40:43]
v_exp_f32 v133, v133
v_mfma_f32_16x16x32_bf16 a[40:43], v[180:183], a[212:215], a[40:43]
ds_read_b128 a[156:159], v5 offset:4096
v_cvt_pk_bf16_f32 v204, v132, v133
v_mfma_f32_16x16x32_bf16 a[44:47], v[188:191], a[212:215], a[44:47]
v_exp_f32 v134, v134
v_mfma_f32_16x16x32_bf16 a[44:47], v[184:187], a[208:211], a[44:47]
ds_read_b128 a[160:163], v2 offset:8192
v_mfma_f32_16x16x32_bf16 a[60:63], v[184:187], a[216:219], a[60:63]
v_exp_f32 v135, v135
v_mfma_f32_16x16x32_bf16 a[60:63], v[188:191], a[220:223], a[60:63]
ds_read_b128 a[164:167], v3 offset:8192
v_cvt_pk_bf16_f32 v205, v134, v135
v_mfma_f32_16x16x32_bf16 a[56:59], v[180:183], a[220:223], a[56:59]
v_exp_f32 v136, v136
v_mfma_f32_16x16x32_bf16 a[56:59], v[176:179], a[216:219], a[56:59]
buffer_load_dwordx4 v15, s[4:7], s41 offen offset:3072 lds
s_add_u32 s41, s41, 16384
v_mfma_f32_16x16x32_bf16 a[52:55], v[168:171], a[216:219], a[52:55]
v_exp_f32 v137, v137
v_mfma_f32_16x16x32_bf16 a[52:55], v[172:175], a[220:223], a[52:55]
ds_read_b128 a[168:171], v4 offset:8192
v_cvt_pk_bf16_f32 v212, v136, v137
v_mfma_f32_16x16x32_bf16 a[48:51], v[164:167], a[220:223], a[48:51]
v_exp_f32 v138, v138
v_mfma_f32_16x16x32_bf16 a[48:51], v[160:163], a[216:219], a[48:51]
ds_read_b128 a[172:175], v5 offset:8192
s_add_u32 m0, s40, 81920
v_mfma_f32_16x16x32_bf16 a[64:67], v[160:163], a[224:227], a[64:67]
v_exp_f32 v139, v139
v_mfma_f32_16x16x32_bf16 a[64:67], v[164:167], a[228:231], a[64:67]
ds_read_b128 a[176:179], v2 offset:12288
v_cvt_pk_bf16_f32 v213, v138, v139
v_mfma_f32_16x16x32_bf16 a[68:71], v[172:175], a[228:231], a[68:71]
v_exp_f32 v140, v140
v_mfma_f32_16x16x32_bf16 a[68:71], v[168:171], a[224:227], a[68:71]
buffer_load_dwordx4 v14, s[8:11], s42 offen offset:0 lds
v_mfma_f32_16x16x32_bf16 a[72:75], v[176:179], a[224:227], a[72:75]
v_exp_f32 v141, v141
v_mfma_f32_16x16x32_bf16 a[72:75], v[180:183], a[228:231], a[72:75]
ds_read_b128 a[180:183], v3 offset:12288
v_cvt_pk_bf16_f32 v220, v140, v141
v_mfma_f32_16x16x32_bf16 a[76:79], v[188:191], a[228:231], a[76:79]
v_exp_f32 v142, v142
v_mfma_f32_16x16x32_bf16 a[76:79], v[184:187], a[224:227], a[76:79]
ds_read_b128 a[184:187], v4 offset:12288
v_mfma_f32_16x16x32_bf16 a[92:95], v[184:187], a[232:235], a[92:95]
v_exp_f32 v143, v143
v_mfma_f32_16x16x32_bf16 a[92:95], v[188:191], a[236:239], a[92:95]
ds_read_b128 a[188:191], v5 offset:12288
v_cvt_pk_bf16_f32 v221, v142, v143
v_mfma_f32_16x16x32_bf16 a[88:91], v[180:183], a[236:239], a[88:91]
v_exp_f32 v144, v144
v_mfma_f32_16x16x32_bf16 a[88:91], v[176:179], a[232:235], a[88:91]
buffer_load_dwordx4 v15, s[8:11], s42 offen offset:1024 lds
v_mfma_f32_16x16x32_bf16 a[84:87], v[168:171], a[232:235], a[84:87]
v_exp_f32 v145, v145
v_mfma_f32_16x16x32_bf16 a[84:87], v[172:175], a[236:239], a[84:87]
v_cvt_pk_bf16_f32 v198, v144, v145
v_mfma_f32_16x16x32_bf16 a[80:83], v[164:167], a[236:239], a[80:83]
v_exp_f32 v146, v146
v_mfma_f32_16x16x32_bf16 a[80:83], v[160:163], a[232:235], a[80:83]
s_cmp_eq_u32 s43, 2
s_cselect_b32 s56, s3, 16777216
v_mfma_f32_16x16x32_bf16 a[96:99], v[160:163], a[240:243], a[96:99]
v_exp_f32 v147, v147
v_mfma_f32_16x16x32_bf16 a[96:99], v[164:167], a[244:247], a[96:99]
v_cvt_pk_bf16_f32 v199, v146, v147
v_mfma_f32_16x16x32_bf16 a[100:103], v[172:175], a[244:247], a[100:103]
v_exp_f32 v148, v148
v_mfma_f32_16x16x32_bf16 a[100:103], v[168:171], a[240:243], a[100:103]
buffer_load_dwordx4 v14, s[8:11], s42 offen offset:2048 lds
v_mfma_f32_16x16x32_bf16 a[104:107], v[176:179], a[240:243], a[104:107]
v_exp_f32 v149, v149
v_mfma_f32_16x16x32_bf16 a[104:107], v[180:183], a[244:247], a[104:107]
v_cvt_pk_bf16_f32 v206, v148, v149
v_mfma_f32_16x16x32_bf16 a[108:111], v[188:191], a[244:247], a[108:111]
v_exp_f32 v150, v150
v_mfma_f32_16x16x32_bf16 a[108:111], v[184:187], a[240:243], a[108:111]
buffer_load_dword v18, v24, s[72:75], s56 offen
v_mfma_f32_16x16x32_bf16 a[124:127], v[184:187], a[248:251], a[124:127]
v_exp_f32 v151, v151
v_mfma_f32_16x16x32_bf16 a[124:127], v[188:191], a[252:255], a[124:127]
v_cvt_pk_bf16_f32 v207, v150, v151
v_mfma_f32_16x16x32_bf16 a[120:123], v[180:183], a[252:255], a[120:123]
v_exp_f32 v152, v152
v_mfma_f32_16x16x32_bf16 a[120:123], v[176:179], a[248:251], a[120:123]
buffer_load_dwordx4 v15, s[8:11], s42 offen offset:3072 lds
s_add_u32 s42, s42, 16384
v_mfma_f32_16x16x32_bf16 a[116:119], v[168:171], a[248:251], a[116:119]
v_exp_f32 v153, v153
v_mfma_f32_16x16x32_bf16 a[116:119], v[172:175], a[252:255], a[116:119]
v_cvt_pk_bf16_f32 v214, v152, v153
v_mfma_f32_16x16x32_bf16 a[112:115], v[164:167], a[252:255], a[112:115]
v_exp_f32 v154, v154
v_mfma_f32_16x16x32_bf16 a[112:115], v[160:163], a[248:251], a[112:115]
s_waitcnt vmcnt(20) lgkmcnt(0)
s_barrier
v_smfmac_f32_16x16x64_bf16 v[240:243], v[28:31], v[160:167], v16
v_exp_f32 v155, v155
v_smfmac_f32_16x16x64_bf16 v[244:247], v[28:31], v[168:175], v16
v_cvt_pk_bf16_f32 v215, v154, v155
v_smfmac_f32_16x16x64_bf16 v[248:251], v[28:31], v[176:183], v16
v_exp_f32 v156, v156
v_smfmac_f32_16x16x64_bf16 v[252:255], v[28:31], v[184:191], v16
v_mfma_f32_16x16x32_bf16 v[96:99], a[128:131], v[32:35], v[224:227]
v_exp_f32 v157, v157
v_mfma_f32_16x16x32_bf16 v[96:99], a[132:135], v[36:39], v[96:99]
ds_read_b64_tr_b16 a[192:193], v6 offset:49152
v_cvt_pk_bf16_f32 v222, v156, v157
v_mfma_f32_16x16x32_bf16 v[96:99], a[136:139], v[40:43], v[96:99]
v_exp_f32 v158, v158
v_mfma_f32_16x16x32_bf16 v[96:99], a[140:143], v[44:47], v[96:99]
ds_read_b64_tr_b16 a[194:195], v6 offset:53248
v_mfma_f32_16x16x32_bf16 v[100:103], a[140:143], v[60:63], v[228:231]
v_exp_f32 v159, v159
v_mfma_f32_16x16x32_bf16 v[100:103], a[136:139], v[56:59], v[100:103]
ds_read_b64_tr_b16 a[196:197], v6 offset:57344
v_cvt_pk_bf16_f32 v223, v158, v159
v_mfma_f32_16x16x32_bf16 v[100:103], a[132:135], v[52:55], v[100:103]
s_add_u32 m0, s40, 0
v_mfma_f32_16x16x32_bf16 v[100:103], a[128:131], v[48:51], v[100:103]
ds_read_b64_tr_b16 a[198:199], v6 offset:61440
v_mfma_f32_16x16x32_bf16 v[104:107], a[128:131], v[64:67], v[232:235]
v_mfma_f32_16x16x32_bf16 v[104:107], a[132:135], v[68:71], v[104:107]
ds_read_b64_tr_b16 a[200:201], v7 offset:49152
v_mfma_f32_16x16x32_bf16 v[104:107], a[136:139], v[72:75], v[104:107]
v_exp_f32 v96, v96
v_mfma_f32_16x16x32_bf16 v[104:107], a[140:143], v[76:79], v[104:107]
ds_read_b64_tr_b16 a[202:203], v7 offset:53248
v_mfma_f32_16x16x32_bf16 v[108:111], a[140:143], v[92:95], v[236:239]
v_exp_f32 v97, v97
v_mfma_f32_16x16x32_bf16 v[108:111], a[136:139], v[88:91], v[108:111]
ds_read_b64_tr_b16 a[204:205], v7 offset:57344
v_cvt_pk_bf16_f32 v160, v96, v97
v_mfma_f32_16x16x32_bf16 v[108:111], a[132:135], v[84:87], v[108:111]
v_exp_f32 v98, v98
v_mfma_f32_16x16x32_bf16 v[108:111], a[128:131], v[80:83], v[108:111]
ds_read_b64_tr_b16 a[206:207], v7 offset:61440
v_mfma_f32_16x16x32_bf16 v[112:115], a[144:147], v[32:35], v[224:227]
v_exp_f32 v99, v99
v_mfma_f32_16x16x32_bf16 v[112:115], a[148:151], v[36:39], v[112:115]
ds_read_b64_tr_b16 a[208:209], v8 offset:49152
v_cvt_pk_bf16_f32 v161, v98, v99
v_mfma_f32_16x16x32_bf16 v[112:115], a[152:155], v[40:43], v[112:115]
v_exp_f32 v100, v100
v_mfma_f32_16x16x32_bf16 v[112:115], a[156:159], v[44:47], v[112:115]
ds_read_b64_tr_b16 a[210:211], v8 offset:53248
v_mfma_f32_16x16x32_bf16 v[116:119], a[156:159], v[60:63], v[228:231]
v_exp_f32 v101, v101
v_mfma_f32_16x16x32_bf16 v[116:119], a[152:155], v[56:59], v[116:119]
ds_read_b64_tr_b16 a[212:213], v8 offset:57344
v_cvt_pk_bf16_f32 v168, v100, v101
v_mfma_f32_16x16x32_bf16 v[116:119], a[148:151], v[52:55], v[116:119]
v_exp_f32 v102, v102
v_mfma_f32_16x16x32_bf16 v[116:119], a[144:147], v[48:51], v[116:119]
ds_read_b64_tr_b16 a[214:215], v8 offset:61440
v_mfma_f32_16x16x32_bf16 v[120:123], a[144:147], v[64:67], v[232:235]
v_exp_f32 v103, v103
v_mfma_f32_16x16x32_bf16 v[120:123], a[148:151], v[68:71], v[120:123]
ds_read_b64_tr_b16 a[216:217], v9 offset:49152
v_cvt_pk_bf16_f32 v169, v102, v103
v_mfma_f32_16x16x32_bf16 v[120:123], a[152:155], v[72:75], v[120:123]
v_exp_f32 v104, v104
v_mfma_f32_16x16x32_bf16 v[120:123], a[156:159], v[76:79], v[120:123]
ds_read_b64_tr_b16 a[218:219], v9 offset:53248
v_mfma_f32_16x16x32_bf16 v[124:127], a[156:159], v[92:95], v[236:239]
v_exp_f32 v105, v105
v_mfma_f32_16x16x32_bf16 v[124:127], a[152:155], v[88:91], v[124:127]
ds_read_b64_tr_b16 a[220:221], v9 offset:57344
v_cvt_pk_bf16_f32 v176, v104, v105
v_mfma_f32_16x16x32_bf16 v[124:127], a[148:151], v[84:87], v[124:127]
v_exp_f32 v106, v106
v_mfma_f32_16x16x32_bf16 v[124:127], a[144:147], v[80:83], v[124:127]
ds_read_b64_tr_b16 a[222:223], v9 offset:61440
v_mfma_f32_16x16x32_bf16 v[128:131], a[160:163], v[32:35], v[224:227]
v_exp_f32 v107, v107
v_mfma_f32_16x16x32_bf16 v[128:131], a[164:167], v[36:39], v[128:131]
ds_read_b64_tr_b16 a[224:225], v10 offset:49152
v_cvt_pk_bf16_f32 v177, v106, v107
v_mfma_f32_16x16x32_bf16 v[128:131], a[168:171], v[40:43], v[128:131]
v_exp_f32 v108, v108
v_mfma_f32_16x16x32_bf16 v[128:131], a[172:175], v[44:47], v[128:131]
ds_read_b64_tr_b16 a[226:227], v10 offset:53248
v_mfma_f32_16x16x32_bf16 v[132:135], a[172:175], v[60:63], v[228:231]
v_exp_f32 v109, v109
v_mfma_f32_16x16x32_bf16 v[132:135], a[168:171], v[56:59], v[132:135]
ds_read_b64_tr_b16 a[228:229], v10 offset:57344
v_cvt_pk_bf16_f32 v184, v108, v109
v_mfma_f32_16x16x32_bf16 v[132:135], a[164:167], v[52:55], v[132:135]
v_exp_f32 v110, v110
v_mfma_f32_16x16x32_bf16 v[132:135], a[160:163], v[48:51], v[132:135]
ds_read_b64_tr_b16 a[230:231], v10 offset:61440
v_mfma_f32_16x16x32_bf16 v[136:139], a[160:163], v[64:67], v[232:235]
v_exp_f32 v111, v111
v_mfma_f32_16x16x32_bf16 v[136:139], a[164:167], v[68:71], v[136:139]
ds_read_b64_tr_b16 a[232:233], v11 offset:49152
v_cvt_pk_bf16_f32 v185, v110, v111
v_mfma_f32_16x16x32_bf16 v[136:139], a[168:171], v[72:75], v[136:139]
v_exp_f32 v112, v112
v_mfma_f32_16x16x32_bf16 v[136:139], a[172:175], v[76:79], v[136:139]
ds_read_b64_tr_b16 a[234:235], v11 offset:53248
v_mfma_f32_16x16x32_bf16 v[140:143], a[172:175], v[92:95], v[236:239]
v_exp_f32 v113, v113
v_mfma_f32_16x16x32_bf16 v[140:143], a[168:171], v[88:91], v[140:143]
ds_read_b64_tr_b16 a[236:237], v11 offset:57344
v_cvt_pk_bf16_f32 v162, v112, v113
v_mfma_f32_16x16x32_bf16 v[140:143], a[164:167], v[84:87], v[140:143]
v_exp_f32 v114, v114
v_mfma_f32_16x16x32_bf16 v[140:143], a[160:163], v[80:83], v[140:143]
ds_read_b64_tr_b16 a[238:239], v11 offset:61440
v_mfma_f32_16x16x32_bf16 v[144:147], a[176:179], v[32:35], v[224:227]
v_exp_f32 v115, v115
v_mfma_f32_16x16x32_bf16 v[144:147], a[180:183], v[36:39], v[144:147]
ds_read_b64_tr_b16 a[240:241], v12 offset:49152
v_cvt_pk_bf16_f32 v163, v114, v115
v_mfma_f32_16x16x32_bf16 v[144:147], a[184:187], v[40:43], v[144:147]
v_exp_f32 v116, v116
v_mfma_f32_16x16x32_bf16 v[144:147], a[188:191], v[44:47], v[144:147]
ds_read_b64_tr_b16 a[242:243], v12 offset:53248
v_mfma_f32_16x16x32_bf16 v[148:151], a[188:191], v[60:63], v[228:231]
v_exp_f32 v117, v117
v_mfma_f32_16x16x32_bf16 v[148:151], a[184:187], v[56:59], v[148:151]
ds_read_b64_tr_b16 a[244:245], v12 offset:57344
v_cvt_pk_bf16_f32 v170, v116, v117
v_mfma_f32_16x16x32_bf16 v[148:151], a[180:183], v[52:55], v[148:151]
v_exp_f32 v118, v118
v_mfma_f32_16x16x32_bf16 v[148:151], a[176:179], v[48:51], v[148:151]
ds_read_b64_tr_b16 a[246:247], v12 offset:61440
v_mfma_f32_16x16x32_bf16 v[152:155], a[176:179], v[64:67], v[232:235]
v_exp_f32 v119, v119
v_mfma_f32_16x16x32_bf16 v[152:155], a[180:183], v[68:71], v[152:155]
ds_read_b64_tr_b16 a[248:249], v13 offset:49152
v_cvt_pk_bf16_f32 v171, v118, v119
v_mfma_f32_16x16x32_bf16 v[152:155], a[184:187], v[72:75], v[152:155]
v_exp_f32 v120, v120
v_mfma_f32_16x16x32_bf16 v[152:155], a[188:191], v[76:79], v[152:155]
ds_read_b64_tr_b16 a[250:251], v13 offset:53248
v_mfma_f32_16x16x32_bf16 v[156:159], a[188:191], v[92:95], v[236:239]
v_exp_f32 v121, v121
v_mfma_f32_16x16x32_bf16 v[156:159], a[184:187], v[88:91], v[156:159]
ds_read_b64_tr_b16 a[252:253], v13 offset:57344
v_cvt_pk_bf16_f32 v178, v120, v121
v_mfma_f32_16x16x32_bf16 v[156:159], a[180:183], v[84:87], v[156:159]
v_exp_f32 v122, v122
v_mfma_f32_16x16x32_bf16 v[156:159], a[176:179], v[80:83], v[156:159]
ds_read_b64_tr_b16 a[254:255], v13 offset:61440
s_waitcnt lgkmcnt(8)
v_mfma_f32_16x16x32_bf16 a[0:3], v[192:195], a[192:195], a[0:3]
v_exp_f32 v123, v123
v_mfma_f32_16x16x32_bf16 a[0:3], v[196:199], a[196:199], a[0:3]
ds_read_b128 a[128:131], v2 offset:16384
v_cvt_pk_bf16_f32 v179, v122, v123
v_mfma_f32_16x16x32_bf16 a[4:7], v[204:207], a[196:199], a[4:7]
v_exp_f32 v124, v124
v_mfma_f32_16x16x32_bf16 a[4:7], v[200:203], a[192:195], a[4:7]
buffer_load_dwordx4 v14, s[4:7], s41 offen offset:0 lds
v_mfma_f32_16x16x32_bf16 a[8:11], v[208:211], a[192:195], a[8:11]
v_exp_f32 v125, v125
v_mfma_f32_16x16x32_bf16 a[8:11], v[212:215], a[196:199], a[8:11]
ds_read_b128 a[132:135], v3 offset:16384
v_cvt_pk_bf16_f32 v186, v124, v125
v_mfma_f32_16x16x32_bf16 a[12:15], v[220:223], a[196:199], a[12:15]
v_exp_f32 v126, v126
v_mfma_f32_16x16x32_bf16 a[12:15], v[216:219], a[192:195], a[12:15]
ds_read_b128 a[136:139], v4 offset:16384
v_mfma_f32_16x16x32_bf16 a[28:31], v[216:219], a[200:203], a[28:31]
v_exp_f32 v127, v127
v_mfma_f32_16x16x32_bf16 a[28:31], v[220:223], a[204:207], a[28:31]
ds_read_b128 a[140:143], v5 offset:16384
v_cvt_pk_bf16_f32 v187, v126, v127
v_mfma_f32_16x16x32_bf16 a[24:27], v[212:215], a[204:207], a[24:27]
v_exp_f32 v128, v128
v_mfma_f32_16x16x32_bf16 a[24:27], v[208:211], a[200:203], a[24:27]
buffer_load_dwordx4 v15, s[4:7], s41 offen offset:1024 lds
s_waitcnt lgkmcnt(4)
v_mfma_f32_16x16x32_bf16 a[20:23], v[200:203], a[200:203], a[20:23]
v_exp_f32 v129, v129
v_mfma_f32_16x16x32_bf16 a[20:23], v[204:207], a[204:207], a[20:23]
ds_read_b128 a[144:147], v2 offset:20480
v_cvt_pk_bf16_f32 v164, v128, v129
v_mfma_f32_16x16x32_bf16 a[16:19], v[196:199], a[204:207], a[16:19]
v_exp_f32 v130, v130
v_mfma_f32_16x16x32_bf16 a[16:19], v[192:195], a[200:203], a[16:19]
ds_read_b128 a[148:151], v3 offset:20480
v_mfma_f32_16x16x32_bf16 a[32:35], v[192:195], a[208:211], a[32:35]
v_exp_f32 v131, v131
v_mfma_f32_16x16x32_bf16 a[32:35], v[196:199], a[212:215], a[32:35]
ds_read_b128 a[152:155], v4 offset:20480
v_cvt_pk_bf16_f32 v165, v130, v131
v_mfma_f32_16x16x32_bf16 a[36:39], v[204:207], a[212:215], a[36:39]
v_exp_f32 v132, v132
v_mfma_f32_16x16x32_bf16 a[36:39], v[200:203], a[208:211], a[36:39]
buffer_load_dwordx4 v14, s[4:7], s41 offen offset:2048 lds
v_mfma_f32_16x16x32_bf16 a[40:43], v[208:211], a[208:211], a[40:43]
v_exp_f32 v133, v133
v_mfma_f32_16x16x32_bf16 a[40:43], v[212:215], a[212:215], a[40:43]
ds_read_b128 a[156:159], v5 offset:20480
v_cvt_pk_bf16_f32 v172, v132, v133
v_mfma_f32_16x16x32_bf16 a[44:47], v[220:223], a[212:215], a[44:47]
v_exp_f32 v134, v134
v_mfma_f32_16x16x32_bf16 a[44:47], v[216:219], a[208:211], a[44:47]
ds_read_b128 a[160:163], v2 offset:24576
v_mfma_f32_16x16x32_bf16 a[60:63], v[216:219], a[216:219], a[60:63]
v_exp_f32 v135, v135
v_mfma_f32_16x16x32_bf16 a[60:63], v[220:223], a[220:223], a[60:63]
ds_read_b128 a[164:167], v3 offset:24576
v_cvt_pk_bf16_f32 v173, v134, v135
v_mfma_f32_16x16x32_bf16 a[56:59], v[212:215], a[220:223], a[56:59]
v_exp_f32 v136, v136
v_mfma_f32_16x16x32_bf16 a[56:59], v[208:211], a[216:219], a[56:59]
buffer_load_dwordx4 v15, s[4:7], s41 offen offset:3072 lds
s_add_u32 s41, s41, 16384
v_mfma_f32_16x16x32_bf16 a[52:55], v[200:203], a[216:219], a[52:55]
v_exp_f32 v137, v137
v_mfma_f32_16x16x32_bf16 a[52:55], v[204:207], a[220:223], a[52:55]
ds_read_b128 a[168:171], v4 offset:24576
v_cvt_pk_bf16_f32 v180, v136, v137
v_mfma_f32_16x16x32_bf16 a[48:51], v[196:199], a[220:223], a[48:51]
v_exp_f32 v138, v138
v_mfma_f32_16x16x32_bf16 a[48:51], v[192:195], a[216:219], a[48:51]
ds_read_b128 a[172:175], v5 offset:24576
s_add_u32 m0, s40, 98304
v_mfma_f32_16x16x32_bf16 a[64:67], v[192:195], a[224:227], a[64:67]
v_exp_f32 v139, v139
v_mfma_f32_16x16x32_bf16 a[64:67], v[196:199], a[228:231], a[64:67]
ds_read_b128 a[176:179], v2 offset:28672
v_cvt_pk_bf16_f32 v181, v138, v139
v_mfma_f32_16x16x32_bf16 a[68:71], v[204:207], a[228:231], a[68:71]
v_exp_f32 v140, v140
v_mfma_f32_16x16x32_bf16 a[68:71], v[200:203], a[224:227], a[68:71]
buffer_load_dwordx4 v14, s[8:11], s42 offen offset:0 lds
v_mfma_f32_16x16x32_bf16 a[72:75], v[208:211], a[224:227], a[72:75]
v_exp_f32 v141, v141
v_mfma_f32_16x16x32_bf16 a[72:75], v[212:215], a[228:231], a[72:75]
ds_read_b128 a[180:183], v3 offset:28672
v_cvt_pk_bf16_f32 v188, v140, v141
v_mfma_f32_16x16x32_bf16 a[76:79], v[220:223], a[228:231], a[76:79]
v_exp_f32 v142, v142
v_mfma_f32_16x16x32_bf16 a[76:79], v[216:219], a[224:227], a[76:79]
ds_read_b128 a[184:187], v4 offset:28672
v_mfma_f32_16x16x32_bf16 a[92:95], v[216:219], a[232:235], a[92:95]
v_exp_f32 v143, v143
v_mfma_f32_16x16x32_bf16 a[92:95], v[220:223], a[236:239], a[92:95]
ds_read_b128 a[188:191], v5 offset:28672
v_cvt_pk_bf16_f32 v189, v142, v143
v_mfma_f32_16x16x32_bf16 a[88:91], v[212:215], a[236:239], a[88:91]
v_exp_f32 v144, v144
v_mfma_f32_16x16x32_bf16 a[88:91], v[208:211], a[232:235], a[88:91]
buffer_load_dwordx4 v15, s[8:11], s42 offen offset:1024 lds
v_mfma_f32_16x16x32_bf16 a[84:87], v[200:203], a[232:235], a[84:87]
v_exp_f32 v145, v145
v_mfma_f32_16x16x32_bf16 a[84:87], v[204:207], a[236:239], a[84:87]
v_cvt_pk_bf16_f32 v166, v144, v145
v_mfma_f32_16x16x32_bf16 a[80:83], v[196:199], a[236:239], a[80:83]
v_exp_f32 v146, v146
v_mfma_f32_16x16x32_bf16 a[80:83], v[192:195], a[232:235], a[80:83]
v_mfma_f32_16x16x32_bf16 a[96:99], v[192:195], a[240:243], a[96:99]
v_exp_f32 v147, v147
v_mfma_f32_16x16x32_bf16 a[96:99], v[196:199], a[244:247], a[96:99]
v_cvt_pk_bf16_f32 v167, v146, v147
v_mfma_f32_16x16x32_bf16 a[100:103], v[204:207], a[244:247], a[100:103]
v_exp_f32 v148, v148
v_mfma_f32_16x16x32_bf16 a[100:103], v[200:203], a[240:243], a[100:103]
buffer_load_dwordx4 v14, s[8:11], s42 offen offset:2048 lds
v_mfma_f32_16x16x32_bf16 a[104:107], v[208:211], a[240:243], a[104:107]
v_exp_f32 v149, v149
v_mfma_f32_16x16x32_bf16 a[104:107], v[212:215], a[244:247], a[104:107]
v_cvt_pk_bf16_f32 v174, v148, v149
v_mfma_f32_16x16x32_bf16 a[108:111], v[220:223], a[244:247], a[108:111]
v_exp_f32 v150, v150
v_mfma_f32_16x16x32_bf16 a[108:111], v[216:219], a[240:243], a[108:111]
v_mfma_f32_16x16x32_bf16 a[124:127], v[216:219], a[248:251], a[124:127]
v_exp_f32 v151, v151
v_mfma_f32_16x16x32_bf16 a[124:127], v[220:223], a[252:255], a[124:127]
v_cvt_pk_bf16_f32 v175, v150, v151
v_mfma_f32_16x16x32_bf16 a[120:123], v[212:215], a[252:255], a[120:123]
v_exp_f32 v152, v152
v_mfma_f32_16x16x32_bf16 a[120:123], v[208:211], a[248:251], a[120:123]
buffer_load_dwordx4 v15, s[8:11], s42 offen offset:3072 lds
s_add_u32 s42, s42, 16384
v_mfma_f32_16x16x32_bf16 a[116:119], v[200:203], a[248:251], a[116:119]
v_exp_f32 v153, v153
v_mfma_f32_16x16x32_bf16 a[116:119], v[204:207], a[252:255], a[116:119]
v_cvt_pk_bf16_f32 v182, v152, v153
v_mfma_f32_16x16x32_bf16 a[112:115], v[196:199], a[252:255], a[112:115]
v_exp_f32 v154, v154
v_mfma_f32_16x16x32_bf16 a[112:115], v[192:195], a[248:251], a[112:115]
s_waitcnt vmcnt(17) lgkmcnt(0)
s_barrier
v_smfmac_f32_16x16x64_bf16 v[240:243], v[28:31], v[192:199], v16
v_exp_f32 v155, v155
v_smfmac_f32_16x16x64_bf16 v[244:247], v[28:31], v[200:207], v16
v_cvt_pk_bf16_f32 v183, v154, v155
v_smfmac_f32_16x16x64_bf16 v[248:251], v[28:31], v[208:215], v16
v_exp_f32 v156, v156
v_smfmac_f32_16x16x64_bf16 v[252:255], v[28:31], v[216:223], v16
v_mfma_f32_16x16x32_bf16 v[96:99], a[128:131], v[32:35], v[224:227]
v_exp_f32 v157, v157
K_pg5:
s_cbranch_execz K_pg8
v_mfma_f32_16x16x32_bf16 v[96:99], a[132:135], v[36:39], v[96:99]
ds_read_b64_tr_b16 a[192:193], v6 offset:0
v_cvt_pk_bf16_f32 v190, v156, v157
v_mfma_f32_16x16x32_bf16 v[96:99], a[136:139], v[40:43], v[96:99]
v_exp_f32 v158, v158
v_mfma_f32_16x16x32_bf16 v[96:99], a[140:143], v[44:47], v[96:99]
ds_read_b64_tr_b16 a[194:195], v6 offset:4096
v_mfma_f32_16x16x32_bf16 v[100:103], a[140:143], v[60:63], v[228:231]
v_exp_f32 v159, v159
v_mfma_f32_16x16x32_bf16 v[100:103], a[136:139], v[56:59], v[100:103]
ds_read_b64_tr_b16 a[196:197], v6 offset:8192
v_cvt_pk_bf16_f32 v191, v158, v159
v_mfma_f32_16x16x32_bf16 v[100:103], a[132:135], v[52:55], v[100:103]
s_add_u32 m0, s40, 16384
v_mfma_f32_16x16x32_bf16 v[100:103], a[128:131], v[48:51], v[100:103]
ds_read_b64_tr_b16 a[198:199], v6 offset:12288
v_mfma_f32_16x16x32_bf16 v[104:107], a[128:131], v[64:67], v[232:235]
s_sub_u32 s101, s101, 5120
v_mfma_f32_16x16x32_bf16 v[104:107], a[132:135], v[68:71], v[104:107]
ds_read_b64_tr_b16 a[200:201], v7 offset:0
v_mfma_f32_16x16x32_bf16 v[104:107], a[136:139], v[72:75], v[104:107]
v_exp_f32 v96, v96
v_mfma_f32_16x16x32_bf16 v[104:107], a[140:143], v[76:79], v[104:107]
ds_read_b64_tr_b16 a[202:203], v7 offset:4096
v_mfma_f32_16x16x32_bf16 v[108:111], a[140:143], v[92:95], v[236:239]
v_exp_f32 v97, v97
v_mfma_f32_16x16x32_bf16 v[108:111], a[136:139], v[88:91], v[108:111]
ds_read_b64_tr_b16 a[204:205], v7 offset:8192
v_cvt_pk_bf16_f32 v192, v96, v97
v_mfma_f32_16x16x32_bf16 v[108:111], a[132:135], v[84:87], v[108:111]
v_exp_f32 v98, v98
v_mfma_f32_16x16x32_bf16 v[108:111], a[128:131], v[80:83], v[108:111]
ds_read_b64_tr_b16 a[206:207], v7 offset:12288
v_mfma_f32_16x16x32_bf16 v[112:115], a[144:147], v[32:35], v[224:227]
v_exp_f32 v99, v99
v_mfma_f32_16x16x32_bf16 v[112:115], a[148:151], v[36:39], v[112:115]
ds_read_b64_tr_b16 a[208:209], v8 offset:0
v_cvt_pk_bf16_f32 v193, v98, v99
v_mfma_f32_16x16x32_bf16 v[112:115], a[152:155], v[40:43], v[112:115]
v_exp_f32 v100, v100
v_mfma_f32_16x16x32_bf16 v[112:115], a[156:159], v[44:47], v[112:115]
ds_read_b64_tr_b16 a[210:211], v8 offset:4096
v_mfma_f32_16x16x32_bf16 v[116:119], a[156:159], v[60:63], v[228:231]
v_exp_f32 v101, v101
v_mfma_f32_16x16x32_bf16 v[116:119], a[152:155], v[56:59], v[116:119]
ds_read_b64_tr_b16 a[212:213], v8 offset:8192
v_cvt_pk_bf16_f32 v200, v100, v101
v_mfma_f32_16x16x32_bf16 v[116:119], a[148:151], v[52:55], v[116:119]
v_exp_f32 v102, v102
v_mfma_f32_16x16x32_bf16 v[116:119], a[144:147], v[48:51], v[116:119]
ds_read_b64_tr_b16 a[214:215], v8 offset:12288
v_mfma_f32_16x16x32_bf16 v[120:123], a[144:147], v[64:67], v[232:235]
v_exp_f32 v103, v103
v_mfma_f32_16x16x32_bf16 v[120:123], a[148:151], v[68:71], v[120:123]
ds_read_b64_tr_b16 a[216:217], v9 offset:0
v_cvt_pk_bf16_f32 v201, v102, v103
v_mfma_f32_16x16x32_bf16 v[120:123], a[152:155], v[72:75], v[120:123]
v_exp_f32 v104, v104
v_mfma_f32_16x16x32_bf16 v[120:123], a[156:159], v[76:79], v[120:123]
ds_read_b64_tr_b16 a[218:219], v9 offset:4096
v_mfma_f32_16x16x32_bf16 v[124:127], a[156:159], v[92:95], v[236:239]
v_exp_f32 v105, v105
v_mfma_f32_16x16x32_bf16 v[124:127], a[152:155], v[88:91], v[124:127]
ds_read_b64_tr_b16 a[220:221], v9 offset:8192
v_cvt_pk_bf16_f32 v208, v104, v105
v_mfma_f32_16x16x32_bf16 v[124:127], a[148:151], v[84:87], v[124:127]
v_exp_f32 v106, v106
v_mfma_f32_16x16x32_bf16 v[124:127], a[144:147], v[80:83], v[124:127]
ds_read_b64_tr_b16 a[222:223], v9 offset:12288
v_mfma_f32_16x16x32_bf16 v[128:131], a[160:163], v[32:35], v[224:227]
v_exp_f32 v107, v107
v_mfma_f32_16x16x32_bf16 v[128:131], a[164:167], v[36:39], v[128:131]
ds_read_b64_tr_b16 a[224:225], v10 offset:0
v_cvt_pk_bf16_f32 v209, v106, v107
v_mfma_f32_16x16x32_bf16 v[128:131], a[168:171], v[40:43], v[128:131]
v_exp_f32 v108, v108
v_mfma_f32_16x16x32_bf16 v[128:131], a[172:175], v[44:47], v[128:131]
ds_read_b64_tr_b16 a[226:227], v10 offset:4096
v_mfma_f32_16x16x32_bf16 v[132:135], a[172:175], v[60:63], v[228:231]
v_exp_f32 v109, v109
v_mfma_f32_16x16x32_bf16 v[132:135], a[168:171], v[56:59], v[132:135]
ds_read_b64_tr_b16 a[228:229], v10 offset:8192
v_cvt_pk_bf16_f32 v216, v108, v109
v_mfma_f32_16x16x32_bf16 v[132:135], a[164:167], v[52:55], v[132:135]
v_exp_f32 v110, v110
v_mfma_f32_16x16x32_bf16 v[132:135], a[160:163], v[48:51], v[132:135]
ds_read_b64_tr_b16 a[230:231], v10 offset:12288
v_mfma_f32_16x16x32_bf16 v[136:139], a[160:163], v[64:67], v[232:235]
v_exp_f32 v111, v111
v_mfma_f32_16x16x32_bf16 v[136:139], a[164:167], v[68:71], v[136:139]
ds_read_b64_tr_b16 a[232:233], v11 offset:0
v_cvt_pk_bf16_f32 v217, v110, v111
v_mfma_f32_16x16x32_bf16 v[136:139], a[168:171], v[72:75], v[136:139]
v_exp_f32 v112, v112
v_mfma_f32_16x16x32_bf16 v[136:139], a[172:175], v[76:79], v[136:139]
ds_read_b64_tr_b16 a[234:235], v11 offset:4096
v_mfma_f32_16x16x32_bf16 v[140:143], a[172:175], v[92:95], v[236:239]
v_exp_f32 v113, v113
v_mfma_f32_16x16x32_bf16 v[140:143], a[168:171], v[88:91], v[140:143]
ds_read_b64_tr_b16 a[236:237], v11 offset:8192
v_cvt_pk_bf16_f32 v194, v112, v113
v_mfma_f32_16x16x32_bf16 v[140:143], a[164:167], v[84:87], v[140:143]
v_exp_f32 v114, v114
v_mfma_f32_16x16x32_bf16 v[140:143], a[160:163], v[80:83], v[140:143]
ds_read_b64_tr_b16 a[238:239], v11 offset:12288
v_mfma_f32_16x16x32_bf16 v[144:147], a[176:179], v[32:35], v[224:227]
v_exp_f32 v115, v115
v_mfma_f32_16x16x32_bf16 v[144:147], a[180:183], v[36:39], v[144:147]
ds_read_b64_tr_b16 a[240:241], v12 offset:0
v_cvt_pk_bf16_f32 v195, v114, v115
v_mfma_f32_16x16x32_bf16 v[144:147], a[184:187], v[40:43], v[144:147]
v_exp_f32 v116, v116
v_mfma_f32_16x16x32_bf16 v[144:147], a[188:191], v[44:47], v[144:147]
ds_read_b64_tr_b16 a[242:243], v12 offset:4096
v_mfma_f32_16x16x32_bf16 v[148:151], a[188:191], v[60:63], v[228:231]
v_exp_f32 v117, v117
v_mfma_f32_16x16x32_bf16 v[148:151], a[184:187], v[56:59], v[148:151]
ds_read_b64_tr_b16 a[244:245], v12 offset:8192
v_cvt_pk_bf16_f32 v202, v116, v117
v_mfma_f32_16x16x32_bf16 v[148:151], a[180:183], v[52:55], v[148:151]
v_exp_f32 v118, v118
v_mfma_f32_16x16x32_bf16 v[148:151], a[176:179], v[48:51], v[148:151]
ds_read_b64_tr_b16 a[246:247], v12 offset:12288
v_mfma_f32_16x16x32_bf16 v[152:155], a[176:179], v[64:67], v[232:235]
v_exp_f32 v119, v119
v_mfma_f32_16x16x32_bf16 v[152:155], a[180:183], v[68:71], v[152:155]
ds_read_b64_tr_b16 a[248:249], v13 offset:0
v_cvt_pk_bf16_f32 v203, v118, v119
v_mfma_f32_16x16x32_bf16 v[152:155], a[184:187], v[72:75], v[152:155]
v_exp_f32 v120, v120
v_mfma_f32_16x16x32_bf16 v[152:155], a[188:191], v[76:79], v[152:155]
ds_read_b64_tr_b16 a[250:251], v13 offset:4096
v_mfma_f32_16x16x32_bf16 v[156:159], a[188:191], v[92:95], v[236:239]
v_exp_f32 v121, v121
v_mfma_f32_16x16x32_bf16 v[156:159], a[184:187], v[88:91], v[156:159]
ds_read_b64_tr_b16 a[252:253], v13 offset:8192
v_cvt_pk_bf16_f32 v210, v120, v121
v_mfma_f32_16x16x32_bf16 v[156:159], a[180:183], v[84:87], v[156:159]
v_exp_f32 v122, v122
v_mfma_f32_16x16x32_bf16 v[156:159], a[176:179], v[80:83], v[156:159]
ds_read_b64_tr_b16 a[254:255], v13 offset:12288
s_waitcnt lgkmcnt(8)
v_mfma_f32_16x16x32_bf16 a[0:3], v[160:163], a[192:195], a[0:3]
v_exp_f32 v123, v123
v_mfma_f32_16x16x32_bf16 a[0:3], v[164:167], a[196:199], a[0:3]
ds_read_b128 a[128:131], v2 offset:32768
v_cvt_pk_bf16_f32 v211, v122, v123
v_mfma_f32_16x16x32_bf16 a[4:7], v[172:175], a[196:199], a[4:7]
v_exp_f32 v124, v124
v_mfma_f32_16x16x32_bf16 a[4:7], v[168:171], a[192:195], a[4:7]
buffer_load_dwordx4 v14, s[4:7], s41 offen offset:0 lds
v_mfma_f32_16x16x32_bf16 a[8:11], v[176:179], a[192:195], a[8:11]
v_exp_f32 v125, v125
v_mfma_f32_16x16x32_bf16 a[8:11], v[180:183], a[196:199], a[8:11]
ds_read_b128 a[132:135], v3 offset:32768
v_cvt_pk_bf16_f32 v218, v124, v125
v_mfma_f32_16x16x32_bf16 a[12:15], v[188:191], a[196:199], a[12:15]
v_exp_f32 v126, v126
v_mfma_f32_16x16x32_bf16 a[12:15], v[184:187], a[192:195], a[12:15]
ds_read_b128 a[136:139], v4 offset:32768
v_mfma_f32_16x16x32_bf16 a[28:31], v[184:187], a[200:203], a[28:31]
v_exp_f32 v127, v127
v_mfma_f32_16x16x32_bf16 a[28:31], v[188:191], a[204:207], a[28:31]
ds_read_b128 a[140:143], v5 offset:32768
v_cvt_pk_bf16_f32 v219, v126, v127
v_mfma_f32_16x16x32_bf16 a[24:27], v[180:183], a[204:207], a[24:27]
v_exp_f32 v128, v128
v_mfma_f32_16x16x32_bf16 a[24:27], v[176:179], a[200:203], a[24:27]
buffer_load_dwordx4 v15, s[4:7], s41 offen offset:1024 lds
s_waitcnt lgkmcnt(4)
v_mfma_f32_16x16x32_bf16 a[20:23], v[168:171], a[200:203], a[20:23]
v_exp_f32 v129, v129
v_mfma_f32_16x16x32_bf16 a[20:23], v[172:175], a[204:207], a[20:23]
ds_read_b128 a[144:147], v2 offset:36864
v_cvt_pk_bf16_f32 v196, v128, v129
v_mfma_f32_16x16x32_bf16 a[16:19], v[164:167], a[204:207], a[16:19]
v_exp_f32 v130, v130
v_mfma_f32_16x16x32_bf16 a[16:19], v[160:163], a[200:203], a[16:19]
ds_read_b128 a[148:151], v3 offset:36864
v_mfma_f32_16x16x32_bf16 a[32:35], v[160:163], a[208:211], a[32:35]
v_exp_f32 v131, v131
v_mfma_f32_16x16x32_bf16 a[32:35], v[164:167], a[212:215], a[32:35]
ds_read_b128 a[152:155], v4 offset:36864
v_cvt_pk_bf16_f32 v197, v130, v131
v_mfma_f32_16x16x32_bf16 a[36:39], v[172:175], a[212:215], a[36:39]
v_exp_f32 v132, v132
v_mfma_f32_16x16x32_bf16 a[36:39], v[168:171], a[208:211], a[36:39]
buffer_load_dwordx4 v14, s[4:7], s41 offen offset:2048 lds
v_mfma_f32_16x16x32_bf16 a[40:43], v[176:179], a[208:211], a[40:43]
v_exp_f32 v133, v133
v_mfma_f32_16x16x32_bf16 a[40:43], v[180:183], a[212:215], a[40:43]
ds_read_b128 a[156:159], v5 offset:36864
v_cvt_pk_bf16_f32 v204, v132, v133
v_mfma_f32_16x16x32_bf16 a[44:47], v[188:191], a[212:215], a[44:47]
v_exp_f32 v134, v134
v_mfma_f32_16x16x32_bf16 a[44:47], v[184:187], a[208:211], a[44:47]
ds_read_b128 a[160:163], v2 offset:40960
v_mfma_f32_16x16x32_bf16 a[60:63], v[184:187], a[216:219], a[60:63]
v_exp_f32 v135, v135
v_mfma_f32_16x16x32_bf16 a[60:63], v[188:191], a[220:223], a[60:63]
ds_read_b128 a[164:167], v3 offset:40960
v_cvt_pk_bf16_f32 v205, v134, v135
v_mfma_f32_16x16x32_bf16 a[56:59], v[180:183], a[220:223], a[56:59]
v_exp_f32 v136, v136
v_mfma_f32_16x16x32_bf16 a[56:59], v[176:179], a[216:219], a[56:59]
buffer_load_dwordx4 v15, s[4:7], s41 offen offset:3072 lds
s_add_u32 s41, s41, 16384
v_mfma_f32_16x16x32_bf16 a[52:55], v[168:171], a[216:219], a[52:55]
v_exp_f32 v137, v137
v_mfma_f32_16x16x32_bf16 a[52:55], v[172:175], a[220:223], a[52:55]
ds_read_b128 a[168:171], v4 offset:40960
v_cvt_pk_bf16_f32 v212, v136, v137
v_mfma_f32_16x16x32_bf16 a[48:51], v[164:167], a[220:223], a[48:51]
v_exp_f32 v138, v138
v_mfma_f32_16x16x32_bf16 a[48:51], v[160:163], a[216:219], a[48:51]
ds_read_b128 a[172:175], v5 offset:40960
s_add_u32 m0, s40, 114688
v_mfma_f32_16x16x32_bf16 a[64:67], v[160:163], a[224:227], a[64:67]
v_exp_f32 v139, v139
v_mfma_f32_16x16x32_bf16 a[64:67], v[164:167], a[228:231], a[64:67]
ds_read_b128 a[176:179], v2 offset:45056
v_cvt_pk_bf16_f32 v213, v138, v139
v_mfma_f32_16x16x32_bf16 a[68:71], v[172:175], a[228:231], a[68:71]
v_exp_f32 v140, v140
v_mfma_f32_16x16x32_bf16 a[68:71], v[168:171], a[224:227], a[68:71]
buffer_load_dwordx4 v14, s[8:11], s42 offen offset:0 lds
v_mfma_f32_16x16x32_bf16 a[72:75], v[176:179], a[224:227], a[72:75]
v_exp_f32 v141, v141
v_mfma_f32_16x16x32_bf16 a[72:75], v[180:183], a[228:231], a[72:75]
ds_read_b128 a[180:183], v3 offset:45056
v_cvt_pk_bf16_f32 v220, v140, v141
v_mfma_f32_16x16x32_bf16 a[76:79], v[188:191], a[228:231], a[76:79]
v_exp_f32 v142, v142
v_mfma_f32_16x16x32_bf16 a[76:79], v[184:187], a[224:227], a[76:79]
ds_read_b128 a[184:187], v4 offset:45056
v_mfma_f32_16x16x32_bf16 a[92:95], v[184:187], a[232:235], a[92:95]
v_exp_f32 v143, v143
v_mfma_f32_16x16x32_bf16 a[92:95], v[188:191], a[236:239], a[92:95]
ds_read_b128 a[188:191], v5 offset:45056
v_cvt_pk_bf16_f32 v221, v142, v143
v_mfma_f32_16x16x32_bf16 a[88:91], v[180:183], a[236:239], a[88:91]
v_exp_f32 v144, v144
v_mfma_f32_16x16x32_bf16 a[88:91], v[176:179], a[232:235], a[88:91]
buffer_load_dwordx4 v15, s[8:11], s42 offen offset:1024 lds
v_mfma_f32_16x16x32_bf16 a[84:87], v[168:171], a[232:235], a[84:87]
v_exp_f32 v145, v145
v_mfma_f32_16x16x32_bf16 a[84:87], v[172:175], a[236:239], a[84:87]
v_cmp_gt_u32 vcc, 32, v20
v_cvt_pk_bf16_f32 v198, v144, v145
v_mfma_f32_16x16x32_bf16 a[80:83], v[164:167], a[236:239], a[80:83]
v_exp_f32 v146, v146
v_mfma_f32_16x16x32_bf16 a[80:83], v[160:163], a[232:235], a[80:83]
buffer_load_dword v18, v24, s[28:31], s59 offen
v_mfma_f32_16x16x32_bf16 a[96:99], v[160:163], a[240:243], a[96:99]
v_exp_f32 v147, v147
v_mfma_f32_16x16x32_bf16 a[96:99], v[164:167], a[244:247], a[96:99]
s_cmp_eq_u64 vcc, 0
s_cselect_b32 s56, s101, 67108864
v_cvt_pk_bf16_f32 v199, v146, v147
v_mfma_f32_16x16x32_bf16 a[100:103], v[172:175], a[244:247], a[100:103]
v_exp_f32 v148, v148
v_mfma_f32_16x16x32_bf16 a[100:103], v[168:171], a[240:243], a[100:103]
buffer_load_dwordx4 v14, s[8:11], s42 offen offset:2048 lds
v_mfma_f32_16x16x32_bf16 a[104:107], v[176:179], a[240:243], a[104:107]
v_exp_f32 v149, v149
v_mfma_f32_16x16x32_bf16 a[104:107], v[180:183], a[244:247], a[104:107]
v_cvt_pk_bf16_f32 v206, v148, v149
v_mfma_f32_16x16x32_bf16 a[108:111], v[188:191], a[244:247], a[108:111]
v_exp_f32 v150, v150
v_mfma_f32_16x16x32_bf16 a[108:111], v[184:187], a[240:243], a[108:111]
buffer_load_dword v18, v24, s[36:39], s59 offen
s_add_u32 s59, s59, 1024
v_mfma_f32_16x16x32_bf16 a[124:127], v[184:187], a[248:251], a[124:127]
v_exp_f32 v151, v151
v_mfma_f32_16x16x32_bf16 a[124:127], v[188:191], a[252:255], a[124:127]
s_cmp_ge_u32 s43, 2
s_cselect_b32 s56, s56, 67108864
v_cvt_pk_bf16_f32 v207, v150, v151
v_mfma_f32_16x16x32_bf16 a[120:123], v[180:183], a[252:255], a[120:123]
v_exp_f32 v152, v152
v_mfma_f32_16x16x32_bf16 a[120:123], v[176:179], a[248:251], a[120:123]
buffer_load_dwordx4 v15, s[8:11], s42 offen offset:3072 lds
s_add_u32 s42, s42, 16384
v_mfma_f32_16x16x32_bf16 a[116:119], v[168:171], a[248:251], a[116:119]
v_exp_f32 v153, v153
v_mfma_f32_16x16x32_bf16 a[116:119], v[172:175], a[252:255], a[116:119]
buffer_load_dword v18, v17, s[16:19], s56 offen
v_cvt_pk_bf16_f32 v214, v152, v153
v_mfma_f32_16x16x32_bf16 a[112:115], v[164:167], a[252:255], a[112:115]
v_exp_f32 v154, v154
v_mfma_f32_16x16x32_bf16 a[112:115], v[160:163], a[248:251], a[112:115]
s_waitcnt vmcnt(19) lgkmcnt(0)
s_barrier
v_smfmac_f32_16x16x64_bf16 v[240:243], v[28:31], v[160:167], v16
v_exp_f32 v155, v155
v_smfmac_f32_16x16x64_bf16 v[244:247], v[28:31], v[168:175], v16
s_sub_u32 s43, s43, 1
v_cvt_pk_bf16_f32 v215, v154, v155
v_smfmac_f32_16x16x64_bf16 v[248:251], v[28:31], v[176:183], v16
v_exp_f32 v156, v156
v_smfmac_f32_16x16x64_bf16 v[252:255], v[28:31], v[184:191], v16
s_cmp_lg_u32 s43, 0
s_cbranch_scc1 K_loop
K_tail:
v_mfma_f32_16x16x32_bf16 v[96:99], a[128:131], v[32:35], v[224:227]
v_exp_f32 v157, v157
v_mfma_f32_16x16x32_bf16 v[96:99], a[132:135], v[36:39], v[96:99]
ds_read_b64_tr_b16 a[192:193], v6 offset:16384
v_cvt_pk_bf16_f32 v222, v156, v157
v_mfma_f32_16x16x32_bf16 v[96:99], a[136:139], v[40:43], v[96:99]
v_exp_f32 v158, v158
v_mfma_f32_16x16x32_bf16 v[96:99], a[140:143], v[44:47], v[96:99]
ds_read_b64_tr_b16 a[194:195], v6 offset:20480
v_mfma_f32_16x16x32_bf16 v[100:103], a[140:143], v[60:63], v[228:231]
v_exp_f32 v159, v159
v_mfma_f32_16x16x32_bf16 v[100:103], a[136:139], v[56:59], v[100:103]
ds_read_b64_tr_b16 a[196:197], v6 offset:24576
v_cvt_pk_bf16_f32 v223, v158, v159
v_mfma_f32_16x16x32_bf16 v[100:103], a[132:135], v[52:55], v[100:103]
v_mfma_f32_16x16x32_bf16 v[100:103], a[128:131], v[48:51], v[100:103]
ds_read_b64_tr_b16 a[198:199], v6 offset:28672
v_mfma_f32_16x16x32_bf16 v[104:107], a[128:131], v[64:67], v[232:235]
buffer_load_dword v17, v26, s[60:63], 0 offen sc1
v_mfma_f32_16x16x32_bf16 v[104:107], a[132:135], v[68:71], v[104:107]
ds_read_b64_tr_b16 a[200:201], v7 offset:16384
v_mfma_f32_16x16x32_bf16 v[104:107], a[136:139], v[72:75], v[104:107]
v_exp_f32 v96, v96
v_mfma_f32_16x16x32_bf16 v[104:107], a[140:143], v[76:79], v[104:107]
ds_read_b64_tr_b16 a[202:203], v7 offset:20480
s_and_b32 s46, s82, 31
s_lshr_b32 s47, s82, 5
v_mfma_f32_16x16x32_bf16 v[108:111], a[140:143], v[92:95], v[236:239]
v_exp_f32 v97, v97
v_mfma_f32_16x16x32_bf16 v[108:111], a[136:139], v[88:91], v[108:111]
ds_read_b64_tr_b16 a[204:205], v7 offset:24576
v_cvt_pk_bf16_f32 v160, v96, v97
v_mfma_f32_16x16x32_bf16 v[108:111], a[132:135], v[84:87], v[108:111]
v_exp_f32 v98, v98
v_mfma_f32_16x16x32_bf16 v[108:111], a[128:131], v[80:83], v[108:111]
ds_read_b64_tr_b16 a[206:207], v7 offset:28672
s_lshl_b32 s53, s44, 13
s_mul_i32 s48, s44, 1769472
v_mfma_f32_16x16x32_bf16 v[112:115], a[144:147], v[32:35], v[224:227]
v_exp_f32 v99, v99
v_mfma_f32_16x16x32_bf16 v[112:115], a[148:151], v[36:39], v[112:115]
ds_read_b64_tr_b16 a[208:209], v8 offset:16384
v_cvt_pk_bf16_f32 v161, v98, v99
v_mfma_f32_16x16x32_bf16 v[112:115], a[152:155], v[40:43], v[112:115]
v_exp_f32 v100, v100
v_mfma_f32_16x16x32_bf16 v[112:115], a[156:159], v[44:47], v[112:115]
ds_read_b64_tr_b16 a[210:211], v8 offset:20480
s_lshl_b32 s51, s46, 7
s_add_u32 s48, s48, s51
v_mfma_f32_16x16x32_bf16 v[116:119], a[156:159], v[60:63], v[228:231]
v_exp_f32 v101, v101
v_mfma_f32_16x16x32_bf16 v[116:119], a[152:155], v[56:59], v[116:119]
ds_read_b64_tr_b16 a[212:213], v8 offset:24576
v_cvt_pk_bf16_f32 v168, v100, v101
v_mfma_f32_16x16x32_bf16 v[116:119], a[148:151], v[52:55], v[116:119]
v_exp_f32 v102, v102
v_mfma_f32_16x16x32_bf16 v[116:119], a[144:147], v[48:51], v[116:119]
ds_read_b64_tr_b16 a[214:215], v8 offset:28672
s_mul_i32 s49, s47, 327680
s_lshl_b32 s51, s44, 14
v_mfma_f32_16x16x32_bf16 v[120:123], a[144:147], v[64:67], v[232:235]
v_exp_f32 v103, v103
v_mfma_f32_16x16x32_bf16 v[120:123], a[148:151], v[68:71], v[120:123]
ds_read_b64_tr_b16 a[216:217], v9 offset:16384
v_cvt_pk_bf16_f32 v169, v102, v103
v_mfma_f32_16x16x32_bf16 v[120:123], a[152:155], v[72:75], v[120:123]
v_exp_f32 v104, v104
v_mfma_f32_16x16x32_bf16 v[120:123], a[156:159], v[76:79], v[120:123]
ds_read_b64_tr_b16 a[218:219], v9 offset:20480
s_add_u32 s49, s49, s51
v_lshrrev_b32 v20, 3, v1
v_mfma_f32_16x16x32_bf16 v[124:127], a[156:159], v[92:95], v[236:239]
v_exp_f32 v105, v105
v_mfma_f32_16x16x32_bf16 v[124:127], a[152:155], v[88:91], v[124:127]
ds_read_b64_tr_b16 a[220:221], v9 offset:24576
v_cvt_pk_bf16_f32 v176, v104, v105
v_mfma_f32_16x16x32_bf16 v[124:127], a[148:151], v[84:87], v[124:127]
v_exp_f32 v106, v106
v_mfma_f32_16x16x32_bf16 v[124:127], a[144:147], v[80:83], v[124:127]
ds_read_b64_tr_b16 a[222:223], v9 offset:28672
v_and_b32 v21, 7, v1
v_and_b32 v22, 6, v20
v_mfma_f32_16x16x32_bf16 v[128:131], a[160:163], v[32:35], v[224:227]
v_exp_f32 v107, v107
v_mfma_f32_16x16x32_bf16 v[128:131], a[164:167], v[36:39], v[128:131]
ds_read_b64_tr_b16 a[224:225], v10 offset:16384
v_cvt_pk_bf16_f32 v177, v106, v107
v_mfma_f32_16x16x32_bf16 v[128:131], a[168:171], v[40:43], v[128:131]
v_exp_f32 v108, v108
v_mfma_f32_16x16x32_bf16 v[128:131], a[172:175], v[44:47], v[128:131]
ds_read_b64_tr_b16 a[226:227], v10 offset:20480
v_xor_b32 v21, v21, v22
v_mul_u32_u24 v20, 3456, v20
v_mfma_f32_16x16x32_bf16 v[132:135], a[172:175], v[60:63], v[228:231]
v_exp_f32 v109, v109
v_mfma_f32_16x16x32_bf16 v[132:135], a[168:171], v[56:59], v[132:135]
ds_read_b64_tr_b16 a[228:229], v10 offset:24576
v_cvt_pk_bf16_f32 v184, v108, v109
v_mfma_f32_16x16x32_bf16 v[132:135], a[164:167], v[52:55], v[132:135]
v_exp_f32 v110, v110
v_mfma_f32_16x16x32_bf16 v[132:135], a[160:163], v[48:51], v[132:135]
ds_read_b64_tr_b16 a[230:231], v10 offset:28672
v_lshl_add_u32 v14, v21, 4, v20
v_lshlrev_b32 v15, 4, v1
v_mfma_f32_16x16x32_bf16 v[136:139], a[160:163], v[64:67], v[232:235]
v_exp_f32 v111, v111
v_mfma_f32_16x16x32_bf16 v[136:139], a[164:167], v[68:71], v[136:139]
ds_read_b64_tr_b16 a[232:233], v11 offset:16384
v_cvt_pk_bf16_f32 v185, v110, v111
v_mfma_f32_16x16x32_bf16 v[136:139], a[168:171], v[72:75], v[136:139]
v_exp_f32 v112, v112
v_mfma_f32_16x16x32_bf16 v[136:139], a[172:175], v[76:79], v[136:139]
ds_read_b64_tr_b16 a[234:235], v11 offset:20480
v_mfma_f32_16x16x32_bf16 v[140:143], a[172:175], v[92:95], v[236:239]
v_exp_f32 v113, v113
v_mfma_f32_16x16x32_bf16 v[140:143], a[168:171], v[88:91], v[140:143]
ds_read_b64_tr_b16 a[236:237], v11 offset:24576
v_cvt_pk_bf16_f32 v162, v112, v113
v_mfma_f32_16x16x32_bf16 v[140:143], a[164:167], v[84:87], v[140:143]
v_exp_f32 v114, v114
v_mfma_f32_16x16x32_bf16 v[140:143], a[160:163], v[80:83], v[140:143]
ds_read_b64_tr_b16 a[238:239], v11 offset:28672
v_mfma_f32_16x16x32_bf16 v[144:147], a[176:179], v[32:35], v[224:227]
v_exp_f32 v115, v115
v_mfma_f32_16x16x32_bf16 v[144:147], a[180:183], v[36:39], v[144:147]
ds_read_b64_tr_b16 a[240:241], v12 offset:16384
v_cvt_pk_bf16_f32 v163, v114, v115
v_mfma_f32_16x16x32_bf16 v[144:147], a[184:187], v[40:43], v[144:147]
v_exp_f32 v116, v116
v_mfma_f32_16x16x32_bf16 v[144:147], a[188:191], v[44:47], v[144:147]
ds_read_b64_tr_b16 a[242:243], v12 offset:20480
v_mfma_f32_16x16x32_bf16 v[148:151], a[188:191], v[60:63], v[228:231]
v_exp_f32 v117, v117
v_mfma_f32_16x16x32_bf16 v[148:151], a[184:187], v[56:59], v[148:151]
ds_read_b64_tr_b16 a[244:245], v12 offset:24576
v_cvt_pk_bf16_f32 v170, v116, v117
v_mfma_f32_16x16x32_bf16 v[148:151], a[180:183], v[52:55], v[148:151]
v_exp_f32 v118, v118
v_mfma_f32_16x16x32_bf16 v[148:151], a[176:179], v[48:51], v[148:151]
ds_read_b64_tr_b16 a[246:247], v12 offset:28672
v_mfma_f32_16x16x32_bf16 v[152:155], a[176:179], v[64:67], v[232:235]
v_exp_f32 v119, v119
v_mfma_f32_16x16x32_bf16 v[152:155], a[180:183], v[68:71], v[152:155]
ds_read_b64_tr_b16 a[248:249], v13 offset:16384
v_cvt_pk_bf16_f32 v171, v118, v119
v_mfma_f32_16x16x32_bf16 v[152:155], a[184:187], v[72:75], v[152:155]
v_exp_f32 v120, v120
v_mfma_f32_16x16x32_bf16 v[152:155], a[188:191], v[76:79], v[152:155]
ds_read_b64_tr_b16 a[250:251], v13 offset:20480
v_mfma_f32_16x16x32_bf16 v[156:159], a[188:191], v[92:95], v[236:239]
v_exp_f32 v121, v121
v_mfma_f32_16x16x32_bf16 v[156:159], a[184:187], v[88:91], v[156:159]
ds_read_b64_tr_b16 a[252:253], v13 offset:24576
v_cvt_pk_bf16_f32 v178, v120, v121
v_mfma_f32_16x16x32_bf16 v[156:159], a[180:183], v[84:87], v[156:159]
v_exp_f32 v122, v122
v_mfma_f32_16x16x32_bf16 v[156:159], a[176:179], v[80:83], v[156:159]
ds_read_b64_tr_b16 a[254:255], v13 offset:28672
s_waitcnt lgkmcnt(8)
v_mfma_f32_16x16x32_bf16 a[0:3], v[192:195], a[192:195], a[0:3]
v_exp_f32 v123, v123
v_mfma_f32_16x16x32_bf16 a[0:3], v[196:199], a[196:199], a[0:3]
ds_read_b128 a[128:131], v2 offset:49152
v_cvt_pk_bf16_f32 v179, v122, v123
v_mfma_f32_16x16x32_bf16 a[4:7], v[204:207], a[196:199], a[4:7]
v_exp_f32 v124, v124
v_mfma_f32_16x16x32_bf16 a[4:7], v[200:203], a[192:195], a[4:7]
s_add_u32 m0, s53, 131072
s_add_u32 s51, s48, 0
buffer_load_dwordx4 v14, s[20:23], s51 offen offset:0 lds
v_mfma_f32_16x16x32_bf16 a[8:11], v[208:211], a[192:195], a[8:11]
v_exp_f32 v125, v125
v_mfma_f32_16x16x32_bf16 a[8:11], v[212:215], a[196:199], a[8:11]
ds_read_b128 a[132:135], v3 offset:49152
v_cvt_pk_bf16_f32 v186, v124, v125
v_mfma_f32_16x16x32_bf16 a[12:15], v[220:223], a[196:199], a[12:15]
v_exp_f32 v126, v126
v_mfma_f32_16x16x32_bf16 a[12:15], v[216:219], a[192:195], a[12:15]
ds_read_b128 a[136:139], v4 offset:49152
v_mfma_f32_16x16x32_bf16 a[28:31], v[216:219], a[200:203], a[28:31]
v_exp_f32 v127, v127
v_mfma_f32_16x16x32_bf16 a[28:31], v[220:223], a[204:207], a[28:31]
ds_read_b128 a[140:143], v5 offset:49152
v_cvt_pk_bf16_f32 v187, v126, v127
v_mfma_f32_16x16x32_bf16 a[24:27], v[212:215], a[204:207], a[24:27]
v_exp_f32 v128, v128
v_mfma_f32_16x16x32_bf16 a[24:27], v[208:211], a[200:203], a[24:27]
s_add_u32 s51, s48, 26624
buffer_load_dwordx4 v14, s[20:23], s51 offen offset:1024 lds
s_waitcnt lgkmcnt(4)
v_mfma_f32_16x16x32_bf16 a[20:23], v[200:203], a[200:203], a[20:23]
v_exp_f32 v129, v129
v_mfma_f32_16x16x32_bf16 a[20:23], v[204:207], a[204:207], a[20:23]
ds_read_b128 a[144:147], v2 offset:53248
v_cvt_pk_bf16_f32 v164, v128, v129
v_mfma_f32_16x16x32_bf16 a[16:19], v[196:199], a[204:207], a[16:19]
v_exp_f32 v130, v130
v_mfma_f32_16x16x32_bf16 a[16:19], v[192:195], a[200:203], a[16:19]
ds_read_b128 a[148:151], v3 offset:53248
v_mfma_f32_16x16x32_bf16 a[32:35], v[192:195], a[208:211], a[32:35]
v_exp_f32 v131, v131
v_mfma_f32_16x16x32_bf16 a[32:35], v[196:199], a[212:215], a[32:35]
ds_read_b128 a[152:155], v4 offset:53248
v_cvt_pk_bf16_f32 v165, v130, v131
v_mfma_f32_16x16x32_bf16 a[36:39], v[204:207], a[212:215], a[36:39]
v_exp_f32 v132, v132
v_mfma_f32_16x16x32_bf16 a[36:39], v[200:203], a[208:211], a[36:39]
s_add_u32 s51, s48, 53248
buffer_load_dwordx4 v14, s[20:23], s51 offen offset:2048 lds
v_mfma_f32_16x16x32_bf16 a[40:43], v[208:211], a[208:211], a[40:43]
v_exp_f32 v133, v133
v_mfma_f32_16x16x32_bf16 a[40:43], v[212:215], a[212:215], a[40:43]
ds_read_b128 a[156:159], v5 offset:53248
v_cvt_pk_bf16_f32 v172, v132, v133
v_mfma_f32_16x16x32_bf16 a[44:47], v[220:223], a[212:215], a[44:47]
v_exp_f32 v134, v134
v_mfma_f32_16x16x32_bf16 a[44:47], v[216:219], a[208:211], a[44:47]
ds_read_b128 a[160:163], v2 offset:57344
v_mfma_f32_16x16x32_bf16 a[60:63], v[216:219], a[216:219], a[60:63]
v_exp_f32 v135, v135
v_mfma_f32_16x16x32_bf16 a[60:63], v[220:223], a[220:223], a[60:63]
ds_read_b128 a[164:167], v3 offset:57344
v_cvt_pk_bf16_f32 v173, v134, v135
v_mfma_f32_16x16x32_bf16 a[56:59], v[212:215], a[220:223], a[56:59]
v_exp_f32 v136, v136
v_mfma_f32_16x16x32_bf16 a[56:59], v[208:211], a[216:219], a[56:59]
s_add_u32 s51, s48, 79872
buffer_load_dwordx4 v14, s[20:23], s51 offen offset:3072 lds
v_mfma_f32_16x16x32_bf16 a[52:55], v[200:203], a[216:219], a[52:55]
v_exp_f32 v137, v137
v_mfma_f32_16x16x32_bf16 a[52:55], v[204:207], a[220:223], a[52:55]
ds_read_b128 a[168:171], v4 offset:57344
v_cvt_pk_bf16_f32 v180, v136, v137
v_mfma_f32_16x16x32_bf16 a[48:51], v[196:199], a[220:223], a[48:51]
v_exp_f32 v138, v138
v_mfma_f32_16x16x32_bf16 a[48:51], v[192:195], a[216:219], a[48:51]
ds_read_b128 a[172:175], v5 offset:57344
v_mfma_f32_16x16x32_bf16 a[64:67], v[192:195], a[224:227], a[64:67]
v_exp_f32 v139, v139
v_mfma_f32_16x16x32_bf16 a[64:67], v[196:199], a[228:231], a[64:67]
ds_read_b128 a[176:179], v2 offset:61440
v_cvt_pk_bf16_f32 v181, v138, v139
v_mfma_f32_16x16x32_bf16 a[68:71], v[204:207], a[228:231], a[68:71]
v_exp_f32 v140, v140
v_mfma_f32_16x16x32_bf16 a[68:71], v[200:203], a[224:227], a[68:71]
s_add_u32 m0, s53, 135168
s_add_u32 s51, s48, 110592
buffer_load_dwordx4 v14, s[20:23], s51 offen offset:0 lds
v_mfma_f32_16x16x32_bf16 a[72:75], v[208:211], a[224:227], a[72:75]
v_exp_f32 v141, v141
v_mfma_f32_16x16x32_bf16 a[72:75], v[212:215], a[228:231], a[72:75]
ds_read_b128 a[180:183], v3 offset:61440
v_cvt_pk_bf16_f32 v188, v140, v141
v_mfma_f32_16x16x32_bf16 a[76:79], v[220:223], a[228:231], a[76:79]
v_exp_f32 v142, v142
v_mfma_f32_16x16x32_bf16 a[76:79], v[216:219], a[224:227], a[76:79]
ds_read_b128 a[184:187], v4 offset:61440
v_mfma_f32_16x16x32_bf16 a[92:95], v[216:219], a[232:235], a[92:95]
v_exp_f32 v143, v143
v_mfma_f32_16x16x32_bf16 a[92:95], v[220:223], a[236:239], a[92:95]
ds_read_b128 a[188:191], v5 offset:61440
v_cvt_pk_bf16_f32 v189, v142, v143
v_mfma_f32_16x16x32_bf16 a[88:91], v[212:215], a[236:239], a[88:91]
v_exp_f32 v144, v144
v_mfma_f32_16x16x32_bf16 a[88:91], v[208:211], a[232:235], a[88:91]
s_add_u32 s51, s48, 137216
buffer_load_dwordx4 v14, s[20:23], s51 offen offset:1024 lds
v_mfma_f32_16x16x32_bf16 a[84:87], v[200:203], a[232:235], a[84:87]
v_exp_f32 v145, v145
v_mfma_f32_16x16x32_bf16 a[84:87], v[204:207], a[236:239], a[84:87]
v_cvt_pk_bf16_f32 v166, v144, v145
v_mfma_f32_16x16x32_bf16 a[80:83], v[196:199], a[236:239], a[80:83]
v_exp_f32 v146, v146
v_mfma_f32_16x16x32_bf16 a[80:83], v[192:195], a[232:235], a[80:83]
s_add_u32 s51, s48, 163840
buffer_load_dwordx4 v14, s[20:23], s51 offen offset:2048 lds
v_mfma_f32_16x16x32_bf16 a[96:99], v[192:195], a[240:243], a[96:99]
v_exp_f32 v147, v147
v_mfma_f32_16x16x32_bf16 a[96:99], v[196:199], a[244:247], a[96:99]
v_cvt_pk_bf16_f32 v167, v146, v147
K_pg6:
s_cbranch_execz K_pg9
v_mfma_f32_16x16x32_bf16 a[100:103], v[204:207], a[244:247], a[100:103]
v_exp_f32 v148, v148
v_mfma_f32_16x16x32_bf16 a[100:103], v[200:203], a[240:243], a[100:103]
s_add_u32 s51, s48, 190464
buffer_load_dwordx4 v14, s[20:23], s51 offen offset:3072 lds
v_mfma_f32_16x16x32_bf16 a[104:107], v[208:211], a[240:243], a[104:107]
v_exp_f32 v149, v149
v_mfma_f32_16x16x32_bf16 a[104:107], v[212:215], a[244:247], a[104:107]
v_cvt_pk_bf16_f32 v174, v148, v149
v_mfma_f32_16x16x32_bf16 a[108:111], v[220:223], a[244:247], a[108:111]
v_exp_f32 v150, v150
v_mfma_f32_16x16x32_bf16 a[108:111], v[216:219], a[240:243], a[108:111]
v_mfma_f32_16x16x32_bf16 a[124:127], v[216:219], a[248:251], a[124:127]
v_exp_f32 v151, v151
v_mfma_f32_16x16x32_bf16 a[124:127], v[220:223], a[252:255], a[124:127]
v_cvt_pk_bf16_f32 v175, v150, v151
v_mfma_f32_16x16x32_bf16 a[120:123], v[212:215], a[252:255], a[120:123]
v_exp_f32 v152, v152
v_mfma_f32_16x16x32_bf16 a[120:123], v[208:211], a[248:251], a[120:123]
v_mfma_f32_16x16x32_bf16 a[116:119], v[200:203], a[248:251], a[116:119]
v_exp_f32 v153, v153
v_mfma_f32_16x16x32_bf16 a[116:119], v[204:207], a[252:255], a[116:119]
v_cvt_pk_bf16_f32 v182, v152, v153
v_mfma_f32_16x16x32_bf16 a[112:115], v[196:199], a[252:255], a[112:115]
v_exp_f32 v154, v154
v_mfma_f32_16x16x32_bf16 a[112:115], v[192:195], a[248:251], a[112:115]
v_smfmac_f32_16x16x64_bf16 v[240:243], v[28:31], v[192:199], v16
v_exp_f32 v155, v155
v_smfmac_f32_16x16x64_bf16 v[244:247], v[28:31], v[200:207], v16
v_and_b32 v24, 7, v1
v_lshl_add_u32 v24, v24, 4, 64
v_cvt_pk_bf16_f32 v183, v154, v155
v_smfmac_f32_16x16x64_bf16 v[248:251], v[28:31], v[208:215], v16
v_exp_f32 v156, v156
v_smfmac_f32_16x16x64_bf16 v[252:255], v[28:31], v[216:223], v16
s_waitcnt vmcnt(8) lgkmcnt(0)
s_barrier
v_cmp_gt_u32 vcc, 32, v17
s_cbranch_vccz Lspun_12
s_mov_b32 s56, 0x40000
Lspin_11:
buffer_load_dword v17, v24, s[60:63], 0 offen sc1
s_waitcnt vmcnt(0)
v_cmp_gt_u32 vcc, 32, v17
s_cbranch_vccz Lspun_12
s_sleep 8
s_sub_u32 s56, s56, 1
s_cmp_lg_u32 s56, 0
s_cbranch_scc1 Lspin_11
Lspun_12:
s_cmp_eq_u32 s78, 0
s_cbranch_scc1 K_plain
s_cmp_lg_u32 s45, 0
s_cbranch_scc1 K_plain
v_mfma_f32_16x16x32_bf16 v[96:99], a[128:131], v[32:35], v[224:227]
v_exp_f32 v157, v157
v_mfma_f32_16x16x32_bf16 v[96:99], a[132:135], v[36:39], v[96:99]
ds_read_b64_tr_b16 a[192:193], v6 offset:32768
v_cvt_pk_bf16_f32 v190, v156, v157
v_mfma_f32_16x16x32_bf16 v[96:99], a[136:139], v[40:43], v[96:99]
v_exp_f32 v158, v158
v_mfma_f32_16x16x32_bf16 v[96:99], a[140:143], v[44:47], v[96:99]
ds_read_b64_tr_b16 a[194:195], v6 offset:36864
s_add_u32 m0, s53, 32768
s_add_u32 s51, s48, 221184
buffer_load_dwordx4 v14, s[20:23], s51 offen offset:0 lds
v_mfma_f32_16x16x32_bf16 v[100:103], a[140:143], v[60:63], v[228:231]
v_exp_f32 v159, v159
v_mfma_f32_16x16x32_bf16 v[100:103], a[136:139], v[56:59], v[100:103]
ds_read_b64_tr_b16 a[196:197], v6 offset:40960
v_cvt_pk_bf16_f32 v191, v158, v159
v_mfma_f32_16x16x32_bf16 v[100:103], a[132:135], v[52:55], v[100:103]
v_mfma_f32_16x16x32_bf16 v[100:103], a[128:131], v[48:51], v[100:103]
ds_read_b64_tr_b16 a[198:199], v6 offset:45056
s_add_u32 s51, s48, 247808
buffer_load_dwordx4 v14, s[20:23], s51 offen offset:1024 lds
v_mfma_f32_16x16x32_bf16 v[104:107], a[128:131], v[64:67], v[232:235]
v_mfma_f32_16x16x32_bf16 v[104:107], a[132:135], v[68:71], v[104:107]
ds_read_b64_tr_b16 a[200:201], v7 offset:32768
v_mfma_f32_16x16x32_bf16 v[104:107], a[136:139], v[72:75], v[104:107]
v_exp_f32 v96, v96
v_mfma_f32_16x16x32_bf16 v[104:107], a[140:143], v[76:79], v[104:107]
ds_read_b64_tr_b16 a[202:203], v7 offset:36864
s_add_u32 s51, s48, 274432
buffer_load_dwordx4 v14, s[20:23], s51 offen offset:2048 lds
v_mfma_f32_16x16x32_bf16 v[108:111], a[140:143], v[92:95], v[236:239]
v_exp_f32 v97, v97
v_mfma_f32_16x16x32_bf16 v[108:111], a[136:139], v[88:91], v[108:111]
ds_read_b64_tr_b16 a[204:205], v7 offset:40960
v_cvt_pk_bf16_f32 v192, v96, v97
v_mfma_f32_16x16x32_bf16 v[108:111], a[132:135], v[84:87], v[108:111]
v_exp_f32 v98, v98
v_mfma_f32_16x16x32_bf16 v[108:111], a[128:131], v[80:83], v[108:111]
ds_read_b64_tr_b16 a[206:207], v7 offset:45056
s_add_u32 s51, s48, 301056
buffer_load_dwordx4 v14, s[20:23], s51 offen offset:3072 lds
v_mfma_f32_16x16x32_bf16 v[112:115], a[144:147], v[32:35], v[224:227]
v_exp_f32 v99, v99
v_mfma_f32_16x16x32_bf16 v[112:115], a[148:151], v[36:39], v[112:115]
ds_read_b64_tr_b16 a[208:209], v8 offset:32768
v_cvt_pk_bf16_f32 v193, v98, v99
v_mfma_f32_16x16x32_bf16 v[112:115], a[152:155], v[40:43], v[112:115]
v_exp_f32 v100, v100
v_mfma_f32_16x16x32_bf16 v[112:115], a[156:159], v[44:47], v[112:115]
ds_read_b64_tr_b16 a[210:211], v8 offset:36864
s_add_u32 m0, s53, 36864
s_add_u32 s51, s48, 331776
buffer_load_dwordx4 v14, s[20:23], s51 offen offset:0 lds
v_mfma_f32_16x16x32_bf16 v[116:119], a[156:159], v[60:63], v[228:231]
v_exp_f32 v101, v101
v_mfma_f32_16x16x32_bf16 v[116:119], a[152:155], v[56:59], v[116:119]
ds_read_b64_tr_b16 a[212:213], v8 offset:40960
v_cvt_pk_bf16_f32 v200, v100, v101
v_mfma_f32_16x16x32_bf16 v[116:119], a[148:151], v[52:55], v[116:119]
v_exp_f32 v102, v102
v_mfma_f32_16x16x32_bf16 v[116:119], a[144:147], v[48:51], v[116:119]
ds_read_b64_tr_b16 a[214:215], v8 offset:45056
s_add_u32 s51, s48, 358400
buffer_load_dwordx4 v14, s[20:23], s51 offen offset:1024 lds
v_mfma_f32_16x16x32_bf16 v[120:123], a[144:147], v[64:67], v[232:235]
v_exp_f32 v103, v103
v_mfma_f32_16x16x32_bf16 v[120:123], a[148:151], v[68:71], v[120:123]
ds_read_b64_tr_b16 a[216:217], v9 offset:32768
v_cvt_pk_bf16_f32 v201, v102, v103
v_mfma_f32_16x16x32_bf16 v[120:123], a[152:155], v[72:75], v[120:123]
v_exp_f32 v104, v104
v_mfma_f32_16x16x32_bf16 v[120:123], a[156:159], v[76:79], v[120:123]
ds_read_b64_tr_b16 a[218:219], v9 offset:36864
s_add_u32 s51, s48, 385024
buffer_load_dwordx4 v14, s[20:23], s51 offen offset:2048 lds
v_mfma_f32_16x16x32_bf16 v[124:127], a[156:159], v[92:95], v[236:239]
v_exp_f32 v105, v105
v_mfma_f32_16x16x32_bf16 v[124:127], a[152:155], v[88:91], v[124:127]
ds_read_b64_tr_b16 a[220:221], v9 offset:40960
v_cvt_pk_bf16_f32 v208, v104, v105
v_mfma_f32_16x16x32_bf16 v[124:127], a[148:151], v[84:87], v[124:127]
v_exp_f32 v106, v106
v_mfma_f32_16x16x32_bf16 v[124:127], a[144:147], v[80:83], v[124:127]
ds_read_b64_tr_b16 a[222:223], v9 offset:45056
s_add_u32 s51, s48, 411648
buffer_load_dwordx4 v14, s[20:23], s51 offen offset:3072 lds
v_mfma_f32_16x16x32_bf16 v[128:131], a[160:163], v[32:35], v[224:227]
v_exp_f32 v107, v107
v_mfma_f32_16x16x32_bf16 v[128:131], a[164:167], v[36:39], v[128:131]
ds_read_b64_tr_b16 a[224:225], v10 offset:32768
v_cvt_pk_bf16_f32 v209, v106, v107
v_mfma_f32_16x16x32_bf16 v[128:131], a[168:171], v[40:43], v[128:131]
v_exp_f32 v108, v108
v_mfma_f32_16x16x32_bf16 v[128:131], a[172:175], v[44:47], v[128:131]
ds_read_b64_tr_b16 a[226:227], v10 offset:36864
s_add_u32 m0, s53, 65536
s_add_u32 s51, s48, 442368
buffer_load_dwordx4 v14, s[20:23], s51 offen offset:0 lds
v_mfma_f32_16x16x32_bf16 v[132:135], a[172:175], v[60:63], v[228:231]
v_exp_f32 v109, v109
v_mfma_f32_16x16x32_bf16 v[132:135], a[168:171], v[56:59], v[132:135]
ds_read_b64_tr_b16 a[228:229], v10 offset:40960
v_cvt_pk_bf16_f32 v216, v108, v109
v_mfma_f32_16x16x32_bf16 v[132:135], a[164:167], v[52:55], v[132:135]
v_exp_f32 v110, v110
v_mfma_f32_16x16x32_bf16 v[132:135], a[160:163], v[48:51], v[132:135]
ds_read_b64_tr_b16 a[230:231], v10 offset:45056
s_add_u32 s51, s48, 468992
buffer_load_dwordx4 v14, s[20:23], s51 offen offset:1024 lds
v_mfma_f32_16x16x32_bf16 v[136:139], a[160:163], v[64:67], v[232:235]
v_exp_f32 v111, v111
v_mfma_f32_16x16x32_bf16 v[136:139], a[164:167], v[68:71], v[136:139]
ds_read_b64_tr_b16 a[232:233], v11 offset:32768
v_cvt_pk_bf16_f32 v217, v110, v111
v_mfma_f32_16x16x32_bf16 v[136:139], a[168:171], v[72:75], v[136:139]
v_exp_f32 v112, v112
v_mfma_f32_16x16x32_bf16 v[136:139], a[172:175], v[76:79], v[136:139]
ds_read_b64_tr_b16 a[234:235], v11 offset:36864
s_add_u32 s51, s48, 495616
buffer_load_dwordx4 v14, s[20:23], s51 offen offset:2048 lds
v_mfma_f32_16x16x32_bf16 v[140:143], a[172:175], v[92:95], v[236:239]
v_exp_f32 v113, v113
v_mfma_f32_16x16x32_bf16 v[140:143], a[168:171], v[88:91], v[140:143]
ds_read_b64_tr_b16 a[236:237], v11 offset:40960
v_cvt_pk_bf16_f32 v194, v112, v113
v_mfma_f32_16x16x32_bf16 v[140:143], a[164:167], v[84:87], v[140:143]
v_exp_f32 v114, v114
v_mfma_f32_16x16x32_bf16 v[140:143], a[160:163], v[80:83], v[140:143]
ds_read_b64_tr_b16 a[238:239], v11 offset:45056
s_add_u32 s51, s48, 522240
buffer_load_dwordx4 v14, s[20:23], s51 offen offset:3072 lds
v_mfma_f32_16x16x32_bf16 v[144:147], a[176:179], v[32:35], v[224:227]
v_exp_f32 v115, v115
v_mfma_f32_16x16x32_bf16 v[144:147], a[180:183], v[36:39], v[144:147]
ds_read_b64_tr_b16 a[240:241], v12 offset:32768
v_cvt_pk_bf16_f32 v195, v114, v115
v_mfma_f32_16x16x32_bf16 v[144:147], a[184:187], v[40:43], v[144:147]
v_exp_f32 v116, v116
v_mfma_f32_16x16x32_bf16 v[144:147], a[188:191], v[44:47], v[144:147]
ds_read_b64_tr_b16 a[242:243], v12 offset:36864
s_add_u32 m0, s53, 69632
s_add_u32 s51, s48, 552960
buffer_load_dwordx4 v14, s[20:23], s51 offen offset:0 lds
v_mfma_f32_16x16x32_bf16 v[148:151], a[188:191], v[60:63], v[228:231]
v_exp_f32 v117, v117
v_mfma_f32_16x16x32_bf16 v[148:151], a[184:187], v[56:59], v[148:151]
ds_read_b64_tr_b16 a[244:245], v12 offset:40960
v_cvt_pk_bf16_f32 v202, v116, v117
v_mfma_f32_16x16x32_bf16 v[148:151], a[180:183], v[52:55], v[148:151]
v_exp_f32 v118, v118
v_mfma_f32_16x16x32_bf16 v[148:151], a[176:179], v[48:51], v[148:151]
ds_read_b64_tr_b16 a[246:247], v12 offset:45056
s_add_u32 s51, s48, 579584
buffer_load_dwordx4 v14, s[20:23], s51 offen offset:1024 lds
v_mfma_f32_16x16x32_bf16 v[152:155], a[176:179], v[64:67], v[232:235]
v_exp_f32 v119, v119
v_mfma_f32_16x16x32_bf16 v[152:155], a[180:183], v[68:71], v[152:155]
ds_read_b64_tr_b16 a[248:249], v13 offset:32768
v_cvt_pk_bf16_f32 v203, v118, v119
v_mfma_f32_16x16x32_bf16 v[152:155], a[184:187], v[72:75], v[152:155]
v_exp_f32 v120, v120
v_mfma_f32_16x16x32_bf16 v[152:155], a[188:191], v[76:79], v[152:155]
ds_read_b64_tr_b16 a[250:251], v13 offset:36864
s_add_u32 s51, s48, 606208
buffer_load_dwordx4 v14, s[20:23], s51 offen offset:2048 lds
v_mfma_f32_16x16x32_bf16 v[156:159], a[188:191], v[92:95], v[236:239]
v_exp_f32 v121, v121
v_mfma_f32_16x16x32_bf16 v[156:159], a[184:187], v[88:91], v[156:159]
ds_read_b64_tr_b16 a[252:253], v13 offset:40960
v_cvt_pk_bf16_f32 v210, v120, v121
v_mfma_f32_16x16x32_bf16 v[156:159], a[180:183], v[84:87], v[156:159]
v_exp_f32 v122, v122
v_mfma_f32_16x16x32_bf16 v[156:159], a[176:179], v[80:83], v[156:159]
ds_read_b64_tr_b16 a[254:255], v13 offset:45056
s_waitcnt lgkmcnt(8)
s_add_u32 s51, s48, 632832
buffer_load_dwordx4 v14, s[20:23], s51 offen offset:3072 lds
v_mfma_f32_16x16x32_bf16 a[0:3], v[160:163], a[192:195], a[0:3]
v_exp_f32 v123, v123
v_mfma_f32_16x16x32_bf16 a[0:3], v[164:167], a[196:199], a[0:3]
v_lshrrev_b32 v20, 2, v1
v_and_b32 v22, 6, v20
v_cvt_pk_bf16_f32 v211, v122, v123
v_mfma_f32_16x16x32_bf16 a[4:7], v[172:175], a[196:199], a[4:7]
v_exp_f32 v124, v124
v_mfma_f32_16x16x32_bf16 a[4:7], v[168:171], a[192:195], a[4:7]
s_add_u32 s52, s49, 2621440
buffer_load_dwordx4 a[128:131], v15, s[16:19], s52 offen sc1
v_mfma_f32_16x16x32_bf16 a[8:11], v[176:179], a[192:195], a[8:11]
v_exp_f32 v125, v125
v_mfma_f32_16x16x32_bf16 a[8:11], v[180:183], a[196:199], a[8:11]
v_bfe_u32 v21, v1, 1, 1
v_xor_b32 v21, v21, v22
v_cvt_pk_bf16_f32 v218, v124, v125
v_mfma_f32_16x16x32_bf16 a[12:15], v[188:191], a[196:199], a[12:15]
v_exp_f32 v126, v126
v_mfma_f32_16x16x32_bf16 a[12:15], v[184:187], a[192:195], a[12:15]
buffer_load_dwordx4 a[132:135], v15, s[16:19], s52 offen offset:1024 sc1
v_mfma_f32_16x16x32_bf16 a[28:31], v[184:187], a[200:203], a[28:31]
v_exp_f32 v127, v127
v_mfma_f32_16x16x32_bf16 a[28:31], v[188:191], a[204:207], a[28:31]
ds_read_b64_tr_b16 a[192:193], v6 offset:49152
v_lshlrev_b32 v21, 4, v21
v_lshl_add_u32 v21, v20, 7, v21
v_cvt_pk_bf16_f32 v219, v126, v127
v_mfma_f32_16x16x32_bf16 a[24:27], v[180:183], a[204:207], a[24:27]
v_exp_f32 v128, v128
v_mfma_f32_16x16x32_bf16 a[24:27], v[176:179], a[200:203], a[24:27]
ds_read_b64_tr_b16 a[194:195], v6 offset:53248
s_add_u32 s52, s49, 2686976
buffer_load_dwordx4 a[136:139], v15, s[16:19], s52 offen sc1
s_waitcnt lgkmcnt(2)
v_mfma_f32_16x16x32_bf16 a[20:23], v[168:171], a[200:203], a[20:23]
v_exp_f32 v129, v129
v_mfma_f32_16x16x32_bf16 a[20:23], v[172:175], a[204:207], a[20:23]
ds_read_b64_tr_b16 a[196:197], v6 offset:57344
v_and_b32 v22, 1, v1
v_lshl_add_u32 v21, v22, 3, v21
v_cvt_pk_bf16_f32 v196, v128, v129
v_mfma_f32_16x16x32_bf16 a[16:19], v[164:167], a[204:207], a[16:19]
v_exp_f32 v130, v130
v_mfma_f32_16x16x32_bf16 a[16:19], v[160:163], a[200:203], a[16:19]
ds_read_b64_tr_b16 a[198:199], v6 offset:61440
buffer_load_dwordx4 a[140:143], v15, s[16:19], s52 offen offset:1024 sc1
v_mfma_f32_16x16x32_bf16 a[32:35], v[160:163], a[208:211], a[32:35]
v_exp_f32 v131, v131
v_mfma_f32_16x16x32_bf16 a[32:35], v[164:167], a[212:215], a[32:35]
ds_read_b64_tr_b16 a[200:201], v7 offset:49152
v_add_u32 v21, s53, v21
s_add_u32 s50, s44, 0
v_cvt_pk_bf16_f32 v197, v130, v131
v_mfma_f32_16x16x32_bf16 a[36:39], v[172:175], a[212:215], a[36:39]
v_exp_f32 v132, v132
v_mfma_f32_16x16x32_bf16 a[36:39], v[168:171], a[208:211], a[36:39]
ds_read_b64_tr_b16 a[202:203], v7 offset:53248
s_add_u32 s52, s49, 2752512
buffer_load_dwordx4 a[144:147], v15, s[16:19], s52 offen sc1
v_mfma_f32_16x16x32_bf16 a[40:43], v[176:179], a[208:211], a[40:43]
v_exp_f32 v133, v133
v_mfma_f32_16x16x32_bf16 a[40:43], v[180:183], a[212:215], a[40:43]
ds_read_b64_tr_b16 a[204:205], v7 offset:57344
s_and_b32 s50, s50, 3
s_lshl_b32 s50, s50, 5
v_cvt_pk_bf16_f32 v204, v132, v133
v_mfma_f32_16x16x32_bf16 a[44:47], v[188:191], a[212:215], a[44:47]
v_exp_f32 v134, v134
v_mfma_f32_16x16x32_bf16 a[44:47], v[184:187], a[208:211], a[44:47]
ds_read_b64_tr_b16 a[206:207], v7 offset:61440
buffer_load_dwordx4 a[148:151], v15, s[16:19], s52 offen offset:1024 sc1
v_mfma_f32_16x16x32_bf16 a[60:63], v[184:187], a[216:219], a[60:63]
v_exp_f32 v135, v135
v_mfma_f32_16x16x32_bf16 a[60:63], v[188:191], a[220:223], a[60:63]
ds_read_b64_tr_b16 a[208:209], v8 offset:49152
v_xor_b32 v2, s50, v21
s_add_u32 s50, s44, 1
v_cvt_pk_bf16_f32 v205, v134, v135
v_mfma_f32_16x16x32_bf16 a[56:59], v[180:183], a[220:223], a[56:59]
v_exp_f32 v136, v136
v_mfma_f32_16x16x32_bf16 a[56:59], v[176:179], a[216:219], a[56:59]
ds_read_b64_tr_b16 a[210:211], v8 offset:53248
s_add_u32 s52, s49, 2818048
buffer_load_dwordx4 a[152:155], v15, s[16:19], s52 offen sc1
v_mfma_f32_16x16x32_bf16 a[52:55], v[168:171], a[216:219], a[52:55]
v_exp_f32 v137, v137
v_mfma_f32_16x16x32_bf16 a[52:55], v[172:175], a[220:223], a[52:55]
ds_read_b64_tr_b16 a[212:213], v8 offset:57344
s_and_b32 s50, s50, 3
s_lshl_b32 s50, s50, 5
v_cvt_pk_bf16_f32 v212, v136, v137
v_mfma_f32_16x16x32_bf16 a[48:51], v[164:167], a[220:223], a[48:51]
v_exp_f32 v138, v138
v_mfma_f32_16x16x32_bf16 a[48:51], v[160:163], a[216:219], a[48:51]
ds_read_b64_tr_b16 a[214:215], v8 offset:61440
buffer_load_dwordx4 a[156:159], v15, s[16:19], s52 offen offset:1024 sc1
v_mfma_f32_16x16x32_bf16 a[64:67], v[160:163], a[224:227], a[64:67]
v_exp_f32 v139, v139
v_mfma_f32_16x16x32_bf16 a[64:67], v[164:167], a[228:231], a[64:67]
ds_read_b64_tr_b16 a[216:217], v9 offset:49152
v_xor_b32 v3, s50, v21
s_add_u32 s50, s44, 2
v_cvt_pk_bf16_f32 v213, v138, v139
v_mfma_f32_16x16x32_bf16 a[68:71], v[172:175], a[228:231], a[68:71]
v_exp_f32 v140, v140
v_mfma_f32_16x16x32_bf16 a[68:71], v[168:171], a[224:227], a[68:71]
ds_read_b64_tr_b16 a[218:219], v9 offset:53248
s_add_u32 s52, s49, 2883584
buffer_load_dwordx4 a[160:163], v15, s[16:19], s52 offen sc1
v_mfma_f32_16x16x32_bf16 a[72:75], v[176:179], a[224:227], a[72:75]
v_exp_f32 v141, v141
v_mfma_f32_16x16x32_bf16 a[72:75], v[180:183], a[228:231], a[72:75]
ds_read_b64_tr_b16 a[220:221], v9 offset:57344
s_and_b32 s50, s50, 3
s_lshl_b32 s50, s50, 5
v_cvt_pk_bf16_f32 v220, v140, v141
v_mfma_f32_16x16x32_bf16 a[76:79], v[188:191], a[228:231], a[76:79]
v_exp_f32 v142, v142
v_mfma_f32_16x16x32_bf16 a[76:79], v[184:187], a[224:227], a[76:79]
ds_read_b64_tr_b16 a[222:223], v9 offset:61440
buffer_load_dwordx4 a[164:167], v15, s[16:19], s52 offen offset:1024 sc1
v_mfma_f32_16x16x32_bf16 a[92:95], v[184:187], a[232:235], a[92:95]
v_exp_f32 v143, v143
v_mfma_f32_16x16x32_bf16 a[92:95], v[188:191], a[236:239], a[92:95]
ds_read_b64_tr_b16 a[224:225], v10 offset:49152
v_xor_b32 v4, s50, v21
s_add_u32 s50, s44, 3
v_cvt_pk_bf16_f32 v221, v142, v143
v_mfma_f32_16x16x32_bf16 a[88:91], v[180:183], a[236:239], a[88:91]
v_exp_f32 v144, v144
v_mfma_f32_16x16x32_bf16 a[88:91], v[176:179], a[232:235], a[88:91]
ds_read_b64_tr_b16 a[226:227], v10 offset:53248
s_add_u32 s52, s49, 2623488
buffer_load_dwordx4 a[168:171], v15, s[16:19], s52 offen sc1
v_mfma_f32_16x16x32_bf16 a[84:87], v[168:171], a[232:235], a[84:87]
v_exp_f32 v145, v145
v_mfma_f32_16x16x32_bf16 a[84:87], v[172:175], a[236:239], a[84:87]
ds_read_b64_tr_b16 a[228:229], v10 offset:57344
s_and_b32 s50, s50, 3
s_lshl_b32 s50, s50, 5
v_cvt_pk_bf16_f32 v198, v144, v145
v_mfma_f32_16x16x32_bf16 a[80:83], v[164:167], a[236:239], a[80:83]
v_exp_f32 v146, v146
v_mfma_f32_16x16x32_bf16 a[80:83], v[160:163], a[232:235], a[80:83]
ds_read_b64_tr_b16 a[230:231], v10 offset:61440
buffer_load_dwordx4 a[172:175], v15, s[16:19], s52 offen offset:1024 sc1
v_mfma_f32_16x16x32_bf16 a[96:99], v[160:163], a[240:243], a[96:99]
v_exp_f32 v147, v147
v_mfma_f32_16x16x32_bf16 a[96:99], v[164:167], a[244:247], a[96:99]
ds_read_b64_tr_b16 a[232:233], v11 offset:49152
v_xor_b32 v5, s50, v21
v_lshrrev_b32 v20, 4, v1
v_cvt_pk_bf16_f32 v199, v146, v147
v_mfma_f32_16x16x32_bf16 a[100:103], v[172:175], a[244:247], a[100:103]
v_exp_f32 v148, v148
v_mfma_f32_16x16x32_bf16 a[100:103], v[168:171], a[240:243], a[100:103]
ds_read_b64_tr_b16 a[234:235], v11 offset:53248
s_add_u32 s52, s49, 2689024
buffer_load_dwordx4 a[176:179], v15, s[16:19], s52 offen sc1
v_mfma_f32_16x16x32_bf16 a[104:107], v[176:179], a[240:243], a[104:107]
v_exp_f32 v149, v149
v_mfma_f32_16x16x32_bf16 a[104:107], v[180:183], a[244:247], a[104:107]
ds_read_b64_tr_b16 a[236:237], v11 offset:57344
v_lshlrev_b32 v20, 3, v20
s_lshl_b32 s50, s46, 2
v_cvt_pk_bf16_f32 v206, v148, v149
v_mfma_f32_16x16x32_bf16 a[108:111], v[188:191], a[244:247], a[108:111]
v_exp_f32 v150, v150
v_mfma_f32_16x16x32_bf16 a[108:111], v[184:187], a[240:243], a[108:111]
ds_read_b64_tr_b16 a[238:239], v11 offset:61440
buffer_load_dwordx4 a[180:183], v15, s[16:19], s52 offen offset:1024 sc1
v_mfma_f32_16x16x32_bf16 a[124:127], v[184:187], a[248:251], a[124:127]
v_exp_f32 v151, v151
v_mfma_f32_16x16x32_bf16 a[124:127], v[188:191], a[252:255], a[124:127]
ds_read_b64_tr_b16 a[240:241], v12 offset:49152
s_add_u32 s50, s50, s44
s_lshl_b32 s50, s50, 5
v_cvt_pk_bf16_f32 v207, v150, v151
v_mfma_f32_16x16x32_bf16 a[120:123], v[180:183], a[252:255], a[120:123]
v_exp_f32 v152, v152
v_mfma_f32_16x16x32_bf16 a[120:123], v[176:179], a[248:251], a[120:123]
ds_read_b64_tr_b16 a[242:243], v12 offset:53248
s_add_u32 s52, s49, 2754560
buffer_load_dwordx4 a[184:187], v15, s[16:19], s52 offen sc1
v_mfma_f32_16x16x32_bf16 a[116:119], v[168:171], a[248:251], a[116:119]
v_exp_f32 v153, v153
v_mfma_f32_16x16x32_bf16 a[116:119], v[172:175], a[252:255], a[116:119]
ds_read_b64_tr_b16 a[244:245], v12 offset:57344
buffer_load_dwordx2 v[18:19], v20, s[24:27], s50 offen
v_cvt_pk_bf16_f32 v214, v152, v153
v_mfma_f32_16x16x32_bf16 a[112:115], v[164:167], a[252:255], a[112:115]
v_exp_f32 v154, v154
v_mfma_f32_16x16x32_bf16 a[112:115], v[160:163], a[248:251], a[112:115]
ds_read_b64_tr_b16 a[246:247], v12 offset:61440
buffer_load_dwordx4 a[188:191], v15, s[16:19], s52 offen offset:1024 sc1
v_smfmac_f32_16x16x64_bf16 v[240:243], v[28:31], v[160:167], v16
ds_read_b64_tr_b16 a[248:249], v13 offset:49152
v_exp_f32 v155, v155
v_smfmac_f32_16x16x64_bf16 v[244:247], v[28:31], v[168:175], v16
ds_read_b64_tr_b16 a[250:251], v13 offset:53248
v_cvt_pk_bf16_f32 v215, v154, v155
v_smfmac_f32_16x16x64_bf16 v[248:251], v[28:31], v[176:183], v16
ds_read_b64_tr_b16 a[252:253], v13 offset:57344
v_exp_f32 v156, v156
v_smfmac_f32_16x16x64_bf16 v[252:255], v[28:31], v[184:191], v16
s_barrier
ds_read_b64_tr_b16 a[254:255], v13 offset:61440
s_nop 0
v_exp_f32 v157, v157
s_nop 0
v_cvt_pk_bf16_f32 v222, v156, v157
s_nop 0
v_exp_f32 v158, v158
s_nop 0
v_exp_f32 v159, v159
s_nop 0
v_cvt_pk_bf16_f32 v223, v158, v159
s_nop 0
s_waitcnt lgkmcnt(8)
v_smfmac_f32_16x16x64_bf16 v[240:243], v[28:31], v[192:199], v16
v_add_u32 v6, 131072, v2
v_smfmac_f32_16x16x64_bf16 v[244:247], v[28:31], v[200:207], v16
s_add_u32 s52, s49, 2820096
buffer_load_dwordx4 v[32:35], v15, s[16:19], s52 offen sc1
v_add_u32 v7, 131072, v3
v_smfmac_f32_16x16x64_bf16 v[248:251], v[28:31], v[208:215], v16
v_add_u32 v8, 131072, v4
v_smfmac_f32_16x16x64_bf16 v[252:255], v[28:31], v[216:223], v16
v_add_u32 v9, 131072, v5
v_mfma_f32_16x16x32_bf16 a[0:3], v[192:195], a[192:195], a[0:3]
v_mfma_f32_16x16x32_bf16 a[0:3], v[196:199], a[196:199], a[0:3]
buffer_load_dwordx4 v[36:39], v15, s[16:19], s52 offen offset:1024 sc1
v_mfma_f32_16x16x32_bf16 a[4:7], v[204:207], a[196:199], a[4:7]
s_waitcnt vmcnt(35)
v_mfma_f32_16x16x32_bf16 a[4:7], v[200:203], a[192:195], a[4:7]
ds_read_b64_tr_b16 v[160:161], v6 offset:0
v_mfma_f32_16x16x32_bf16 a[8:11], v[208:211], a[192:195], a[8:11]
v_mfma_f32_16x16x32_bf16 a[8:11], v[212:215], a[196:199], a[8:11]
s_add_u32 s52, s49, 2885632
buffer_load_dwordx4 v[40:43], v15, s[16:19], s52 offen sc1
v_add_f32 v240, v240, v241
v_add_f32 v244, v244, v245
v_mfma_f32_16x16x32_bf16 a[12:15], v[220:223], a[196:199], a[12:15]
v_add_f32 v248, v248, v249
v_add_f32 v252, v252, v253
v_mov_b32 v241, v240
v_mfma_f32_16x16x32_bf16 a[12:15], v[216:219], a[192:195], a[12:15]
s_waitcnt lgkmcnt(1)
ds_read_b64_tr_b16 v[162:163], v6 offset:2048
v_mov_b32 v245, v244
v_mov_b32 v249, v248
v_mfma_f32_16x16x32_bf16 a[28:31], v[216:219], a[200:203], a[28:31]
v_mov_b32 v253, v252
v_permlane16_swap_b32 v241, v240
v_permlane16_swap_b32 v245, v244
v_mfma_f32_16x16x32_bf16 a[28:31], v[220:223], a[204:207], a[28:31]
buffer_load_dwordx4 v[44:47], v15, s[16:19], s52 offen offset:1024 sc1
v_permlane16_swap_b32 v249, v248
v_permlane16_swap_b32 v253, v252
v_mfma_f32_16x16x32_bf16 a[24:27], v[212:215], a[204:207], a[24:27]
v_add_f32 v240, v240, v241
v_add_f32 v244, v244, v245
v_add_f32 v248, v248, v249
v_mfma_f32_16x16x32_bf16 a[24:27], v[208:211], a[200:203], a[24:27]
ds_read_b64_tr_b16 v[164:165], v6 offset:4096
v_add_f32 v252, v252, v253
v_mov_b32 v241, v240
v_mfma_f32_16x16x32_bf16 a[20:23], v[200:203], a[200:203], a[20:23]
v_mov_b32 v245, v244
v_mov_b32 v249, v248
v_mov_b32 v253, v252
v_mfma_f32_16x16x32_bf16 a[20:23], v[204:207], a[204:207], a[20:23]
s_add_u32 s52, s49, 2625536
buffer_load_dwordx4 a[192:195], v15, s[16:19], s52 offen sc1
v_permlane32_swap_b32 v241, v240
v_permlane32_swap_b32 v245, v244
v_mfma_f32_16x16x32_bf16 a[16:19], v[196:199], a[204:207], a[16:19]
v_permlane32_swap_b32 v249, v248
v_permlane32_swap_b32 v253, v252
v_add_f32 v240, v240, v241
v_mfma_f32_16x16x32_bf16 a[16:19], v[192:195], a[200:203], a[16:19]
ds_read_b64_tr_b16 v[166:167], v6 offset:6144
v_add_f32 v244, v244, v245
v_add_f32 v248, v248, v249
v_mfma_f32_16x16x32_bf16 a[32:35], v[192:195], a[208:211], a[32:35]
v_add_f32 v252, v252, v253
s_mov_b32 s56, 0x53800000
v_cmp_nge_f32 s[54:55], s56, v240
v_mfma_f32_16x16x32_bf16 a[32:35], v[196:199], a[212:215], a[32:35]
buffer_load_dwordx4 a[196:199], v15, s[16:19], s52 offen offset:1024 sc1
v_cmp_nge_f32 vcc, s56, v244
s_or_b64 s[54:55], s[54:55], vcc
v_mfma_f32_16x16x32_bf16 a[36:39], v[204:207], a[212:215], a[36:39]
v_cmp_nge_f32 vcc, s56, v248
s_or_b64 s[54:55], s[54:55], vcc
v_cmp_nge_f32 vcc, s56, v252
v_mfma_f32_16x16x32_bf16 a[36:39], v[200:203], a[208:211], a[36:39]
ds_read_b64_tr_b16 v[168:169], v7 offset:0
s_or_b64 s[54:55], s[54:55], vcc
v_rcp_f32 v240, v240
v_mfma_f32_16x16x32_bf16 a[40:43], v[208:211], a[208:211], a[40:43]
s_or_b32 s54, s54, s55
v_rcp_f32 v244, v244
s_lshl_b32 s55, s44, 2
v_mfma_f32_16x16x32_bf16 a[40:43], v[212:215], a[212:215], a[40:43]
s_add_u32 s52, s49, 2691072
buffer_load_dwordx4 a[200:203], v15, s[16:19], s52 offen sc1
v_rcp_f32 v248, v248
s_add_u32 s55, s55, 98304
v_mfma_f32_16x16x32_bf16 a[44:47], v[220:223], a[212:215], a[44:47]
v_rcp_f32 v252, v252
v_mov_b32 v241, s55
v_mov_b32 v242, s54
v_mfma_f32_16x16x32_bf16 a[44:47], v[216:219], a[208:211], a[44:47]
ds_read_b64_tr_b16 v[170:171], v7 offset:2048
v_and_b32 v16, 48, v1
ds_write_b32 v241, v242
v_mfma_f32_16x16x32_bf16 a[60:63], v[216:219], a[216:219], a[60:63]
ds_bpermute_b32 v243, v16, v240 offset:12
ds_bpermute_b32 v242, v16, v240 offset:8
ds_bpermute_b32 v241, v16, v240 offset:4
v_mfma_f32_16x16x32_bf16 a[60:63], v[220:223], a[220:223], a[60:63]
buffer_load_dwordx4 a[204:207], v15, s[16:19], s52 offen offset:1024 sc1
ds_bpermute_b32 v240, v16, v240 offset:0
ds_bpermute_b32 v247, v16, v244 offset:12
v_mfma_f32_16x16x32_bf16 a[56:59], v[212:215], a[220:223], a[56:59]
ds_bpermute_b32 v246, v16, v244 offset:8
ds_bpermute_b32 v245, v16, v244 offset:4
ds_bpermute_b32 v244, v16, v244 offset:0
v_mfma_f32_16x16x32_bf16 a[56:59], v[208:211], a[216:219], a[56:59]
ds_read_b64_tr_b16 v[172:173], v7 offset:4096
ds_bpermute_b32 v251, v16, v248 offset:12
ds_bpermute_b32 v250, v16, v248 offset:8
v_mfma_f32_16x16x32_bf16 a[52:55], v[200:203], a[216:219], a[52:55]
ds_bpermute_b32 v249, v16, v248 offset:4
ds_bpermute_b32 v248, v16, v248 offset:0
ds_bpermute_b32 v255, v16, v252 offset:12
v_mfma_f32_16x16x32_bf16 a[52:55], v[204:207], a[220:223], a[52:55]
s_add_u32 s52, s49, 2756608
buffer_load_dwordx4 a[208:211], v15, s[16:19], s52 offen sc1
ds_bpermute_b32 v254, v16, v252 offset:8
ds_bpermute_b32 v253, v16, v252 offset:4
v_mfma_f32_16x16x32_bf16 a[48:51], v[196:199], a[220:223], a[48:51]
ds_bpermute_b32 v252, v16, v252 offset:0
s_waitcnt vmcnt(10)
v_lshlrev_b32 v10, 16, v18
v_mfma_f32_16x16x32_bf16 a[48:51], v[192:195], a[216:219], a[48:51]
ds_read_b64_tr_b16 v[174:175], v7 offset:6144
v_and_b32 v11, 0xffff0000, v18
v_lshlrev_b32 v12, 16, v19
v_mfma_f32_16x16x32_bf16 a[64:67], v[192:195], a[224:227], a[64:67]
v_and_b32 v13, 0xffff0000, v19
v_and_b32 v48, 15, v1
v_lshrrev_b32 v49, 4, v1
v_mfma_f32_16x16x32_bf16 a[64:67], v[196:199], a[228:231], a[64:67]
buffer_load_dwordx4 a[212:215], v15, s[16:19], s52 offen offset:1024 sc1
v_lshlrev_b32 v49, 2, v49
v_sub_u32 v48, v48, v49
v_mfma_f32_16x16x32_bf16 a[68:71], v[204:207], a[228:231], a[68:71]
v_mov_b32 v50, 0x3f80
v_mov_b32 v51, 0x3f800000
v_cmp_eq_u32 vcc, 0, v48
v_mfma_f32_16x16x32_bf16 a[68:71], v[200:203], a[224:227], a[68:71]
ds_read_b64_tr_b16 v[176:177], v8 offset:0
v_mov_b32 v18, 0
v_mov_b32 v19, 0
v_mfma_f32_16x16x32_bf16 a[72:75], v[208:211], a[224:227], a[72:75]
v_cndmask_b32 v20, 0, v50, vcc
v_cmp_eq_u32 vcc, 1, v48
v_mov_b32 v22, 0
v_mfma_f32_16x16x32_bf16 a[72:75], v[212:215], a[228:231], a[72:75]
s_add_u32 s52, s49, 2822144
buffer_load_dwordx4 a[216:219], v15, s[16:19], s52 offen sc1
v_mov_b32 v23, 0
v_cndmask_b32 v20, v20, v51, vcc
v_mfma_f32_16x16x32_bf16 a[76:79], v[220:223], a[228:231], a[76:79]
K_pg7:
s_cbranch_execz K_pg10
v_cmp_eq_u32 vcc, 2, v48
s_add_u32 s76, s57, 135424
s_add_u32 s77, s57, 270848
v_mfma_f32_16x16x32_bf16 a[76:79], v[216:219], a[224:227], a[76:79]
ds_read_b64_tr_b16 v[178:179], v8 offset:2048
v_cndmask_b32 v21, 0, v50, vcc
v_cmp_eq_u32 vcc, 3, v48
v_mfma_f32_16x16x32_bf16 a[92:95], v[216:219], a[232:235], a[92:95]
s_add_u32 s59, s57, 406272
s_nop 0
v_cndmask_b32 v21, v21, v51, vcc
v_mfma_f32_16x16x32_bf16 a[92:95], v[220:223], a[236:239], a[92:95]
buffer_load_dwordx4 a[220:223], v15, s[16:19], s52 offen offset:1024 sc1
s_waitcnt lgkmcnt(3)
v_accvgpr_read_b32 v48, a0
v_mfma_f32_16x16x32_bf16 a[88:91], v[212:215], a[236:239], a[88:91]
v_accvgpr_read_b32 v49, a1
v_accvgpr_read_b32 v50, a2
v_accvgpr_read_b32 v51, a3
v_mfma_f32_16x16x32_bf16 a[88:91], v[208:211], a[232:235], a[88:91]
ds_read_b64_tr_b16 v[180:181], v8 offset:4096
v_accvgpr_read_b32 v52, a4
v_accvgpr_read_b32 v53, a5
v_mfma_f32_16x16x32_bf16 a[84:87], v[200:203], a[232:235], a[84:87]
v_accvgpr_read_b32 v54, a6
v_accvgpr_read_b32 v55, a7
v_accvgpr_read_b32 v56, a16
v_mfma_f32_16x16x32_bf16 a[84:87], v[204:207], a[236:239], a[84:87]
s_add_u32 s52, s49, 2887680
buffer_load_dwordx4 a[224:227], v15, s[16:19], s52 offen sc1
v_accvgpr_read_b32 v57, a17
v_accvgpr_read_b32 v58, a18
v_mfma_f32_16x16x32_bf16 a[80:83], v[196:199], a[236:239], a[80:83]
v_accvgpr_read_b32 v59, a19
v_accvgpr_read_b32 v60, a20
v_accvgpr_read_b32 v61, a21
v_mfma_f32_16x16x32_bf16 a[80:83], v[192:195], a[232:235], a[80:83]
ds_read_b64_tr_b16 v[182:183], v8 offset:6144
v_accvgpr_read_b32 v62, a22
v_accvgpr_read_b32 v63, a23
v_mfma_f32_16x16x32_bf16 a[96:99], v[192:195], a[240:243], a[96:99]
v_mul_f32 v48, v48, v240
v_mul_f32 v49, v49, v241
v_mul_f32 v50, v50, v242
v_mfma_f32_16x16x32_bf16 a[96:99], v[196:199], a[244:247], a[96:99]
buffer_load_dwordx4 a[228:231], v15, s[16:19], s52 offen offset:1024 sc1
v_mul_f32 v51, v51, v243
v_mul_f32 v52, v52, v244
v_mfma_f32_16x16x32_bf16 a[100:103], v[204:207], a[244:247], a[100:103]
v_mul_f32 v53, v53, v245
v_mul_f32 v54, v54, v246
v_mul_f32 v55, v55, v247
v_mfma_f32_16x16x32_bf16 a[100:103], v[200:203], a[240:243], a[100:103]
ds_read_b64_tr_b16 v[184:185], v9 offset:0
v_mul_f32 v56, v56, v240
v_mul_f32 v57, v57, v241
v_mfma_f32_16x16x32_bf16 a[104:107], v[208:211], a[240:243], a[104:107]
v_mul_f32 v58, v58, v242
v_mul_f32 v59, v59, v243
v_mul_f32 v60, v60, v244
v_mfma_f32_16x16x32_bf16 a[104:107], v[212:215], a[244:247], a[104:107]
v_mul_f32 v61, v61, v245
v_mul_f32 v62, v62, v246
v_mul_f32 v63, v63, v247
v_mfma_f32_16x16x32_bf16 a[108:111], v[220:223], a[244:247], a[108:111]
v_cvt_pk_bf16_f32 v24, v48, v49
v_cvt_pk_bf16_f32 v25, v50, v51
v_cvt_pk_bf16_f32 v26, v52, v53
v_mfma_f32_16x16x32_bf16 a[108:111], v[216:219], a[240:243], a[108:111]
ds_read_b64_tr_b16 v[186:187], v9 offset:2048
v_cvt_pk_bf16_f32 v27, v54, v55
v_cvt_pk_bf16_f32 v28, v56, v57
v_mfma_f32_16x16x32_bf16 a[124:127], v[216:219], a[248:251], a[124:127]
v_cvt_pk_bf16_f32 v29, v58, v59
v_cvt_pk_bf16_f32 v30, v60, v61
v_cvt_pk_bf16_f32 v31, v62, v63
v_mfma_f32_16x16x32_bf16 a[124:127], v[220:223], a[252:255], a[124:127]
s_nop 0
v_mfma_f32_16x16x32_bf16 v[64:67], v[24:27], v[20:23], 0
v_mfma_f32_16x16x32_bf16 v[68:71], v[28:31], v[20:23], 0
v_mfma_f32_16x16x32_bf16 a[120:123], v[212:215], a[252:255], a[120:123]
v_mfma_f32_16x16x32_bf16 v[72:75], v[24:27], v[18:21], 0
v_mfma_f32_16x16x32_bf16 v[76:79], v[28:31], v[18:21], 0
v_accvgpr_read_b32 v48, a8
v_mfma_f32_16x16x32_bf16 a[120:123], v[208:211], a[248:251], a[120:123]
ds_read_b64_tr_b16 v[188:189], v9 offset:4096
v_accvgpr_read_b32 v49, a9
v_accvgpr_read_b32 v50, a10
v_mfma_f32_16x16x32_bf16 a[116:119], v[200:203], a[248:251], a[116:119]
v_accvgpr_read_b32 v51, a11
v_accvgpr_read_b32 v52, a12
v_accvgpr_read_b32 v53, a13
v_mfma_f32_16x16x32_bf16 a[116:119], v[204:207], a[252:255], a[116:119]
ds_read_b64_tr_b16 v[190:191], v9 offset:6144
v_accvgpr_read_b32 v54, a14
v_accvgpr_read_b32 v55, a15
v_mfma_f32_16x16x32_bf16 a[112:115], v[196:199], a[252:255], a[112:115]
v_accvgpr_read_b32 v56, a24
v_accvgpr_read_b32 v57, a25
v_accvgpr_read_b32 v58, a26
v_mfma_f32_16x16x32_bf16 a[112:115], v[192:195], a[248:251], a[112:115]
v_accvgpr_read_b32 v59, a27
v_accvgpr_read_b32 v60, a28
v_accvgpr_read_b32 v61, a29
s_waitcnt vmcnt(39)
s_waitcnt vmcnt(21)
s_waitcnt lgkmcnt(0)
v_mfma_f32_16x16x32_bf16 v[96:99], v[160:163], a[128:131], v[10:13]
ds_read_b64_tr_b16 v[192:193], v2 offset:32768
v_add_u32 v6, 65536, v2
v_add_u32 v7, 65536, v3
v_add_u32 v8, 65536, v4
v_add_u32 v9, 65536, v5
v_accvgpr_read_b32 v62, a30
v_mfma_f32_16x16x32_bf16 v[96:99], v[164:167], a[132:135], v[96:99]
s_add_u32 m0, s53, 0
s_add_u32 s51, s48, 663552
buffer_load_dwordx4 v14, s[20:23], s51 offen offset:0 lds
v_accvgpr_read_b32 v63, a31
v_cvt_pk_bf16_f32 v64, v64, v65
v_cvt_pk_bf16_f32 v65, v66, v67
v_cvt_pk_bf16_f32 v66, v68, v69
v_cvt_pk_bf16_f32 v67, v70, v71
v_mfma_f32_16x16x32_bf16 v[100:103], v[164:167], a[140:143], v[10:13]
ds_read_b64_tr_b16 v[194:195], v2 offset:34816
buffer_store_dwordx4 v[64:67], v15, s[16:19], s57 offen offset:0 sc1
v_mul_f32 v48, v48, v248
v_mul_f32 v49, v49, v249
v_mul_f32 v50, v50, v250
v_mul_f32 v51, v51, v251
v_mfma_f32_16x16x32_bf16 v[100:103], v[160:163], a[136:139], v[100:103]
v_mul_f32 v52, v52, v252
v_mul_f32 v53, v53, v253
v_mul_f32 v54, v54, v254
v_mul_f32 v55, v55, v255
v_mfma_f32_16x16x32_bf16 v[104:107], v[160:163], a[144:147], v[10:13]
ds_read_b64_tr_b16 v[196:197], v2 offset:36864
v_mul_f32 v56, v56, v248
v_mul_f32 v57, v57, v249
v_mul_f32 v58, v58, v250
v_mul_f32 v59, v59, v251
v_mul_f32 v60, v60, v252
v_mfma_f32_16x16x32_bf16 v[104:107], v[164:167], a[148:151], v[104:107]
s_add_u32 s51, s48, 690176
buffer_load_dwordx4 v14, s[20:23], s51 offen offset:1024 lds
v_mul_f32 v61, v61, v253
v_mul_f32 v62, v62, v254
v_mul_f32 v63, v63, v255
v_cvt_pk_bf16_f32 v24, v48, v49
v_cvt_pk_bf16_f32 v25, v50, v51
v_mfma_f32_16x16x32_bf16 v[108:111], v[164:167], a[156:159], v[10:13]
ds_read_b64_tr_b16 v[198:199], v2 offset:38912
v_cvt_pk_bf16_f32 v26, v52, v53
v_cvt_pk_bf16_f32 v27, v54, v55
v_cvt_pk_bf16_f32 v28, v56, v57
v_cvt_pk_bf16_f32 v29, v58, v59
v_cvt_pk_bf16_f32 v30, v60, v61
v_mfma_f32_16x16x32_bf16 v[108:111], v[160:163], a[152:155], v[108:111]
v_cvt_pk_bf16_f32 v31, v62, v63
v_cvt_pk_bf16_f32 v72, v72, v73
v_cvt_pk_bf16_f32 v73, v74, v75
v_cvt_pk_bf16_f32 v74, v76, v77
v_mfma_f32_16x16x32_bf16 v[112:115], v[160:163], a[160:163], v[10:13]
ds_read_b64_tr_b16 v[200:201], v3 offset:32768
v_cvt_pk_bf16_f32 v75, v78, v79
buffer_store_dwordx4 v[72:75], v15, s[16:19], s76 offen offset:0 sc1
v_mfma_f32_16x16x32_bf16 v[80:83], v[24:27], v[20:23], 0
v_mfma_f32_16x16x32_bf16 v[84:87], v[28:31], v[20:23], 0
v_mfma_f32_16x16x32_bf16 v[88:91], v[24:27], v[18:21], 0
v_mfma_f32_16x16x32_bf16 v[112:115], v[164:167], a[164:167], v[112:115]
s_add_u32 s51, s48, 716800
buffer_load_dwordx4 v14, s[20:23], s51 offen offset:2048 lds
v_mfma_f32_16x16x32_bf16 v[92:95], v[28:31], v[18:21], 0
v_accvgpr_read_b32 v48, a32
v_accvgpr_read_b32 v49, a33
v_accvgpr_read_b32 v50, a34
v_accvgpr_read_b32 v51, a35
v_mfma_f32_16x16x32_bf16 v[132:135], v[172:175], a[164:167], 0
ds_read_b64_tr_b16 v[202:203], v3 offset:34816
v_accvgpr_read_b32 v52, a36
v_accvgpr_read_b32 v53, a37
v_accvgpr_read_b32 v54, a38
v_accvgpr_read_b32 v55, a39
v_mfma_f32_16x16x32_bf16 v[132:135], v[168:171], a[160:163], v[132:135]
v_accvgpr_read_b32 v56, a48
v_accvgpr_read_b32 v57, a49
v_accvgpr_read_b32 v58, a50
v_accvgpr_read_b32 v59, a51
v_accvgpr_read_b32 v60, a52
v_mfma_f32_16x16x32_bf16 v[128:131], v[168:171], a[152:155], 0
ds_read_b64_tr_b16 v[204:205], v3 offset:36864
v_accvgpr_read_b32 v61, a53
v_accvgpr_read_b32 v62, a54
v_accvgpr_read_b32 v63, a55
v_cvt_pk_bf16_f32 v80, v80, v81
v_cvt_pk_bf16_f32 v81, v82, v83
v_mfma_f32_16x16x32_bf16 v[128:131], v[172:175], a[156:159], v[128:131]
s_add_u32 s51, s48, 743424
buffer_load_dwordx4 v14, s[20:23], s51 offen offset:3072 lds
v_cvt_pk_bf16_f32 v82, v84, v85
v_cvt_pk_bf16_f32 v83, v86, v87
buffer_store_dwordx4 v[80:83], v15, s[16:19], s77 offen offset:0 sc1
v_mul_f32 v48, v48, v240
v_mul_f32 v49, v49, v241
v_mfma_f32_16x16x32_bf16 v[124:127], v[172:175], a[148:151], 0
ds_read_b64_tr_b16 v[206:207], v3 offset:38912
v_mul_f32 v50, v50, v242
v_mul_f32 v51, v51, v243
v_mul_f32 v52, v52, v244
v_mul_f32 v53, v53, v245
v_mfma_f32_16x16x32_bf16 v[124:127], v[168:171], a[144:147], v[124:127]
v_mul_f32 v54, v54, v246
v_mul_f32 v55, v55, v247
v_mul_f32 v56, v56, v240
v_mul_f32 v57, v57, v241
v_mul_f32 v58, v58, v242
v_mfma_f32_16x16x32_bf16 v[120:123], v[168:171], a[136:139], 0
ds_read_b64_tr_b16 v[208:209], v4 offset:32768
v_mul_f32 v59, v59, v243
v_mul_f32 v60, v60, v244
v_mul_f32 v61, v61, v245
v_mul_f32 v62, v62, v246
v_mul_f32 v63, v63, v247
v_mfma_f32_16x16x32_bf16 v[120:123], v[172:175], a[140:143], v[120:123]
s_add_u32 m0, s53, 4096
s_add_u32 s51, s48, 774144
buffer_load_dwordx4 v14, s[20:23], s51 offen offset:0 lds
v_cvt_pk_bf16_f32 v24, v48, v49
v_cvt_pk_bf16_f32 v25, v50, v51
v_cvt_pk_bf16_f32 v26, v52, v53
v_cvt_pk_bf16_f32 v27, v54, v55
v_cvt_pk_bf16_f32 v28, v56, v57
v_mfma_f32_16x16x32_bf16 v[116:119], v[172:175], a[132:135], 0
ds_read_b64_tr_b16 v[210:211], v4 offset:34816
v_cvt_pk_bf16_f32 v29, v58, v59
v_cvt_pk_bf16_f32 v30, v60, v61
v_cvt_pk_bf16_f32 v31, v62, v63
v_cvt_pk_bf16_f32 v88, v88, v89
v_mfma_f32_16x16x32_bf16 v[116:119], v[168:171], a[128:131], v[116:119]
v_cvt_pk_bf16_f32 v89, v90, v91
v_cvt_pk_bf16_f32 v90, v92, v93
v_cvt_pk_bf16_f32 v91, v94, v95
buffer_store_dwordx4 v[88:91], v15, s[16:19], s59 offen offset:0 sc1
v_mfma_f32_16x16x32_bf16 v[64:67], v[24:27], v[20:23], 0
v_mfma_f32_16x16x32_bf16 v[136:139], v[176:179], a[128:131], 0
ds_read_b64_tr_b16 v[212:213], v4 offset:36864
v_mfma_f32_16x16x32_bf16 v[68:71], v[28:31], v[20:23], 0
v_mfma_f32_16x16x32_bf16 v[72:75], v[24:27], v[18:21], 0
v_mfma_f32_16x16x32_bf16 v[76:79], v[28:31], v[18:21], 0
v_accvgpr_read_b32 v48, a40
v_accvgpr_read_b32 v49, a41
v_mfma_f32_16x16x32_bf16 v[136:139], v[180:183], a[132:135], v[136:139]
s_add_u32 s51, s48, 800768
buffer_load_dwordx4 v14, s[20:23], s51 offen offset:1024 lds
v_accvgpr_read_b32 v50, a42
v_accvgpr_read_b32 v51, a43
v_accvgpr_read_b32 v52, a44
v_accvgpr_read_b32 v53, a45
v_mfma_f32_16x16x32_bf16 v[140:143], v[180:183], a[140:143], 0
ds_read_b64_tr_b16 v[214:215], v4 offset:38912
v_accvgpr_read_b32 v54, a46
v_accvgpr_read_b32 v55, a47
v_accvgpr_read_b32 v56, a56
v_accvgpr_read_b32 v57, a57
v_accvgpr_read_b32 v58, a58
v_mfma_f32_16x16x32_bf16 v[140:143], v[176:179], a[136:139], v[140:143]
v_accvgpr_read_b32 v59, a59
v_accvgpr_read_b32 v60, a60
v_accvgpr_read_b32 v61, a61
v_accvgpr_read_b32 v62, a62
v_accvgpr_read_b32 v63, a63
v_mfma_f32_16x16x32_bf16 v[144:147], v[176:179], a[144:147], 0
ds_read_b64_tr_b16 v[216:217], v5 offset:32768
v_cvt_pk_bf16_f32 v64, v64, v65
v_cvt_pk_bf16_f32 v65, v66, v67
v_cvt_pk_bf16_f32 v66, v68, v69
v_cvt_pk_bf16_f32 v67, v70, v71
buffer_store_dwordx4 v[64:67], v15, s[16:19], s57 offen offset:1024 sc1
v_mfma_f32_16x16x32_bf16 v[144:147], v[180:183], a[148:151], v[144:147]
s_add_u32 s51, s48, 827392
buffer_load_dwordx4 v14, s[20:23], s51 offen offset:2048 lds
v_mul_f32 v48, v48, v248
v_mul_f32 v49, v49, v249
v_mul_f32 v50, v50, v250
v_mul_f32 v51, v51, v251
v_mfma_f32_16x16x32_bf16 v[148:151], v[180:183], a[156:159], 0
ds_read_b64_tr_b16 v[218:219], v5 offset:34816
v_mul_f32 v52, v52, v252
v_mul_f32 v53, v53, v253
v_mul_f32 v54, v54, v254
v_mul_f32 v55, v55, v255
v_mul_f32 v56, v56, v248
v_mfma_f32_16x16x32_bf16 v[148:151], v[176:179], a[152:155], v[148:151]
v_mul_f32 v57, v57, v249
v_mul_f32 v58, v58, v250
v_mul_f32 v59, v59, v251
v_mul_f32 v60, v60, v252
v_mul_f32 v61, v61, v253
v_mfma_f32_16x16x32_bf16 v[152:155], v[176:179], a[160:163], 0
ds_read_b64_tr_b16 v[220:221], v5 offset:36864
v_mul_f32 v62, v62, v254
v_mul_f32 v63, v63, v255
v_cvt_pk_bf16_f32 v24, v48, v49
v_cvt_pk_bf16_f32 v25, v50, v51
v_cvt_pk_bf16_f32 v26, v52, v53
v_mfma_f32_16x16x32_bf16 v[152:155], v[180:183], a[164:167], v[152:155]
s_add_u32 s51, s48, 854016
buffer_load_dwordx4 v14, s[20:23], s51 offen offset:3072 lds
v_cvt_pk_bf16_f32 v27, v54, v55
v_cvt_pk_bf16_f32 v28, v56, v57
v_cvt_pk_bf16_f32 v29, v58, v59
v_cvt_pk_bf16_f32 v30, v60, v61
v_mfma_f32_16x16x32_bf16 v[236:239], v[188:191], a[164:167], 0
ds_read_b64_tr_b16 v[222:223], v5 offset:38912
v_cvt_pk_bf16_f32 v31, v62, v63
v_cvt_pk_bf16_f32 v72, v72, v73
v_cvt_pk_bf16_f32 v73, v74, v75
v_cvt_pk_bf16_f32 v74, v76, v77
v_cvt_pk_bf16_f32 v75, v78, v79
v_mfma_f32_16x16x32_bf16 v[236:239], v[184:187], a[160:163], v[236:239]
buffer_store_dwordx4 v[72:75], v15, s[16:19], s76 offen offset:1024 sc1
v_mfma_f32_16x16x32_bf16 v[80:83], v[24:27], v[20:23], 0
v_mfma_f32_16x16x32_bf16 v[84:87], v[28:31], v[20:23], 0
v_mfma_f32_16x16x32_bf16 v[88:91], v[24:27], v[18:21], 0
v_mfma_f32_16x16x32_bf16 v[92:95], v[28:31], v[18:21], 0
v_mfma_f32_16x16x32_bf16 v[232:235], v[184:187], a[152:155], 0
v_accvgpr_read_b32 v48, a64
v_accvgpr_read_b32 v49, a65
v_accvgpr_read_b32 v50, a66
v_accvgpr_read_b32 v51, a67
v_mfma_f32_16x16x32_bf16 v[232:235], v[188:191], a[156:159], v[232:235]
v_accvgpr_read_b32 v52, a68
v_accvgpr_read_b32 v53, a69
v_accvgpr_read_b32 v54, a70
v_accvgpr_read_b32 v55, a71
v_accvgpr_read_b32 v56, a80
v_mfma_f32_16x16x32_bf16 v[228:231], v[188:191], a[148:151], 0
v_accvgpr_read_b32 v57, a81
v_accvgpr_read_b32 v58, a82
v_accvgpr_read_b32 v59, a83
v_accvgpr_read_b32 v60, a84
v_accvgpr_read_b32 v61, a85
v_mfma_f32_16x16x32_bf16 v[228:231], v[184:187], a[144:147], v[228:231]
v_accvgpr_read_b32 v62, a86
v_accvgpr_read_b32 v63, a87
v_cvt_pk_bf16_f32 v80, v80, v81
v_cvt_pk_bf16_f32 v81, v82, v83
v_cvt_pk_bf16_f32 v82, v84, v85
v_mfma_f32_16x16x32_bf16 v[224:227], v[184:187], a[136:139], 0
v_cvt_pk_bf16_f32 v83, v86, v87
buffer_store_dwordx4 v[80:83], v15, s[16:19], s77 offen offset:1024 sc1
v_mul_f32 v48, v48, v240
v_mul_f32 v49, v49, v241
v_mfma_f32_16x16x32_bf16 v[224:227], v[188:191], a[140:143], v[224:227]
v_mul_f32 v50, v50, v242
v_mul_f32 v51, v51, v243
v_mul_f32 v52, v52, v244
v_mul_f32 v53, v53, v245
v_mul_f32 v54, v54, v246
v_mfma_f32_16x16x32_bf16 v[156:159], v[188:191], a[132:135], 0
v_mul_f32 v55, v55, v247
v_mul_f32 v56, v56, v240
v_mul_f32 v57, v57, v241
v_mul_f32 v58, v58, v242
v_mul_f32 v59, v59, v243
v_mfma_f32_16x16x32_bf16 v[156:159], v[184:187], a[128:131], v[156:159]
v_mul_f32 v60, v60, v244
v_mul_f32 v61, v61, v245
v_mul_f32 v62, v62, v246
v_mul_f32 v63, v63, v247
s_waitcnt vmcnt(46)
s_waitcnt vmcnt(25)
s_waitcnt lgkmcnt(0)
v_mfma_f32_16x16x32_bf16 v[96:99], v[192:195], a[168:171], v[96:99]
ds_read_b64_tr_b16 v[160:161], v6 offset:0
v_cvt_pk_bf16_f32 v24, v48, v49
v_cvt_pk_bf16_f32 v25, v50, v51
v_cvt_pk_bf16_f32 v26, v52, v53
v_cvt_pk_bf16_f32 v27, v54, v55
v_cvt_pk_bf16_f32 v28, v56, v57
v_mfma_f32_16x16x32_bf16 v[96:99], v[196:199], a[172:175], v[96:99]
s_add_u32 s52, s49, 2627584
buffer_load_dwordx4 a[128:131], v15, s[16:19], s52 offen sc1
v_cvt_pk_bf16_f32 v29, v58, v59
v_cvt_pk_bf16_f32 v30, v60, v61
v_cvt_pk_bf16_f32 v31, v62, v63
v_cvt_pk_bf16_f32 v88, v88, v89
v_cvt_pk_bf16_f32 v89, v90, v91
v_mfma_f32_16x16x32_bf16 v[100:103], v[196:199], a[180:183], v[100:103]
ds_read_b64_tr_b16 v[162:163], v6 offset:2048
v_cvt_pk_bf16_f32 v90, v92, v93
v_cvt_pk_bf16_f32 v91, v94, v95
buffer_store_dwordx4 v[88:91], v15, s[16:19], s59 offen offset:1024 sc1
v_mfma_f32_16x16x32_bf16 v[64:67], v[24:27], v[20:23], 0
v_mfma_f32_16x16x32_bf16 v[68:71], v[28:31], v[20:23], 0
v_mfma_f32_16x16x32_bf16 v[100:103], v[192:195], a[176:179], v[100:103]
buffer_load_dwordx4 a[132:135], v15, s[16:19], s52 offen offset:1024 sc1
v_mfma_f32_16x16x32_bf16 v[72:75], v[24:27], v[18:21], 0
v_mfma_f32_16x16x32_bf16 v[76:79], v[28:31], v[18:21], 0
v_accvgpr_read_b32 v48, a72
v_accvgpr_read_b32 v49, a73
v_mfma_f32_16x16x32_bf16 v[104:107], v[192:195], a[184:187], v[104:107]
ds_read_b64_tr_b16 v[164:165], v6 offset:4096
v_accvgpr_read_b32 v50, a74
v_accvgpr_read_b32 v51, a75
v_accvgpr_read_b32 v52, a76
v_accvgpr_read_b32 v53, a77
v_accvgpr_read_b32 v54, a78
v_mfma_f32_16x16x32_bf16 v[104:107], v[196:199], a[188:191], v[104:107]
s_add_u32 s52, s49, 2693120
buffer_load_dwordx4 a[136:139], v15, s[16:19], s52 offen sc1
v_accvgpr_read_b32 v55, a79
v_accvgpr_read_b32 v56, a88
v_accvgpr_read_b32 v57, a89
v_accvgpr_read_b32 v58, a90
v_accvgpr_read_b32 v59, a91
v_mfma_f32_16x16x32_bf16 v[108:111], v[196:199], v[36:39], v[108:111]
ds_read_b64_tr_b16 v[166:167], v6 offset:6144
v_accvgpr_read_b32 v60, a92
v_accvgpr_read_b32 v61, a93
v_accvgpr_read_b32 v62, a94
v_accvgpr_read_b32 v63, a95
v_cvt_pk_bf16_f32 v64, v64, v65
v_mfma_f32_16x16x32_bf16 v[108:111], v[192:195], v[32:35], v[108:111]
buffer_load_dwordx4 a[140:143], v15, s[16:19], s52 offen offset:1024 sc1
v_cvt_pk_bf16_f32 v65, v66, v67
v_cvt_pk_bf16_f32 v66, v68, v69
v_cvt_pk_bf16_f32 v67, v70, v71
buffer_store_dwordx4 v[64:67], v15, s[16:19], s57 offen offset:2048 sc1
v_mfma_f32_16x16x32_bf16 v[112:115], v[192:195], v[40:43], v[112:115]
ds_read_b64_tr_b16 v[168:169], v7 offset:0
v_mul_f32 v48, v48, v248
v_mul_f32 v49, v49, v249
v_mul_f32 v50, v50, v250
v_mul_f32 v51, v51, v251
v_mul_f32 v52, v52, v252
v_mfma_f32_16x16x32_bf16 v[112:115], v[196:199], v[44:47], v[112:115]
s_add_u32 s52, s49, 2758656
buffer_load_dwordx4 a[144:147], v15, s[16:19], s52 offen sc1
v_mul_f32 v53, v53, v253
v_mul_f32 v54, v54, v254
v_mul_f32 v55, v55, v255
v_mul_f32 v56, v56, v248
v_mul_f32 v57, v57, v249
v_mfma_f32_16x16x32_bf16 v[132:135], v[204:207], v[44:47], v[132:135]
ds_read_b64_tr_b16 v[170:171], v7 offset:2048
v_mul_f32 v58, v58, v250
v_mul_f32 v59, v59, v251
v_mul_f32 v60, v60, v252
v_mul_f32 v61, v61, v253
v_mul_f32 v62, v62, v254
v_mfma_f32_16x16x32_bf16 v[132:135], v[200:203], v[40:43], v[132:135]
buffer_load_dwordx4 a[148:151], v15, s[16:19], s52 offen offset:1024 sc1
v_mul_f32 v63, v63, v255
v_cvt_pk_bf16_f32 v24, v48, v49
v_cvt_pk_bf16_f32 v25, v50, v51
v_cvt_pk_bf16_f32 v26, v52, v53
v_mfma_f32_16x16x32_bf16 v[128:131], v[200:203], v[32:35], v[128:131]
ds_read_b64_tr_b16 v[172:173], v7 offset:4096
v_cvt_pk_bf16_f32 v27, v54, v55
v_cvt_pk_bf16_f32 v28, v56, v57
v_cvt_pk_bf16_f32 v29, v58, v59
v_cvt_pk_bf16_f32 v30, v60, v61
v_cvt_pk_bf16_f32 v31, v62, v63
v_mfma_f32_16x16x32_bf16 v[128:131], v[204:207], v[36:39], v[128:131]
s_add_u32 s52, s49, 2824192
buffer_load_dwordx4 a[152:155], v15, s[16:19], s52 offen sc1
v_cvt_pk_bf16_f32 v72, v72, v73
v_cvt_pk_bf16_f32 v73, v74, v75
v_cvt_pk_bf16_f32 v74, v76, v77
v_cvt_pk_bf16_f32 v75, v78, v79
buffer_store_dwordx4 v[72:75], v15, s[16:19], s76 offen offset:2048 sc1
v_mfma_f32_16x16x32_bf16 v[124:127], v[204:207], a[188:191], v[124:127]
ds_read_b64_tr_b16 v[174:175], v7 offset:6144
v_mfma_f32_16x16x32_bf16 v[80:83], v[24:27], v[20:23], 0
v_mfma_f32_16x16x32_bf16 v[84:87], v[28:31], v[20:23], 0
v_mfma_f32_16x16x32_bf16 v[88:91], v[24:27], v[18:21], 0
v_mfma_f32_16x16x32_bf16 v[92:95], v[28:31], v[18:21], 0
v_accvgpr_read_b32 v48, a96
v_mfma_f32_16x16x32_bf16 v[124:127], v[200:203], a[184:187], v[124:127]
buffer_load_dwordx4 a[156:159], v15, s[16:19], s52 offen offset:1024 sc1
v_accvgpr_read_b32 v49, a97
v_accvgpr_read_b32 v50, a98
v_accvgpr_read_b32 v51, a99
v_accvgpr_read_b32 v52, a100
v_mfma_f32_16x16x32_bf16 v[120:123], v[200:203], a[176:179], v[120:123]
ds_read_b64_tr_b16 v[176:177], v8 offset:0
v_accvgpr_read_b32 v53, a101
v_accvgpr_read_b32 v54, a102
v_accvgpr_read_b32 v55, a103
v_accvgpr_read_b32 v56, a112
v_accvgpr_read_b32 v57, a113
v_mfma_f32_16x16x32_bf16 v[120:123], v[204:207], a[180:183], v[120:123]
s_add_u32 s52, s49, 2889728
buffer_load_dwordx4 a[160:163], v15, s[16:19], s52 offen sc1
v_accvgpr_read_b32 v58, a114
v_accvgpr_read_b32 v59, a115
v_accvgpr_read_b32 v60, a116
v_accvgpr_read_b32 v61, a117
v_accvgpr_read_b32 v62, a118
v_mfma_f32_16x16x32_bf16 v[116:119], v[204:207], a[172:175], v[116:119]
ds_read_b64_tr_b16 v[178:179], v8 offset:2048
v_accvgpr_read_b32 v63, a119
v_cvt_pk_bf16_f32 v80, v80, v81
v_cvt_pk_bf16_f32 v81, v82, v83
v_cvt_pk_bf16_f32 v82, v84, v85
v_cvt_pk_bf16_f32 v83, v86, v87
v_mfma_f32_16x16x32_bf16 v[116:119], v[200:203], a[168:171], v[116:119]
buffer_load_dwordx4 a[164:167], v15, s[16:19], s52 offen offset:1024 sc1
buffer_store_dwordx4 v[80:83], v15, s[16:19], s77 offen offset:2048 sc1
v_mul_f32 v48, v48, v240
v_mul_f32 v49, v49, v241
v_mul_f32 v50, v50, v242
v_mfma_f32_16x16x32_bf16 v[136:139], v[208:211], a[168:171], v[136:139]
ds_read_b64_tr_b16 v[180:181], v8 offset:4096
v_mul_f32 v51, v51, v243
v_mul_f32 v52, v52, v244
v_mul_f32 v53, v53, v245
v_mul_f32 v54, v54, v246
v_mul_f32 v55, v55, v247
v_mfma_f32_16x16x32_bf16 v[136:139], v[212:215], a[172:175], v[136:139]
s_add_u32 m0, s53, 32768
s_add_u32 s51, s48, 884736
buffer_load_dwordx4 v14, s[20:23], s51 offen offset:0 lds
v_mul_f32 v56, v56, v240
v_mul_f32 v57, v57, v241
v_mul_f32 v58, v58, v242
v_mul_f32 v59, v59, v243
v_mul_f32 v60, v60, v244
v_mfma_f32_16x16x32_bf16 v[140:143], v[212:215], a[180:183], v[140:143]
ds_read_b64_tr_b16 v[182:183], v8 offset:6144
v_mul_f32 v61, v61, v245
v_mul_f32 v62, v62, v246
v_mul_f32 v63, v63, v247
v_cvt_pk_bf16_f32 v24, v48, v49
v_cvt_pk_bf16_f32 v25, v50, v51
v_mfma_f32_16x16x32_bf16 v[140:143], v[208:211], a[176:179], v[140:143]
s_add_u32 s51, s48, 911360
buffer_load_dwordx4 v14, s[20:23], s51 offen offset:1024 lds
v_cvt_pk_bf16_f32 v26, v52, v53
v_cvt_pk_bf16_f32 v27, v54, v55
v_cvt_pk_bf16_f32 v28, v56, v57
v_cvt_pk_bf16_f32 v29, v58, v59
v_mfma_f32_16x16x32_bf16 v[144:147], v[208:211], a[184:187], v[144:147]
ds_read_b64_tr_b16 v[184:185], v9 offset:0
v_cvt_pk_bf16_f32 v30, v60, v61
v_cvt_pk_bf16_f32 v31, v62, v63
v_cvt_pk_bf16_f32 v88, v88, v89
v_cvt_pk_bf16_f32 v89, v90, v91
v_cvt_pk_bf16_f32 v90, v92, v93
v_mfma_f32_16x16x32_bf16 v[144:147], v[212:215], a[188:191], v[144:147]
s_add_u32 s51, s48, 937984
buffer_load_dwordx4 v14, s[20:23], s51 offen offset:2048 lds
v_cvt_pk_bf16_f32 v91, v94, v95
buffer_store_dwordx4 v[88:91], v15, s[16:19], s59 offen offset:2048 sc1
v_mfma_f32_16x16x32_bf16 v[64:67], v[24:27], v[20:23], 0
v_mfma_f32_16x16x32_bf16 v[68:71], v[28:31], v[20:23], 0
v_mfma_f32_16x16x32_bf16 v[72:75], v[24:27], v[18:21], 0
v_mfma_f32_16x16x32_bf16 v[148:151], v[212:215], v[36:39], v[148:151]
ds_read_b64_tr_b16 v[186:187], v9 offset:2048
v_mfma_f32_16x16x32_bf16 v[76:79], v[28:31], v[18:21], 0
v_accvgpr_read_b32 v48, a104
v_accvgpr_read_b32 v49, a105
v_accvgpr_read_b32 v50, a106
v_accvgpr_read_b32 v51, a107
v_mfma_f32_16x16x32_bf16 v[148:151], v[208:211], v[32:35], v[148:151]
s_add_u32 s51, s48, 964608
buffer_load_dwordx4 v14, s[20:23], s51 offen offset:3072 lds
v_accvgpr_read_b32 v52, a108
v_accvgpr_read_b32 v53, a109
v_accvgpr_read_b32 v54, a110
v_accvgpr_read_b32 v55, a111
v_mfma_f32_16x16x32_bf16 v[152:155], v[208:211], v[40:43], v[152:155]
ds_read_b64_tr_b16 v[188:189], v9 offset:4096
K_pg8:
s_cbranch_execz K_pg11
v_accvgpr_read_b32 v56, a120
v_accvgpr_read_b32 v57, a121
v_accvgpr_read_b32 v58, a122
v_accvgpr_read_b32 v59, a123
v_accvgpr_read_b32 v60, a124
v_mfma_f32_16x16x32_bf16 v[152:155], v[212:215], v[44:47], v[152:155]
s_add_u32 m0, s53, 36864
s_add_u32 s51, s48, 995328
buffer_load_dwordx4 v14, s[20:23], s51 offen offset:0 lds
v_accvgpr_read_b32 v61, a125
v_accvgpr_read_b32 v62, a126
v_accvgpr_read_b32 v63, a127
v_cvt_pk_bf16_f32 v64, v64, v65
v_cvt_pk_bf16_f32 v65, v66, v67
v_mfma_f32_16x16x32_bf16 v[236:239], v[220:223], v[44:47], v[236:239]
ds_read_b64_tr_b16 v[190:191], v9 offset:6144
v_cvt_pk_bf16_f32 v66, v68, v69
v_cvt_pk_bf16_f32 v67, v70, v71
buffer_store_dwordx4 v[64:67], v15, s[16:19], s57 offen offset:3072 sc1
v_mul_f32 v48, v48, v248
v_mul_f32 v49, v49, v249
v_mfma_f32_16x16x32_bf16 v[236:239], v[216:219], v[40:43], v[236:239]
s_add_u32 s51, s48, 1021952
buffer_load_dwordx4 v14, s[20:23], s51 offen offset:1024 lds
v_mul_f32 v50, v50, v250
v_mul_f32 v51, v51, v251
v_mul_f32 v52, v52, v252
v_mul_f32 v53, v53, v253
v_mfma_f32_16x16x32_bf16 v[232:235], v[216:219], v[32:35], v[232:235]
v_mul_f32 v54, v54, v254
v_mul_f32 v55, v55, v255
v_mul_f32 v56, v56, v248
v_mul_f32 v57, v57, v249
v_mul_f32 v58, v58, v250
v_mfma_f32_16x16x32_bf16 v[232:235], v[220:223], v[36:39], v[232:235]
s_add_u32 s51, s48, 1048576
buffer_load_dwordx4 v14, s[20:23], s51 offen offset:2048 lds
v_mul_f32 v59, v59, v251
v_mul_f32 v60, v60, v252
v_mul_f32 v61, v61, v253
v_mul_f32 v62, v62, v254
v_mul_f32 v63, v63, v255
v_mfma_f32_16x16x32_bf16 v[228:231], v[220:223], a[188:191], v[228:231]
v_cvt_pk_bf16_f32 v24, v48, v49
v_cvt_pk_bf16_f32 v25, v50, v51
v_cvt_pk_bf16_f32 v26, v52, v53
v_cvt_pk_bf16_f32 v27, v54, v55
v_cvt_pk_bf16_f32 v28, v56, v57
v_mfma_f32_16x16x32_bf16 v[228:231], v[216:219], a[184:187], v[228:231]
s_add_u32 s51, s48, 1075200
buffer_load_dwordx4 v14, s[20:23], s51 offen offset:3072 lds
v_cvt_pk_bf16_f32 v29, v58, v59
v_cvt_pk_bf16_f32 v30, v60, v61
v_cvt_pk_bf16_f32 v31, v62, v63
v_cvt_pk_bf16_f32 v72, v72, v73
v_mfma_f32_16x16x32_bf16 v[224:227], v[216:219], a[176:179], v[224:227]
v_cvt_pk_bf16_f32 v73, v74, v75
v_cvt_pk_bf16_f32 v74, v76, v77
v_cvt_pk_bf16_f32 v75, v78, v79
buffer_store_dwordx4 v[72:75], v15, s[16:19], s76 offen offset:3072 sc1
v_mfma_f32_16x16x32_bf16 v[80:83], v[24:27], v[20:23], 0
v_mfma_f32_16x16x32_bf16 v[224:227], v[220:223], a[180:183], v[224:227]
v_mfma_f32_16x16x32_bf16 v[84:87], v[28:31], v[20:23], 0
v_mfma_f32_16x16x32_bf16 v[88:91], v[24:27], v[18:21], 0
v_mfma_f32_16x16x32_bf16 v[92:95], v[28:31], v[18:21], 0
s_nop 7
v_cvt_pk_bf16_f32 v80, v80, v81
v_mfma_f32_16x16x32_bf16 v[156:159], v[220:223], a[172:175], v[156:159]
v_cvt_pk_bf16_f32 v81, v82, v83
v_cvt_pk_bf16_f32 v82, v84, v85
v_cvt_pk_bf16_f32 v83, v86, v87
buffer_store_dwordx4 v[80:83], v15, s[16:19], s77 offen offset:3072 sc1
v_cvt_pk_bf16_f32 v88, v88, v89
v_mfma_f32_16x16x32_bf16 v[156:159], v[216:219], a[168:171], v[156:159]
v_cvt_pk_bf16_f32 v89, v90, v91
v_cvt_pk_bf16_f32 v90, v92, v93
v_cvt_pk_bf16_f32 v91, v94, v95
buffer_store_dwordx4 v[88:91], v15, s[16:19], s59 offen offset:3072 sc1
s_waitcnt vmcnt(29)
s_waitcnt vmcnt(42)
s_waitcnt lgkmcnt(0)
v_mfma_f32_16x16x32_bf16 v[96:99], v[160:163], a[192:195], v[96:99]
ds_read_b64_tr_b16 v[192:193], v2 offset:0
s_lshr_b32 s100, s81, 1
s_and_b32 s50, s81, 1
v_mfma_f32_16x16x32_bf16 v[96:99], v[164:167], a[196:199], v[96:99]
s_add_u32 s52, s49, 2629632
buffer_load_dwordx4 a[168:171], v15, s[16:19], s52 offen sc1
s_lshl_b32 s50, s50, 5
v_mfma_f32_16x16x32_bf16 v[100:103], v[164:167], a[204:207], v[100:103]
ds_read_b64_tr_b16 v[194:195], v2 offset:2048
s_lshr_b32 s56, s2, 3
v_mfma_f32_16x16x32_bf16 v[100:103], v[160:163], a[200:203], v[100:103]
buffer_load_dwordx4 a[172:175], v15, s[16:19], s52 offen offset:1024 sc1
s_add_u32 s50, s50, s56
s_lshl_b32 s99, s50, 2
v_mfma_f32_16x16x32_bf16 v[104:107], v[160:163], a[208:211], v[104:107]
ds_read_b64_tr_b16 v[196:197], v2 offset:4096
s_add_u32 s99, s99, s100
v_mfma_f32_16x16x32_bf16 v[104:107], v[164:167], a[212:215], v[104:107]
s_add_u32 s52, s49, 2695168
buffer_load_dwordx4 a[176:179], v15, s[16:19], s52 offen sc1
s_lshr_b32 s56, s50, 3
v_mfma_f32_16x16x32_bf16 v[108:111], v[164:167], a[220:223], v[108:111]
ds_read_b64_tr_b16 v[198:199], v2 offset:6144
s_lshl_b32 s56, s56, 5
v_mfma_f32_16x16x32_bf16 v[108:111], v[160:163], a[216:219], v[108:111]
buffer_load_dwordx4 a[180:183], v15, s[16:19], s52 offen offset:1024 sc1
s_lshl_b32 s76, s100, 1
s_add_u32 s56, s56, s76
v_mfma_f32_16x16x32_bf16 v[112:115], v[160:163], a[224:227], v[112:115]
ds_read_b64_tr_b16 v[200:201], v3 offset:0
s_lshl_b32 s56, s56, 7
v_mfma_f32_16x16x32_bf16 v[112:115], v[164:167], a[228:231], v[112:115]
s_add_u32 s52, s49, 2760704
buffer_load_dwordx4 a[184:187], v15, s[16:19], s52 offen sc1
s_add_u32 s56, s56, 14745600
v_mfma_f32_16x16x32_bf16 v[132:135], v[172:175], a[228:231], v[132:135]
ds_read_b64_tr_b16 v[202:203], v3 offset:2048
v_bfe_u32 v245, v1, 1, 2
v_and_b32 v244, 1, v1
v_mfma_f32_16x16x32_bf16 v[132:135], v[168:171], a[224:227], v[132:135]
buffer_load_dwordx4 a[188:191], v15, s[16:19], s52 offen offset:1024 sc1
v_lshl_add_u32 v245, v245, 3, v244
v_mfma_f32_16x16x32_bf16 v[128:131], v[168:171], a[216:219], v[128:131]
ds_read_b64_tr_b16 v[204:205], v3 offset:4096
v_and_b32 v244, 0, v1
v_mfma_f32_16x16x32_bf16 v[128:131], v[172:175], a[220:223], v[128:131]
s_add_u32 s52, s49, 2826240
buffer_load_dwordx4 v[32:35], v15, s[16:19], s52 offen sc1
v_lshl_add_u32 v245, v244, 4, v245
v_mfma_f32_16x16x32_bf16 v[124:127], v[172:175], a[212:215], v[124:127]
ds_read_b64_tr_b16 v[206:207], v3 offset:6144
v_lshlrev_b32 v245, 7, v245
v_add_u32 v245, s56, v245
v_mfma_f32_16x16x32_bf16 v[124:127], v[168:171], a[208:211], v[124:127]
buffer_load_dwordx4 v[36:39], v15, s[16:19], s52 offen offset:1024 sc1
v_lshlrev_b32 v244, 4, v1
v_mfma_f32_16x16x32_bf16 v[120:123], v[168:171], a[200:203], v[120:123]
ds_read_b64_tr_b16 v[208:209], v4 offset:0
s_lshr_b32 s41, s50, 2
v_mfma_f32_16x16x32_bf16 v[120:123], v[172:175], a[204:207], v[120:123]
s_add_u32 s52, s49, 2891776
buffer_load_dwordx4 v[40:43], v15, s[16:19], s52 offen sc1
s_lshl_b32 s41, s41, 1
v_mfma_f32_16x16x32_bf16 v[116:119], v[172:175], a[196:199], v[116:119]
ds_read_b64_tr_b16 v[210:211], v4 offset:2048
s_lshr_b32 s76, s100, 1
s_lshl_b32 s76, s76, 0
v_mfma_f32_16x16x32_bf16 v[116:119], v[168:171], a[192:195], v[116:119]
buffer_load_dwordx4 v[44:47], v15, s[16:19], s52 offen offset:1024 sc1
s_add_u32 s41, s41, s76
v_mfma_f32_16x16x32_bf16 v[136:139], v[176:179], a[192:195], v[136:139]
ds_read_b64_tr_b16 v[212:213], v4 offset:4096
s_and_b32 s42, s50, 3
v_mfma_f32_16x16x32_bf16 v[136:139], v[180:183], a[196:199], v[136:139]
s_add_u32 m0, s53, 65536
s_add_u32 s51, s48, 1105920
buffer_load_dwordx4 v14, s[20:23], s51 offen offset:0 lds
s_and_b32 s76, s100, 1
s_lshl_b32 s76, s76, 2
v_mfma_f32_16x16x32_bf16 v[140:143], v[180:183], a[204:207], v[140:143]
ds_read_b64_tr_b16 v[214:215], v4 offset:6144
s_add_u32 s42, s42, s76
v_mfma_f32_16x16x32_bf16 v[140:143], v[176:179], a[200:203], v[140:143]
s_add_u32 s51, s48, 1132544
buffer_load_dwordx4 v14, s[20:23], s51 offen offset:1024 lds
v_and_b32 v250, 15, v1
v_mfma_f32_16x16x32_bf16 v[144:147], v[176:179], a[208:211], v[144:147]
ds_read_b64_tr_b16 v[216:217], v5 offset:0
v_lshrrev_b32 v252, 4, v1
v_mfma_f32_16x16x32_bf16 v[144:147], v[180:183], a[212:215], v[144:147]
s_add_u32 s51, s48, 1159168
buffer_load_dwordx4 v14, s[20:23], s51 offen offset:2048 lds
v_mul_u32_u24 v251, 1280, v250
v_lshl_add_u32 v251, v252, 3, v251
v_mfma_f32_16x16x32_bf16 v[148:151], v[180:183], a[220:223], v[148:151]
ds_read_b64_tr_b16 v[218:219], v5 offset:2048
s_lshl_b32 s43, s41, 2
v_mfma_f32_16x16x32_bf16 v[148:151], v[176:179], a[216:219], v[148:151]
s_add_u32 s51, s48, 1185792
buffer_load_dwordx4 v14, s[20:23], s51 offen offset:3072 lds
s_add_u32 s43, s43, s44
v_mfma_f32_16x16x32_bf16 v[152:155], v[176:179], a[224:227], v[152:155]
ds_read_b64_tr_b16 v[220:221], v5 offset:4096
s_lshl_b32 s76, s43, 4
v_mfma_f32_16x16x32_bf16 v[152:155], v[180:183], a[228:231], v[152:155]
s_add_u32 m0, s53, 69632
s_add_u32 s51, s48, 1216512
buffer_load_dwordx4 v14, s[20:23], s51 offen offset:0 lds
v_add_lshl_u32 v252, v250, s76, 1
s_mul_i32 s43, s43, 20480
v_mfma_f32_16x16x32_bf16 v[236:239], v[188:191], a[228:231], v[236:239]
ds_read_b64_tr_b16 v[222:223], v5 offset:6144
s_mul_i32 s76, s42, 160
v_mfma_f32_16x16x32_bf16 v[236:239], v[184:187], a[224:227], v[236:239]
s_add_u32 s51, s48, 1243136
buffer_load_dwordx4 v14, s[20:23], s51 offen offset:1024 lds
s_add_u32 s43, s43, s76
v_mfma_f32_16x16x32_bf16 v[232:235], v[184:187], a[216:219], v[232:235]
s_lshl_b32 s76, s100, 15
s_and_b32 s56, s50, 3
v_mfma_f32_16x16x32_bf16 v[232:235], v[188:191], a[220:223], v[232:235]
s_add_u32 s51, s48, 1269760
buffer_load_dwordx4 v14, s[20:23], s51 offen offset:2048 lds
s_mul_i32 s56, s56, 677120
v_mfma_f32_16x16x32_bf16 v[228:231], v[188:191], a[212:215], v[228:231]
s_add_u32 s56, s56, s76
v_mfma_f32_16x16x32_bf16 v[228:231], v[184:187], a[208:211], v[228:231]
s_add_u32 s51, s48, 1296384
buffer_load_dwordx4 v14, s[20:23], s51 offen offset:3072 lds
s_add_u32 s56, s56, 7305216
v_mfma_f32_16x16x32_bf16 v[224:227], v[184:187], a[200:203], v[224:227]
s_lshr_b32 s50, s50, 2
s_mul_i32 s50, s50, 1083392
v_mfma_f32_16x16x32_bf16 v[224:227], v[188:191], a[204:207], v[224:227]
s_add_u32 s50, s50, s76
v_mfma_f32_16x16x32_bf16 v[156:159], v[188:191], a[196:199], v[156:159]
s_add_u32 s50, s50, 16777216
v_mfma_f32_16x16x32_bf16 v[156:159], v[184:187], a[192:195], v[156:159]
s_mul_i32 s98, s44, 9
s_waitcnt vmcnt(21)
s_waitcnt vmcnt(32)
s_waitcnt vmcnt(18)
s_waitcnt lgkmcnt(0)
v_mfma_f32_16x16x32_bf16 v[96:99], v[192:195], a[128:131], v[96:99]
s_barrier
v_mov_b32 v23, 98304
ds_read_b128 v[24:27], v23
ds_read_b64_tr_b16 v[160:161], v2 offset:32768
v_mfma_f32_16x16x32_bf16 v[96:99], v[196:199], a[132:135], v[96:99]
s_add_u32 s52, s49, 2631680
buffer_load_dwordx4 a[192:195], v15, s[16:19], s52 offen sc1
v_mfma_f32_16x16x32_bf16 v[100:103], v[196:199], a[140:143], v[100:103]
ds_read_b64_tr_b16 v[162:163], v2 offset:34816
v_mfma_f32_16x16x32_bf16 v[100:103], v[192:195], a[136:139], v[100:103]
buffer_load_dwordx4 a[196:199], v15, s[16:19], s52 offen offset:1024 sc1
v_mfma_f32_16x16x32_bf16 v[104:107], v[192:195], a[144:147], v[104:107]
ds_read_b64_tr_b16 v[164:165], v2 offset:36864
v_mfma_f32_16x16x32_bf16 v[104:107], v[196:199], a[148:151], v[104:107]
s_add_u32 s52, s49, 2697216
buffer_load_dwordx4 a[200:203], v15, s[16:19], s52 offen sc1
v_mfma_f32_16x16x32_bf16 v[108:111], v[196:199], a[156:159], v[108:111]
ds_read_b64_tr_b16 v[166:167], v2 offset:38912
s_waitcnt lgkmcnt(4)
v_or3_b32 v24, v24, v25, v26
v_or_b32 v24, v24, v27
s_nop 0
v_readfirstlane_b32 s55, v24
s_nop 3
s_cmp_lg_u32 s55, 0
s_cbranch_scc1 Lnosig_13
s_bitcmp1_b32 s58, 2
s_cbranch_scc1 Lsig_14
s_bitset1_b32 s58, 2
v_mov_b32 v21, s83
v_mov_b32 v20, s88
v_lshlrev_b32 v21, 7, v21
v_add_u32 v21, 14745600, v21
s_mov_b64 exec, 1
buffer_store_dword v20, v21, s[16:19], 0 offen sc1
s_mov_b64 exec, -1
Lsig_14:
Lnosig_13:
v_mfma_f32_16x16x32_bf16 v[108:111], v[192:195], a[152:155], v[108:111]
buffer_load_dwordx4 a[204:207], v15, s[16:19], s52 offen offset:1024 sc1
v_mfma_f32_16x16x32_bf16 v[112:115], v[192:195], a[160:163], v[112:115]
ds_read_b64_tr_b16 v[168:169], v3 offset:32768
v_mfma_f32_16x16x32_bf16 v[112:115], v[196:199], a[164:167], v[112:115]
s_add_u32 s52, s49, 2762752
buffer_load_dwordx4 a[208:211], v15, s[16:19], s52 offen sc1
v_mfma_f32_16x16x32_bf16 v[132:135], v[204:207], a[164:167], v[132:135]
ds_read_b64_tr_b16 v[170:171], v3 offset:34816
v_mfma_f32_16x16x32_bf16 v[132:135], v[200:203], a[160:163], v[132:135]
buffer_load_dwordx4 a[212:215], v15, s[16:19], s52 offen offset:1024 sc1
v_mfma_f32_16x16x32_bf16 v[128:131], v[200:203], a[152:155], v[128:131]
ds_read_b64_tr_b16 v[172:173], v3 offset:36864
v_mfma_f32_16x16x32_bf16 v[128:131], v[204:207], a[156:159], v[128:131]
s_add_u32 s52, s49, 2828288
buffer_load_dwordx4 a[216:219], v15, s[16:19], s52 offen sc1
v_mfma_f32_16x16x32_bf16 v[124:127], v[204:207], a[148:151], v[124:127]
ds_read_b64_tr_b16 v[174:175], v3 offset:38912
v_mfma_f32_16x16x32_bf16 v[124:127], v[200:203], a[144:147], v[124:127]
buffer_load_dwordx4 a[220:223], v15, s[16:19], s52 offen offset:1024 sc1
v_mfma_f32_16x16x32_bf16 v[120:123], v[200:203], a[136:139], v[120:123]
ds_read_b64_tr_b16 v[176:177], v4 offset:32768
v_mfma_f32_16x16x32_bf16 v[120:123], v[204:207], a[140:143], v[120:123]
s_add_u32 s52, s49, 2893824
buffer_load_dwordx4 a[224:227], v15, s[16:19], s52 offen sc1
v_mfma_f32_16x16x32_bf16 v[116:119], v[204:207], a[132:135], v[116:119]
ds_read_b64_tr_b16 v[178:179], v4 offset:34816
v_mfma_f32_16x16x32_bf16 v[116:119], v[200:203], a[128:131], v[116:119]
buffer_load_dwordx4 a[228:231], v15, s[16:19], s52 offen offset:1024 sc1
v_mfma_f32_16x16x32_bf16 v[136:139], v[208:211], a[128:131], v[136:139]
ds_read_b64_tr_b16 v[180:181], v4 offset:36864
v_mfma_f32_16x16x32_bf16 v[136:139], v[212:215], a[132:135], v[136:139]
s_add_u32 m0, s53, 0
s_add_u32 s51, s48, 1327104
buffer_load_dwordx4 v14, s[20:23], s51 offen offset:0 lds
v_mfma_f32_16x16x32_bf16 v[140:143], v[212:215], a[140:143], v[140:143]
ds_read_b64_tr_b16 v[182:183], v4 offset:38912
v_mfma_f32_16x16x32_bf16 v[140:143], v[208:211], a[136:139], v[140:143]
s_add_u32 s51, s48, 1353728
buffer_load_dwordx4 v14, s[20:23], s51 offen offset:1024 lds
v_mfma_f32_16x16x32_bf16 v[144:147], v[208:211], a[144:147], v[144:147]
ds_read_b64_tr_b16 v[184:185], v5 offset:32768
v_mfma_f32_16x16x32_bf16 v[144:147], v[212:215], a[148:151], v[144:147]
s_add_u32 s51, s48, 1380352
buffer_load_dwordx4 v14, s[20:23], s51 offen offset:2048 lds
v_mfma_f32_16x16x32_bf16 v[148:151], v[212:215], a[156:159], v[148:151]
ds_read_b64_tr_b16 v[186:187], v5 offset:34816
v_mfma_f32_16x16x32_bf16 v[148:151], v[208:211], a[152:155], v[148:151]
s_add_u32 s51, s48, 1406976
buffer_load_dwordx4 v14, s[20:23], s51 offen offset:3072 lds
v_mfma_f32_16x16x32_bf16 v[152:155], v[208:211], a[160:163], v[152:155]
ds_read_b64_tr_b16 v[188:189], v5 offset:36864
v_mfma_f32_16x16x32_bf16 v[152:155], v[212:215], a[164:167], v[152:155]
s_add_u32 m0, s53, 4096
s_add_u32 s51, s48, 1437696
buffer_load_dwordx4 v14, s[20:23], s51 offen offset:0 lds
v_mfma_f32_16x16x32_bf16 v[236:239], v[220:223], a[164:167], v[236:239]
ds_read_b64_tr_b16 v[190:191], v5 offset:38912
v_mfma_f32_16x16x32_bf16 v[236:239], v[216:219], a[160:163], v[236:239]
s_add_u32 s51, s48, 1464320
buffer_load_dwordx4 v14, s[20:23], s51 offen offset:1024 lds
v_mfma_f32_16x16x32_bf16 v[232:235], v[216:219], a[152:155], v[232:235]
v_mfma_f32_16x16x32_bf16 v[232:235], v[220:223], a[156:159], v[232:235]
s_add_u32 s51, s48, 1490944
buffer_load_dwordx4 v14, s[20:23], s51 offen offset:2048 lds
v_mfma_f32_16x16x32_bf16 v[228:231], v[220:223], a[148:151], v[228:231]
v_mfma_f32_16x16x32_bf16 v[228:231], v[216:219], a[144:147], v[228:231]
s_add_u32 s51, s48, 1517568
buffer_load_dwordx4 v14, s[20:23], s51 offen offset:3072 lds
v_mfma_f32_16x16x32_bf16 v[224:227], v[216:219], a[136:139], v[224:227]
v_mfma_f32_16x16x32_bf16 v[224:227], v[220:223], a[140:143], v[224:227]
v_mfma_f32_16x16x32_bf16 v[156:159], v[220:223], a[132:135], v[156:159]
v_mfma_f32_16x16x32_bf16 v[156:159], v[216:219], a[128:131], v[156:159]
s_waitcnt vmcnt(18)
s_waitcnt vmcnt(26)
s_waitcnt lgkmcnt(0)
v_mfma_f32_16x16x32_bf16 v[96:99], v[160:163], a[168:171], v[96:99]
ds_read_b64_tr_b16 v[192:193], v6 offset:0
s_add_u32 s76, s98, 0
s_cmp_lt_u32 s76, 16
s_cselect_b32 s89, s50, s56
v_mfma_f32_16x16x32_bf16 v[96:99], v[164:167], a[172:175], v[96:99]
s_add_u32 s52, s49, 2633728
buffer_load_dwordx4 a[128:131], v15, s[16:19], s52 offen sc1
s_cmp_ge_u32 s76, 8
s_cselect_b32 s101, 0, 0
s_add_u32 s89, s89, s101
s_cmp_ge_u32 s76, 26
s_cselect_b32 s101, 2031360, 0
s_add_u32 s89, s89, s101
v_mfma_f32_16x16x32_bf16 v[100:103], v[164:167], a[180:183], v[100:103]
ds_read_b64_tr_b16 v[194:195], v6 offset:2048
s_and_b32 s101, s76, 1
s_lshl_b32 s101, s101, 10
s_add_u32 s89, s89, s101
s_sub_u32 s89, s89, 0
v_mfma_f32_16x16x32_bf16 v[100:103], v[160:163], a[176:179], v[100:103]
buffer_load_dwordx4 a[132:135], v15, s[16:19], s52 offen offset:1024 sc1
s_lshr_b32 s76, s76, 1
s_mul_i32 s76, s76, 135424
s_add_u32 s89, s89, s76
s_add_u32 s76, s98, 1
v_mfma_f32_16x16x32_bf16 v[104:107], v[160:163], a[184:187], v[104:107]
ds_read_b64_tr_b16 v[196:197], v6 offset:4096
s_cmp_lt_u32 s76, 16
s_cselect_b32 s90, s50, s56
s_cmp_ge_u32 s76, 8
s_cselect_b32 s101, 0, 0
s_add_u32 s90, s90, s101
v_mfma_f32_16x16x32_bf16 v[104:107], v[164:167], a[188:191], v[104:107]
s_add_u32 s52, s49, 2699264
buffer_load_dwordx4 a[136:139], v15, s[16:19], s52 offen sc1
s_cmp_ge_u32 s76, 26
s_cselect_b32 s101, 2031360, 0
s_add_u32 s90, s90, s101
s_and_b32 s101, s76, 1
s_lshl_b32 s101, s101, 10
v_mfma_f32_16x16x32_bf16 v[108:111], v[164:167], v[36:39], v[108:111]
ds_read_b64_tr_b16 v[198:199], v6 offset:6144
s_add_u32 s90, s90, s101
s_sub_u32 s90, s90, 1024
s_lshr_b32 s76, s76, 1
s_mul_i32 s76, s76, 135424
s_add_u32 s90, s90, s76
v_mfma_f32_16x16x32_bf16 v[108:111], v[160:163], v[32:35], v[108:111]
buffer_load_dwordx4 a[140:143], v15, s[16:19], s52 offen offset:1024 sc1
s_add_u32 s76, s98, 2
s_cmp_lt_u32 s76, 16
s_cselect_b32 s91, s50, s56
v_mfma_f32_16x16x32_bf16 v[112:115], v[160:163], v[40:43], v[112:115]
ds_read_b64_tr_b16 v[200:201], v7 offset:0
s_cmp_ge_u32 s76, 8
s_cselect_b32 s101, 0, 0
s_add_u32 s91, s91, s101
s_cmp_ge_u32 s76, 26
s_cselect_b32 s101, 2031360, 0
s_add_u32 s91, s91, s101
v_mfma_f32_16x16x32_bf16 v[112:115], v[164:167], v[44:47], v[112:115]
s_add_u32 s52, s49, 2764800
buffer_load_dwordx4 a[144:147], v15, s[16:19], s52 offen sc1
s_and_b32 s101, s76, 1
s_lshl_b32 s101, s101, 10
s_add_u32 s91, s91, s101
s_sub_u32 s91, s91, 2048
v_mfma_f32_16x16x32_bf16 v[132:135], v[172:175], v[44:47], v[132:135]
ds_read_b64_tr_b16 v[202:203], v7 offset:2048
s_lshr_b32 s76, s76, 1
s_mul_i32 s76, s76, 135424
s_add_u32 s91, s91, s76
s_add_u32 s76, s98, 3
v_mfma_f32_16x16x32_bf16 v[132:135], v[168:171], v[40:43], v[132:135]
buffer_load_dwordx4 a[148:151], v15, s[16:19], s52 offen offset:1024 sc1
s_cmp_lt_u32 s76, 16
s_cselect_b32 s92, s50, s56
s_cmp_ge_u32 s76, 8
s_cselect_b32 s101, 0, 0
s_add_u32 s92, s92, s101
v_mfma_f32_16x16x32_bf16 v[128:131], v[168:171], v[32:35], v[128:131]
ds_read_b64_tr_b16 v[204:205], v7 offset:4096
s_cmp_ge_u32 s76, 26
s_cselect_b32 s101, 2031360, 0
s_add_u32 s92, s92, s101
s_and_b32 s101, s76, 1
s_lshl_b32 s101, s101, 10
v_mfma_f32_16x16x32_bf16 v[128:131], v[172:175], v[36:39], v[128:131]
s_add_u32 s52, s49, 2830336
buffer_load_dwordx4 a[152:155], v15, s[16:19], s52 offen sc1
s_add_u32 s92, s92, s101
s_sub_u32 s92, s92, 3072
s_lshr_b32 s76, s76, 1
s_mul_i32 s76, s76, 135424
s_add_u32 s92, s92, s76
v_mfma_f32_16x16x32_bf16 v[124:127], v[172:175], a[188:191], v[124:127]
ds_read_b64_tr_b16 v[206:207], v7 offset:6144
s_add_u32 s76, s98, 4
s_cmp_lt_u32 s76, 16
s_cselect_b32 s93, s50, s56
v_mfma_f32_16x16x32_bf16 v[124:127], v[168:171], a[184:187], v[124:127]
buffer_load_dwordx4 a[156:159], v15, s[16:19], s52 offen offset:1024 sc1
s_cmp_ge_u32 s76, 8
s_cselect_b32 s101, 0, 0
s_add_u32 s93, s93, s101
s_cmp_ge_u32 s76, 26
s_cselect_b32 s101, 2031360, 0
s_add_u32 s93, s93, s101
v_mfma_f32_16x16x32_bf16 v[120:123], v[168:171], a[176:179], v[120:123]
ds_read_b64_tr_b16 v[208:209], v8 offset:0
s_and_b32 s101, s76, 1
s_lshl_b32 s101, s101, 10
s_add_u32 s93, s93, s101
s_sub_u32 s93, s93, 0
v_mfma_f32_16x16x32_bf16 v[120:123], v[172:175], a[180:183], v[120:123]
s_add_u32 s52, s49, 2895872
buffer_load_dwordx4 a[160:163], v15, s[16:19], s52 offen sc1
s_lshr_b32 s76, s76, 1
s_mul_i32 s76, s76, 135424
s_add_u32 s93, s93, s76
s_add_u32 s76, s98, 5
v_mfma_f32_16x16x32_bf16 v[116:119], v[172:175], a[172:175], v[116:119]
ds_read_b64_tr_b16 v[210:211], v8 offset:2048
s_cmp_lt_u32 s76, 16
s_cselect_b32 s94, s50, s56
s_cmp_ge_u32 s76, 8
s_cselect_b32 s101, 0, 0
s_add_u32 s94, s94, s101
v_mfma_f32_16x16x32_bf16 v[116:119], v[168:171], a[168:171], v[116:119]
buffer_load_dwordx4 a[164:167], v15, s[16:19], s52 offen offset:1024 sc1
s_cmp_ge_u32 s76, 26
s_cselect_b32 s101, 2031360, 0
s_add_u32 s94, s94, s101
s_and_b32 s101, s76, 1
s_lshl_b32 s101, s101, 10
v_mfma_f32_16x16x32_bf16 v[136:139], v[176:179], a[168:171], v[136:139]
ds_read_b64_tr_b16 v[212:213], v8 offset:4096
s_add_u32 s94, s94, s101
s_sub_u32 s94, s94, 1024
s_lshr_b32 s76, s76, 1
s_mul_i32 s76, s76, 135424
s_add_u32 s94, s94, s76
v_mfma_f32_16x16x32_bf16 v[136:139], v[180:183], a[172:175], v[136:139]
s_add_u32 m0, s53, 32768
s_add_u32 s51, s48, 1548288
buffer_load_dwordx4 v14, s[20:23], s51 offen offset:0 lds
s_add_u32 s76, s98, 6
s_cmp_lt_u32 s76, 16
s_cselect_b32 s95, s50, s56
v_mfma_f32_16x16x32_bf16 v[140:143], v[180:183], a[180:183], v[140:143]
ds_read_b64_tr_b16 v[214:215], v8 offset:6144
s_cmp_ge_u32 s76, 8
s_cselect_b32 s101, 0, 0
s_add_u32 s95, s95, s101
s_cmp_ge_u32 s76, 26
s_cselect_b32 s101, 2031360, 0
s_add_u32 s95, s95, s101
v_mfma_f32_16x16x32_bf16 v[140:143], v[176:179], a[176:179], v[140:143]
s_add_u32 s51, s48, 1574912
buffer_load_dwordx4 v14, s[20:23], s51 offen offset:1024 lds
s_and_b32 s101, s76, 1
s_lshl_b32 s101, s101, 10
s_add_u32 s95, s95, s101
s_sub_u32 s95, s95, 2048
v_mfma_f32_16x16x32_bf16 v[144:147], v[176:179], a[184:187], v[144:147]
ds_read_b64_tr_b16 v[216:217], v9 offset:0
s_lshr_b32 s76, s76, 1
s_mul_i32 s76, s76, 135424
s_add_u32 s95, s95, s76
s_add_u32 s76, s98, 7
v_mfma_f32_16x16x32_bf16 v[144:147], v[180:183], a[188:191], v[144:147]
s_add_u32 s51, s48, 1601536
buffer_load_dwordx4 v14, s[20:23], s51 offen offset:2048 lds
s_cmp_lt_u32 s76, 16
s_cselect_b32 s96, s50, s56
s_cmp_ge_u32 s76, 8
s_cselect_b32 s101, 0, 0
s_add_u32 s96, s96, s101
v_mfma_f32_16x16x32_bf16 v[148:151], v[180:183], v[36:39], v[148:151]
ds_read_b64_tr_b16 v[218:219], v9 offset:2048
s_cmp_ge_u32 s76, 26
s_cselect_b32 s101, 2031360, 0
s_add_u32 s96, s96, s101
s_and_b32 s101, s76, 1
s_lshl_b32 s101, s101, 10
v_mfma_f32_16x16x32_bf16 v[148:151], v[176:179], v[32:35], v[148:151]
s_add_u32 s51, s48, 1628160
buffer_load_dwordx4 v14, s[20:23], s51 offen offset:3072 lds
s_add_u32 s96, s96, s101
s_sub_u32 s96, s96, 3072
s_lshr_b32 s76, s76, 1
s_mul_i32 s76, s76, 135424
s_add_u32 s96, s96, s76
v_mfma_f32_16x16x32_bf16 v[152:155], v[176:179], v[40:43], v[152:155]
ds_read_b64_tr_b16 v[220:221], v9 offset:4096
s_add_u32 s76, s98, 8
s_cmp_lt_u32 s76, 16
s_cselect_b32 s97, s50, s56
v_mfma_f32_16x16x32_bf16 v[152:155], v[180:183], v[44:47], v[152:155]
s_add_u32 m0, s53, 36864
s_add_u32 s51, s48, 1658880
buffer_load_dwordx4 v14, s[20:23], s51 offen offset:0 lds
s_cmp_ge_u32 s76, 8
s_cselect_b32 s101, 0, 0
s_add_u32 s97, s97, s101
s_cmp_ge_u32 s76, 26
s_cselect_b32 s101, 2031360, 0
s_add_u32 s97, s97, s101
v_mfma_f32_16x16x32_bf16 v[236:239], v[188:191], v[44:47], v[236:239]
ds_read_b64_tr_b16 v[222:223], v9 offset:6144
s_and_b32 s101, s76, 1
s_lshl_b32 s101, s101, 10
s_add_u32 s97, s97, s101
s_sub_u32 s97, s97, 0
v_mfma_f32_16x16x32_bf16 v[236:239], v[184:187], v[40:43], v[236:239]
s_add_u32 s51, s48, 1685504
buffer_load_dwordx4 v14, s[20:23], s51 offen offset:1024 lds
s_lshr_b32 s76, s76, 1
s_mul_i32 s76, s76, 135424
s_add_u32 s97, s97, s76
s_lshl_b32 s98, s98, 10
v_mfma_f32_16x16x32_bf16 v[232:235], v[184:187], v[32:35], v[232:235]
s_lshr_b32 s76, s44, 1
s_mul_i32 s101, s76, 541696
v_mfma_f32_16x16x32_bf16 v[232:235], v[188:191], v[36:39], v[232:235]
s_add_u32 s51, s48, 1712128
buffer_load_dwordx4 v14, s[20:23], s51 offen offset:2048 lds
s_add_u32 s59, s50, s101
s_lshl_b32 s76, s76, 13
v_mfma_f32_16x16x32_bf16 v[228:231], v[188:191], a[188:191], v[228:231]
v_add_u32 v240, s76, v244
s_and_b32 s76, s44, 1
v_mfma_f32_16x16x32_bf16 v[228:231], v[184:187], a[184:187], v[228:231]
s_add_u32 s51, s48, 1738752
buffer_load_dwordx4 v14, s[20:23], s51 offen offset:3072 lds
s_mul_i32 s101, s76, 2708480
s_add_u32 s101, s101, 1083392
v_mfma_f32_16x16x32_bf16 v[224:227], v[184:187], a[176:179], v[224:227]
s_add_u32 s77, s56, s101
s_mul_i32 s76, s76, 5
v_mfma_f32_16x16x32_bf16 v[224:227], v[188:191], a[180:183], v[224:227]
s_add_u32 s76, s76, 8
s_lshl_b32 s76, s76, 11
v_mfma_f32_16x16x32_bf16 v[156:159], v[188:191], a[172:175], v[156:159]
v_add_u32 v241, s76, v244
v_add_u32 v242, 73728, v240
v_mfma_f32_16x16x32_bf16 v[156:159], v[184:187], a[168:171], v[156:159]
v_add_u32 v243, 73728, v241
s_waitcnt vmcnt(18)
s_waitcnt vmcnt(26)
s_waitcnt lgkmcnt(0)
v_mfma_f32_16x16x32_bf16 v[96:99], v[192:195], a[192:195], v[96:99]
ds_read_b64_tr_b16 v[160:161], v2 offset:0
buffer_load_dword v246, v245, s[16:19], 0 offen sc1
v_mfma_f32_16x16x32_bf16 v[96:99], v[196:199], a[196:199], v[96:99]
s_add_u32 s52, s49, 2635776
buffer_load_dwordx4 a[168:171], v15, s[16:19], s52 offen sc1
v_mfma_f32_16x16x32_bf16 v[100:103], v[196:199], a[204:207], v[100:103]
ds_read_b64_tr_b16 v[162:163], v2 offset:2048
v_mfma_f32_16x16x32_bf16 v[100:103], v[192:195], a[200:203], v[100:103]
v_mfma_f32_16x16x32_bf16 v[104:107], v[192:195], a[208:211], v[104:107]
ds_read_b64_tr_b16 v[164:165], v2 offset:4096
v_mfma_f32_16x16x32_bf16 v[104:107], v[196:199], a[212:215], v[104:107]
buffer_load_dwordx4 a[172:175], v15, s[16:19], s52 offen offset:1024 sc1
v_mfma_f32_16x16x32_bf16 v[108:111], v[196:199], a[220:223], v[108:111]
ds_read_b64_tr_b16 v[166:167], v2 offset:6144
v_mfma_f32_16x16x32_bf16 v[108:111], v[192:195], a[216:219], v[108:111]
v_mfma_f32_16x16x32_bf16 v[112:115], v[192:195], a[224:227], v[112:115]
ds_read_b64_tr_b16 v[168:169], v3 offset:0
v_mfma_f32_16x16x32_bf16 v[112:115], v[196:199], a[228:231], v[112:115]
s_add_u32 s52, s49, 2701312
buffer_load_dwordx4 a[176:179], v15, s[16:19], s52 offen sc1
v_mfma_f32_16x16x32_bf16 v[132:135], v[204:207], a[228:231], v[132:135]
ds_read_b64_tr_b16 v[170:171], v3 offset:2048
v_mfma_f32_16x16x32_bf16 v[132:135], v[200:203], a[224:227], v[132:135]
v_mfma_f32_16x16x32_bf16 v[128:131], v[200:203], a[216:219], v[128:131]
ds_read_b64_tr_b16 v[172:173], v3 offset:4096
v_mfma_f32_16x16x32_bf16 v[128:131], v[204:207], a[220:223], v[128:131]
buffer_load_dwordx4 a[180:183], v15, s[16:19], s52 offen offset:1024 sc1
v_mfma_f32_16x16x32_bf16 v[124:127], v[204:207], a[212:215], v[124:127]
ds_read_b64_tr_b16 v[174:175], v3 offset:6144
K_pg9:
s_cbranch_execz K_pg12
v_mfma_f32_16x16x32_bf16 v[124:127], v[200:203], a[208:211], v[124:127]
v_mfma_f32_16x16x32_bf16 v[120:123], v[200:203], a[200:203], v[120:123]
ds_read_b64_tr_b16 v[176:177], v4 offset:0
v_mfma_f32_16x16x32_bf16 v[120:123], v[204:207], a[204:207], v[120:123]
s_add_u32 s52, s49, 2766848
buffer_load_dwordx4 a[184:187], v15, s[16:19], s52 offen sc1
v_mfma_f32_16x16x32_bf16 v[116:119], v[204:207], a[196:199], v[116:119]
ds_read_b64_tr_b16 v[178:179], v4 offset:2048
v_mfma_f32_16x16x32_bf16 v[116:119], v[200:203], a[192:195], v[116:119]
v_mfma_f32_16x16x32_bf16 v[136:139], v[208:211], a[192:195], v[136:139]
ds_read_b64_tr_b16 v[180:181], v4 offset:4096
v_mfma_f32_16x16x32_bf16 v[136:139], v[212:215], a[196:199], v[136:139]
buffer_load_dwordx4 a[188:191], v15, s[16:19], s52 offen offset:1024 sc1
v_mfma_f32_16x16x32_bf16 v[140:143], v[212:215], a[204:207], v[140:143]
ds_read_b64_tr_b16 v[182:183], v4 offset:6144
v_mfma_f32_16x16x32_bf16 v[140:143], v[208:211], a[200:203], v[140:143]
v_mfma_f32_16x16x32_bf16 v[144:147], v[208:211], a[208:211], v[144:147]
ds_read_b64_tr_b16 v[184:185], v5 offset:0
v_mfma_f32_16x16x32_bf16 v[144:147], v[212:215], a[212:215], v[144:147]
s_add_u32 s52, s49, 2832384
buffer_load_dwordx4 v[32:35], v15, s[16:19], s52 offen sc1
v_mfma_f32_16x16x32_bf16 v[148:151], v[212:215], a[220:223], v[148:151]
ds_read_b64_tr_b16 v[186:187], v5 offset:2048
v_mfma_f32_16x16x32_bf16 v[148:151], v[208:211], a[216:219], v[148:151]
v_mfma_f32_16x16x32_bf16 v[152:155], v[208:211], a[224:227], v[152:155]
ds_read_b64_tr_b16 v[188:189], v5 offset:4096
v_mfma_f32_16x16x32_bf16 v[152:155], v[212:215], a[228:231], v[152:155]
buffer_load_dwordx4 v[36:39], v15, s[16:19], s52 offen offset:1024 sc1
v_mfma_f32_16x16x32_bf16 v[236:239], v[220:223], a[228:231], v[236:239]
ds_read_b64_tr_b16 v[190:191], v5 offset:6144
v_mfma_f32_16x16x32_bf16 v[236:239], v[216:219], a[224:227], v[236:239]
v_mfma_f32_16x16x32_bf16 v[232:235], v[216:219], a[216:219], v[232:235]
v_mfma_f32_16x16x32_bf16 v[232:235], v[220:223], a[220:223], v[232:235]
s_add_u32 s52, s49, 2897920
buffer_load_dwordx4 v[40:43], v15, s[16:19], s52 offen sc1
v_mfma_f32_16x16x32_bf16 v[228:231], v[220:223], a[212:215], v[228:231]
v_mfma_f32_16x16x32_bf16 v[228:231], v[216:219], a[208:211], v[228:231]
v_mfma_f32_16x16x32_bf16 v[224:227], v[216:219], a[200:203], v[224:227]
v_mfma_f32_16x16x32_bf16 v[224:227], v[220:223], a[204:207], v[224:227]
buffer_load_dwordx4 v[44:47], v15, s[16:19], s52 offen offset:1024 sc1
v_mfma_f32_16x16x32_bf16 v[156:159], v[220:223], a[196:199], v[156:159]
v_mfma_f32_16x16x32_bf16 v[156:159], v[216:219], a[192:195], v[156:159]
s_waitcnt vmcnt(10)
v_cmp_ne_u32 vcc, s88, v246
s_nop 1
s_cmp_lg_u64 vcc, 0
s_cselect_b32 s54, 67108864, 0
v_add_u32 v244, s54, v244
s_waitcnt vmcnt(11)
s_waitcnt vmcnt(19)
s_waitcnt lgkmcnt(0)
v_mfma_f32_16x16x32_bf16 v[96:99], v[160:163], a[128:131], v[96:99]
s_barrier
ds_read_b64_tr_b16 v[192:193], v2 offset:32768
v_mfma_f32_16x16x32_bf16 v[96:99], v[164:167], a[132:135], v[96:99]
v_mfma_f32_16x16x32_bf16 v[100:103], v[164:167], a[140:143], v[100:103]
ds_read_b64_tr_b16 v[194:195], v2 offset:34816
v_add_u32 v10, s53, v15
v_mfma_f32_16x16x32_bf16 v[100:103], v[160:163], a[136:139], v[100:103]
s_add_u32 s101, s59, 0
buffer_load_dwordx4 a[40:43], v244, s[16:19], s101 offen offset:0 sc1
v_mfma_f32_16x16x32_bf16 v[104:107], v[160:163], a[144:147], v[104:107]
ds_read_b64_tr_b16 v[196:197], v2 offset:36864
s_add_u32 s50, s44, 3
v_mfma_f32_16x16x32_bf16 v[104:107], v[164:167], a[148:151], v[104:107]
buffer_load_dwordx4 a[44:47], v244, s[16:19], s101 offen offset:1024 sc1
v_mfma_f32_16x16x32_bf16 v[108:111], v[164:167], a[156:159], v[108:111]
ds_read_b64_tr_b16 v[198:199], v2 offset:38912
s_and_b32 s50, s50, 3
v_mfma_f32_16x16x32_bf16 v[108:111], v[160:163], a[152:155], v[108:111]
s_add_u32 s101, s77, 0
buffer_load_dwordx4 a[0:3], v244, s[16:19], s101 offen offset:0 sc1
v_mfma_f32_16x16x32_bf16 v[112:115], v[160:163], a[160:163], v[112:115]
ds_read_b64_tr_b16 v[200:201], v3 offset:32768
s_lshl_b32 s50, s50, 13
v_mfma_f32_16x16x32_bf16 v[112:115], v[164:167], a[164:167], v[112:115]
buffer_load_dwordx4 a[4:7], v244, s[16:19], s101 offen offset:1024 sc1
v_mfma_f32_16x16x32_bf16 v[132:135], v[172:175], a[164:167], v[132:135]
ds_read_b64_tr_b16 v[202:203], v3 offset:34816
v_add_u32 v11, s50, v15
v_mfma_f32_16x16x32_bf16 v[132:135], v[168:171], a[160:163], v[132:135]
s_add_u32 s101, s77, 135424
buffer_load_dwordx4 a[8:11], v244, s[16:19], s101 offen offset:0 sc1
v_mfma_f32_16x16x32_bf16 v[128:131], v[168:171], a[152:155], v[128:131]
ds_read_b64_tr_b16 v[204:205], v3 offset:36864
v_mfma_f32_16x16x32_bf16 v[128:131], v[172:175], a[156:159], v[128:131]
buffer_load_dwordx4 a[12:15], v244, s[16:19], s101 offen offset:1024 sc1
s_add_u32 s50, s44, 2
v_mfma_f32_16x16x32_bf16 v[124:127], v[172:175], a[148:151], v[124:127]
ds_read_b64_tr_b16 v[206:207], v3 offset:38912
v_mfma_f32_16x16x32_bf16 v[124:127], v[168:171], a[144:147], v[124:127]
s_add_u32 s101, s77, 270848
buffer_load_dwordx4 a[16:19], v244, s[16:19], s101 offen offset:0 sc1
s_and_b32 s50, s50, 3
v_mfma_f32_16x16x32_bf16 v[120:123], v[168:171], a[136:139], v[120:123]
ds_read_b64_tr_b16 v[208:209], v4 offset:32768
v_mfma_f32_16x16x32_bf16 v[120:123], v[172:175], a[140:143], v[120:123]
buffer_load_dwordx4 a[20:23], v244, s[16:19], s101 offen offset:1024 sc1
s_lshl_b32 s50, s50, 13
v_mfma_f32_16x16x32_bf16 v[116:119], v[172:175], a[132:135], v[116:119]
ds_read_b64_tr_b16 v[210:211], v4 offset:34816
v_mfma_f32_16x16x32_bf16 v[116:119], v[168:171], a[128:131], v[116:119]
s_add_u32 s101, s77, 406272
buffer_load_dwordx4 a[24:27], v244, s[16:19], s101 offen offset:0 sc1
v_add_u32 v12, s50, v15
v_mfma_f32_16x16x32_bf16 v[136:139], v[176:179], a[128:131], v[136:139]
ds_read_b64_tr_b16 v[212:213], v4 offset:36864
v_mfma_f32_16x16x32_bf16 v[136:139], v[180:183], a[132:135], v[136:139]
buffer_load_dwordx4 a[28:31], v244, s[16:19], s101 offen offset:1024 sc1
v_mfma_f32_16x16x32_bf16 v[140:143], v[180:183], a[140:143], v[140:143]
ds_read_b64_tr_b16 v[214:215], v4 offset:38912
s_add_u32 s50, s44, 1
v_mfma_f32_16x16x32_bf16 v[140:143], v[176:179], a[136:139], v[140:143]
s_add_u32 s101, s77, 541696
buffer_load_dwordx4 a[32:35], v244, s[16:19], s101 offen offset:0 sc1
v_mfma_f32_16x16x32_bf16 v[144:147], v[176:179], a[144:147], v[144:147]
ds_read_b64_tr_b16 v[216:217], v5 offset:32768
s_and_b32 s50, s50, 3
v_mfma_f32_16x16x32_bf16 v[144:147], v[180:183], a[148:151], v[144:147]
buffer_load_dwordx4 a[36:39], v244, s[16:19], s101 offen offset:1024 sc1
v_mfma_f32_16x16x32_bf16 v[148:151], v[180:183], a[156:159], v[148:151]
ds_read_b64_tr_b16 v[218:219], v5 offset:34816
s_lshl_b32 s50, s50, 13
v_mfma_f32_16x16x32_bf16 v[148:151], v[176:179], a[152:155], v[148:151]
s_add_u32 s101, s59, 135424
buffer_load_dwordx4 a[48:51], v244, s[16:19], s101 offen offset:0 sc1
v_mfma_f32_16x16x32_bf16 v[152:155], v[176:179], a[160:163], v[152:155]
ds_read_b64_tr_b16 v[220:221], v5 offset:36864
v_add_u32 v13, s50, v15
v_mfma_f32_16x16x32_bf16 v[152:155], v[180:183], a[164:167], v[152:155]
buffer_load_dwordx4 a[52:55], v244, s[16:19], s101 offen offset:1024 sc1
v_mfma_f32_16x16x32_bf16 v[236:239], v[188:191], a[164:167], v[236:239]
ds_read_b64_tr_b16 v[222:223], v5 offset:38912
v_mfma_f32_16x16x32_bf16 v[236:239], v[184:187], a[160:163], v[236:239]
s_add_u32 s101, s59, 270848
buffer_load_dwordx4 a[56:59], v244, s[16:19], s101 offen offset:0 sc1
s_mul_i32 s79, s47, 276480
v_mfma_f32_16x16x32_bf16 v[232:235], v[184:187], a[152:155], v[232:235]
v_mfma_f32_16x16x32_bf16 v[232:235], v[188:191], a[156:159], v[232:235]
buffer_load_dwordx4 a[60:63], v244, s[16:19], s101 offen offset:1024 sc1
s_lshl_b32 s50, s46, 11
v_mfma_f32_16x16x32_bf16 v[228:231], v[188:191], a[148:151], v[228:231]
v_mfma_f32_16x16x32_bf16 v[228:231], v[184:187], a[144:147], v[228:231]
s_add_u32 s101, s59, 406272
buffer_load_dwordx4 a[64:67], v244, s[16:19], s101 offen offset:0 sc1
s_add_u32 s79, s79, s50
v_mfma_f32_16x16x32_bf16 v[224:227], v[184:187], a[136:139], v[224:227]
v_mfma_f32_16x16x32_bf16 v[224:227], v[188:191], a[140:143], v[224:227]
buffer_load_dwordx4 a[68:71], v244, s[16:19], s101 offen offset:1024 sc1
v_add_u32 v244, 2048, v244
s_add_u32 s79, s79, 5767168
v_mfma_f32_16x16x32_bf16 v[156:159], v[188:191], a[132:135], v[156:159]
v_mfma_f32_16x16x32_bf16 v[156:159], v[184:187], a[128:131], v[156:159]
s_waitcnt vmcnt(18)
s_waitcnt lgkmcnt(0)
v_mfma_f32_16x16x32_bf16 v[156:159], v[216:219], a[168:171], v[156:159]
v_mfma_f32_16x16x32_bf16 v[156:159], v[220:223], a[172:175], v[156:159]
s_add_u32 m0, s98, 110592
v_mfma_f32_16x16x32_bf16 v[224:227], v[220:223], a[180:183], v[224:227]
buffer_load_dwordx4 v244, s[16:19], s89 offen offset:0 sc1 lds
v_mfma_f32_16x16x32_bf16 v[224:227], v[216:219], a[176:179], v[224:227]
v_mfma_f32_16x16x32_bf16 v[228:231], v[216:219], a[184:187], v[228:231]
buffer_load_dwordx4 v244, s[16:19], s90 offen offset:1024 sc1 lds
v_mfma_f32_16x16x32_bf16 v[228:231], v[220:223], a[188:191], v[228:231]
v_mfma_f32_16x16x32_bf16 v[232:235], v[220:223], v[36:39], v[232:235]
buffer_load_dwordx4 v244, s[16:19], s91 offen offset:2048 sc1 lds
v_mfma_f32_16x16x32_bf16 v[232:235], v[216:219], v[32:35], v[232:235]
v_mfma_f32_16x16x32_bf16 v[236:239], v[216:219], v[40:43], v[236:239]
buffer_load_dwordx4 v244, s[16:19], s92 offen offset:3072 sc1 lds
v_mfma_f32_16x16x32_bf16 v[236:239], v[220:223], v[44:47], v[236:239]
s_add_u32 m0, s98, 114688
v_mfma_f32_16x16x32_bf16 v[136:139], v[212:215], a[172:175], v[136:139]
buffer_load_dwordx4 v244, s[16:19], s93 offen offset:0 sc1 lds
v_mfma_f32_16x16x32_bf16 v[136:139], v[208:211], a[168:171], v[136:139]
ds_write_b128 v10, v[156:159] offset:34816
v_mfma_f32_16x16x32_bf16 v[140:143], v[208:211], a[176:179], v[140:143]
buffer_load_dwordx4 v244, s[16:19], s94 offen offset:1024 sc1 lds
v_mfma_f32_16x16x32_bf16 v[140:143], v[212:215], a[180:183], v[140:143]
ds_write_b128 v10, v[224:227] offset:35840
v_mfma_f32_16x16x32_bf16 v[144:147], v[212:215], a[188:191], v[144:147]
buffer_load_dwordx4 v244, s[16:19], s95 offen offset:2048 sc1 lds
v_mfma_f32_16x16x32_bf16 v[144:147], v[208:211], a[184:187], v[144:147]
ds_write_b128 v10, v[228:231] offset:36864
v_mfma_f32_16x16x32_bf16 v[148:151], v[208:211], v[32:35], v[148:151]
buffer_load_dwordx4 v244, s[16:19], s96 offen offset:3072 sc1 lds
v_mfma_f32_16x16x32_bf16 v[148:151], v[212:215], v[36:39], v[148:151]
ds_write_b128 v10, v[232:235] offset:37888
s_add_u32 m0, s98, 118784
v_mfma_f32_16x16x32_bf16 v[152:155], v[212:215], v[44:47], v[152:155]
buffer_load_dwordx4 v244, s[16:19], s97 offen offset:0 sc1 lds
v_add_u32 v244, 2048, v244
v_mfma_f32_16x16x32_bf16 v[152:155], v[208:211], v[40:43], v[152:155]
ds_write_b128 v10, v[236:239] offset:38912
s_add_u32 m0, s98, 73728
v_mfma_f32_16x16x32_bf16 v[116:119], v[200:203], a[168:171], v[116:119]
buffer_load_dwordx4 v244, s[16:19], s89 offen offset:0 sc1 lds
v_mfma_f32_16x16x32_bf16 v[116:119], v[204:207], a[172:175], v[116:119]
ds_write_b128 v10, v[136:139] offset:5120
v_mfma_f32_16x16x32_bf16 v[120:123], v[204:207], a[180:183], v[120:123]
buffer_load_dwordx4 v244, s[16:19], s90 offen offset:1024 sc1 lds
v_mfma_f32_16x16x32_bf16 v[120:123], v[200:203], a[176:179], v[120:123]
ds_write_b128 v10, v[140:143] offset:6144
v_mfma_f32_16x16x32_bf16 v[124:127], v[200:203], a[184:187], v[124:127]
buffer_load_dwordx4 v244, s[16:19], s91 offen offset:2048 sc1 lds
v_mfma_f32_16x16x32_bf16 v[124:127], v[204:207], a[188:191], v[124:127]
ds_write_b128 v10, v[144:147] offset:7168
v_mfma_f32_16x16x32_bf16 v[128:131], v[204:207], v[36:39], v[128:131]
buffer_load_dwordx4 v244, s[16:19], s92 offen offset:3072 sc1 lds
v_mfma_f32_16x16x32_bf16 v[128:131], v[200:203], v[32:35], v[128:131]
ds_write_b128 v10, v[148:151] offset:32768
s_add_u32 m0, s98, 77824
v_mfma_f32_16x16x32_bf16 v[132:135], v[200:203], v[40:43], v[132:135]
buffer_load_dwordx4 v244, s[16:19], s93 offen offset:0 sc1 lds
v_mfma_f32_16x16x32_bf16 v[132:135], v[204:207], v[44:47], v[132:135]
ds_write_b128 v10, v[152:155] offset:33792
v_mfma_f32_16x16x32_bf16 v[96:99], v[196:199], a[172:175], v[96:99]
buffer_load_dwordx4 v244, s[16:19], s94 offen offset:1024 sc1 lds
v_mfma_f32_16x16x32_bf16 v[96:99], v[192:195], a[168:171], v[96:99]
ds_write_b128 v10, v[116:119] offset:0
v_mfma_f32_16x16x32_bf16 v[100:103], v[192:195], a[176:179], v[100:103]
buffer_load_dwordx4 v244, s[16:19], s95 offen offset:2048 sc1 lds
v_mfma_f32_16x16x32_bf16 v[100:103], v[196:199], a[180:183], v[100:103]
ds_write_b128 v10, v[120:123] offset:1024
v_mfma_f32_16x16x32_bf16 v[104:107], v[196:199], a[188:191], v[104:107]
buffer_load_dwordx4 v244, s[16:19], s96 offen offset:3072 sc1 lds
v_mfma_f32_16x16x32_bf16 v[104:107], v[192:195], a[184:187], v[104:107]
ds_write_b128 v10, v[124:127] offset:2048
s_add_u32 m0, s98, 81920
v_mfma_f32_16x16x32_bf16 v[108:111], v[192:195], v[32:35], v[108:111]
buffer_load_dwordx4 v244, s[16:19], s97 offen offset:0 sc1 lds
v_add_u32 v244, 2048, v244
v_mfma_f32_16x16x32_bf16 v[108:111], v[196:199], v[36:39], v[108:111]
ds_write_b128 v10, v[128:131] offset:3072
v_mfma_f32_16x16x32_bf16 v[112:115], v[196:199], v[44:47], v[112:115]
v_mfma_f32_16x16x32_bf16 v[112:115], v[192:195], v[40:43], v[112:115]
ds_write_b128 v10, v[132:135] offset:4096
s_cmp_lg_u32 s55, 0
s_cbranch_scc1 K_redo_u
s_cmp_lg_u32 s54, 0
s_cbranch_scc1 K_late
K_final:
s_waitcnt vmcnt(18) lgkmcnt(0)
s_barrier
v_mfma_f32_16x16x32_bf16 v[16:19], a[0:3], a[40:43], 0
ds_read_b128 v[116:119], v11 offset:0
v_mfma_f32_16x16x32_bf16 v[16:19], a[4:7], a[44:47], v[16:19]
ds_read_b128 v[120:123], v11 offset:1024
v_mfma_f32_16x16x32_bf16 v[20:23], a[12:15], a[44:47], 0
ds_read_b128 v[124:127], v11 offset:2048
v_mfma_f32_16x16x32_bf16 v[20:23], a[8:11], a[40:43], v[20:23]
ds_read_b128 v[128:131], v11 offset:3072
v_mfma_f32_16x16x32_bf16 v[24:27], a[16:19], a[40:43], 0
ds_read_b128 v[132:135], v11 offset:4096
v_mfma_f32_16x16x32_bf16 v[24:27], a[20:23], a[44:47], v[24:27]
ds_read_b128 v[136:139], v12 offset:5120
v_mfma_f32_16x16x32_bf16 v[28:31], a[28:31], a[44:47], 0
ds_read_b128 v[140:143], v12 offset:6144
v_mfma_f32_16x16x32_bf16 v[28:31], a[24:27], a[40:43], v[28:31]
ds_read_b128 v[144:147], v12 offset:7168
v_mfma_f32_16x16x32_bf16 v[32:35], a[32:35], a[40:43], 0
ds_read_b128 v[148:151], v12 offset:32768
v_mfma_f32_16x16x32_bf16 v[32:35], a[36:39], a[44:47], v[32:35]
ds_read_b128 v[152:155], v12 offset:33792
v_mfma_f32_16x16x32_bf16 v[52:55], a[36:39], a[52:55], 0
ds_read_b128 v[156:159], v13 offset:34816
v_mfma_f32_16x16x32_bf16 v[52:55], a[32:35], a[48:51], v[52:55]
ds_read_b128 v[160:163], v13 offset:35840
v_mfma_f32_16x16x32_bf16 v[48:51], a[24:27], a[48:51], 0
ds_read_b128 v[164:167], v13 offset:36864
v_mfma_f32_16x16x32_bf16 v[48:51], a[28:31], a[52:55], v[48:51]
ds_read_b128 v[168:171], v13 offset:37888
v_mfma_f32_16x16x32_bf16 v[44:47], a[20:23], a[52:55], 0
ds_read_b128 v[172:175], v13 offset:38912
v_mfma_f32_16x16x32_bf16 v[44:47], a[16:19], a[48:51], v[44:47]
v_mfma_f32_16x16x32_bf16 v[40:43], a[8:11], a[48:51], 0
v_mfma_f32_16x16x32_bf16 v[40:43], a[12:15], a[52:55], v[40:43]
v_mfma_f32_16x16x32_bf16 v[36:39], a[4:7], a[52:55], 0
s_waitcnt vmcnt(9) lgkmcnt(0)
s_barrier
v_mfma_f32_16x16x32_bf16 v[36:39], a[0:3], a[48:51], v[36:39]
ds_read_b128 a[112:115], v242 offset:36864
v_mfma_f32_16x16x32_bf16 v[56:59], a[0:3], a[56:59], 0
ds_read_b128 a[72:75], v243 offset:36864
s_add_u32 m0, s98, 36864
v_add_f32 v96, v96, v116
v_add_f32 v97, v97, v117
v_mfma_f32_16x16x32_bf16 v[56:59], a[4:7], a[60:63], v[56:59]
ds_read_b128 a[116:119], v242 offset:37888
buffer_load_dwordx4 v244, s[16:19], s89 offen offset:0 sc1 lds
v_mfma_f32_16x16x32_bf16 v[60:63], a[12:15], a[60:63], 0
ds_read_b128 a[76:79], v243 offset:37888
v_add_f32 v98, v98, v118
v_mfma_f32_16x16x32_bf16 v[60:63], a[8:11], a[56:59], v[60:63]
ds_read_b128 a[120:123], v242 offset:38912
buffer_load_dwordx4 v244, s[16:19], s90 offen offset:1024 sc1 lds
v_mfma_f32_16x16x32_bf16 v[64:67], a[16:19], a[56:59], 0
ds_read_b128 a[80:83], v243 offset:38912
v_add_f32 v99, v99, v119
v_add_f32 v100, v100, v120
v_mfma_f32_16x16x32_bf16 v[64:67], a[20:23], a[60:63], v[64:67]
ds_read_b128 a[124:127], v242 offset:39936
buffer_load_dwordx4 v244, s[16:19], s91 offen offset:2048 sc1 lds
v_mfma_f32_16x16x32_bf16 v[68:71], a[28:31], a[60:63], 0
ds_read_b128 a[84:87], v243 offset:39936
v_add_f32 v101, v101, v121
v_add_f32 v102, v102, v122
v_mfma_f32_16x16x32_bf16 v[68:71], a[24:27], a[56:59], v[68:71]
ds_read_b128 a[128:131], v242 offset:40960
buffer_load_dwordx4 v244, s[16:19], s92 offen offset:3072 sc1 lds
v_mfma_f32_16x16x32_bf16 v[72:75], a[32:35], a[56:59], 0
ds_read_b128 a[88:91], v243 offset:40960
s_add_u32 m0, s98, 40960
v_add_f32 v103, v103, v123
v_add_f32 v104, v104, v124
v_mfma_f32_16x16x32_bf16 v[72:75], a[36:39], a[60:63], v[72:75]
ds_read_b128 a[132:135], v242 offset:41984
buffer_load_dwordx4 v244, s[16:19], s93 offen offset:0 sc1 lds
v_mfma_f32_16x16x32_bf16 v[92:95], a[36:39], a[68:71], 0
ds_read_b128 a[92:95], v243 offset:41984
v_add_f32 v105, v105, v125
v_mfma_f32_16x16x32_bf16 v[92:95], a[32:35], a[64:67], v[92:95]
ds_read_b128 a[136:139], v242 offset:43008
buffer_load_dwordx4 v244, s[16:19], s94 offen offset:1024 sc1 lds
v_mfma_f32_16x16x32_bf16 v[88:91], a[24:27], a[64:67], 0
ds_read_b128 a[96:99], v243 offset:43008
v_add_f32 v106, v106, v126
v_add_f32 v107, v107, v127
v_mfma_f32_16x16x32_bf16 v[88:91], a[28:31], a[68:71], v[88:91]
ds_read_b128 a[140:143], v242 offset:44032
buffer_load_dwordx4 v244, s[16:19], s95 offen offset:2048 sc1 lds
v_mfma_f32_16x16x32_bf16 v[84:87], a[20:23], a[68:71], 0
ds_read_b128 a[100:103], v243 offset:44032
v_add_f32 v108, v108, v128
v_add_f32 v109, v109, v129
v_mfma_f32_16x16x32_bf16 v[84:87], a[16:19], a[64:67], v[84:87]
ds_read_b128 a[104:107], v243 offset:45056
buffer_load_dwordx4 v244, s[16:19], s96 offen offset:3072 sc1 lds
v_mfma_f32_16x16x32_bf16 v[80:83], a[8:11], a[64:67], 0
ds_read_b128 a[108:111], v243 offset:46080
s_add_u32 m0, s98, 45056
v_add_f32 v110, v110, v130
v_add_f32 v111, v111, v131
v_mfma_f32_16x16x32_bf16 v[80:83], a[12:15], a[68:71], v[80:83]
buffer_load_dwordx4 v244, s[16:19], s97 offen offset:0 sc1 lds
v_add_u32 v244, 2048, v244
v_mfma_f32_16x16x32_bf16 v[76:79], a[4:7], a[68:71], 0
v_add_f32 v112, v112, v132
v_add_f32 v113, v113, v133
v_add_f32 v114, v114, v134
v_mfma_f32_16x16x32_bf16 v[76:79], a[0:3], a[64:67], v[76:79]
v_add_f32 v115, v115, v135
v_add_f32 v96, v96, v136
v_add_f32 v97, v97, v137
v_add_f32 v98, v98, v138
s_waitcnt vmcnt(9) lgkmcnt(0)
s_barrier
v_mfma_f32_16x16x32_bf16 v[16:19], a[72:75], a[112:115], v[16:19]
ds_read_b128 a[40:43], v242 offset:0
v_add_f32 v99, v99, v139
v_add_f32 v100, v100, v140
v_mfma_f32_16x16x32_bf16 v[16:19], a[76:79], a[116:119], v[16:19]
v_add_f32 v101, v101, v141
v_add_f32 v102, v102, v142
v_add_f32 v103, v103, v143
v_mfma_f32_16x16x32_bf16 v[20:23], a[84:87], a[116:119], v[20:23]
ds_read_b128 a[0:3], v243 offset:0
s_add_u32 m0, s98, 0
v_add_f32 v104, v104, v144
v_add_f32 v105, v105, v145
v_mfma_f32_16x16x32_bf16 v[20:23], a[80:83], a[112:115], v[20:23]
buffer_load_dwordx4 v244, s[16:19], s89 offen offset:0 sc1 lds
v_add_f32 v106, v106, v146
v_add_f32 v107, v107, v147
v_mfma_f32_16x16x32_bf16 v[24:27], a[88:91], a[112:115], v[24:27]
ds_read_b128 a[44:47], v242 offset:1024
v_add_f32 v108, v108, v148
v_add_f32 v109, v109, v149
v_mfma_f32_16x16x32_bf16 v[24:27], a[92:95], a[116:119], v[24:27]
buffer_load_dwordx4 v244, s[16:19], s90 offen offset:1024 sc1 lds
v_add_f32 v110, v110, v150
v_add_f32 v111, v111, v151
v_mfma_f32_16x16x32_bf16 v[28:31], a[100:103], a[116:119], v[28:31]
ds_read_b128 a[4:7], v243 offset:1024
v_add_f32 v112, v112, v152
v_mfma_f32_16x16x32_bf16 v[28:31], a[96:99], a[112:115], v[28:31]
v_add_f32 v113, v113, v153
v_add_f32 v114, v114, v154
v_add_f32 v115, v115, v155
v_add_f32 v96, v96, v156
v_mfma_f32_16x16x32_bf16 v[32:35], a[104:107], a[112:115], v[32:35]
ds_read_b128 a[48:51], v242 offset:2048
v_add_f32 v97, v97, v157
v_add_f32 v98, v98, v158
v_mfma_f32_16x16x32_bf16 v[32:35], a[108:111], a[116:119], v[32:35]
buffer_load_dwordx4 v244, s[16:19], s91 offen offset:2048 sc1 lds
v_add_f32 v99, v99, v159
v_mfma_f32_16x16x32_bf16 v[52:55], a[108:111], a[124:127], v[52:55]
ds_read_b128 a[8:11], v243 offset:2048
v_add_f32 v100, v100, v160
v_add_f32 v101, v101, v161
v_mfma_f32_16x16x32_bf16 v[52:55], a[104:107], a[120:123], v[52:55]
buffer_load_dwordx4 v244, s[16:19], s92 offen offset:3072 sc1 lds
v_add_f32 v102, v102, v162
v_add_f32 v103, v103, v163
v_mfma_f32_16x16x32_bf16 v[48:51], a[96:99], a[120:123], v[48:51]
ds_read_b128 a[52:55], v242 offset:3072
v_add_f32 v104, v104, v164
v_add_f32 v105, v105, v165
v_mfma_f32_16x16x32_bf16 v[48:51], a[100:103], a[124:127], v[48:51]
v_add_f32 v106, v106, v166
v_add_f32 v107, v107, v167
v_add_f32 v108, v108, v168
v_mfma_f32_16x16x32_bf16 v[44:47], a[92:95], a[124:127], v[44:47]
ds_read_b128 a[12:15], v243 offset:3072
s_add_u32 m0, s98, 4096
v_add_f32 v109, v109, v169
v_add_f32 v110, v110, v170
v_mfma_f32_16x16x32_bf16 v[44:47], a[88:91], a[120:123], v[44:47]
buffer_load_dwordx4 v244, s[16:19], s93 offen offset:0 sc1 lds
v_add_f32 v111, v111, v171
v_add_f32 v112, v112, v172
v_mfma_f32_16x16x32_bf16 v[40:43], a[80:83], a[120:123], v[40:43]
ds_read_b128 a[56:59], v242 offset:4096
v_add_f32 v113, v113, v173
v_add_f32 v114, v114, v174
v_mfma_f32_16x16x32_bf16 v[40:43], a[84:87], a[124:127], v[40:43]
buffer_load_dwordx4 v244, s[16:19], s94 offen offset:1024 sc1 lds
v_add_f32 v115, v115, v175
v_mov_b32 v146, 0xc0135761
v_mfma_f32_16x16x32_bf16 v[36:39], a[76:79], a[124:127], v[36:39]
ds_read_b128 a[16:19], v243 offset:4096
v_mov_b32 v147, 0xbdd2d3e8
s_lshr_b32 s48, s44, 1
v_mfma_f32_16x16x32_bf16 v[36:39], a[72:75], a[120:123], v[36:39]
s_lshl_b32 s48, s48, 10
v_add_u32 v148, s48, v15
s_and_b32 s48, s44, 1
s_lshl_b32 s48, s48, 3
s_add_u32 s48, s48, 147456
v_add_u32 v148, s48, v148
v_mfma_f32_16x16x32_bf16 v[56:59], a[72:75], a[128:131], v[56:59]
ds_read_b128 a[60:63], v242 offset:5120
v_mul_f32 v116, v96, v96
v_fma_f32 v116, v116, v147, v146
v_mfma_f32_16x16x32_bf16 v[56:59], a[76:79], a[132:135], v[56:59]
buffer_load_dwordx4 v244, s[16:19], s95 offen offset:2048 sc1 lds
v_mul_f32 v116, v116, v96
v_mul_f32 v117, v97, v97
v_mfma_f32_16x16x32_bf16 v[60:63], a[84:87], a[132:135], v[60:63]
ds_read_b128 a[20:23], v243 offset:5120
v_fma_f32 v117, v117, v147, v146
v_mul_f32 v117, v117, v97
v_mfma_f32_16x16x32_bf16 v[60:63], a[80:83], a[128:131], v[60:63]
buffer_load_dwordx4 v244, s[16:19], s96 offen offset:3072 sc1 lds
v_exp_f32 v116, v116
v_mfma_f32_16x16x32_bf16 v[64:67], a[88:91], a[128:131], v[64:67]
ds_read_b128 a[64:67], v242 offset:6144
v_mul_f32 v118, v98, v98
v_mfma_f32_16x16x32_bf16 v[64:67], a[92:95], a[132:135], v[64:67]
v_fma_f32 v118, v118, v147, v146
v_mul_f32 v118, v118, v98
v_exp_f32 v117, v117
v_mfma_f32_16x16x32_bf16 v[68:71], a[100:103], a[132:135], v[68:71]
ds_read_b128 a[24:27], v243 offset:6144
s_add_u32 m0, s98, 8192
v_add_f32 v116, 1.0, v116
v_mul_f32 v119, v99, v99
v_mfma_f32_16x16x32_bf16 v[68:71], a[96:99], a[128:131], v[68:71]
buffer_load_dwordx4 v244, s[16:19], s97 offen offset:0 sc1 lds
v_add_u32 v244, 2048, v244
v_mfma_f32_16x16x32_bf16 v[72:75], a[104:107], a[128:131], v[72:75]
ds_read_b128 a[68:71], v242 offset:7168
s_add_u32 m0, s98, 110592
v_fma_f32 v119, v119, v147, v146
v_mfma_f32_16x16x32_bf16 v[72:75], a[108:111], a[132:135], v[72:75]
buffer_load_dwordx4 v244, s[16:19], s89 offen offset:0 sc1 lds
v_mul_f32 v119, v119, v99
v_exp_f32 v118, v118
v_mfma_f32_16x16x32_bf16 v[92:95], a[108:111], a[140:143], v[92:95]
ds_read_b128 a[28:31], v243 offset:7168
v_add_f32 v117, 1.0, v117
v_mfma_f32_16x16x32_bf16 v[92:95], a[104:107], a[136:139], v[92:95]
v_rcp_f32 v116, v116
v_mul_f32 v120, v100, v100
v_fma_f32 v120, v120, v147, v146
v_mfma_f32_16x16x32_bf16 v[88:91], a[96:99], a[136:139], v[88:91]
ds_read_b128 a[32:35], v243 offset:8192
v_mul_f32 v120, v120, v100
v_mfma_f32_16x16x32_bf16 v[88:91], a[100:103], a[140:143], v[88:91]
buffer_load_dwordx4 v244, s[16:19], s90 offen offset:1024 sc1 lds
v_exp_f32 v119, v119
v_mfma_f32_16x16x32_bf16 v[84:87], a[92:95], a[140:143], v[84:87]
ds_read_b128 a[36:39], v243 offset:9216
v_mul_f32 v96, v96, v116
v_add_f32 v118, 1.0, v118
v_mfma_f32_16x16x32_bf16 v[84:87], a[88:91], a[136:139], v[84:87]
buffer_load_dwordx4 v244, s[16:19], s91 offen offset:2048 sc1 lds
v_rcp_f32 v117, v117
v_mfma_f32_16x16x32_bf16 v[80:83], a[80:83], a[136:139], v[80:83]
v_mul_f32 v121, v101, v101
v_fma_f32 v121, v121, v147, v146
v_mul_f32 v121, v121, v101
v_mfma_f32_16x16x32_bf16 v[80:83], a[84:87], a[140:143], v[80:83]
v_exp_f32 v120, v120
v_mul_f32 v97, v97, v117
v_add_f32 v119, 1.0, v119
v_mfma_f32_16x16x32_bf16 v[76:79], a[76:79], a[140:143], v[76:79]
v_rcp_f32 v118, v118
v_mul_f32 v122, v102, v102
v_mfma_f32_16x16x32_bf16 v[76:79], a[72:75], a[136:139], v[76:79]
v_fma_f32 v122, v122, v147, v146
v_mul_f32 v122, v122, v102
v_exp_f32 v121, v121
s_waitcnt vmcnt(12) lgkmcnt(0)
s_barrier
v_mfma_f32_16x16x32_bf16 v[16:19], a[0:3], a[40:43], v[16:19]
ds_read_b128 a[112:115], v240 offset:36864
v_mul_f32 v98, v98, v118
v_add_f32 v120, 1.0, v120
v_mfma_f32_16x16x32_bf16 v[16:19], a[4:7], a[44:47], v[16:19]
v_cvt_pk_bf16_f32 v136, v96, v97
v_rcp_f32 v119, v119
v_mul_f32 v123, v103, v103
v_mfma_f32_16x16x32_bf16 v[20:23], a[12:15], a[44:47], v[20:23]
ds_read_b128 a[72:75], v241 offset:36864
v_fma_f32 v123, v123, v147, v146
v_mfma_f32_16x16x32_bf16 v[20:23], a[8:11], a[40:43], v[20:23]
buffer_load_dwordx4 v244, s[16:19], s92 offen offset:3072 sc1 lds
v_mul_f32 v123, v123, v103
v_exp_f32 v122, v122
v_mfma_f32_16x16x32_bf16 v[24:27], a[16:19], a[40:43], v[24:27]
ds_read_b128 a[116:119], v240 offset:37888
s_add_u32 m0, s98, 114688
v_mul_f32 v99, v99, v119
v_mfma_f32_16x16x32_bf16 v[24:27], a[20:23], a[44:47], v[24:27]
buffer_load_dwordx4 v244, s[16:19], s93 offen offset:0 sc1 lds
v_add_f32 v121, 1.0, v121
v_mfma_f32_16x16x32_bf16 v[28:31], a[28:31], a[44:47], v[28:31]
ds_read_b128 a[76:79], v241 offset:37888
v_rcp_f32 v120, v120
v_mul_f32 v124, v104, v104
v_mfma_f32_16x16x32_bf16 v[28:31], a[24:27], a[40:43], v[28:31]
v_fma_f32 v124, v124, v147, v146
v_mul_f32 v124, v124, v104
v_exp_f32 v123, v123
v_mfma_f32_16x16x32_bf16 v[32:35], a[32:35], a[40:43], v[32:35]
ds_read_b128 a[120:123], v240 offset:38912
v_mul_f32 v100, v100, v120
v_mfma_f32_16x16x32_bf16 v[32:35], a[36:39], a[44:47], v[32:35]
buffer_load_dwordx4 v244, s[16:19], s94 offen offset:1024 sc1 lds
v_add_f32 v122, 1.0, v122
v_cvt_pk_bf16_f32 v137, v98, v99
v_mfma_f32_16x16x32_bf16 v[52:55], a[36:39], a[52:55], v[52:55]
ds_read_b128 a[80:83], v241 offset:38912
v_rcp_f32 v121, v121
v_mfma_f32_16x16x32_bf16 v[52:55], a[32:35], a[48:51], v[52:55]
buffer_load_dwordx4 v244, s[16:19], s95 offen offset:2048 sc1 lds
v_mul_f32 v125, v105, v105
v_fma_f32 v125, v125, v147, v146
v_mfma_f32_16x16x32_bf16 v[48:51], a[24:27], a[48:51], v[48:51]
ds_read_b128 a[124:127], v240 offset:39936
v_mul_f32 v125, v125, v105
v_mfma_f32_16x16x32_bf16 v[48:51], a[28:31], a[52:55], v[48:51]
v_exp_f32 v124, v124
v_mul_f32 v101, v101, v121
v_add_f32 v123, 1.0, v123
v_mfma_f32_16x16x32_bf16 v[44:47], a[20:23], a[52:55], v[44:47]
ds_read_b128 a[84:87], v241 offset:39936
v_rcp_f32 v122, v122
v_mfma_f32_16x16x32_bf16 v[44:47], a[16:19], a[48:51], v[44:47]
buffer_load_dwordx4 v244, s[16:19], s96 offen offset:3072 sc1 lds
v_mul_f32 v126, v106, v106
v_fma_f32 v126, v126, v147, v146
v_mfma_f32_16x16x32_bf16 v[40:43], a[8:11], a[48:51], v[40:43]
ds_read_b128 a[128:131], v240 offset:40960
s_add_u32 m0, s98, 118784
v_mul_f32 v126, v126, v106
v_exp_f32 v125, v125
v_mfma_f32_16x16x32_bf16 v[40:43], a[12:15], a[52:55], v[40:43]
buffer_load_dwordx4 v244, s[16:19], s97 offen offset:0 sc1 lds
v_add_u32 v244, 2048, v244
v_mfma_f32_16x16x32_bf16 v[36:39], a[4:7], a[52:55], v[36:39]
ds_read_b128 a[88:91], v241 offset:40960
v_mul_f32 v102, v102, v122
v_mfma_f32_16x16x32_bf16 v[36:39], a[0:3], a[48:51], v[36:39]
v_add_f32 v124, 1.0, v124
v_cvt_pk_bf16_f32 v138, v100, v101
v_rcp_f32 v123, v123
v_mfma_f32_16x16x32_bf16 v[56:59], a[0:3], a[56:59], v[56:59]
ds_read_b128 a[132:135], v240 offset:41984
s_add_u32 m0, s98, 73728
v_mul_f32 v127, v107, v107
v_fma_f32 v127, v127, v147, v146
v_mfma_f32_16x16x32_bf16 v[56:59], a[4:7], a[60:63], v[56:59]
K_pg10:
s_cbranch_execz K_pg13
buffer_load_dwordx4 v244, s[16:19], s89 offen offset:0 sc1 lds
v_mul_f32 v127, v127, v107
v_mfma_f32_16x16x32_bf16 v[60:63], a[12:15], a[60:63], v[60:63]
ds_read_b128 a[92:95], v241 offset:41984
v_exp_f32 v126, v126
v_mfma_f32_16x16x32_bf16 v[60:63], a[8:11], a[56:59], v[60:63]
buffer_load_dwordx4 v244, s[16:19], s90 offen offset:1024 sc1 lds
v_mul_f32 v103, v103, v123
v_add_f32 v125, 1.0, v125
v_mfma_f32_16x16x32_bf16 v[64:67], a[16:19], a[56:59], v[64:67]
ds_read_b128 a[136:139], v240 offset:43008
v_rcp_f32 v124, v124
v_mfma_f32_16x16x32_bf16 v[64:67], a[20:23], a[60:63], v[64:67]
v_mul_f32 v128, v108, v108
v_fma_f32 v128, v128, v147, v146
v_mul_f32 v128, v128, v108
v_mfma_f32_16x16x32_bf16 v[68:71], a[28:31], a[60:63], v[68:71]
ds_read_b128 a[96:99], v241 offset:43008
v_exp_f32 v127, v127
v_mfma_f32_16x16x32_bf16 v[68:71], a[24:27], a[56:59], v[68:71]
buffer_load_dwordx4 v244, s[16:19], s91 offen offset:2048 sc1 lds
v_mul_f32 v104, v104, v124
v_add_f32 v126, 1.0, v126
v_mfma_f32_16x16x32_bf16 v[72:75], a[32:35], a[56:59], v[72:75]
ds_read_b128 a[140:143], v240 offset:44032
v_cvt_pk_bf16_f32 v139, v102, v103
v_rcp_f32 v125, v125
v_mfma_f32_16x16x32_bf16 v[72:75], a[36:39], a[60:63], v[72:75]
buffer_load_dwordx4 v244, s[16:19], s92 offen offset:3072 sc1 lds
v_mul_f32 v129, v109, v109
v_mfma_f32_16x16x32_bf16 v[92:95], a[36:39], a[68:71], v[92:95]
ds_read_b128 a[100:103], v241 offset:44032
v_fma_f32 v129, v129, v147, v146
v_mul_f32 v129, v129, v109
v_mfma_f32_16x16x32_bf16 v[92:95], a[32:35], a[64:67], v[92:95]
v_exp_f32 v128, v128
v_mul_f32 v105, v105, v125
v_add_f32 v127, 1.0, v127
v_mfma_f32_16x16x32_bf16 v[88:91], a[24:27], a[64:67], v[88:91]
ds_read_b128 a[104:107], v241 offset:45056
s_add_u32 m0, s98, 77824
v_rcp_f32 v126, v126
v_mfma_f32_16x16x32_bf16 v[88:91], a[28:31], a[68:71], v[88:91]
buffer_load_dwordx4 v244, s[16:19], s93 offen offset:0 sc1 lds
v_mul_f32 v130, v110, v110
v_mfma_f32_16x16x32_bf16 v[84:87], a[20:23], a[68:71], v[84:87]
ds_read_b128 a[108:111], v241 offset:46080
v_fma_f32 v130, v130, v147, v146
v_mul_f32 v130, v130, v110
v_mfma_f32_16x16x32_bf16 v[84:87], a[16:19], a[64:67], v[84:87]
buffer_load_dwordx4 v244, s[16:19], s94 offen offset:1024 sc1 lds
v_exp_f32 v129, v129
v_mfma_f32_16x16x32_bf16 v[80:83], a[8:11], a[64:67], v[80:83]
v_mul_f32 v106, v106, v126
v_add_f32 v128, 1.0, v128
v_cvt_pk_bf16_f32 v140, v104, v105
v_mfma_f32_16x16x32_bf16 v[80:83], a[12:15], a[68:71], v[80:83]
v_rcp_f32 v127, v127
v_mul_f32 v131, v111, v111
v_fma_f32 v131, v131, v147, v146
v_mfma_f32_16x16x32_bf16 v[76:79], a[4:7], a[68:71], v[76:79]
v_mul_f32 v131, v131, v111
v_exp_f32 v130, v130
v_mul_f32 v107, v107, v127
v_mfma_f32_16x16x32_bf16 v[76:79], a[0:3], a[64:67], v[76:79]
v_add_f32 v129, 1.0, v129
v_rcp_f32 v128, v128
v_mul_f32 v132, v112, v112
s_waitcnt vmcnt(15) lgkmcnt(0)
s_barrier
v_mfma_f32_16x16x32_bf16 v[16:19], a[72:75], a[112:115], v[16:19]
ds_read_b128 a[40:43], v240 offset:0
v_fma_f32 v132, v132, v147, v146
v_mul_f32 v132, v132, v112
v_mfma_f32_16x16x32_bf16 v[16:19], a[76:79], a[116:119], v[16:19]
v_exp_f32 v131, v131
v_mul_f32 v108, v108, v128
v_add_f32 v130, 1.0, v130
v_mfma_f32_16x16x32_bf16 v[20:23], a[84:87], a[116:119], v[20:23]
ds_read_b128 a[0:3], v241 offset:0
v_cvt_pk_bf16_f32 v141, v106, v107
v_rcp_f32 v129, v129
v_mfma_f32_16x16x32_bf16 v[20:23], a[80:83], a[112:115], v[20:23]
buffer_load_dwordx4 v244, s[16:19], s95 offen offset:2048 sc1 lds
v_mul_f32 v133, v113, v113
v_mfma_f32_16x16x32_bf16 v[24:27], a[88:91], a[112:115], v[24:27]
ds_read_b128 a[44:47], v240 offset:1024
v_fma_f32 v133, v133, v147, v146
v_mul_f32 v133, v133, v113
v_mfma_f32_16x16x32_bf16 v[24:27], a[92:95], a[116:119], v[24:27]
buffer_load_dwordx4 v244, s[16:19], s96 offen offset:3072 sc1 lds
v_exp_f32 v132, v132
v_mfma_f32_16x16x32_bf16 v[28:31], a[100:103], a[116:119], v[28:31]
ds_read_b128 a[4:7], v241 offset:1024
v_mul_f32 v109, v109, v129
v_add_f32 v131, 1.0, v131
v_mfma_f32_16x16x32_bf16 v[28:31], a[96:99], a[112:115], v[28:31]
v_rcp_f32 v130, v130
v_mul_f32 v134, v114, v114
v_fma_f32 v134, v134, v147, v146
v_mul_f32 v134, v134, v114
v_mfma_f32_16x16x32_bf16 v[32:35], a[104:107], a[112:115], v[32:35]
ds_read_b128 a[48:51], v240 offset:2048
s_add_u32 m0, s98, 81920
v_exp_f32 v133, v133
v_mfma_f32_16x16x32_bf16 v[32:35], a[108:111], a[116:119], v[32:35]
buffer_load_dwordx4 v244, s[16:19], s97 offen offset:0 sc1 lds
v_add_u32 v244, 2048, v244
v_mfma_f32_16x16x32_bf16 v[52:55], a[108:111], a[124:127], v[52:55]
ds_read_b128 a[8:11], v241 offset:2048
s_add_u32 m0, s98, 36864
v_mul_f32 v110, v110, v130
v_add_f32 v132, 1.0, v132
v_mfma_f32_16x16x32_bf16 v[52:55], a[104:107], a[120:123], v[52:55]
buffer_load_dwordx4 v244, s[16:19], s89 offen offset:0 sc1 lds
v_cvt_pk_bf16_f32 v142, v108, v109
v_mfma_f32_16x16x32_bf16 v[48:51], a[96:99], a[120:123], v[48:51]
ds_read_b128 a[52:55], v240 offset:3072
v_rcp_f32 v131, v131
v_mul_f32 v135, v115, v115
v_mfma_f32_16x16x32_bf16 v[48:51], a[100:103], a[124:127], v[48:51]
v_fma_f32 v135, v135, v147, v146
v_mul_f32 v135, v135, v115
v_exp_f32 v134, v134
v_mfma_f32_16x16x32_bf16 v[44:47], a[92:95], a[124:127], v[44:47]
ds_read_b128 a[12:15], v241 offset:3072
v_mul_f32 v111, v111, v131
v_add_f32 v133, 1.0, v133
v_mfma_f32_16x16x32_bf16 v[44:47], a[88:91], a[120:123], v[44:47]
buffer_load_dwordx4 v244, s[16:19], s90 offen offset:1024 sc1 lds
v_rcp_f32 v132, v132
v_mfma_f32_16x16x32_bf16 v[40:43], a[80:83], a[120:123], v[40:43]
ds_read_b128 a[56:59], v240 offset:4096
v_exp_f32 v135, v135
v_mfma_f32_16x16x32_bf16 v[40:43], a[84:87], a[124:127], v[40:43]
buffer_load_dwordx4 v244, s[16:19], s91 offen offset:2048 sc1 lds
v_mul_f32 v112, v112, v132
v_add_f32 v134, 1.0, v134
v_mfma_f32_16x16x32_bf16 v[36:39], a[76:79], a[124:127], v[36:39]
ds_read_b128 a[16:19], v241 offset:4096
v_cvt_pk_bf16_f32 v143, v110, v111
v_rcp_f32 v133, v133
v_mfma_f32_16x16x32_bf16 v[36:39], a[72:75], a[120:123], v[36:39]
s_nop 0
v_mul_f32 v113, v113, v133
v_add_f32 v135, 1.0, v135
v_mfma_f32_16x16x32_bf16 v[56:59], a[72:75], a[128:131], v[56:59]
ds_read_b128 a[60:63], v240 offset:5120
v_rcp_f32 v134, v134
s_nop 0
v_mul_f32 v114, v114, v134
v_mfma_f32_16x16x32_bf16 v[56:59], a[76:79], a[132:135], v[56:59]
buffer_load_dwordx4 v244, s[16:19], s92 offen offset:3072 sc1 lds
v_cvt_pk_bf16_f32 v144, v112, v113
v_mfma_f32_16x16x32_bf16 v[60:63], a[84:87], a[132:135], v[60:63]
ds_read_b128 a[20:23], v241 offset:5120
s_add_u32 m0, s98, 40960
v_rcp_f32 v135, v135
s_nop 0
v_mul_f32 v115, v115, v135
v_mfma_f32_16x16x32_bf16 v[60:63], a[80:83], a[128:131], v[60:63]
buffer_load_dwordx4 v244, s[16:19], s93 offen offset:0 sc1 lds
s_nop 0
v_cvt_pk_bf16_f32 v145, v114, v115
s_nop 0
v_mfma_f32_16x16x32_bf16 v[64:67], a[88:91], a[128:131], v[64:67]
ds_read_b128 a[64:67], v240 offset:6144
v_mfma_f32_16x16x32_bf16 v[64:67], a[92:95], a[132:135], v[64:67]
ds_write_b64 v148, v[136:137] offset:0
v_mfma_f32_16x16x32_bf16 v[68:71], a[100:103], a[132:135], v[68:71]
ds_read_b128 a[24:27], v241 offset:6144
v_mfma_f32_16x16x32_bf16 v[68:71], a[96:99], a[128:131], v[68:71]
ds_write_b64 v148, v[138:139] offset:2048
buffer_load_dwordx4 v244, s[16:19], s94 offen offset:1024 sc1 lds
v_mfma_f32_16x16x32_bf16 v[72:75], a[104:107], a[128:131], v[72:75]
ds_read_b128 a[68:71], v240 offset:7168
v_mfma_f32_16x16x32_bf16 v[72:75], a[108:111], a[132:135], v[72:75]
ds_write_b64 v148, v[140:141] offset:4096
buffer_load_dwordx4 v244, s[16:19], s95 offen offset:2048 sc1 lds
v_mfma_f32_16x16x32_bf16 v[92:95], a[108:111], a[140:143], v[92:95]
ds_read_b128 a[28:31], v241 offset:7168
v_mfma_f32_16x16x32_bf16 v[92:95], a[104:107], a[136:139], v[92:95]
ds_write_b64 v148, v[142:143] offset:6144
v_mfma_f32_16x16x32_bf16 v[88:91], a[96:99], a[136:139], v[88:91]
ds_read_b128 a[32:35], v241 offset:8192
v_mfma_f32_16x16x32_bf16 v[88:91], a[100:103], a[140:143], v[88:91]
ds_write_b64 v148, v[144:145] offset:8192
buffer_load_dwordx4 v244, s[16:19], s96 offen offset:3072 sc1 lds
v_mfma_f32_16x16x32_bf16 v[84:87], a[92:95], a[140:143], v[84:87]
ds_read_b128 a[36:39], v241 offset:9216
s_add_u32 m0, s98, 45056
v_mfma_f32_16x16x32_bf16 v[84:87], a[88:91], a[136:139], v[84:87]
buffer_load_dwordx4 v244, s[16:19], s97 offen offset:0 sc1 lds
v_add_u32 v244, 2048, v244
v_mfma_f32_16x16x32_bf16 v[80:83], a[80:83], a[136:139], v[80:83]
v_mfma_f32_16x16x32_bf16 v[80:83], a[84:87], a[140:143], v[80:83]
v_mfma_f32_16x16x32_bf16 v[76:79], a[76:79], a[140:143], v[76:79]
v_mfma_f32_16x16x32_bf16 v[76:79], a[72:75], a[136:139], v[76:79]
s_waitcnt vmcnt(18) lgkmcnt(0)
s_barrier
v_mfma_f32_16x16x32_bf16 v[16:19], a[0:3], a[40:43], v[16:19]
ds_read_b128 a[112:115], v242 offset:36864
v_mfma_f32_16x16x32_bf16 v[16:19], a[4:7], a[44:47], v[16:19]
s_lshl_b32 s48, s44, 10
s_add_u32 s48, s48, 147456
v_add_u32 v148, s48, v15
v_mfma_f32_16x16x32_bf16 v[20:23], a[12:15], a[44:47], v[20:23]
ds_read_b128 a[72:75], v243 offset:36864
s_add_u32 m0, s98, 0
v_mfma_f32_16x16x32_bf16 v[20:23], a[8:11], a[40:43], v[20:23]
buffer_load_dwordx4 v244, s[16:19], s89 offen offset:0 sc1 lds
ds_read_b128 v[96:99], v148 offset:0
v_mfma_f32_16x16x32_bf16 v[24:27], a[16:19], a[40:43], v[24:27]
ds_read_b128 a[116:119], v242 offset:37888
v_mfma_f32_16x16x32_bf16 v[24:27], a[20:23], a[44:47], v[24:27]
ds_read_b128 v[100:103], v148 offset:4096
v_mfma_f32_16x16x32_bf16 v[28:31], a[28:31], a[44:47], v[28:31]
ds_read_b128 a[76:79], v243 offset:37888
v_mfma_f32_16x16x32_bf16 v[28:31], a[24:27], a[40:43], v[28:31]
buffer_load_dwordx4 v244, s[16:19], s90 offen offset:1024 sc1 lds
ds_read_b128 v[104:107], v148 offset:8192
v_mfma_f32_16x16x32_bf16 v[32:35], a[32:35], a[40:43], v[32:35]
ds_read_b128 a[120:123], v242 offset:38912
v_mfma_f32_16x16x32_bf16 v[32:35], a[36:39], a[44:47], v[32:35]
s_lshr_b32 s48, s44, 1
s_mul_i32 s48, s48, 55296
s_add_u32 s79, s79, s48
v_mfma_f32_16x16x32_bf16 v[52:55], a[36:39], a[52:55], v[52:55]
ds_read_b128 a[80:83], v243 offset:38912
v_mfma_f32_16x16x32_bf16 v[52:55], a[32:35], a[48:51], v[52:55]
buffer_load_dwordx4 v244, s[16:19], s91 offen offset:2048 sc1 lds
v_mfma_f32_16x16x32_bf16 v[48:51], a[24:27], a[48:51], v[48:51]
ds_read_b128 a[124:127], v242 offset:39936
v_mfma_f32_16x16x32_bf16 v[48:51], a[28:31], a[52:55], v[48:51]
s_and_b32 s48, s44, 1
s_lshl_b32 s48, s48, 10
s_add_u32 s79, s79, s48
v_mfma_f32_16x16x32_bf16 v[44:47], a[20:23], a[52:55], v[44:47]
ds_read_b128 a[84:87], v243 offset:39936
v_mfma_f32_16x16x32_bf16 v[44:47], a[16:19], a[48:51], v[44:47]
buffer_load_dwordx4 v244, s[16:19], s92 offen offset:3072 sc1 lds
v_mfma_f32_16x16x32_bf16 v[40:43], a[8:11], a[48:51], v[40:43]
ds_read_b128 a[128:131], v242 offset:40960
v_mfma_f32_16x16x32_bf16 v[40:43], a[12:15], a[52:55], v[40:43]
s_waitcnt lgkmcnt(5)
v_mfma_f32_16x16x32_bf16 v[36:39], a[4:7], a[52:55], v[36:39]
ds_read_b128 a[88:91], v243 offset:40960
s_add_u32 m0, s98, 4096
v_mfma_f32_16x16x32_bf16 v[36:39], a[0:3], a[48:51], v[36:39]
buffer_load_dwordx4 v244, s[16:19], s93 offen offset:0 sc1 lds
v_mfma_f32_16x16x32_bf16 v[56:59], a[0:3], a[56:59], v[56:59]
ds_read_b128 a[132:135], v242 offset:41984
v_mfma_f32_16x16x32_bf16 v[56:59], a[4:7], a[60:63], v[56:59]
buffer_store_dwordx4 v[96:99], v15, s[16:19], s79 offen sc1
s_add_u32 s79, s79, 110592
v_mfma_f32_16x16x32_bf16 v[60:63], a[12:15], a[60:63], v[60:63]
ds_read_b128 a[92:95], v243 offset:41984
v_mfma_f32_16x16x32_bf16 v[60:63], a[8:11], a[56:59], v[60:63]
buffer_load_dwordx4 v244, s[16:19], s94 offen offset:1024 sc1 lds
v_mfma_f32_16x16x32_bf16 v[64:67], a[16:19], a[56:59], v[64:67]
ds_read_b128 a[136:139], v242 offset:43008
v_mfma_f32_16x16x32_bf16 v[64:67], a[20:23], a[60:63], v[64:67]
buffer_store_dwordx4 v[100:103], v15, s[16:19], s79 offen sc1
s_add_u32 s79, s79, 110592
s_cmp_ge_u32 s44, 2
s_cselect_b32 s79, 67108864, s79
v_mfma_f32_16x16x32_bf16 v[68:71], a[28:31], a[60:63], v[68:71]
ds_read_b128 a[96:99], v243 offset:43008
v_mfma_f32_16x16x32_bf16 v[68:71], a[24:27], a[56:59], v[68:71]
buffer_load_dwordx4 v244, s[16:19], s95 offen offset:2048 sc1 lds
v_mfma_f32_16x16x32_bf16 v[72:75], a[32:35], a[56:59], v[72:75]
ds_read_b128 a[140:143], v242 offset:44032
v_mfma_f32_16x16x32_bf16 v[72:75], a[36:39], a[60:63], v[72:75]
buffer_store_dwordx4 v[104:107], v15, s[16:19], s79 offen sc1
v_mfma_f32_16x16x32_bf16 v[92:95], a[36:39], a[68:71], v[92:95]
ds_read_b128 a[100:103], v243 offset:44032
v_mfma_f32_16x16x32_bf16 v[92:95], a[32:35], a[64:67], v[92:95]
buffer_load_dwordx4 v244, s[16:19], s96 offen offset:3072 sc1 lds
v_mfma_f32_16x16x32_bf16 v[88:91], a[24:27], a[64:67], v[88:91]
ds_read_b128 a[104:107], v243 offset:45056
v_mfma_f32_16x16x32_bf16 v[88:91], a[28:31], a[68:71], v[88:91]
v_mfma_f32_16x16x32_bf16 v[84:87], a[20:23], a[68:71], v[84:87]
ds_read_b128 a[108:111], v243 offset:46080
s_add_u32 m0, s98, 8192
v_mfma_f32_16x16x32_bf16 v[84:87], a[16:19], a[64:67], v[84:87]
buffer_load_dwordx4 v244, s[16:19], s97 offen offset:0 sc1 lds
v_add_u32 v244, 2048, v244
v_mfma_f32_16x16x32_bf16 v[80:83], a[8:11], a[64:67], v[80:83]
v_mfma_f32_16x16x32_bf16 v[80:83], a[12:15], a[68:71], v[80:83]
v_mfma_f32_16x16x32_bf16 v[76:79], a[4:7], a[68:71], v[76:79]
v_mfma_f32_16x16x32_bf16 v[76:79], a[0:3], a[64:67], v[76:79]
s_waitcnt vmcnt(21) lgkmcnt(0)
s_barrier
v_mfma_f32_16x16x32_bf16 v[16:19], a[72:75], a[112:115], v[16:19]
ds_read_b128 a[40:43], v242 offset:0
v_mfma_f32_16x16x32_bf16 v[16:19], a[76:79], a[116:119], v[16:19]
v_mfma_f32_16x16x32_bf16 v[20:23], a[84:87], a[116:119], v[20:23]
ds_read_b128 a[0:3], v243 offset:0
s_add_u32 m0, s98, 110592
v_mfma_f32_16x16x32_bf16 v[20:23], a[80:83], a[112:115], v[20:23]
buffer_load_dwordx4 v244, s[16:19], s89 offen offset:0 sc1 lds
v_mfma_f32_16x16x32_bf16 v[24:27], a[88:91], a[112:115], v[24:27]
ds_read_b128 a[44:47], v242 offset:1024
v_mfma_f32_16x16x32_bf16 v[24:27], a[92:95], a[116:119], v[24:27]
v_mfma_f32_16x16x32_bf16 v[28:31], a[100:103], a[116:119], v[28:31]
ds_read_b128 a[4:7], v243 offset:1024
v_mfma_f32_16x16x32_bf16 v[28:31], a[96:99], a[112:115], v[28:31]
buffer_load_dwordx4 v244, s[16:19], s90 offen offset:1024 sc1 lds
v_mfma_f32_16x16x32_bf16 v[32:35], a[104:107], a[112:115], v[32:35]
ds_read_b128 a[48:51], v242 offset:2048
v_mfma_f32_16x16x32_bf16 v[32:35], a[108:111], a[116:119], v[32:35]
v_mfma_f32_16x16x32_bf16 v[52:55], a[108:111], a[124:127], v[52:55]
ds_read_b128 a[8:11], v243 offset:2048
v_mfma_f32_16x16x32_bf16 v[52:55], a[104:107], a[120:123], v[52:55]
buffer_load_dwordx4 v244, s[16:19], s91 offen offset:2048 sc1 lds
v_mfma_f32_16x16x32_bf16 v[48:51], a[96:99], a[120:123], v[48:51]
ds_read_b128 a[52:55], v242 offset:3072
v_mfma_f32_16x16x32_bf16 v[48:51], a[100:103], a[124:127], v[48:51]
v_mfma_f32_16x16x32_bf16 v[44:47], a[92:95], a[124:127], v[44:47]
ds_read_b128 a[12:15], v243 offset:3072
v_mfma_f32_16x16x32_bf16 v[44:47], a[88:91], a[120:123], v[44:47]
buffer_load_dwordx4 v244, s[16:19], s92 offen offset:3072 sc1 lds
v_mfma_f32_16x16x32_bf16 v[40:43], a[80:83], a[120:123], v[40:43]
ds_read_b128 a[56:59], v242 offset:4096
v_mfma_f32_16x16x32_bf16 v[40:43], a[84:87], a[124:127], v[40:43]
v_mfma_f32_16x16x32_bf16 v[36:39], a[76:79], a[124:127], v[36:39]
ds_read_b128 a[16:19], v243 offset:4096
s_add_u32 m0, s98, 114688
v_mfma_f32_16x16x32_bf16 v[36:39], a[72:75], a[120:123], v[36:39]
buffer_load_dwordx4 v244, s[16:19], s93 offen offset:0 sc1 lds
v_mfma_f32_16x16x32_bf16 v[56:59], a[72:75], a[128:131], v[56:59]
ds_read_b128 a[60:63], v242 offset:5120
v_mfma_f32_16x16x32_bf16 v[56:59], a[76:79], a[132:135], v[56:59]
v_mfma_f32_16x16x32_bf16 v[60:63], a[84:87], a[132:135], v[60:63]
ds_read_b128 a[20:23], v243 offset:5120
v_mfma_f32_16x16x32_bf16 v[60:63], a[80:83], a[128:131], v[60:63]
buffer_load_dwordx4 v244, s[16:19], s94 offen offset:1024 sc1 lds
v_mfma_f32_16x16x32_bf16 v[64:67], a[88:91], a[128:131], v[64:67]
ds_read_b128 a[64:67], v242 offset:6144
v_mfma_f32_16x16x32_bf16 v[64:67], a[92:95], a[132:135], v[64:67]
v_mfma_f32_16x16x32_bf16 v[68:71], a[100:103], a[132:135], v[68:71]
ds_read_b128 a[24:27], v243 offset:6144
v_mfma_f32_16x16x32_bf16 v[68:71], a[96:99], a[128:131], v[68:71]
buffer_load_dwordx4 v244, s[16:19], s95 offen offset:2048 sc1 lds
v_mfma_f32_16x16x32_bf16 v[72:75], a[104:107], a[128:131], v[72:75]
ds_read_b128 a[68:71], v242 offset:7168
v_mfma_f32_16x16x32_bf16 v[72:75], a[108:111], a[132:135], v[72:75]
v_mfma_f32_16x16x32_bf16 v[92:95], a[108:111], a[140:143], v[92:95]
ds_read_b128 a[28:31], v243 offset:7168
v_mfma_f32_16x16x32_bf16 v[92:95], a[104:107], a[136:139], v[92:95]
buffer_load_dwordx4 v244, s[16:19], s96 offen offset:3072 sc1 lds
v_mfma_f32_16x16x32_bf16 v[88:91], a[96:99], a[136:139], v[88:91]
ds_read_b128 a[32:35], v243 offset:8192
v_mfma_f32_16x16x32_bf16 v[88:91], a[100:103], a[140:143], v[88:91]
v_mfma_f32_16x16x32_bf16 v[84:87], a[92:95], a[140:143], v[84:87]
ds_read_b128 a[36:39], v243 offset:9216
s_add_u32 m0, s98, 118784
v_mfma_f32_16x16x32_bf16 v[84:87], a[88:91], a[136:139], v[84:87]
buffer_load_dwordx4 v244, s[16:19], s97 offen offset:0 sc1 lds
v_add_u32 v244, 2048, v244
v_mfma_f32_16x16x32_bf16 v[80:83], a[80:83], a[136:139], v[80:83]
v_mfma_f32_16x16x32_bf16 v[80:83], a[84:87], a[140:143], v[80:83]
v_mfma_f32_16x16x32_bf16 v[76:79], a[76:79], a[140:143], v[76:79]
v_mfma_f32_16x16x32_bf16 v[76:79], a[72:75], a[136:139], v[76:79]
s_waitcnt vmcnt(11)
s_waitcnt vmcnt(21) lgkmcnt(0)
s_barrier
v_mfma_f32_16x16x32_bf16 v[16:19], a[0:3], a[40:43], v[16:19]
ds_read_b128 a[112:115], v240 offset:36864
v_mfma_f32_16x16x32_bf16 v[16:19], a[4:7], a[44:47], v[16:19]
s_bitcmp1_b32 s58, 3
s_cbranch_scc1 Lsig_15
s_bitset1_b32 s58, 3
v_mov_b32 v222, s82
v_mov_b32 v221, s88
v_lshlrev_b32 v222, 7, v222
v_add_u32 v222, 14778368, v222
s_mov_b64 exec, 1
buffer_store_dword v221, v222, s[16:19], 0 offen sc1
s_mov_b64 exec, -1
Lsig_15:
v_mfma_f32_16x16x32_bf16 v[20:23], a[12:15], a[44:47], v[20:23]
ds_read_b128 a[72:75], v241 offset:36864
s_add_u32 m0, s98, 73728
v_mfma_f32_16x16x32_bf16 v[20:23], a[8:11], a[40:43], v[20:23]
buffer_load_dwordx4 v244, s[16:19], s89 offen offset:0 sc1 lds
v_mfma_f32_16x16x32_bf16 v[24:27], a[16:19], a[40:43], v[24:27]
ds_read_b128 a[116:119], v240 offset:37888
v_mfma_f32_16x16x32_bf16 v[24:27], a[20:23], a[44:47], v[24:27]
v_mfma_f32_16x16x32_bf16 v[28:31], a[28:31], a[44:47], v[28:31]
ds_read_b128 a[76:79], v241 offset:37888
v_mfma_f32_16x16x32_bf16 v[28:31], a[24:27], a[40:43], v[28:31]
buffer_load_dwordx4 v244, s[16:19], s90 offen offset:1024 sc1 lds
v_mfma_f32_16x16x32_bf16 v[32:35], a[32:35], a[40:43], v[32:35]
ds_read_b128 a[120:123], v240 offset:38912
v_mfma_f32_16x16x32_bf16 v[32:35], a[36:39], a[44:47], v[32:35]
v_mfma_f32_16x16x32_bf16 v[52:55], a[36:39], a[52:55], v[52:55]
ds_read_b128 a[80:83], v241 offset:38912
v_mfma_f32_16x16x32_bf16 v[52:55], a[32:35], a[48:51], v[52:55]
buffer_load_dwordx4 v244, s[16:19], s91 offen offset:2048 sc1 lds
v_mfma_f32_16x16x32_bf16 v[48:51], a[24:27], a[48:51], v[48:51]
ds_read_b128 a[124:127], v240 offset:39936
v_mfma_f32_16x16x32_bf16 v[48:51], a[28:31], a[52:55], v[48:51]
v_mfma_f32_16x16x32_bf16 v[44:47], a[20:23], a[52:55], v[44:47]
ds_read_b128 a[84:87], v241 offset:39936
v_mfma_f32_16x16x32_bf16 v[44:47], a[16:19], a[48:51], v[44:47]
buffer_load_dwordx4 v244, s[16:19], s92 offen offset:3072 sc1 lds
v_mfma_f32_16x16x32_bf16 v[40:43], a[8:11], a[48:51], v[40:43]
ds_read_b128 a[128:131], v240 offset:40960
v_mfma_f32_16x16x32_bf16 v[40:43], a[12:15], a[52:55], v[40:43]
v_mfma_f32_16x16x32_bf16 v[36:39], a[4:7], a[52:55], v[36:39]
ds_read_b128 a[88:91], v241 offset:40960
s_add_u32 m0, s98, 77824
v_mfma_f32_16x16x32_bf16 v[36:39], a[0:3], a[48:51], v[36:39]
buffer_load_dwordx4 v244, s[16:19], s93 offen offset:0 sc1 lds
v_mfma_f32_16x16x32_bf16 v[56:59], a[0:3], a[56:59], v[56:59]
ds_read_b128 a[132:135], v240 offset:41984
v_mfma_f32_16x16x32_bf16 v[56:59], a[4:7], a[60:63], v[56:59]
v_mfma_f32_16x16x32_bf16 v[60:63], a[12:15], a[60:63], v[60:63]
ds_read_b128 a[92:95], v241 offset:41984
v_mfma_f32_16x16x32_bf16 v[60:63], a[8:11], a[56:59], v[60:63]
buffer_load_dwordx4 v244, s[16:19], s94 offen offset:1024 sc1 lds
v_mfma_f32_16x16x32_bf16 v[64:67], a[16:19], a[56:59], v[64:67]
ds_read_b128 a[136:139], v240 offset:43008
v_mfma_f32_16x16x32_bf16 v[64:67], a[20:23], a[60:63], v[64:67]
v_mfma_f32_16x16x32_bf16 v[68:71], a[28:31], a[60:63], v[68:71]
ds_read_b128 a[96:99], v241 offset:43008
v_mfma_f32_16x16x32_bf16 v[68:71], a[24:27], a[56:59], v[68:71]
buffer_load_dwordx4 v244, s[16:19], s95 offen offset:2048 sc1 lds
v_mfma_f32_16x16x32_bf16 v[72:75], a[32:35], a[56:59], v[72:75]
ds_read_b128 a[140:143], v240 offset:44032
v_mfma_f32_16x16x32_bf16 v[72:75], a[36:39], a[60:63], v[72:75]
v_mfma_f32_16x16x32_bf16 v[92:95], a[36:39], a[68:71], v[92:95]
ds_read_b128 a[100:103], v241 offset:44032
v_mfma_f32_16x16x32_bf16 v[92:95], a[32:35], a[64:67], v[92:95]
buffer_load_dwordx4 v244, s[16:19], s96 offen offset:3072 sc1 lds
v_mfma_f32_16x16x32_bf16 v[88:91], a[24:27], a[64:67], v[88:91]
ds_read_b128 a[104:107], v241 offset:45056
v_mfma_f32_16x16x32_bf16 v[88:91], a[28:31], a[68:71], v[88:91]
v_mfma_f32_16x16x32_bf16 v[84:87], a[20:23], a[68:71], v[84:87]
ds_read_b128 a[108:111], v241 offset:46080
s_add_u32 m0, s98, 81920
v_mfma_f32_16x16x32_bf16 v[84:87], a[16:19], a[64:67], v[84:87]
buffer_load_dwordx4 v244, s[16:19], s97 offen offset:0 sc1 lds
v_add_u32 v244, 2048, v244
v_mfma_f32_16x16x32_bf16 v[80:83], a[8:11], a[64:67], v[80:83]
v_mfma_f32_16x16x32_bf16 v[80:83], a[12:15], a[68:71], v[80:83]
v_mfma_f32_16x16x32_bf16 v[76:79], a[4:7], a[68:71], v[76:79]
v_mfma_f32_16x16x32_bf16 v[76:79], a[0:3], a[64:67], v[76:79]
s_waitcnt vmcnt(18) lgkmcnt(0)
s_barrier
v_mfma_f32_16x16x32_bf16 v[16:19], a[72:75], a[112:115], v[16:19]
ds_read_b128 a[40:43], v240 offset:0
v_mfma_f32_16x16x32_bf16 v[16:19], a[76:79], a[116:119], v[16:19]
v_mfma_f32_16x16x32_bf16 v[20:23], a[84:87], a[116:119], v[20:23]
ds_read_b128 a[0:3], v241 offset:0
s_add_u32 m0, s98, 36864
v_mfma_f32_16x16x32_bf16 v[20:23], a[80:83], a[112:115], v[20:23]
buffer_load_dwordx4 v244, s[16:19], s89 offen offset:0 sc1 lds
v_mfma_f32_16x16x32_bf16 v[24:27], a[88:91], a[112:115], v[24:27]
ds_read_b128 a[44:47], v240 offset:1024
v_mfma_f32_16x16x32_bf16 v[24:27], a[92:95], a[116:119], v[24:27]
v_mfma_f32_16x16x32_bf16 v[28:31], a[100:103], a[116:119], v[28:31]
ds_read_b128 a[4:7], v241 offset:1024
v_mfma_f32_16x16x32_bf16 v[28:31], a[96:99], a[112:115], v[28:31]
buffer_load_dwordx4 v244, s[16:19], s90 offen offset:1024 sc1 lds
v_mfma_f32_16x16x32_bf16 v[32:35], a[104:107], a[112:115], v[32:35]
ds_read_b128 a[48:51], v240 offset:2048
v_mfma_f32_16x16x32_bf16 v[32:35], a[108:111], a[116:119], v[32:35]
v_mfma_f32_16x16x32_bf16 v[52:55], a[108:111], a[124:127], v[52:55]
ds_read_b128 a[8:11], v241 offset:2048
v_mfma_f32_16x16x32_bf16 v[52:55], a[104:107], a[120:123], v[52:55]
buffer_load_dwordx4 v244, s[16:19], s91 offen offset:2048 sc1 lds
v_mfma_f32_16x16x32_bf16 v[48:51], a[96:99], a[120:123], v[48:51]
ds_read_b128 a[52:55], v240 offset:3072
v_mfma_f32_16x16x32_bf16 v[48:51], a[100:103], a[124:127], v[48:51]
v_mfma_f32_16x16x32_bf16 v[44:47], a[92:95], a[124:127], v[44:47]
ds_read_b128 a[12:15], v241 offset:3072
v_mfma_f32_16x16x32_bf16 v[44:47], a[88:91], a[120:123], v[44:47]
buffer_load_dwordx4 v244, s[16:19], s92 offen offset:3072 sc1 lds
v_mfma_f32_16x16x32_bf16 v[40:43], a[80:83], a[120:123], v[40:43]
ds_read_b128 a[56:59], v240 offset:4096
v_mfma_f32_16x16x32_bf16 v[40:43], a[84:87], a[124:127], v[40:43]
v_mfma_f32_16x16x32_bf16 v[36:39], a[76:79], a[124:127], v[36:39]
ds_read_b128 a[16:19], v241 offset:4096
s_add_u32 m0, s98, 40960
v_mfma_f32_16x16x32_bf16 v[36:39], a[72:75], a[120:123], v[36:39]
buffer_load_dwordx4 v244, s[16:19], s93 offen offset:0 sc1 lds
v_mfma_f32_16x16x32_bf16 v[56:59], a[72:75], a[128:131], v[56:59]
ds_read_b128 a[60:63], v240 offset:5120
v_mfma_f32_16x16x32_bf16 v[56:59], a[76:79], a[132:135], v[56:59]
v_mfma_f32_16x16x32_bf16 v[60:63], a[84:87], a[132:135], v[60:63]
ds_read_b128 a[20:23], v241 offset:5120
v_mfma_f32_16x16x32_bf16 v[60:63], a[80:83], a[128:131], v[60:63]
buffer_load_dwordx4 v244, s[16:19], s94 offen offset:1024 sc1 lds
v_mfma_f32_16x16x32_bf16 v[64:67], a[88:91], a[128:131], v[64:67]
ds_read_b128 a[64:67], v240 offset:6144
v_mfma_f32_16x16x32_bf16 v[64:67], a[92:95], a[132:135], v[64:67]
v_mfma_f32_16x16x32_bf16 v[68:71], a[100:103], a[132:135], v[68:71]
ds_read_b128 a[24:27], v241 offset:6144
v_mfma_f32_16x16x32_bf16 v[68:71], a[96:99], a[128:131], v[68:71]
buffer_load_dwordx4 v244, s[16:19], s95 offen offset:2048 sc1 lds
v_mfma_f32_16x16x32_bf16 v[72:75], a[104:107], a[128:131], v[72:75]
ds_read_b128 a[68:71], v240 offset:7168
v_mfma_f32_16x16x32_bf16 v[72:75], a[108:111], a[132:135], v[72:75]
v_mfma_f32_16x16x32_bf16 v[92:95], a[108:111], a[140:143], v[92:95]
ds_read_b128 a[28:31], v241 offset:7168
v_mfma_f32_16x16x32_bf16 v[92:95], a[104:107], a[136:139], v[92:95]
buffer_load_dwordx4 v244, s[16:19], s96 offen offset:3072 sc1 lds
v_mfma_f32_16x16x32_bf16 v[88:91], a[96:99], a[136:139], v[88:91]
ds_read_b128 a[32:35], v241 offset:8192
v_mfma_f32_16x16x32_bf16 v[88:91], a[100:103], a[140:143], v[88:91]
v_mfma_f32_16x16x32_bf16 v[84:87], a[92:95], a[140:143], v[84:87]
ds_read_b128 a[36:39], v241 offset:9216
s_add_u32 m0, s98, 45056
v_mfma_f32_16x16x32_bf16 v[84:87], a[88:91], a[136:139], v[84:87]
buffer_load_dwordx4 v244, s[16:19], s97 offen offset:0 sc1 lds
v_add_u32 v244, 2048, v244
v_mfma_f32_16x16x32_bf16 v[80:83], a[80:83], a[136:139], v[80:83]
v_mfma_f32_16x16x32_bf16 v[80:83], a[84:87], a[140:143], v[80:83]
v_mfma_f32_16x16x32_bf16 v[76:79], a[76:79], a[140:143], v[76:79]
v_mfma_f32_16x16x32_bf16 v[76:79], a[72:75], a[136:139], v[76:79]
s_waitcnt vmcnt(18) lgkmcnt(0)
s_barrier
v_mfma_f32_16x16x32_bf16 v[16:19], a[0:3], a[40:43], v[16:19]
ds_read_b128 a[112:115], v242 offset:36864
v_lshrrev_b32 v216, 3, v1
v_mfma_f32_16x16x32_bf16 v[16:19], a[4:7], a[44:47], v[16:19]
v_mfma_f32_16x16x32_bf16 v[20:23], a[12:15], a[44:47], v[20:23]
ds_read_b128 a[72:75], v243 offset:36864
s_add_u32 m0, s98, 0
v_and_b32 v217, 7, v1
v_mfma_f32_16x16x32_bf16 v[20:23], a[8:11], a[40:43], v[20:23]
buffer_load_dwordx4 v244, s[16:19], s89 offen offset:0 sc1 lds
v_mfma_f32_16x16x32_bf16 v[24:27], a[16:19], a[40:43], v[24:27]
ds_read_b128 a[116:119], v242 offset:37888
v_and_b32 v3, 6, v216
v_mfma_f32_16x16x32_bf16 v[24:27], a[20:23], a[44:47], v[24:27]
v_mfma_f32_16x16x32_bf16 v[28:31], a[28:31], a[44:47], v[28:31]
ds_read_b128 a[76:79], v243 offset:37888
v_xor_b32 v217, v217, v3
v_mfma_f32_16x16x32_bf16 v[28:31], a[24:27], a[40:43], v[28:31]
buffer_load_dwordx4 v244, s[16:19], s90 offen offset:1024 sc1 lds
v_mfma_f32_16x16x32_bf16 v[32:35], a[32:35], a[40:43], v[32:35]
ds_read_b128 a[120:123], v242 offset:38912
v_lshlrev_b32 v216, 12, v216
v_mfma_f32_16x16x32_bf16 v[32:35], a[36:39], a[44:47], v[32:35]
v_mfma_f32_16x16x32_bf16 v[52:55], a[36:39], a[52:55], v[52:55]
ds_read_b128 a[80:83], v243 offset:38912
v_lshl_add_u32 v3, v217, 4, v216
v_mfma_f32_16x16x32_bf16 v[52:55], a[32:35], a[48:51], v[52:55]
buffer_load_dwordx4 v244, s[16:19], s91 offen offset:2048 sc1 lds
v_mfma_f32_16x16x32_bf16 v[48:51], a[24:27], a[48:51], v[48:51]
ds_read_b128 a[124:127], v242 offset:39936
v_lshrrev_b32 v216, 2, v1
v_mfma_f32_16x16x32_bf16 v[48:51], a[28:31], a[52:55], v[48:51]
v_mfma_f32_16x16x32_bf16 v[44:47], a[20:23], a[52:55], v[44:47]
ds_read_b128 a[84:87], v243 offset:39936
v_and_b32 v8, 6, v216
v_mfma_f32_16x16x32_bf16 v[44:47], a[16:19], a[48:51], v[44:47]
buffer_load_dwordx4 v244, s[16:19], s92 offen offset:3072 sc1 lds
v_mfma_f32_16x16x32_bf16 v[40:43], a[8:11], a[48:51], v[40:43]
ds_read_b128 a[128:131], v242 offset:40960
v_bfe_u32 v217, v1, 1, 1
v_mfma_f32_16x16x32_bf16 v[40:43], a[12:15], a[52:55], v[40:43]
v_mfma_f32_16x16x32_bf16 v[36:39], a[4:7], a[52:55], v[36:39]
K_pg11:
s_cbranch_execz K_pg14
ds_read_b128 a[88:91], v243 offset:40960
s_add_u32 m0, s98, 4096
v_xor_b32 v217, v217, v8
v_mfma_f32_16x16x32_bf16 v[36:39], a[0:3], a[48:51], v[36:39]
buffer_load_dwordx4 v244, s[16:19], s93 offen offset:0 sc1 lds
v_mfma_f32_16x16x32_bf16 v[56:59], a[0:3], a[56:59], v[56:59]
ds_read_b128 a[132:135], v242 offset:41984
v_lshlrev_b32 v217, 4, v217
v_mfma_f32_16x16x32_bf16 v[56:59], a[4:7], a[60:63], v[56:59]
v_mfma_f32_16x16x32_bf16 v[60:63], a[12:15], a[60:63], v[60:63]
ds_read_b128 a[92:95], v243 offset:41984
v_lshl_add_u32 v217, v216, 7, v217
v_mfma_f32_16x16x32_bf16 v[60:63], a[8:11], a[56:59], v[60:63]
buffer_load_dwordx4 v244, s[16:19], s94 offen offset:1024 sc1 lds
v_mfma_f32_16x16x32_bf16 v[64:67], a[16:19], a[56:59], v[64:67]
ds_read_b128 a[136:139], v242 offset:43008
v_and_b32 v216, 1, v1
v_mfma_f32_16x16x32_bf16 v[64:67], a[20:23], a[60:63], v[64:67]
v_mfma_f32_16x16x32_bf16 v[68:71], a[28:31], a[60:63], v[68:71]
ds_read_b128 a[96:99], v243 offset:43008
v_lshl_add_u32 v217, v216, 3, v217
v_mfma_f32_16x16x32_bf16 v[68:71], a[24:27], a[56:59], v[68:71]
buffer_load_dwordx4 v244, s[16:19], s95 offen offset:2048 sc1 lds
v_mfma_f32_16x16x32_bf16 v[72:75], a[32:35], a[56:59], v[72:75]
ds_read_b128 a[140:143], v242 offset:44032
s_lshl_b32 s40, s44, 13
v_mfma_f32_16x16x32_bf16 v[72:75], a[36:39], a[60:63], v[72:75]
v_mfma_f32_16x16x32_bf16 v[92:95], a[36:39], a[68:71], v[92:95]
ds_read_b128 a[100:103], v243 offset:44032
v_mfma_f32_16x16x32_bf16 v[92:95], a[32:35], a[64:67], v[92:95]
buffer_load_dwordx4 v244, s[16:19], s96 offen offset:3072 sc1 lds
v_mfma_f32_16x16x32_bf16 v[88:91], a[24:27], a[64:67], v[88:91]
ds_read_b128 a[104:107], v243 offset:45056
v_mfma_f32_16x16x32_bf16 v[88:91], a[28:31], a[68:71], v[88:91]
v_mfma_f32_16x16x32_bf16 v[84:87], a[20:23], a[68:71], v[84:87]
ds_read_b128 a[108:111], v243 offset:46080
s_add_u32 m0, s98, 8192
v_mfma_f32_16x16x32_bf16 v[84:87], a[16:19], a[64:67], v[84:87]
buffer_load_dwordx4 v244, s[16:19], s97 offen offset:0 sc1 lds
v_add_u32 v244, 2048, v244
v_mfma_f32_16x16x32_bf16 v[80:83], a[8:11], a[64:67], v[80:83]
v_mfma_f32_16x16x32_bf16 v[80:83], a[12:15], a[68:71], v[80:83]
v_mfma_f32_16x16x32_bf16 v[76:79], a[4:7], a[68:71], v[76:79]
v_mfma_f32_16x16x32_bf16 v[76:79], a[0:3], a[64:67], v[76:79]
s_waitcnt vmcnt(18) lgkmcnt(0)
s_barrier
v_mfma_f32_16x16x32_bf16 v[16:19], a[72:75], a[112:115], v[16:19]
ds_read_b128 a[40:43], v242 offset:0
v_add_u32 v217, s40, v217
v_mfma_f32_16x16x32_bf16 v[16:19], a[76:79], a[116:119], v[16:19]
v_mfma_f32_16x16x32_bf16 v[20:23], a[84:87], a[116:119], v[20:23]
ds_read_b128 a[0:3], v243 offset:0
s_add_u32 m0, s98, 110592
v_add_u32 v217, 73728, v217
v_mfma_f32_16x16x32_bf16 v[20:23], a[80:83], a[112:115], v[20:23]
buffer_load_dwordx4 v244, s[16:19], s89 offen offset:0 sc1 lds
v_mfma_f32_16x16x32_bf16 v[24:27], a[88:91], a[112:115], v[24:27]
ds_read_b128 a[44:47], v242 offset:1024
v_lshlrev_b32 v12, 3, v1
v_mfma_f32_16x16x32_bf16 v[24:27], a[92:95], a[116:119], v[24:27]
v_mfma_f32_16x16x32_bf16 v[28:31], a[100:103], a[116:119], v[28:31]
ds_read_b128 a[4:7], v243 offset:1024
s_mul_i32 s52, s44, 1835008
v_mfma_f32_16x16x32_bf16 v[28:31], a[96:99], a[112:115], v[28:31]
buffer_load_dwordx4 v244, s[16:19], s90 offen offset:1024 sc1 lds
v_mfma_f32_16x16x32_bf16 v[32:35], a[104:107], a[112:115], v[32:35]
ds_read_b128 a[48:51], v242 offset:2048
s_lshl_b32 s46, s41, 7
v_mfma_f32_16x16x32_bf16 v[32:35], a[108:111], a[116:119], v[32:35]
v_mfma_f32_16x16x32_bf16 v[52:55], a[108:111], a[124:127], v[52:55]
ds_read_b128 a[8:11], v243 offset:2048
s_add_u32 s52, s52, s46
v_mfma_f32_16x16x32_bf16 v[52:55], a[104:107], a[120:123], v[52:55]
buffer_load_dwordx4 v244, s[16:19], s91 offen offset:2048 sc1 lds
v_mfma_f32_16x16x32_bf16 v[48:51], a[96:99], a[120:123], v[48:51]
ds_read_b128 a[52:55], v242 offset:3072
s_mul_i32 s53, s42, 276480
v_mfma_f32_16x16x32_bf16 v[48:51], a[100:103], a[124:127], v[48:51]
v_mfma_f32_16x16x32_bf16 v[44:47], a[92:95], a[124:127], v[44:47]
ds_read_b128 a[12:15], v243 offset:3072
s_mul_i32 s46, s44, 14336
v_mfma_f32_16x16x32_bf16 v[44:47], a[88:91], a[120:123], v[44:47]
buffer_load_dwordx4 v244, s[16:19], s92 offen offset:3072 sc1 lds
v_mfma_f32_16x16x32_bf16 v[40:43], a[80:83], a[120:123], v[40:43]
ds_read_b128 a[56:59], v242 offset:4096
s_add_u32 s53, s53, s46
v_mfma_f32_16x16x32_bf16 v[40:43], a[84:87], a[124:127], v[40:43]
v_mfma_f32_16x16x32_bf16 v[36:39], a[76:79], a[124:127], v[36:39]
ds_read_b128 a[16:19], v243 offset:4096
s_add_u32 m0, s98, 114688
s_add_u32 s46, s44, 0
v_mfma_f32_16x16x32_bf16 v[36:39], a[72:75], a[120:123], v[36:39]
buffer_load_dwordx4 v244, s[16:19], s93 offen offset:0 sc1 lds
v_mfma_f32_16x16x32_bf16 v[56:59], a[72:75], a[128:131], v[56:59]
ds_read_b128 a[60:63], v242 offset:5120
s_and_b32 s46, s46, 3
v_mfma_f32_16x16x32_bf16 v[56:59], a[76:79], a[132:135], v[56:59]
v_mfma_f32_16x16x32_bf16 v[60:63], a[84:87], a[132:135], v[60:63]
ds_read_b128 a[20:23], v243 offset:5120
s_lshl_b32 s46, s46, 5
v_mfma_f32_16x16x32_bf16 v[60:63], a[80:83], a[128:131], v[60:63]
buffer_load_dwordx4 v244, s[16:19], s94 offen offset:1024 sc1 lds
v_mfma_f32_16x16x32_bf16 v[64:67], a[88:91], a[128:131], v[64:67]
ds_read_b128 a[64:67], v242 offset:6144
v_xor_b32 v4, s46, v217
v_mfma_f32_16x16x32_bf16 v[64:67], a[92:95], a[132:135], v[64:67]
v_mfma_f32_16x16x32_bf16 v[68:71], a[100:103], a[132:135], v[68:71]
ds_read_b128 a[24:27], v243 offset:6144
v_add_u32 v8, -73728, v4
v_mfma_f32_16x16x32_bf16 v[68:71], a[96:99], a[128:131], v[68:71]
buffer_load_dwordx4 v244, s[16:19], s95 offen offset:2048 sc1 lds
v_mfma_f32_16x16x32_bf16 v[72:75], a[104:107], a[128:131], v[72:75]
ds_read_b128 a[68:71], v242 offset:7168
s_add_u32 s46, s44, 1
v_mfma_f32_16x16x32_bf16 v[72:75], a[108:111], a[132:135], v[72:75]
v_mfma_f32_16x16x32_bf16 v[92:95], a[108:111], a[140:143], v[92:95]
ds_read_b128 a[28:31], v243 offset:7168
v_mfma_f32_16x16x32_bf16 v[92:95], a[104:107], a[136:139], v[92:95]
buffer_load_dwordx4 v244, s[16:19], s96 offen offset:3072 sc1 lds
v_mfma_f32_16x16x32_bf16 v[88:91], a[96:99], a[136:139], v[88:91]
ds_read_b128 a[32:35], v243 offset:8192
v_mfma_f32_16x16x32_bf16 v[88:91], a[100:103], a[140:143], v[88:91]
v_mfma_f32_16x16x32_bf16 v[84:87], a[92:95], a[140:143], v[84:87]
ds_read_b128 a[36:39], v243 offset:9216
s_add_u32 m0, s98, 118784
v_mfma_f32_16x16x32_bf16 v[84:87], a[88:91], a[136:139], v[84:87]
buffer_load_dwordx4 v244, s[16:19], s97 offen offset:0 sc1 lds
v_add_u32 v244, 2048, v244
v_mfma_f32_16x16x32_bf16 v[80:83], a[80:83], a[136:139], v[80:83]
v_mfma_f32_16x16x32_bf16 v[80:83], a[84:87], a[140:143], v[80:83]
v_mfma_f32_16x16x32_bf16 v[76:79], a[76:79], a[140:143], v[76:79]
v_mfma_f32_16x16x32_bf16 v[76:79], a[72:75], a[136:139], v[76:79]
s_waitcnt vmcnt(18) lgkmcnt(0)
s_barrier
v_mfma_f32_16x16x32_bf16 v[16:19], a[0:3], a[40:43], v[16:19]
ds_read_b128 a[112:115], v240 offset:36864
s_and_b32 s46, s46, 3
v_mfma_f32_16x16x32_bf16 v[16:19], a[4:7], a[44:47], v[16:19]
v_mfma_f32_16x16x32_bf16 v[20:23], a[12:15], a[44:47], v[20:23]
ds_read_b128 a[72:75], v241 offset:36864
s_add_u32 m0, s98, 73728
s_lshl_b32 s46, s46, 5
v_mfma_f32_16x16x32_bf16 v[20:23], a[8:11], a[40:43], v[20:23]
buffer_load_dwordx4 v244, s[16:19], s89 offen offset:0 sc1 lds
v_mfma_f32_16x16x32_bf16 v[24:27], a[16:19], a[40:43], v[24:27]
ds_read_b128 a[116:119], v240 offset:37888
v_xor_b32 v5, s46, v217
v_mfma_f32_16x16x32_bf16 v[24:27], a[20:23], a[44:47], v[24:27]
v_mfma_f32_16x16x32_bf16 v[28:31], a[28:31], a[44:47], v[28:31]
ds_read_b128 a[76:79], v241 offset:37888
v_add_u32 v9, -73728, v5
v_mfma_f32_16x16x32_bf16 v[28:31], a[24:27], a[40:43], v[28:31]
buffer_load_dwordx4 v244, s[16:19], s90 offen offset:1024 sc1 lds
v_mfma_f32_16x16x32_bf16 v[32:35], a[32:35], a[40:43], v[32:35]
ds_read_b128 a[120:123], v240 offset:38912
s_add_u32 s46, s44, 2
v_mfma_f32_16x16x32_bf16 v[32:35], a[36:39], a[44:47], v[32:35]
v_mfma_f32_16x16x32_bf16 v[52:55], a[36:39], a[52:55], v[52:55]
ds_read_b128 a[80:83], v241 offset:38912
s_and_b32 s46, s46, 3
v_mfma_f32_16x16x32_bf16 v[52:55], a[32:35], a[48:51], v[52:55]
buffer_load_dwordx4 v244, s[16:19], s91 offen offset:2048 sc1 lds
v_mfma_f32_16x16x32_bf16 v[48:51], a[24:27], a[48:51], v[48:51]
ds_read_b128 a[124:127], v240 offset:39936
s_lshl_b32 s46, s46, 5
v_mfma_f32_16x16x32_bf16 v[48:51], a[28:31], a[52:55], v[48:51]
v_mfma_f32_16x16x32_bf16 v[44:47], a[20:23], a[52:55], v[44:47]
ds_read_b128 a[84:87], v241 offset:39936
v_xor_b32 v6, s46, v217
v_mfma_f32_16x16x32_bf16 v[44:47], a[16:19], a[48:51], v[44:47]
buffer_load_dwordx4 v244, s[16:19], s92 offen offset:3072 sc1 lds
v_mfma_f32_16x16x32_bf16 v[40:43], a[8:11], a[48:51], v[40:43]
ds_read_b128 a[128:131], v240 offset:40960
v_add_u32 v10, -73728, v6
v_mfma_f32_16x16x32_bf16 v[40:43], a[12:15], a[52:55], v[40:43]
v_mfma_f32_16x16x32_bf16 v[36:39], a[4:7], a[52:55], v[36:39]
ds_read_b128 a[88:91], v241 offset:40960
s_add_u32 m0, s98, 77824
s_add_u32 s46, s44, 3
v_mfma_f32_16x16x32_bf16 v[36:39], a[0:3], a[48:51], v[36:39]
buffer_load_dwordx4 v244, s[16:19], s93 offen offset:0 sc1 lds
v_mfma_f32_16x16x32_bf16 v[56:59], a[0:3], a[56:59], v[56:59]
ds_read_b128 a[132:135], v240 offset:41984
s_and_b32 s46, s46, 3
v_mfma_f32_16x16x32_bf16 v[56:59], a[4:7], a[60:63], v[56:59]
v_mfma_f32_16x16x32_bf16 v[60:63], a[12:15], a[60:63], v[60:63]
ds_read_b128 a[92:95], v241 offset:41984
s_lshl_b32 s46, s46, 5
v_mfma_f32_16x16x32_bf16 v[60:63], a[8:11], a[56:59], v[60:63]
buffer_load_dwordx4 v244, s[16:19], s94 offen offset:1024 sc1 lds
v_mfma_f32_16x16x32_bf16 v[64:67], a[16:19], a[56:59], v[64:67]
ds_read_b128 a[136:139], v240 offset:43008
v_xor_b32 v7, s46, v217
v_mfma_f32_16x16x32_bf16 v[64:67], a[20:23], a[60:63], v[64:67]
v_mfma_f32_16x16x32_bf16 v[68:71], a[28:31], a[60:63], v[68:71]
ds_read_b128 a[96:99], v241 offset:43008
v_add_u32 v11, -73728, v7
v_mfma_f32_16x16x32_bf16 v[68:71], a[24:27], a[56:59], v[68:71]
buffer_load_dwordx4 v244, s[16:19], s95 offen offset:2048 sc1 lds
v_mfma_f32_16x16x32_bf16 v[72:75], a[32:35], a[56:59], v[72:75]
ds_read_b128 a[140:143], v240 offset:44032
s_and_b32 s46, s99, 0xfc
v_mfma_f32_16x16x32_bf16 v[72:75], a[36:39], a[60:63], v[72:75]
v_mfma_f32_16x16x32_bf16 v[92:95], a[36:39], a[68:71], v[92:95]
ds_read_b128 a[100:103], v241 offset:44032
v_mfma_f32_16x16x32_bf16 v[92:95], a[32:35], a[64:67], v[92:95]
buffer_load_dwordx4 v244, s[16:19], s96 offen offset:3072 sc1 lds
v_mfma_f32_16x16x32_bf16 v[88:91], a[24:27], a[64:67], v[88:91]
ds_read_b128 a[104:107], v241 offset:45056
v_mfma_f32_16x16x32_bf16 v[88:91], a[28:31], a[68:71], v[88:91]
v_mfma_f32_16x16x32_bf16 v[84:87], a[20:23], a[68:71], v[84:87]
ds_read_b128 a[108:111], v241 offset:46080
s_add_u32 m0, s98, 81920
v_mfma_f32_16x16x32_bf16 v[84:87], a[16:19], a[64:67], v[84:87]
buffer_load_dwordx4 v244, s[16:19], s97 offen offset:0 sc1 lds
v_add_u32 v244, 2048, v244
v_mfma_f32_16x16x32_bf16 v[80:83], a[8:11], a[64:67], v[80:83]
v_mfma_f32_16x16x32_bf16 v[80:83], a[12:15], a[68:71], v[80:83]
v_mfma_f32_16x16x32_bf16 v[76:79], a[4:7], a[68:71], v[76:79]
v_mfma_f32_16x16x32_bf16 v[76:79], a[0:3], a[64:67], v[76:79]
s_waitcnt vmcnt(18) lgkmcnt(0)
s_barrier
v_mfma_f32_16x16x32_bf16 v[16:19], a[72:75], a[112:115], v[16:19]
ds_read_b128 a[40:43], v240 offset:0
s_add_u32 s46, s46, s44
v_mfma_f32_16x16x32_bf16 v[16:19], a[76:79], a[116:119], v[16:19]
v_min_u32 v221, 26, v1
v_mfma_f32_16x16x32_bf16 v[20:23], a[84:87], a[116:119], v[20:23]
ds_read_b128 a[0:3], v241 offset:0
s_add_u32 m0, s98, 36864
s_lshl_b32 s46, s46, 2
v_mfma_f32_16x16x32_bf16 v[20:23], a[80:83], a[112:115], v[20:23]
buffer_load_dwordx4 v244, s[16:19], s89 offen offset:0 sc1 lds
v_mfma_f32_16x16x32_bf16 v[24:27], a[88:91], a[112:115], v[24:27]
ds_read_b128 a[44:47], v240 offset:1024
s_add_u32 s46, s46, s100
v_mfma_f32_16x16x32_bf16 v[24:27], a[92:95], a[116:119], v[24:27]
v_lshlrev_b32 v221, 7, v221
v_mfma_f32_16x16x32_bf16 v[28:31], a[100:103], a[116:119], v[28:31]
ds_read_b128 a[4:7], v241 offset:1024
s_mul_i32 s54, s46, 10240
v_mfma_f32_16x16x32_bf16 v[28:31], a[96:99], a[112:115], v[28:31]
buffer_load_dwordx4 v244, s[16:19], s90 offen offset:1024 sc1 lds
v_mfma_f32_16x16x32_bf16 v[32:35], a[104:107], a[112:115], v[32:35]
ds_read_b128 a[48:51], v240 offset:2048
s_add_u32 s54, s54, 37748736
v_mfma_f32_16x16x32_bf16 v[32:35], a[108:111], a[116:119], v[32:35]
s_lshl_b32 s56, s42, 12
v_mfma_f32_16x16x32_bf16 v[52:55], a[108:111], a[124:127], v[52:55]
ds_read_b128 a[8:11], v241 offset:2048
s_mul_i32 s55, s99, 40960
v_mfma_f32_16x16x32_bf16 v[52:55], a[104:107], a[120:123], v[52:55]
buffer_load_dwordx4 v244, s[16:19], s91 offen offset:2048 sc1 lds
v_mfma_f32_16x16x32_bf16 v[48:51], a[96:99], a[120:123], v[48:51]
ds_read_b128 a[52:55], v240 offset:3072
s_mul_i32 s46, s44, 2560
v_mfma_f32_16x16x32_bf16 v[48:51], a[100:103], a[124:127], v[48:51]
s_add_u32 s56, s56, 14778368
v_mfma_f32_16x16x32_bf16 v[44:47], a[92:95], a[124:127], v[44:47]
ds_read_b128 a[12:15], v241 offset:3072
s_add_u32 s55, s55, s46
v_mfma_f32_16x16x32_bf16 v[44:47], a[88:91], a[120:123], v[44:47]
buffer_load_dwordx4 v244, s[16:19], s92 offen offset:3072 sc1 lds
v_mfma_f32_16x16x32_bf16 v[40:43], a[80:83], a[120:123], v[40:43]
ds_read_b128 a[56:59], v240 offset:4096
s_add_u32 s55, s55, 37748736
v_mfma_f32_16x16x32_bf16 v[40:43], a[84:87], a[124:127], v[40:43]
v_add_u32 v221, s56, v221
v_mfma_f32_16x16x32_bf16 v[36:39], a[76:79], a[124:127], v[36:39]
ds_read_b128 a[16:19], v241 offset:4096
s_add_u32 m0, s98, 40960
s_mov_b32 s76, 0xbfb8aa3b
v_mfma_f32_16x16x32_bf16 v[36:39], a[72:75], a[120:123], v[36:39]
buffer_load_dwordx4 v244, s[16:19], s93 offen offset:0 sc1 lds
v_mfma_f32_16x16x32_bf16 v[56:59], a[72:75], a[128:131], v[56:59]
ds_read_b128 a[60:63], v240 offset:5120
v_add_u32 v13, 147456, v15
v_mfma_f32_16x16x32_bf16 v[56:59], a[76:79], a[132:135], v[56:59]
v_mfma_f32_16x16x32_bf16 v[60:63], a[84:87], a[132:135], v[60:63]
ds_read_b128 a[20:23], v241 offset:5120
v_add_u32 v223, 147456, v12
v_mfma_f32_16x16x32_bf16 v[60:63], a[80:83], a[128:131], v[60:63]
buffer_load_dwordx4 v244, s[16:19], s94 offen offset:1024 sc1 lds
v_mfma_f32_16x16x32_bf16 v[64:67], a[88:91], a[128:131], v[64:67]
ds_read_b128 a[64:67], v240 offset:6144
v_mfma_f32_16x16x32_bf16 v[64:67], a[92:95], a[132:135], v[64:67]
v_mfma_f32_16x16x32_bf16 v[68:71], a[100:103], a[132:135], v[68:71]
ds_read_b128 a[24:27], v241 offset:6144
v_mfma_f32_16x16x32_bf16 v[68:71], a[96:99], a[128:131], v[68:71]
buffer_load_dwordx4 v244, s[16:19], s95 offen offset:2048 sc1 lds
v_mfma_f32_16x16x32_bf16 v[72:75], a[104:107], a[128:131], v[72:75]
ds_read_b128 a[68:71], v240 offset:7168
v_mfma_f32_16x16x32_bf16 v[72:75], a[108:111], a[132:135], v[72:75]
v_mfma_f32_16x16x32_bf16 v[92:95], a[108:111], a[140:143], v[92:95]
ds_read_b128 a[28:31], v241 offset:7168
v_mfma_f32_16x16x32_bf16 v[92:95], a[104:107], a[136:139], v[92:95]
buffer_load_dwordx4 v244, s[16:19], s96 offen offset:3072 sc1 lds
v_mfma_f32_16x16x32_bf16 v[88:91], a[96:99], a[136:139], v[88:91]
ds_read_b128 a[32:35], v241 offset:8192
v_mfma_f32_16x16x32_bf16 v[88:91], a[100:103], a[140:143], v[88:91]
v_mfma_f32_16x16x32_bf16 v[84:87], a[92:95], a[140:143], v[84:87]
ds_read_b128 a[36:39], v241 offset:9216
s_add_u32 m0, s98, 45056
v_mfma_f32_16x16x32_bf16 v[84:87], a[88:91], a[136:139], v[84:87]
buffer_load_dwordx4 v244, s[16:19], s97 offen offset:0 sc1 lds
v_add_u32 v244, 2048, v244
v_mfma_f32_16x16x32_bf16 v[80:83], a[80:83], a[136:139], v[80:83]
v_mfma_f32_16x16x32_bf16 v[80:83], a[84:87], a[140:143], v[80:83]
v_mfma_f32_16x16x32_bf16 v[76:79], a[76:79], a[140:143], v[76:79]
v_mfma_f32_16x16x32_bf16 v[76:79], a[72:75], a[136:139], v[76:79]
s_waitcnt vmcnt(18) lgkmcnt(0)
s_barrier
v_mfma_f32_16x16x32_bf16 v[16:19], a[0:3], a[40:43], v[16:19]
ds_read_b128 a[112:115], v242 offset:36864
v_mfma_f32_16x16x32_bf16 v[16:19], a[4:7], a[44:47], v[16:19]
buffer_load_dword v222, v221, s[16:19], 0 offen sc1
v_mfma_f32_16x16x32_bf16 v[20:23], a[12:15], a[44:47], v[20:23]
ds_read_b128 a[72:75], v243 offset:36864
v_mfma_f32_16x16x32_bf16 v[20:23], a[8:11], a[40:43], v[20:23]
s_add_u32 m0, s40, 0
s_add_u32 s46, s52, 0
buffer_load_dwordx4 v3, s[28:31], s46 offen offset:0 lds
v_mfma_f32_16x16x32_bf16 v[24:27], a[16:19], a[40:43], v[24:27]
ds_read_b128 a[116:119], v242 offset:37888
v_mfma_f32_16x16x32_bf16 v[24:27], a[20:23], a[44:47], v[24:27]
v_mfma_f32_16x16x32_bf16 v[28:31], a[28:31], a[44:47], v[28:31]
ds_read_b128 a[76:79], v243 offset:37888
v_mfma_f32_16x16x32_bf16 v[28:31], a[24:27], a[40:43], v[28:31]
s_add_u32 s46, s52, 31744
buffer_load_dwordx4 v3, s[28:31], s46 offen offset:1024 lds
v_mfma_f32_16x16x32_bf16 v[32:35], a[32:35], a[40:43], v[32:35]
ds_read_b128 a[120:123], v242 offset:38912
v_mfma_f32_16x16x32_bf16 v[32:35], a[36:39], a[44:47], v[32:35]
v_mfma_f32_16x16x32_bf16 v[52:55], a[36:39], a[52:55], v[52:55]
ds_read_b128 a[80:83], v243 offset:38912
v_mfma_f32_16x16x32_bf16 v[52:55], a[32:35], a[48:51], v[52:55]
s_add_u32 s46, s52, 63488
buffer_load_dwordx4 v3, s[28:31], s46 offen offset:2048 lds
v_mfma_f32_16x16x32_bf16 v[48:51], a[24:27], a[48:51], v[48:51]
ds_read_b128 a[124:127], v242 offset:39936
v_mfma_f32_16x16x32_bf16 v[48:51], a[28:31], a[52:55], v[48:51]
v_mfma_f32_16x16x32_bf16 v[44:47], a[20:23], a[52:55], v[44:47]
ds_read_b128 a[84:87], v243 offset:39936
v_mfma_f32_16x16x32_bf16 v[44:47], a[16:19], a[48:51], v[44:47]
s_add_u32 s46, s52, 95232
buffer_load_dwordx4 v3, s[28:31], s46 offen offset:3072 lds
v_mfma_f32_16x16x32_bf16 v[40:43], a[8:11], a[48:51], v[40:43]
ds_read_b128 a[128:131], v242 offset:40960
v_mfma_f32_16x16x32_bf16 v[40:43], a[12:15], a[52:55], v[40:43]
v_mfma_f32_16x16x32_bf16 v[36:39], a[4:7], a[52:55], v[36:39]
ds_read_b128 a[88:91], v243 offset:40960
v_mfma_f32_16x16x32_bf16 v[36:39], a[0:3], a[48:51], v[36:39]
s_add_u32 m0, s40, 4096
s_add_u32 s46, s52, 131072
buffer_load_dwordx4 v3, s[28:31], s46 offen offset:0 lds
v_mfma_f32_16x16x32_bf16 v[56:59], a[0:3], a[56:59], v[56:59]
ds_read_b128 a[132:135], v242 offset:41984
v_mfma_f32_16x16x32_bf16 v[56:59], a[4:7], a[60:63], v[56:59]
v_mfma_f32_16x16x32_bf16 v[60:63], a[12:15], a[60:63], v[60:63]
ds_read_b128 a[92:95], v243 offset:41984
v_mfma_f32_16x16x32_bf16 v[60:63], a[8:11], a[56:59], v[60:63]
s_add_u32 s46, s52, 162816
buffer_load_dwordx4 v3, s[28:31], s46 offen offset:1024 lds
v_mfma_f32_16x16x32_bf16 v[64:67], a[16:19], a[56:59], v[64:67]
ds_read_b128 a[136:139], v242 offset:43008
v_mfma_f32_16x16x32_bf16 v[64:67], a[20:23], a[60:63], v[64:67]
v_mfma_f32_16x16x32_bf16 v[68:71], a[28:31], a[60:63], v[68:71]
ds_read_b128 a[96:99], v243 offset:43008
v_mfma_f32_16x16x32_bf16 v[68:71], a[24:27], a[56:59], v[68:71]
s_add_u32 s46, s52, 194560
buffer_load_dwordx4 v3, s[28:31], s46 offen offset:2048 lds
v_mfma_f32_16x16x32_bf16 v[72:75], a[32:35], a[56:59], v[72:75]
ds_read_b128 a[140:143], v242 offset:44032
v_mfma_f32_16x16x32_bf16 v[72:75], a[36:39], a[60:63], v[72:75]
v_mfma_f32_16x16x32_bf16 v[92:95], a[36:39], a[68:71], v[92:95]
ds_read_b128 a[100:103], v243 offset:44032
v_mfma_f32_16x16x32_bf16 v[92:95], a[32:35], a[64:67], v[92:95]
s_add_u32 s46, s52, 226304
buffer_load_dwordx4 v3, s[28:31], s46 offen offset:3072 lds
v_mfma_f32_16x16x32_bf16 v[88:91], a[24:27], a[64:67], v[88:91]
ds_read_b128 a[104:107], v243 offset:45056
v_mfma_f32_16x16x32_bf16 v[88:91], a[28:31], a[68:71], v[88:91]
v_mfma_f32_16x16x32_bf16 v[84:87], a[20:23], a[68:71], v[84:87]
ds_read_b128 a[108:111], v243 offset:46080
v_mfma_f32_16x16x32_bf16 v[84:87], a[16:19], a[64:67], v[84:87]
v_mfma_f32_16x16x32_bf16 v[80:83], a[8:11], a[64:67], v[80:83]
v_mfma_f32_16x16x32_bf16 v[80:83], a[12:15], a[68:71], v[80:83]
v_mfma_f32_16x16x32_bf16 v[76:79], a[4:7], a[68:71], v[76:79]
v_mfma_f32_16x16x32_bf16 v[76:79], a[0:3], a[64:67], v[76:79]
s_cmp_eq_u32 s44, s100
s_cselect_b64 s[50:51], -1, 0
s_cselect_b32 s54, 67108864, s54
s_waitcnt vmcnt(8)
v_cmp_ne_u32 vcc, s88, v222
s_cbranch_vccz Lspun_17
s_mov_b32 s56, 0x40000
Lspin_16:
buffer_load_dword v222, v221, s[16:19], 0 offen sc1
s_waitcnt vmcnt(0)
v_cmp_ne_u32 vcc, s88, v222
s_cbranch_vccz Lspun_17
s_sleep 4
s_sub_u32 s56, s56, 1
s_cmp_lg_u32 s56, 0
s_cbranch_scc1 Lspin_16
Lspun_17:
s_waitcnt vmcnt(18) lgkmcnt(0)
s_barrier
v_mfma_f32_16x16x32_bf16 v[16:19], a[72:75], a[112:115], v[16:19]
ds_read_b128 a[40:43], v242 offset:0
v_mfma_f32_16x16x32_bf16 v[16:19], a[76:79], a[116:119], v[16:19]
v_mfma_f32_16x16x32_bf16 v[20:23], a[84:87], a[116:119], v[20:23]
ds_read_b128 a[0:3], v243 offset:0
v_mfma_f32_16x16x32_bf16 v[20:23], a[80:83], a[112:115], v[20:23]
s_add_u32 s47, s53, 5767168
buffer_load_dwordx4 a[144:147], v15, s[16:19], s47 offen sc1
v_mfma_f32_16x16x32_bf16 v[24:27], a[88:91], a[112:115], v[24:27]
ds_read_b128 a[44:47], v242 offset:1024
v_mfma_f32_16x16x32_bf16 v[24:27], a[92:95], a[116:119], v[24:27]
buffer_load_dwordx4 a[148:151], v15, s[16:19], s47 offen offset:1024 sc1
v_mfma_f32_16x16x32_bf16 v[28:31], a[100:103], a[116:119], v[28:31]
ds_read_b128 a[4:7], v243 offset:1024
v_mfma_f32_16x16x32_bf16 v[28:31], a[96:99], a[112:115], v[28:31]
v_mfma_f32_16x16x32_bf16 v[32:35], a[104:107], a[112:115], v[32:35]
ds_read_b128 a[48:51], v242 offset:2048
v_mfma_f32_16x16x32_bf16 v[32:35], a[108:111], a[116:119], v[32:35]
s_add_u32 s47, s53, 5822464
buffer_load_dwordx4 a[152:155], v15, s[16:19], s47 offen sc1
v_mfma_f32_16x16x32_bf16 v[52:55], a[108:111], a[124:127], v[52:55]
ds_read_b128 a[8:11], v243 offset:2048
v_mfma_f32_16x16x32_bf16 v[52:55], a[104:107], a[120:123], v[52:55]
buffer_load_dwordx4 a[156:159], v15, s[16:19], s47 offen offset:1024 sc1
v_mfma_f32_16x16x32_bf16 v[48:51], a[96:99], a[120:123], v[48:51]
ds_read_b128 a[52:55], v242 offset:3072
v_mfma_f32_16x16x32_bf16 v[48:51], a[100:103], a[124:127], v[48:51]
v_mfma_f32_16x16x32_bf16 v[44:47], a[92:95], a[124:127], v[44:47]
ds_read_b128 a[12:15], v243 offset:3072
v_mfma_f32_16x16x32_bf16 v[44:47], a[88:91], a[120:123], v[44:47]
s_add_u32 s47, s53, 5877760
buffer_load_dwordx4 a[160:163], v15, s[16:19], s47 offen sc1
v_mfma_f32_16x16x32_bf16 v[40:43], a[80:83], a[120:123], v[40:43]
ds_read_b128 a[56:59], v242 offset:4096
v_mfma_f32_16x16x32_bf16 v[40:43], a[84:87], a[124:127], v[40:43]
buffer_load_dwordx4 a[164:167], v15, s[16:19], s47 offen offset:1024 sc1
v_mfma_f32_16x16x32_bf16 v[36:39], a[76:79], a[124:127], v[36:39]
ds_read_b128 a[16:19], v243 offset:4096
v_mfma_f32_16x16x32_bf16 v[36:39], a[72:75], a[120:123], v[36:39]
v_mfma_f32_16x16x32_bf16 v[56:59], a[72:75], a[128:131], v[56:59]
ds_read_b128 a[60:63], v242 offset:5120
v_mfma_f32_16x16x32_bf16 v[56:59], a[76:79], a[132:135], v[56:59]
s_add_u32 s47, s53, 5933056
buffer_load_dwordx4 a[168:171], v15, s[16:19], s47 offen sc1
v_mfma_f32_16x16x32_bf16 v[60:63], a[84:87], a[132:135], v[60:63]
ds_read_b128 a[20:23], v243 offset:5120
v_mfma_f32_16x16x32_bf16 v[60:63], a[80:83], a[128:131], v[60:63]
buffer_load_dwordx4 a[172:175], v15, s[16:19], s47 offen offset:1024 sc1
v_mfma_f32_16x16x32_bf16 v[64:67], a[88:91], a[128:131], v[64:67]
ds_read_b128 a[64:67], v242 offset:6144
v_mfma_f32_16x16x32_bf16 v[64:67], a[92:95], a[132:135], v[64:67]
v_mfma_f32_16x16x32_bf16 v[68:71], a[100:103], a[132:135], v[68:71]
ds_read_b128 a[24:27], v243 offset:6144
v_mfma_f32_16x16x32_bf16 v[68:71], a[96:99], a[128:131], v[68:71]
s_add_u32 s47, s53, 5988352
buffer_load_dwordx4 a[176:179], v15, s[16:19], s47 offen sc1
v_mfma_f32_16x16x32_bf16 v[72:75], a[104:107], a[128:131], v[72:75]
ds_read_b128 a[68:71], v242 offset:7168
v_mfma_f32_16x16x32_bf16 v[72:75], a[108:111], a[132:135], v[72:75]
buffer_load_dwordx4 a[180:183], v15, s[16:19], s47 offen offset:1024 sc1
v_mfma_f32_16x16x32_bf16 v[92:95], a[108:111], a[140:143], v[92:95]
ds_read_b128 a[28:31], v243 offset:7168
v_mfma_f32_16x16x32_bf16 v[92:95], a[104:107], a[136:139], v[92:95]
v_mfma_f32_16x16x32_bf16 v[88:91], a[96:99], a[136:139], v[88:91]
ds_read_b128 a[32:35], v243 offset:8192
v_mfma_f32_16x16x32_bf16 v[88:91], a[100:103], a[140:143], v[88:91]
s_add_u32 m0, s40, 110592
s_add_u32 s46, s52, 262144
buffer_load_dwordx4 v3, s[28:31], s46 offen offset:0 lds
v_mfma_f32_16x16x32_bf16 v[84:87], a[92:95], a[140:143], v[84:87]
ds_read_b128 a[36:39], v243 offset:9216
v_mfma_f32_16x16x32_bf16 v[84:87], a[88:91], a[136:139], v[84:87]
s_add_u32 s46, s52, 293888
buffer_load_dwordx4 v3, s[28:31], s46 offen offset:1024 lds
v_mfma_f32_16x16x32_bf16 v[80:83], a[80:83], a[136:139], v[80:83]
v_mfma_f32_16x16x32_bf16 v[80:83], a[84:87], a[140:143], v[80:83]
v_mfma_f32_16x16x32_bf16 v[76:79], a[76:79], a[140:143], v[76:79]
v_mfma_f32_16x16x32_bf16 v[76:79], a[72:75], a[136:139], v[76:79]
s_waitcnt vmcnt(21) lgkmcnt(0)
s_barrier
v_mfma_f32_16x16x32_bf16 v[16:19], a[0:3], a[40:43], v[16:19]
ds_read_b128 a[112:115], v240 offset:36864
v_mfma_f32_16x16x32_bf16 v[16:19], a[4:7], a[44:47], v[16:19]
v_mfma_f32_16x16x32_bf16 v[20:23], a[12:15], a[44:47], v[20:23]
ds_read_b128 a[72:75], v241 offset:36864
v_mfma_f32_16x16x32_bf16 v[20:23], a[8:11], a[40:43], v[20:23]
s_add_u32 s46, s52, 325632
buffer_load_dwordx4 v3, s[28:31], s46 offen offset:2048 lds
v_mfma_f32_16x16x32_bf16 v[24:27], a[16:19], a[40:43], v[24:27]
ds_read_b128 a[116:119], v240 offset:37888
v_mfma_f32_16x16x32_bf16 v[24:27], a[20:23], a[44:47], v[24:27]
s_add_u32 s46, s52, 357376
buffer_load_dwordx4 v3, s[28:31], s46 offen offset:3072 lds
v_mfma_f32_16x16x32_bf16 v[28:31], a[28:31], a[44:47], v[28:31]
ds_read_b128 a[76:79], v241 offset:37888
v_mfma_f32_16x16x32_bf16 v[28:31], a[24:27], a[40:43], v[28:31]
v_mfma_f32_16x16x32_bf16 v[32:35], a[32:35], a[40:43], v[32:35]
ds_read_b128 a[120:123], v240 offset:38912
v_mfma_f32_16x16x32_bf16 v[32:35], a[36:39], a[44:47], v[32:35]
s_add_u32 m0, s40, 114688
s_add_u32 s46, s52, 393216
buffer_load_dwordx4 v3, s[28:31], s46 offen offset:0 lds
v_mfma_f32_16x16x32_bf16 v[52:55], a[36:39], a[52:55], v[52:55]
ds_read_b128 a[80:83], v241 offset:38912
v_mfma_f32_16x16x32_bf16 v[52:55], a[32:35], a[48:51], v[52:55]
s_add_u32 s46, s52, 424960
buffer_load_dwordx4 v3, s[28:31], s46 offen offset:1024 lds
v_mfma_f32_16x16x32_bf16 v[48:51], a[24:27], a[48:51], v[48:51]
ds_read_b128 a[124:127], v240 offset:39936
v_mfma_f32_16x16x32_bf16 v[48:51], a[28:31], a[52:55], v[48:51]
v_mfma_f32_16x16x32_bf16 v[44:47], a[20:23], a[52:55], v[44:47]
ds_read_b128 a[84:87], v241 offset:39936
v_mfma_f32_16x16x32_bf16 v[44:47], a[16:19], a[48:51], v[44:47]
s_add_u32 s46, s52, 456704
buffer_load_dwordx4 v3, s[28:31], s46 offen offset:2048 lds
v_mfma_f32_16x16x32_bf16 v[40:43], a[8:11], a[48:51], v[40:43]
ds_read_b128 a[128:131], v240 offset:40960
v_mfma_f32_16x16x32_bf16 v[40:43], a[12:15], a[52:55], v[40:43]
s_add_u32 s46, s52, 488448
buffer_load_dwordx4 v3, s[28:31], s46 offen offset:3072 lds
v_mfma_f32_16x16x32_bf16 v[36:39], a[4:7], a[52:55], v[36:39]
ds_read_b128 a[88:91], v241 offset:40960
v_mfma_f32_16x16x32_bf16 v[36:39], a[0:3], a[48:51], v[36:39]
v_mfma_f32_16x16x32_bf16 v[56:59], a[0:3], a[56:59], v[56:59]
ds_read_b128 a[132:135], v240 offset:41984
v_mfma_f32_16x16x32_bf16 v[56:59], a[4:7], a[60:63], v[56:59]
s_add_u32 s47, s53, 5769216
buffer_load_dwordx4 a[184:187], v15, s[16:19], s47 offen sc1
v_mfma_f32_16x16x32_bf16 v[60:63], a[12:15], a[60:63], v[60:63]
ds_read_b128 a[92:95], v241 offset:41984
v_mfma_f32_16x16x32_bf16 v[60:63], a[8:11], a[56:59], v[60:63]
buffer_load_dwordx4 a[188:191], v15, s[16:19], s47 offen offset:1024 sc1
v_mfma_f32_16x16x32_bf16 v[64:67], a[16:19], a[56:59], v[64:67]
ds_read_b128 a[136:139], v240 offset:43008
v_mfma_f32_16x16x32_bf16 v[64:67], a[20:23], a[60:63], v[64:67]
K_pg12:
s_cbranch_execz K_back0
v_mfma_f32_16x16x32_bf16 v[68:71], a[28:31], a[60:63], v[68:71]
ds_read_b128 a[96:99], v241 offset:43008
v_mfma_f32_16x16x32_bf16 v[68:71], a[24:27], a[56:59], v[68:71]
s_add_u32 s47, s53, 5824512
buffer_load_dwordx4 a[192:195], v15, s[16:19], s47 offen sc1
v_mfma_f32_16x16x32_bf16 v[72:75], a[32:35], a[56:59], v[72:75]
ds_read_b128 a[140:143], v240 offset:44032
v_mfma_f32_16x16x32_bf16 v[72:75], a[36:39], a[60:63], v[72:75]
buffer_load_dwordx4 a[196:199], v15, s[16:19], s47 offen offset:1024 sc1
v_mfma_f32_16x16x32_bf16 v[92:95], a[36:39], a[68:71], v[92:95]
ds_read_b128 a[100:103], v241 offset:44032
v_mfma_f32_16x16x32_bf16 v[92:95], a[32:35], a[64:67], v[92:95]
v_mfma_f32_16x16x32_bf16 v[88:91], a[24:27], a[64:67], v[88:91]
ds_read_b128 a[104:107], v241 offset:45056
v_mfma_f32_16x16x32_bf16 v[88:91], a[28:31], a[68:71], v[88:91]
s_add_u32 s47, s53, 5879808
buffer_load_dwordx4 a[200:203], v15, s[16:19], s47 offen sc1
v_mfma_f32_16x16x32_bf16 v[84:87], a[20:23], a[68:71], v[84:87]
ds_read_b128 a[108:111], v241 offset:46080
v_mfma_f32_16x16x32_bf16 v[84:87], a[16:19], a[64:67], v[84:87]
buffer_load_dwordx4 a[204:207], v15, s[16:19], s47 offen offset:1024 sc1
v_mfma_f32_16x16x32_bf16 v[80:83], a[8:11], a[64:67], v[80:83]
v_mfma_f32_16x16x32_bf16 v[80:83], a[12:15], a[68:71], v[80:83]
v_mfma_f32_16x16x32_bf16 v[76:79], a[4:7], a[68:71], v[76:79]
v_mfma_f32_16x16x32_bf16 v[76:79], a[0:3], a[64:67], v[76:79]
s_waitcnt vmcnt(24) lgkmcnt(0)
v_mfma_f32_16x16x32_bf16 v[16:19], a[72:75], a[112:115], v[16:19]
ds_read_b64_tr_b16 a[224:225], v8 offset:0
v_mfma_f32_16x16x32_bf16 v[16:19], a[76:79], a[116:119], v[16:19]
ds_read_b64_tr_b16 a[226:227], v8 offset:2048
s_add_u32 s47, s53, 5935104
buffer_load_dwordx4 a[208:211], v15, s[16:19], s47 offen sc1
v_mfma_f32_16x16x32_bf16 v[20:23], a[84:87], a[116:119], v[20:23]
ds_read_b64_tr_b16 a[228:229], v8 offset:4096
buffer_load_dwordx4 a[212:215], v15, s[16:19], s47 offen offset:1024 sc1
v_mfma_f32_16x16x32_bf16 v[20:23], a[80:83], a[112:115], v[20:23]
ds_read_b64_tr_b16 a[230:231], v8 offset:6144
v_mfma_f32_16x16x32_bf16 v[24:27], a[88:91], a[112:115], v[24:27]
ds_read_b64_tr_b16 a[232:233], v9 offset:0
s_add_u32 s47, s53, 5990400
buffer_load_dwordx4 a[216:219], v15, s[16:19], s47 offen sc1
v_mfma_f32_16x16x32_bf16 v[24:27], a[92:95], a[116:119], v[24:27]
ds_read_b64_tr_b16 a[234:235], v9 offset:2048
buffer_load_dwordx4 a[220:223], v15, s[16:19], s47 offen offset:1024 sc1
v_mfma_f32_16x16x32_bf16 v[28:31], a[100:103], a[116:119], v[28:31]
ds_read_b64_tr_b16 a[236:237], v9 offset:4096
v_mfma_f32_16x16x32_bf16 v[28:31], a[96:99], a[112:115], v[28:31]
ds_read_b64_tr_b16 a[238:239], v9 offset:6144
s_add_u32 m0, s40, 73728
s_add_u32 s46, s52, 524288
buffer_load_dwordx4 v3, s[28:31], s46 offen offset:0 lds
v_mfma_f32_16x16x32_bf16 v[32:35], a[104:107], a[112:115], v[32:35]
ds_read_b64_tr_b16 a[240:241], v10 offset:0
s_add_u32 s46, s52, 556032
buffer_load_dwordx4 v3, s[28:31], s46 offen offset:1024 lds
v_mfma_f32_16x16x32_bf16 v[32:35], a[108:111], a[116:119], v[32:35]
ds_read_b64_tr_b16 a[242:243], v10 offset:2048
v_mfma_f32_16x16x32_bf16 v[36:39], a[76:79], a[124:127], v[36:39]
ds_read_b64_tr_b16 a[244:245], v10 offset:4096
s_add_u32 s46, s52, 587776
buffer_load_dwordx4 v3, s[28:31], s46 offen offset:2048 lds
v_mfma_f32_16x16x32_bf16 v[36:39], a[72:75], a[120:123], v[36:39]
ds_read_b64_tr_b16 a[246:247], v10 offset:6144
s_add_u32 s46, s52, 619520
buffer_load_dwordx4 v3, s[28:31], s46 offen offset:3072 lds
v_mfma_f32_16x16x32_bf16 v[40:43], a[80:83], a[120:123], v[40:43]
ds_read_b64_tr_b16 a[248:249], v11 offset:0
v_mfma_f32_16x16x32_bf16 v[40:43], a[84:87], a[124:127], v[40:43]
ds_read_b64_tr_b16 a[250:251], v11 offset:2048
s_add_u32 m0, s40, 77824
s_add_u32 s46, s52, 655360
buffer_load_dwordx4 v3, s[28:31], s46 offen offset:0 lds
v_mfma_f32_16x16x32_bf16 v[44:47], a[92:95], a[124:127], v[44:47]
ds_read_b64_tr_b16 a[252:253], v11 offset:4096
s_add_u32 s46, s52, 687104
buffer_load_dwordx4 v3, s[28:31], s46 offen offset:1024 lds
v_mfma_f32_16x16x32_bf16 v[44:47], a[88:91], a[120:123], v[44:47]
ds_read_b64_tr_b16 a[254:255], v11 offset:6144
v_mfma_f32_16x16x32_bf16 v[48:51], a[96:99], a[120:123], v[48:51]
s_add_u32 s46, s52, 718848
buffer_load_dwordx4 v3, s[28:31], s46 offen offset:2048 lds
v_mfma_f32_16x16x32_bf16 v[48:51], a[100:103], a[124:127], v[48:51]
s_add_u32 s46, s52, 750592
buffer_load_dwordx4 v3, s[28:31], s46 offen offset:3072 lds
v_mfma_f32_16x16x32_bf16 v[52:55], a[108:111], a[124:127], v[52:55]
v_cvt_pk_bf16_f32 v16, v16, v17
v_cvt_pk_bf16_f32 v17, v18, v19
v_mfma_f32_16x16x32_bf16 v[52:55], a[104:107], a[120:123], v[52:55]
v_cvt_pk_bf16_f32 v18, v20, v21
v_mfma_f32_16x16x32_bf16 v[56:59], a[72:75], a[128:131], v[56:59]
v_cvt_pk_bf16_f32 v19, v22, v23
buffer_store_dwordx4 v[16:19], v15, s[16:19], s54 offen sc1
v_mfma_f32_16x16x32_bf16 v[56:59], a[76:79], a[132:135], v[56:59]
v_cvt_pk_bf16_f32 v20, v24, v25
v_mfma_f32_16x16x32_bf16 v[60:63], a[84:87], a[132:135], v[60:63]
v_cvt_pk_bf16_f32 v21, v26, v27
v_mfma_f32_16x16x32_bf16 v[60:63], a[80:83], a[128:131], v[60:63]
v_cvt_pk_bf16_f32 v22, v28, v29
v_cvt_pk_bf16_f32 v23, v30, v31
v_mfma_f32_16x16x32_bf16 v[64:67], a[88:91], a[128:131], v[64:67]
buffer_store_dwordx4 v[20:23], v15, s[16:19], s54 offen offset:1024 sc1
v_mfma_f32_16x16x32_bf16 v[64:67], a[92:95], a[132:135], v[64:67]
v_cvt_pk_bf16_f32 v24, v32, v33
v_cvt_pk_bf16_f32 v25, v34, v35
v_mfma_f32_16x16x32_bf16 v[68:71], a[100:103], a[132:135], v[68:71]
buffer_store_dwordx2 v[24:25], v12, s[16:19], s54 offen offset:2048 sc1
s_add_u32 s54, s54, 2560
v_mfma_f32_16x16x32_bf16 v[68:71], a[96:99], a[128:131], v[68:71]
s_mov_b64 exec, s[50:51]
ds_write_b128 v13, v[16:19] offset:0
ds_write_b128 v13, v[20:23] offset:1024
ds_write_b64 v223, v[24:25] offset:2048
s_mov_b64 exec, -1
v_mfma_f32_16x16x32_bf16 v[72:75], a[104:107], a[128:131], v[72:75]
v_cvt_pk_bf16_f32 v36, v36, v37
v_cvt_pk_bf16_f32 v37, v38, v39
v_mfma_f32_16x16x32_bf16 v[72:75], a[108:111], a[132:135], v[72:75]
v_cvt_pk_bf16_f32 v38, v40, v41
v_mfma_f32_16x16x32_bf16 v[76:79], a[76:79], a[140:143], v[76:79]
v_cvt_pk_bf16_f32 v39, v42, v43
buffer_store_dwordx4 v[36:39], v15, s[16:19], s54 offen sc1
v_mfma_f32_16x16x32_bf16 v[76:79], a[72:75], a[136:139], v[76:79]
v_cvt_pk_bf16_f32 v40, v44, v45
v_mfma_f32_16x16x32_bf16 v[80:83], a[80:83], a[136:139], v[80:83]
v_cvt_pk_bf16_f32 v41, v46, v47
v_mfma_f32_16x16x32_bf16 v[80:83], a[84:87], a[140:143], v[80:83]
v_cvt_pk_bf16_f32 v42, v48, v49
v_cvt_pk_bf16_f32 v43, v50, v51
v_mfma_f32_16x16x32_bf16 v[84:87], a[92:95], a[140:143], v[84:87]
buffer_store_dwordx4 v[40:43], v15, s[16:19], s54 offen offset:1024 sc1
v_mfma_f32_16x16x32_bf16 v[84:87], a[88:91], a[136:139], v[84:87]
v_cvt_pk_bf16_f32 v44, v52, v53
v_cvt_pk_bf16_f32 v45, v54, v55
v_mfma_f32_16x16x32_bf16 v[88:91], a[96:99], a[136:139], v[88:91]
buffer_store_dwordx2 v[44:45], v12, s[16:19], s54 offen offset:2048 sc1
s_add_u32 s54, s54, 2560
v_mfma_f32_16x16x32_bf16 v[88:91], a[100:103], a[140:143], v[88:91]
s_mov_b64 exec, s[50:51]
ds_write_b128 v13, v[36:39] offset:2560
ds_write_b128 v13, v[40:43] offset:3584
ds_write_b64 v223, v[44:45] offset:4608
s_mov_b64 exec, -1
v_mfma_f32_16x16x32_bf16 v[92:95], a[108:111], a[140:143], v[92:95]
v_mfma_f32_16x16x32_bf16 v[92:95], a[104:107], a[136:139], v[92:95]
s_waitcnt vmcnt(24)
s_waitcnt vmcnt(32) lgkmcnt(0)
v_mfma_f32_16x16x32_bf16 v[96:99], a[144:147], a[224:227], 0
ds_read_b64_tr_b16 a[40:41], v4 offset:36864
v_cvt_pk_bf16_f32 v56, v56, v57
v_cvt_pk_bf16_f32 v57, v58, v59
v_mfma_f32_16x16x32_bf16 v[96:99], a[148:151], a[228:231], v[96:99]
v_cvt_pk_bf16_f32 v58, v60, v61
v_cvt_pk_bf16_f32 v59, v62, v63
v_mfma_f32_16x16x32_bf16 v[116:119], a[148:151], a[236:239], 0
ds_read_b64_tr_b16 a[42:43], v4 offset:38912
buffer_store_dwordx4 v[56:59], v15, s[16:19], s54 offen sc1
v_cvt_pk_bf16_f32 v60, v64, v65
v_mfma_f32_16x16x32_bf16 v[116:119], a[144:147], a[232:235], v[116:119]
v_cvt_pk_bf16_f32 v61, v66, v67
v_cvt_pk_bf16_f32 v62, v68, v69
v_mfma_f32_16x16x32_bf16 v[136:139], a[144:147], a[240:243], 0
ds_read_b64_tr_b16 a[44:45], v4 offset:40960
v_cvt_pk_bf16_f32 v63, v70, v71
buffer_store_dwordx4 v[60:63], v15, s[16:19], s54 offen offset:1024 sc1
v_mfma_f32_16x16x32_bf16 v[136:139], a[148:151], a[244:247], v[136:139]
v_cvt_pk_bf16_f32 v64, v72, v73
v_cvt_pk_bf16_f32 v65, v74, v75
s_add_u32 s47, s53, 5771264
buffer_load_dwordx4 v[176:179], v15, s[16:19], s47 offen sc1
v_mfma_f32_16x16x32_bf16 v[156:159], a[148:151], a[252:255], 0
ds_read_b64_tr_b16 a[46:47], v4 offset:43008
buffer_store_dwordx2 v[64:65], v12, s[16:19], s54 offen offset:2048 sc1
s_add_u32 s54, s54, 2560
s_mov_b64 exec, s[50:51]
ds_write_b128 v13, v[56:59] offset:5120
ds_write_b128 v13, v[60:63] offset:6144
ds_write_b64 v223, v[64:65] offset:7168
s_mov_b64 exec, -1
v_mfma_f32_16x16x32_bf16 v[156:159], a[144:147], a[248:251], v[156:159]
v_cvt_pk_bf16_f32 v76, v76, v77
v_cvt_pk_bf16_f32 v77, v78, v79
buffer_load_dwordx4 v[180:183], v15, s[16:19], s47 offen offset:1024 sc1
v_mfma_f32_16x16x32_bf16 v[160:163], a[152:155], a[248:251], 0
ds_read_b64_tr_b16 a[48:49], v5 offset:36864
v_cvt_pk_bf16_f32 v78, v80, v81
v_cvt_pk_bf16_f32 v79, v82, v83
v_mfma_f32_16x16x32_bf16 v[160:163], a[156:159], a[252:255], v[160:163]
buffer_store_dwordx4 v[76:79], v15, s[16:19], s54 offen sc1
v_cvt_pk_bf16_f32 v80, v84, v85
s_add_u32 s47, s53, 5826560
buffer_load_dwordx4 v[184:187], v15, s[16:19], s47 offen sc1
v_mfma_f32_16x16x32_bf16 v[140:143], a[156:159], a[244:247], 0
ds_read_b64_tr_b16 a[50:51], v5 offset:38912
v_cvt_pk_bf16_f32 v81, v86, v87
v_cvt_pk_bf16_f32 v82, v88, v89
v_mfma_f32_16x16x32_bf16 v[140:143], a[152:155], a[240:243], v[140:143]
v_cvt_pk_bf16_f32 v83, v90, v91
buffer_store_dwordx4 v[80:83], v15, s[16:19], s54 offen offset:1024 sc1
buffer_load_dwordx4 v[188:191], v15, s[16:19], s47 offen offset:1024 sc1
v_mfma_f32_16x16x32_bf16 v[120:123], a[152:155], a[232:235], 0
ds_read_b64_tr_b16 a[52:53], v5 offset:40960
v_cvt_pk_bf16_f32 v84, v92, v93
v_cvt_pk_bf16_f32 v85, v94, v95
v_mfma_f32_16x16x32_bf16 v[120:123], a[156:159], a[236:239], v[120:123]
buffer_store_dwordx2 v[84:85], v12, s[16:19], s54 offen offset:2048 sc1
s_add_u32 s54, s54, 2560
s_mov_b64 exec, s[50:51]
ds_write_b128 v13, v[76:79] offset:7680
ds_write_b128 v13, v[80:83] offset:8704
ds_write_b64 v223, v[84:85] offset:9728
s_mov_b64 exec, -1
s_add_u32 s47, s53, 5881856
buffer_load_dwordx4 v[192:195], v15, s[16:19], s47 offen sc1
v_mfma_f32_16x16x32_bf16 v[100:103], a[156:159], a[228:231], 0
ds_read_b64_tr_b16 a[54:55], v5 offset:43008
v_mfma_f32_16x16x32_bf16 v[100:103], a[152:155], a[224:227], v[100:103]
buffer_load_dwordx4 v[196:199], v15, s[16:19], s47 offen offset:1024 sc1
v_mfma_f32_16x16x32_bf16 v[104:107], a[160:163], a[224:227], 0
ds_read_b64_tr_b16 a[56:57], v6 offset:36864
v_mfma_f32_16x16x32_bf16 v[104:107], a[164:167], a[228:231], v[104:107]
s_add_u32 s47, s53, 5937152
buffer_load_dwordx4 v[200:203], v15, s[16:19], s47 offen sc1
v_mfma_f32_16x16x32_bf16 v[124:127], a[164:167], a[236:239], 0
ds_read_b64_tr_b16 a[58:59], v6 offset:38912
v_mfma_f32_16x16x32_bf16 v[124:127], a[160:163], a[232:235], v[124:127]
buffer_load_dwordx4 v[204:207], v15, s[16:19], s47 offen offset:1024 sc1
v_mfma_f32_16x16x32_bf16 v[144:147], a[160:163], a[240:243], 0
ds_read_b64_tr_b16 a[60:61], v6 offset:40960
v_mfma_f32_16x16x32_bf16 v[144:147], a[164:167], a[244:247], v[144:147]
s_add_u32 s47, s53, 5992448
buffer_load_dwordx4 v[208:211], v15, s[16:19], s47 offen sc1
v_mfma_f32_16x16x32_bf16 v[164:167], a[164:167], a[252:255], 0
ds_read_b64_tr_b16 a[62:63], v6 offset:43008
v_mfma_f32_16x16x32_bf16 v[164:167], a[160:163], a[248:251], v[164:167]
buffer_load_dwordx4 v[212:215], v15, s[16:19], s47 offen offset:1024 sc1
v_mfma_f32_16x16x32_bf16 v[168:171], a[168:171], a[248:251], 0
ds_read_b64_tr_b16 a[64:65], v7 offset:36864
v_mfma_f32_16x16x32_bf16 v[168:171], a[172:175], a[252:255], v[168:171]
s_add_u32 m0, s40, 0
s_add_u32 s46, s52, 786432
buffer_load_dwordx4 v3, s[28:31], s46 offen offset:0 lds
v_mfma_f32_16x16x32_bf16 v[148:151], a[172:175], a[244:247], 0
ds_read_b64_tr_b16 a[66:67], v7 offset:38912
v_mfma_f32_16x16x32_bf16 v[148:151], a[168:171], a[240:243], v[148:151]
s_add_u32 s46, s52, 818176
buffer_load_dwordx4 v3, s[28:31], s46 offen offset:1024 lds
v_mfma_f32_16x16x32_bf16 v[128:131], a[168:171], a[232:235], 0
ds_read_b64_tr_b16 a[68:69], v7 offset:40960
v_mfma_f32_16x16x32_bf16 v[128:131], a[172:175], a[236:239], v[128:131]
s_add_u32 s46, s52, 849920
buffer_load_dwordx4 v3, s[28:31], s46 offen offset:2048 lds
v_mfma_f32_16x16x32_bf16 v[108:111], a[172:175], a[228:231], 0
ds_read_b64_tr_b16 a[70:71], v7 offset:43008
v_mfma_f32_16x16x32_bf16 v[108:111], a[168:171], a[224:227], v[108:111]
s_add_u32 s46, s52, 881664
buffer_load_dwordx4 v3, s[28:31], s46 offen offset:3072 lds
v_mfma_f32_16x16x32_bf16 v[112:115], a[176:179], a[224:227], 0
v_mfma_f32_16x16x32_bf16 v[112:115], a[180:183], a[228:231], v[112:115]
s_add_u32 m0, s40, 4096
s_add_u32 s46, s52, 917504
buffer_load_dwordx4 v3, s[28:31], s46 offen offset:0 lds
v_mfma_f32_16x16x32_bf16 v[132:135], a[180:183], a[236:239], 0
v_mfma_f32_16x16x32_bf16 v[132:135], a[176:179], a[232:235], v[132:135]
s_add_u32 s46, s52, 949248
buffer_load_dwordx4 v3, s[28:31], s46 offen offset:1024 lds
v_mfma_f32_16x16x32_bf16 v[152:155], a[176:179], a[240:243], 0
v_mfma_f32_16x16x32_bf16 v[152:155], a[180:183], a[244:247], v[152:155]
s_add_u32 s46, s52, 980992
buffer_load_dwordx4 v3, s[28:31], s46 offen offset:2048 lds
v_mfma_f32_16x16x32_bf16 v[172:175], a[180:183], a[252:255], 0
v_mfma_f32_16x16x32_bf16 v[172:175], a[176:179], a[248:251], v[172:175]
s_add_u32 s46, s52, 1012736
buffer_load_dwordx4 v3, s[28:31], s46 offen offset:3072 lds
s_waitcnt vmcnt(30)
s_waitcnt vmcnt(14)
s_waitcnt vmcnt(38) lgkmcnt(0)
v_mfma_f32_16x16x32_bf16 v[96:99], a[184:187], a[40:43], v[96:99]
ds_read_b64_tr_b16 a[224:225], v4 offset:0
s_barrier
s_bitcmp1_b32 s58, 4
s_cbranch_scc1 Lsig_18
s_bitset1_b32 s58, 4
v_mov_b32 v217, s99
v_mov_b32 v216, s88
v_lshlrev_b32 v217, 7, v217
v_add_u32 v217, 14811136, v217
s_mov_b64 exec, 1
buffer_store_dword v216, v217, s[16:19], 0 offen sc1
s_mov_b64 exec, -1
Lsig_18:
v_mfma_f32_16x16x32_bf16 v[96:99], a[188:191], a[44:47], v[96:99]
s_add_u32 s47, s53, 5773312
buffer_load_dwordx4 a[0:3], v15, s[16:19], s47 offen sc1
v_mfma_f32_16x16x32_bf16 v[116:119], a[188:191], a[52:55], v[116:119]
ds_read_b64_tr_b16 a[226:227], v4 offset:2048
s_mul_i32 s48, s44, 2560
v_add_u32 v13, s48, v13
v_add_u32 v223, s48, v223
v_mfma_f32_16x16x32_bf16 v[116:119], a[184:187], a[48:51], v[116:119]
buffer_load_dwordx4 a[4:7], v15, s[16:19], s47 offen offset:1024 sc1
v_mfma_f32_16x16x32_bf16 v[136:139], a[184:187], a[56:59], v[136:139]
ds_read_b64_tr_b16 a[228:229], v4 offset:4096
v_mfma_f32_16x16x32_bf16 v[136:139], a[188:191], a[60:63], v[136:139]
s_add_u32 s47, s53, 5828608
buffer_load_dwordx4 a[8:11], v15, s[16:19], s47 offen sc1
v_mfma_f32_16x16x32_bf16 v[156:159], a[188:191], a[68:71], v[156:159]
ds_read_b64_tr_b16 a[230:231], v4 offset:6144
v_mfma_f32_16x16x32_bf16 v[156:159], a[184:187], a[64:67], v[156:159]
buffer_load_dwordx4 a[12:15], v15, s[16:19], s47 offen offset:1024 sc1
v_mfma_f32_16x16x32_bf16 v[160:163], a[192:195], a[64:67], v[160:163]
ds_read_b64_tr_b16 a[232:233], v5 offset:0
v_mfma_f32_16x16x32_bf16 v[160:163], a[196:199], a[68:71], v[160:163]
s_add_u32 s47, s53, 5883904
buffer_load_dwordx4 a[16:19], v15, s[16:19], s47 offen sc1
v_mfma_f32_16x16x32_bf16 v[140:143], a[196:199], a[60:63], v[140:143]
ds_read_b64_tr_b16 a[234:235], v5 offset:2048
v_mfma_f32_16x16x32_bf16 v[140:143], a[192:195], a[56:59], v[140:143]
buffer_load_dwordx4 a[20:23], v15, s[16:19], s47 offen offset:1024 sc1
v_mfma_f32_16x16x32_bf16 v[120:123], a[192:195], a[48:51], v[120:123]
ds_read_b64_tr_b16 a[236:237], v5 offset:4096
v_mfma_f32_16x16x32_bf16 v[120:123], a[196:199], a[52:55], v[120:123]
s_add_u32 s47, s53, 5939200
buffer_load_dwordx4 a[24:27], v15, s[16:19], s47 offen sc1
v_mfma_f32_16x16x32_bf16 v[100:103], a[196:199], a[44:47], v[100:103]
ds_read_b64_tr_b16 a[238:239], v5 offset:6144
v_mfma_f32_16x16x32_bf16 v[100:103], a[192:195], a[40:43], v[100:103]
buffer_load_dwordx4 a[28:31], v15, s[16:19], s47 offen offset:1024 sc1
v_mfma_f32_16x16x32_bf16 v[104:107], a[200:203], a[40:43], v[104:107]
ds_read_b64_tr_b16 a[240:241], v6 offset:0
v_mfma_f32_16x16x32_bf16 v[104:107], a[204:207], a[44:47], v[104:107]
s_add_u32 s47, s53, 5994496
buffer_load_dwordx4 a[32:35], v15, s[16:19], s47 offen sc1
v_mfma_f32_16x16x32_bf16 v[124:127], a[204:207], a[52:55], v[124:127]
ds_read_b64_tr_b16 a[242:243], v6 offset:2048
v_mfma_f32_16x16x32_bf16 v[124:127], a[200:203], a[48:51], v[124:127]
buffer_load_dwordx4 a[36:39], v15, s[16:19], s47 offen offset:1024 sc1
v_mfma_f32_16x16x32_bf16 v[144:147], a[200:203], a[56:59], v[144:147]
ds_read_b64_tr_b16 a[244:245], v6 offset:4096
v_mfma_f32_16x16x32_bf16 v[144:147], a[204:207], a[60:63], v[144:147]
s_add_u32 m0, s40, 110592
s_add_u32 s46, s52, 1048576
buffer_load_dwordx4 v3, s[28:31], s46 offen offset:0 lds
v_mfma_f32_16x16x32_bf16 v[164:167], a[204:207], a[68:71], v[164:167]
ds_read_b64_tr_b16 a[246:247], v6 offset:6144
v_mfma_f32_16x16x32_bf16 v[164:167], a[200:203], a[64:67], v[164:167]
s_add_u32 s46, s52, 1080320
buffer_load_dwordx4 v3, s[28:31], s46 offen offset:1024 lds
v_mfma_f32_16x16x32_bf16 v[168:171], a[208:211], a[64:67], v[168:171]
ds_read_b64_tr_b16 a[248:249], v7 offset:0
v_mfma_f32_16x16x32_bf16 v[168:171], a[212:215], a[68:71], v[168:171]
s_add_u32 s46, s52, 1112064
buffer_load_dwordx4 v3, s[28:31], s46 offen offset:2048 lds
v_mfma_f32_16x16x32_bf16 v[148:151], a[212:215], a[60:63], v[148:151]
ds_read_b64_tr_b16 a[250:251], v7 offset:2048
v_mfma_f32_16x16x32_bf16 v[148:151], a[208:211], a[56:59], v[148:151]
s_add_u32 s46, s52, 1143808
buffer_load_dwordx4 v3, s[28:31], s46 offen offset:3072 lds
v_mfma_f32_16x16x32_bf16 v[128:131], a[208:211], a[48:51], v[128:131]
ds_read_b64_tr_b16 a[252:253], v7 offset:4096
v_mfma_f32_16x16x32_bf16 v[128:131], a[212:215], a[52:55], v[128:131]
s_add_u32 m0, s40, 114688
s_add_u32 s46, s52, 1179648
buffer_load_dwordx4 v3, s[28:31], s46 offen offset:0 lds
v_mfma_f32_16x16x32_bf16 v[108:111], a[212:215], a[44:47], v[108:111]
ds_read_b64_tr_b16 a[254:255], v7 offset:6144
v_mfma_f32_16x16x32_bf16 v[108:111], a[208:211], a[40:43], v[108:111]
s_add_u32 s46, s52, 1211392
buffer_load_dwordx4 v3, s[28:31], s46 offen offset:1024 lds
v_mfma_f32_16x16x32_bf16 v[112:115], a[216:219], a[40:43], v[112:115]
ds_read_b128 v[16:19], v13
v_mfma_f32_16x16x32_bf16 v[112:115], a[220:223], a[44:47], v[112:115]
s_add_u32 s46, s52, 1243136
buffer_load_dwordx4 v3, s[28:31], s46 offen offset:2048 lds
v_mfma_f32_16x16x32_bf16 v[132:135], a[220:223], a[52:55], v[132:135]
ds_read_b128 v[20:23], v13 offset:1024
v_mfma_f32_16x16x32_bf16 v[132:135], a[216:219], a[48:51], v[132:135]
s_add_u32 s46, s52, 1274880
buffer_load_dwordx4 v3, s[28:31], s46 offen offset:3072 lds
v_mfma_f32_16x16x32_bf16 v[152:155], a[216:219], a[56:59], v[152:155]
ds_read_b64 v[24:25], v223 offset:2048
v_mfma_f32_16x16x32_bf16 v[152:155], a[220:223], a[60:63], v[152:155]
v_mfma_f32_16x16x32_bf16 v[172:175], a[220:223], a[68:71], v[172:175]
v_mfma_f32_16x16x32_bf16 v[172:175], a[216:219], a[64:67], v[172:175]
s_waitcnt vmcnt(18)
s_waitcnt vmcnt(26) lgkmcnt(0)
v_mfma_f32_16x16x32_bf16 v[96:99], v[176:179], a[224:227], v[96:99]
ds_read_b64_tr_b16 a[40:41], v8 offset:0
v_min_u32 v221, 2, v1
v_mfma_f32_16x16x32_bf16 v[96:99], v[180:183], a[228:231], v[96:99]
s_add_u32 s47, s53, 5775360
buffer_load_dwordx4 a[144:147], v15, s[16:19], s47 offen sc1
v_add_u32 v221, s100, v221
v_mfma_f32_16x16x32_bf16 v[116:119], v[180:183], a[236:239], v[116:119]
ds_read_b64_tr_b16 a[42:43], v8 offset:2048
v_add_u32 v221, 1, v221
v_mfma_f32_16x16x32_bf16 v[116:119], v[176:179], a[232:235], v[116:119]
buffer_load_dwordx4 a[148:151], v15, s[16:19], s47 offen offset:1024 sc1
v_and_b32 v221, 3, v221
v_mfma_f32_16x16x32_bf16 v[136:139], v[176:179], a[240:243], v[136:139]
ds_read_b64_tr_b16 a[44:45], v8 offset:4096
s_and_b32 s48, s99, 0xfc
v_mfma_f32_16x16x32_bf16 v[136:139], v[180:183], a[244:247], v[136:139]
s_add_u32 s47, s53, 5830656
buffer_load_dwordx4 a[152:155], v15, s[16:19], s47 offen sc1
v_add_u32 v221, s48, v221
v_mfma_f32_16x16x32_bf16 v[156:159], v[180:183], a[252:255], v[156:159]
ds_read_b64_tr_b16 a[46:47], v8 offset:6144
v_lshlrev_b32 v221, 7, v221
v_mfma_f32_16x16x32_bf16 v[156:159], v[176:179], a[248:251], v[156:159]
buffer_load_dwordx4 a[156:159], v15, s[16:19], s47 offen offset:1024 sc1
v_add_u32 v221, 14811136, v221
v_mfma_f32_16x16x32_bf16 v[160:163], v[184:187], a[248:251], v[160:163]
ds_read_b64_tr_b16 a[48:49], v9 offset:0
v_mfma_f32_16x16x32_bf16 v[160:163], v[188:191], a[252:255], v[160:163]
s_add_u32 s47, s53, 5885952
buffer_load_dwordx4 a[160:163], v15, s[16:19], s47 offen sc1
v_mfma_f32_16x16x32_bf16 v[140:143], v[188:191], a[244:247], v[140:143]
ds_read_b64_tr_b16 a[50:51], v9 offset:2048
v_mfma_f32_16x16x32_bf16 v[140:143], v[184:187], a[240:243], v[140:143]
buffer_load_dwordx4 a[164:167], v15, s[16:19], s47 offen offset:1024 sc1
v_lshlrev_b32 v64, 16, v16
v_mfma_f32_16x16x32_bf16 v[120:123], v[184:187], a[232:235], v[120:123]
ds_read_b64_tr_b16 a[52:53], v9 offset:4096
v_and_b32 v65, 0xffff0000, v16
v_mfma_f32_16x16x32_bf16 v[120:123], v[188:191], a[236:239], v[120:123]
s_add_u32 s47, s53, 5941248
buffer_load_dwordx4 a[168:171], v15, s[16:19], s47 offen sc1
v_mfma_f32_16x16x32_bf16 v[100:103], v[188:191], a[228:231], v[100:103]
ds_read_b64_tr_b16 a[54:55], v9 offset:6144
v_lshlrev_b32 v66, 16, v17
v_mfma_f32_16x16x32_bf16 v[100:103], v[184:187], a[224:227], v[100:103]
buffer_load_dwordx4 a[172:175], v15, s[16:19], s47 offen offset:1024 sc1
v_and_b32 v67, 0xffff0000, v17
v_mfma_f32_16x16x32_bf16 v[104:107], v[192:195], a[224:227], v[104:107]
ds_read_b64_tr_b16 a[56:57], v10 offset:0
v_mfma_f32_16x16x32_bf16 v[104:107], v[196:199], a[228:231], v[104:107]
s_add_u32 s47, s53, 5996544
buffer_load_dwordx4 a[176:179], v15, s[16:19], s47 offen sc1
v_lshlrev_b32 v68, 16, v18
v_mfma_f32_16x16x32_bf16 v[124:127], v[196:199], a[236:239], v[124:127]
ds_read_b64_tr_b16 a[58:59], v10 offset:2048
v_and_b32 v69, 0xffff0000, v18
v_mfma_f32_16x16x32_bf16 v[124:127], v[192:195], a[232:235], v[124:127]
buffer_load_dwordx4 a[180:183], v15, s[16:19], s47 offen offset:1024 sc1
v_mfma_f32_16x16x32_bf16 v[144:147], v[192:195], a[240:243], v[144:147]
ds_read_b64_tr_b16 a[60:61], v10 offset:4096
v_lshlrev_b32 v70, 16, v19
v_mfma_f32_16x16x32_bf16 v[144:147], v[196:199], a[244:247], v[144:147]
s_add_u32 m0, s40, 73728
s_add_u32 s46, s52, 1310720
buffer_load_dwordx4 v3, s[28:31], s46 offen offset:0 lds
v_and_b32 v71, 0xffff0000, v19
v_mfma_f32_16x16x32_bf16 v[164:167], v[196:199], a[252:255], v[164:167]
ds_read_b64_tr_b16 a[62:63], v10 offset:6144
v_lshlrev_b32 v72, 16, v20
v_mfma_f32_16x16x32_bf16 v[164:167], v[192:195], a[248:251], v[164:167]
s_add_u32 s46, s52, 1342464
buffer_load_dwordx4 v3, s[28:31], s46 offen offset:1024 lds
v_mfma_f32_16x16x32_bf16 v[168:171], v[200:203], a[248:251], v[168:171]
ds_read_b64_tr_b16 a[64:65], v11 offset:0
v_and_b32 v73, 0xffff0000, v20
v_mfma_f32_16x16x32_bf16 v[168:171], v[204:207], a[252:255], v[168:171]
s_add_u32 s46, s52, 1374208
buffer_load_dwordx4 v3, s[28:31], s46 offen offset:2048 lds
v_lshlrev_b32 v74, 16, v21
v_mfma_f32_16x16x32_bf16 v[148:151], v[204:207], a[244:247], v[148:151]
ds_read_b64_tr_b16 a[66:67], v11 offset:2048
v_mfma_f32_16x16x32_bf16 v[148:151], v[200:203], a[240:243], v[148:151]
s_add_u32 s46, s52, 1405952
buffer_load_dwordx4 v3, s[28:31], s46 offen offset:3072 lds
v_and_b32 v75, 0xffff0000, v21
v_mfma_f32_16x16x32_bf16 v[128:131], v[200:203], a[232:235], v[128:131]
ds_read_b64_tr_b16 a[68:69], v11 offset:4096
v_lshlrev_b32 v76, 16, v22
v_mfma_f32_16x16x32_bf16 v[128:131], v[204:207], a[236:239], v[128:131]
s_add_u32 m0, s40, 77824
s_add_u32 s46, s52, 1441792
buffer_load_dwordx4 v3, s[28:31], s46 offen offset:0 lds
v_mfma_f32_16x16x32_bf16 v[108:111], v[204:207], a[228:231], v[108:111]
ds_read_b64_tr_b16 a[70:71], v11 offset:6144
v_and_b32 v77, 0xffff0000, v22
v_mfma_f32_16x16x32_bf16 v[108:111], v[200:203], a[224:227], v[108:111]
s_add_u32 s46, s52, 1473536
buffer_load_dwordx4 v3, s[28:31], s46 offen offset:1024 lds
v_lshlrev_b32 v78, 16, v23
v_mfma_f32_16x16x32_bf16 v[112:115], v[208:211], a[224:227], v[112:115]
v_and_b32 v79, 0xffff0000, v23
v_mfma_f32_16x16x32_bf16 v[112:115], v[212:215], a[228:231], v[112:115]
s_add_u32 s46, s52, 1505280
buffer_load_dwordx4 v3, s[28:31], s46 offen offset:2048 lds
v_mfma_f32_16x16x32_bf16 v[132:135], v[212:215], a[236:239], v[132:135]
v_lshlrev_b32 v80, 16, v24
v_mfma_f32_16x16x32_bf16 v[132:135], v[208:211], a[232:235], v[132:135]
s_add_u32 s46, s52, 1537024
buffer_load_dwordx4 v3, s[28:31], s46 offen offset:3072 lds
v_and_b32 v81, 0xffff0000, v24
v_mfma_f32_16x16x32_bf16 v[152:155], v[208:211], a[240:243], v[152:155]
v_mfma_f32_16x16x32_bf16 v[152:155], v[212:215], a[244:247], v[152:155]
v_lshlrev_b32 v82, 16, v25
v_mfma_f32_16x16x32_bf16 v[172:175], v[212:215], a[252:255], v[172:175]
v_and_b32 v83, 0xffff0000, v25
v_mfma_f32_16x16x32_bf16 v[172:175], v[208:211], a[248:251], v[172:175]
s_waitcnt vmcnt(18)
s_waitcnt vmcnt(26) lgkmcnt(0)
v_mfma_f32_16x16x32_bf16 v[96:99], a[0:3], a[40:43], v[96:99]
ds_read_b64_tr_b16 a[224:225], v4 offset:36864
v_mfma_f32_16x16x32_bf16 v[96:99], a[4:7], a[44:47], v[96:99]
s_add_u32 s47, s53, 5777408
buffer_load_dwordx4 a[184:187], v15, s[16:19], s47 offen sc1
v_mfma_f32_16x16x32_bf16 v[116:119], a[4:7], a[52:55], v[116:119]
ds_read_b64_tr_b16 a[226:227], v4 offset:38912
v_mfma_f32_16x16x32_bf16 v[116:119], a[0:3], a[48:51], v[116:119]
buffer_load_dwordx4 a[188:191], v15, s[16:19], s47 offen offset:1024 sc1
v_mfma_f32_16x16x32_bf16 v[136:139], a[0:3], a[56:59], v[136:139]
ds_read_b64_tr_b16 a[228:229], v4 offset:40960
v_mfma_f32_16x16x32_bf16 v[136:139], a[4:7], a[60:63], v[136:139]
s_add_u32 s47, s53, 5832704
buffer_load_dwordx4 a[192:195], v15, s[16:19], s47 offen sc1
v_mfma_f32_16x16x32_bf16 v[156:159], a[4:7], a[68:71], v[156:159]
ds_read_b64_tr_b16 a[230:231], v4 offset:43008
v_mfma_f32_16x16x32_bf16 v[156:159], a[0:3], a[64:67], v[156:159]
buffer_load_dwordx4 a[196:199], v15, s[16:19], s47 offen offset:1024 sc1
v_mfma_f32_16x16x32_bf16 v[160:163], a[8:11], a[64:67], v[160:163]
ds_read_b64_tr_b16 a[232:233], v5 offset:36864
v_mfma_f32_16x16x32_bf16 v[160:163], a[12:15], a[68:71], v[160:163]
s_add_u32 s47, s53, 5888000
buffer_load_dwordx4 a[200:203], v15, s[16:19], s47 offen sc1
v_mfma_f32_16x16x32_bf16 v[140:143], a[12:15], a[60:63], v[140:143]
ds_read_b64_tr_b16 a[234:235], v5 offset:38912
v_mfma_f32_16x16x32_bf16 v[140:143], a[8:11], a[56:59], v[140:143]
buffer_load_dwordx4 a[204:207], v15, s[16:19], s47 offen offset:1024 sc1
v_mfma_f32_16x16x32_bf16 v[120:123], a[8:11], a[48:51], v[120:123]
ds_read_b64_tr_b16 a[236:237], v5 offset:40960
v_mfma_f32_16x16x32_bf16 v[120:123], a[12:15], a[52:55], v[120:123]
s_add_u32 s47, s53, 5943296
buffer_load_dwordx4 a[208:211], v15, s[16:19], s47 offen sc1
K_pg13:
s_cbranch_execz K_back1
v_mfma_f32_16x16x32_bf16 v[100:103], a[12:15], a[44:47], v[100:103]
ds_read_b64_tr_b16 a[238:239], v5 offset:43008
v_mfma_f32_16x16x32_bf16 v[100:103], a[8:11], a[40:43], v[100:103]
buffer_load_dwordx4 a[212:215], v15, s[16:19], s47 offen offset:1024 sc1
v_mfma_f32_16x16x32_bf16 v[104:107], a[16:19], a[40:43], v[104:107]
ds_read_b64_tr_b16 a[240:241], v6 offset:36864
buffer_load_dword v222, v221, s[16:19], 0 offen sc1
v_mfma_f32_16x16x32_bf16 v[104:107], a[20:23], a[44:47], v[104:107]
s_add_u32 s47, s53, 5998592
buffer_load_dwordx4 a[216:219], v15, s[16:19], s47 offen sc1
v_mfma_f32_16x16x32_bf16 v[124:127], a[20:23], a[52:55], v[124:127]
ds_read_b64_tr_b16 a[242:243], v6 offset:38912
v_mfma_f32_16x16x32_bf16 v[124:127], a[16:19], a[48:51], v[124:127]
buffer_load_dwordx4 a[220:223], v15, s[16:19], s47 offen offset:1024 sc1
v_mfma_f32_16x16x32_bf16 v[144:147], a[16:19], a[56:59], v[144:147]
ds_read_b64_tr_b16 a[244:245], v6 offset:40960
v_mfma_f32_16x16x32_bf16 v[144:147], a[20:23], a[60:63], v[144:147]
s_add_u32 m0, s40, 0
s_add_u32 s46, s52, 1572864
buffer_load_dwordx4 v3, s[28:31], s46 offen offset:0 lds
v_mfma_f32_16x16x32_bf16 v[164:167], a[20:23], a[68:71], v[164:167]
ds_read_b64_tr_b16 a[246:247], v6 offset:43008
v_mfma_f32_16x16x32_bf16 v[164:167], a[16:19], a[64:67], v[164:167]
s_add_u32 s46, s52, 1604608
buffer_load_dwordx4 v3, s[28:31], s46 offen offset:1024 lds
v_mfma_f32_16x16x32_bf16 v[168:171], a[24:27], a[64:67], v[168:171]
ds_read_b64_tr_b16 a[248:249], v7 offset:36864
v_mfma_f32_16x16x32_bf16 v[168:171], a[28:31], a[68:71], v[168:171]
s_add_u32 s46, s52, 1636352
buffer_load_dwordx4 v3, s[28:31], s46 offen offset:2048 lds
v_mfma_f32_16x16x32_bf16 v[148:151], a[28:31], a[60:63], v[148:151]
ds_read_b64_tr_b16 a[250:251], v7 offset:38912
v_mfma_f32_16x16x32_bf16 v[148:151], a[24:27], a[56:59], v[148:151]
s_add_u32 s46, s52, 1668096
buffer_load_dwordx4 v3, s[28:31], s46 offen offset:3072 lds
v_mfma_f32_16x16x32_bf16 v[128:131], a[24:27], a[48:51], v[128:131]
ds_read_b64_tr_b16 a[252:253], v7 offset:40960
v_mfma_f32_16x16x32_bf16 v[128:131], a[28:31], a[52:55], v[128:131]
s_add_u32 m0, s40, 4096
s_add_u32 s46, s52, 1703936
buffer_load_dwordx4 v3, s[28:31], s46 offen offset:0 lds
v_mfma_f32_16x16x32_bf16 v[108:111], a[28:31], a[44:47], v[108:111]
ds_read_b64_tr_b16 a[254:255], v7 offset:43008
v_mfma_f32_16x16x32_bf16 v[108:111], a[24:27], a[40:43], v[108:111]
s_add_u32 s46, s52, 1735680
buffer_load_dwordx4 v3, s[28:31], s46 offen offset:1024 lds
v_mfma_f32_16x16x32_bf16 v[112:115], a[32:35], a[40:43], v[112:115]
v_mfma_f32_16x16x32_bf16 v[112:115], a[36:39], a[44:47], v[112:115]
s_add_u32 s46, s52, 1767424
buffer_load_dwordx4 v3, s[28:31], s46 offen offset:2048 lds
v_mfma_f32_16x16x32_bf16 v[132:135], a[36:39], a[52:55], v[132:135]
v_mfma_f32_16x16x32_bf16 v[132:135], a[32:35], a[48:51], v[132:135]
s_add_u32 s46, s52, 1799168
buffer_load_dwordx4 v3, s[28:31], s46 offen offset:3072 lds
v_mfma_f32_16x16x32_bf16 v[152:155], a[32:35], a[56:59], v[152:155]
s_waitcnt vmcnt(10)
v_cmp_ne_u32 vcc, s88, v222
s_cbranch_vccz Lspun_20
s_mov_b32 s56, 0x40000
Lspin_19:
buffer_load_dword v222, v221, s[16:19], 0 offen sc1
s_waitcnt vmcnt(0)
v_cmp_ne_u32 vcc, s88, v222
s_cbranch_vccz Lspun_20
s_sleep 2
s_sub_u32 s56, s56, 1
s_cmp_lg_u32 s56, 0
s_cbranch_scc1 Lspin_19
Lspun_20:
v_mfma_f32_16x16x32_bf16 v[152:155], a[36:39], a[60:63], v[152:155]
s_add_u32 s48, s100, 1
s_and_b32 s48, s48, 3
s_mul_i32 s48, s48, 10240
s_add_u32 s48, s48, s55
buffer_load_dwordx4 v[28:31], v15, s[16:19], s48 offen sc1
buffer_load_dwordx4 v[32:35], v15, s[16:19], s48 offen offset:1024 sc1
buffer_load_dwordx2 v[36:37], v12, s[16:19], s48 offen offset:2048 sc1
v_mfma_f32_16x16x32_bf16 v[172:175], a[36:39], a[68:71], v[172:175]
s_add_u32 s48, s100, 2
s_and_b32 s48, s48, 3
s_mul_i32 s48, s48, 10240
s_add_u32 s48, s48, s55
buffer_load_dwordx4 v[40:43], v15, s[16:19], s48 offen sc1
buffer_load_dwordx4 v[44:47], v15, s[16:19], s48 offen offset:1024 sc1
buffer_load_dwordx2 v[48:49], v12, s[16:19], s48 offen offset:2048 sc1
v_mfma_f32_16x16x32_bf16 v[172:175], a[32:35], a[64:67], v[172:175]
s_add_u32 s48, s100, 3
s_and_b32 s48, s48, 3
s_mul_i32 s48, s48, 10240
s_add_u32 s48, s48, s55
buffer_load_dwordx4 v[52:55], v15, s[16:19], s48 offen sc1
buffer_load_dwordx4 v[56:59], v15, s[16:19], s48 offen offset:1024 sc1
buffer_load_dwordx2 v[60:61], v12, s[16:19], s48 offen offset:2048 sc1
s_waitcnt vmcnt(28)
s_waitcnt vmcnt(36) lgkmcnt(0)
v_mfma_f32_16x16x32_bf16 v[96:99], a[144:147], a[224:227], v[96:99]
ds_read_b64_tr_b16 a[40:41], v4 offset:0
v_mfma_f32_16x16x32_bf16 v[96:99], a[148:151], a[228:231], v[96:99]
s_add_u32 s47, s53, 5779456
s_cmp_eq_u32 s44, 3
s_cselect_b32 s47, 67108864, s47
buffer_load_dwordx4 v[176:179], v15, s[16:19], s47 offen sc1
v_mfma_f32_16x16x32_bf16 v[116:119], a[148:151], a[236:239], v[116:119]
ds_read_b64_tr_b16 a[42:43], v4 offset:2048
v_mfma_f32_16x16x32_bf16 v[116:119], a[144:147], a[232:235], v[116:119]
buffer_load_dwordx4 v[180:183], v15, s[16:19], s47 offen offset:1024 sc1
v_mfma_f32_16x16x32_bf16 v[136:139], a[144:147], a[240:243], v[136:139]
ds_read_b64_tr_b16 a[44:45], v4 offset:4096
v_mfma_f32_16x16x32_bf16 v[136:139], a[148:151], a[244:247], v[136:139]
s_add_u32 s47, s53, 5834752
s_cmp_eq_u32 s44, 3
s_cselect_b32 s47, 67108864, s47
buffer_load_dwordx4 v[184:187], v15, s[16:19], s47 offen sc1
v_mfma_f32_16x16x32_bf16 v[156:159], a[148:151], a[252:255], v[156:159]
ds_read_b64_tr_b16 a[46:47], v4 offset:6144
v_mfma_f32_16x16x32_bf16 v[156:159], a[144:147], a[248:251], v[156:159]
buffer_load_dwordx4 v[188:191], v15, s[16:19], s47 offen offset:1024 sc1
v_mfma_f32_16x16x32_bf16 v[160:163], a[152:155], a[248:251], v[160:163]
ds_read_b64_tr_b16 a[48:49], v5 offset:0
v_mfma_f32_16x16x32_bf16 v[160:163], a[156:159], a[252:255], v[160:163]
s_add_u32 s47, s53, 5890048
s_cmp_eq_u32 s44, 3
s_cselect_b32 s47, 67108864, s47
buffer_load_dwordx4 v[192:195], v15, s[16:19], s47 offen sc1
v_mfma_f32_16x16x32_bf16 v[140:143], a[156:159], a[244:247], v[140:143]
ds_read_b64_tr_b16 a[50:51], v5 offset:2048
v_mfma_f32_16x16x32_bf16 v[140:143], a[152:155], a[240:243], v[140:143]
buffer_load_dwordx4 v[196:199], v15, s[16:19], s47 offen offset:1024 sc1
v_mfma_f32_16x16x32_bf16 v[120:123], a[152:155], a[232:235], v[120:123]
ds_read_b64_tr_b16 a[52:53], v5 offset:4096
v_mfma_f32_16x16x32_bf16 v[120:123], a[156:159], a[236:239], v[120:123]
s_add_u32 s47, s53, 5945344
s_cmp_eq_u32 s44, 3
s_cselect_b32 s47, 67108864, s47
buffer_load_dwordx4 v[200:203], v15, s[16:19], s47 offen sc1
v_mfma_f32_16x16x32_bf16 v[100:103], a[156:159], a[228:231], v[100:103]
ds_read_b64_tr_b16 a[54:55], v5 offset:6144
v_mfma_f32_16x16x32_bf16 v[100:103], a[152:155], a[224:227], v[100:103]
buffer_load_dwordx4 v[204:207], v15, s[16:19], s47 offen offset:1024 sc1
v_mfma_f32_16x16x32_bf16 v[104:107], a[160:163], a[224:227], v[104:107]
ds_read_b64_tr_b16 a[56:57], v6 offset:0
v_mfma_f32_16x16x32_bf16 v[104:107], a[164:167], a[228:231], v[104:107]
s_add_u32 s47, s53, 6000640
s_cmp_eq_u32 s44, 3
s_cselect_b32 s47, 67108864, s47
buffer_load_dwordx4 v[208:211], v15, s[16:19], s47 offen sc1
v_mfma_f32_16x16x32_bf16 v[124:127], a[164:167], a[236:239], v[124:127]
ds_read_b64_tr_b16 a[58:59], v6 offset:2048
v_mfma_f32_16x16x32_bf16 v[124:127], a[160:163], a[232:235], v[124:127]
buffer_load_dwordx4 v[212:215], v15, s[16:19], s47 offen offset:1024 sc1
v_mfma_f32_16x16x32_bf16 v[144:147], a[160:163], a[240:243], v[144:147]
ds_read_b64_tr_b16 a[60:61], v6 offset:4096
v_mfma_f32_16x16x32_bf16 v[144:147], a[164:167], a[244:247], v[144:147]
v_mfma_f32_16x16x32_bf16 v[164:167], a[164:167], a[252:255], v[164:167]
ds_read_b64_tr_b16 a[62:63], v6 offset:6144
v_mfma_f32_16x16x32_bf16 v[164:167], a[160:163], a[248:251], v[164:167]
v_mfma_f32_16x16x32_bf16 v[168:171], a[168:171], a[248:251], v[168:171]
ds_read_b64_tr_b16 a[64:65], v7 offset:0
v_mfma_f32_16x16x32_bf16 v[168:171], a[172:175], a[252:255], v[168:171]
v_mfma_f32_16x16x32_bf16 v[148:151], a[172:175], a[244:247], v[148:151]
ds_read_b64_tr_b16 a[66:67], v7 offset:2048
v_mfma_f32_16x16x32_bf16 v[148:151], a[168:171], a[240:243], v[148:151]
v_mfma_f32_16x16x32_bf16 v[128:131], a[168:171], a[232:235], v[128:131]
ds_read_b64_tr_b16 a[68:69], v7 offset:4096
v_mfma_f32_16x16x32_bf16 v[128:131], a[172:175], a[236:239], v[128:131]
v_mfma_f32_16x16x32_bf16 v[108:111], a[172:175], a[228:231], v[108:111]
ds_read_b64_tr_b16 a[70:71], v7 offset:6144
v_mfma_f32_16x16x32_bf16 v[108:111], a[168:171], a[224:227], v[108:111]
v_mfma_f32_16x16x32_bf16 v[112:115], a[176:179], a[224:227], v[112:115]
v_mfma_f32_16x16x32_bf16 v[112:115], a[180:183], a[228:231], v[112:115]
v_mfma_f32_16x16x32_bf16 v[132:135], a[180:183], a[236:239], v[132:135]
v_mfma_f32_16x16x32_bf16 v[132:135], a[176:179], a[232:235], v[132:135]
v_mfma_f32_16x16x32_bf16 v[152:155], a[176:179], a[240:243], v[152:155]
v_mfma_f32_16x16x32_bf16 v[152:155], a[180:183], a[244:247], v[152:155]
v_mfma_f32_16x16x32_bf16 v[172:175], a[180:183], a[252:255], v[172:175]
v_mfma_f32_16x16x32_bf16 v[172:175], a[176:179], a[248:251], v[172:175]
s_waitcnt vmcnt(19)
s_waitcnt vmcnt(10)
s_waitcnt vmcnt(27) lgkmcnt(0)
v_mfma_f32_16x16x32_bf16 v[96:99], a[184:187], a[40:43], v[96:99]
ds_read_b64_tr_b16 a[224:225], v8 offset:0
v_lshlrev_b32 v84, 16, v28
v_and_b32 v28, 0xffff0000, v28
v_mfma_f32_16x16x32_bf16 v[96:99], a[188:191], a[44:47], v[96:99]
buffer_load_ushort v250, v252, s[64:67], 0 offen
v_add_f32 v64, v64, v84
v_mfma_f32_16x16x32_bf16 v[116:119], a[188:191], a[52:55], v[116:119]
ds_read_b64_tr_b16 a[226:227], v8 offset:2048
v_add_f32 v65, v65, v28
v_lshlrev_b32 v84, 16, v29
v_mfma_f32_16x16x32_bf16 v[116:119], a[184:187], a[48:51], v[116:119]
v_and_b32 v29, 0xffff0000, v29
v_mfma_f32_16x16x32_bf16 v[136:139], a[184:187], a[56:59], v[136:139]
ds_read_b64_tr_b16 a[228:229], v8 offset:4096
v_add_f32 v66, v66, v84
v_add_f32 v67, v67, v29
v_mfma_f32_16x16x32_bf16 v[136:139], a[188:191], a[60:63], v[136:139]
buffer_load_dwordx2 v[240:241], v251, s[36:39], s43 offen offset:0
v_lshlrev_b32 v84, 16, v30
v_mfma_f32_16x16x32_bf16 v[156:159], a[188:191], a[68:71], v[156:159]
ds_read_b64_tr_b16 a[230:231], v8 offset:6144
v_and_b32 v30, 0xffff0000, v30
v_add_f32 v68, v68, v84
v_mfma_f32_16x16x32_bf16 v[156:159], a[184:187], a[64:67], v[156:159]
v_add_f32 v69, v69, v30
v_mfma_f32_16x16x32_bf16 v[160:163], a[192:195], a[64:67], v[160:163]
ds_read_b64_tr_b16 a[232:233], v9 offset:0
v_lshlrev_b32 v84, 16, v31
v_and_b32 v31, 0xffff0000, v31
v_mfma_f32_16x16x32_bf16 v[160:163], a[196:199], a[68:71], v[160:163]
buffer_load_dwordx2 v[242:243], v251, s[36:39], s43 offen offset:32
v_add_f32 v70, v70, v84
v_mfma_f32_16x16x32_bf16 v[140:143], a[196:199], a[60:63], v[140:143]
ds_read_b64_tr_b16 a[234:235], v9 offset:2048
v_add_f32 v71, v71, v31
v_lshlrev_b32 v84, 16, v32
v_mfma_f32_16x16x32_bf16 v[140:143], a[192:195], a[56:59], v[140:143]
v_and_b32 v32, 0xffff0000, v32
v_mfma_f32_16x16x32_bf16 v[120:123], a[192:195], a[48:51], v[120:123]
ds_read_b64_tr_b16 a[236:237], v9 offset:4096
v_add_f32 v72, v72, v84
v_add_f32 v73, v73, v32
v_mfma_f32_16x16x32_bf16 v[120:123], a[196:199], a[52:55], v[120:123]
buffer_load_dwordx2 v[244:245], v251, s[36:39], s43 offen offset:64
v_lshlrev_b32 v84, 16, v33
v_mfma_f32_16x16x32_bf16 v[100:103], a[196:199], a[44:47], v[100:103]
ds_read_b64_tr_b16 a[238:239], v9 offset:6144
v_and_b32 v33, 0xffff0000, v33
v_add_f32 v74, v74, v84
v_mfma_f32_16x16x32_bf16 v[100:103], a[192:195], a[40:43], v[100:103]
v_add_f32 v75, v75, v33
v_mfma_f32_16x16x32_bf16 v[104:107], a[200:203], a[40:43], v[104:107]
ds_read_b64_tr_b16 a[240:241], v10 offset:0
v_lshlrev_b32 v84, 16, v34
v_and_b32 v34, 0xffff0000, v34
v_mfma_f32_16x16x32_bf16 v[104:107], a[204:207], a[44:47], v[104:107]
buffer_load_dwordx2 v[246:247], v251, s[36:39], s43 offen offset:96
v_add_f32 v76, v76, v84
v_mfma_f32_16x16x32_bf16 v[124:127], a[204:207], a[52:55], v[124:127]
ds_read_b64_tr_b16 a[242:243], v10 offset:2048
v_add_f32 v77, v77, v34
v_lshlrev_b32 v84, 16, v35
v_mfma_f32_16x16x32_bf16 v[124:127], a[200:203], a[48:51], v[124:127]
v_and_b32 v35, 0xffff0000, v35
v_mfma_f32_16x16x32_bf16 v[144:147], a[200:203], a[56:59], v[144:147]
ds_read_b64_tr_b16 a[244:245], v10 offset:4096
v_add_f32 v78, v78, v84
v_add_f32 v79, v79, v35
v_mfma_f32_16x16x32_bf16 v[144:147], a[204:207], a[60:63], v[144:147]
buffer_load_dwordx2 v[248:249], v251, s[36:39], s43 offen offset:128
v_lshlrev_b32 v84, 16, v36
v_mfma_f32_16x16x32_bf16 v[164:167], a[204:207], a[68:71], v[164:167]
ds_read_b64_tr_b16 a[246:247], v10 offset:6144
v_and_b32 v36, 0xffff0000, v36
v_add_f32 v80, v80, v84
v_mfma_f32_16x16x32_bf16 v[164:167], a[200:203], a[64:67], v[164:167]
v_add_f32 v81, v81, v36
v_mfma_f32_16x16x32_bf16 v[168:171], a[208:211], a[64:67], v[168:171]
ds_read_b64_tr_b16 a[248:249], v11 offset:0
v_lshlrev_b32 v84, 16, v37
v_and_b32 v37, 0xffff0000, v37
v_mfma_f32_16x16x32_bf16 v[168:171], a[212:215], a[68:71], v[168:171]
v_add_f32 v82, v82, v84
v_mfma_f32_16x16x32_bf16 v[148:151], a[212:215], a[60:63], v[148:151]
ds_read_b64_tr_b16 a[250:251], v11 offset:2048
v_add_f32 v83, v83, v37
v_lshlrev_b32 v84, 16, v40
v_mfma_f32_16x16x32_bf16 v[148:151], a[208:211], a[56:59], v[148:151]
v_and_b32 v40, 0xffff0000, v40
v_mfma_f32_16x16x32_bf16 v[128:131], a[208:211], a[48:51], v[128:131]
ds_read_b64_tr_b16 a[252:253], v11 offset:4096
v_add_f32 v64, v64, v84
v_add_f32 v65, v65, v40
v_mfma_f32_16x16x32_bf16 v[128:131], a[212:215], a[52:55], v[128:131]
v_lshlrev_b32 v84, 16, v41
v_mfma_f32_16x16x32_bf16 v[108:111], a[212:215], a[44:47], v[108:111]
ds_read_b64_tr_b16 a[254:255], v11 offset:6144
v_and_b32 v41, 0xffff0000, v41
v_add_f32 v66, v66, v84
v_mfma_f32_16x16x32_bf16 v[108:111], a[208:211], a[40:43], v[108:111]
v_add_f32 v67, v67, v41
v_mfma_f32_16x16x32_bf16 v[112:115], a[216:219], a[40:43], v[112:115]
v_lshlrev_b32 v84, 16, v42
v_and_b32 v42, 0xffff0000, v42
v_mfma_f32_16x16x32_bf16 v[112:115], a[220:223], a[44:47], v[112:115]
v_add_f32 v68, v68, v84
v_mfma_f32_16x16x32_bf16 v[132:135], a[220:223], a[52:55], v[132:135]
v_add_f32 v69, v69, v42
v_lshlrev_b32 v84, 16, v43
v_mfma_f32_16x16x32_bf16 v[132:135], a[216:219], a[48:51], v[132:135]
v_and_b32 v43, 0xffff0000, v43
v_mfma_f32_16x16x32_bf16 v[152:155], a[216:219], a[56:59], v[152:155]
v_add_f32 v70, v70, v84
v_add_f32 v71, v71, v43
v_mfma_f32_16x16x32_bf16 v[152:155], a[220:223], a[60:63], v[152:155]
v_lshlrev_b32 v84, 16, v44
v_mfma_f32_16x16x32_bf16 v[172:175], a[220:223], a[68:71], v[172:175]
v_and_b32 v44, 0xffff0000, v44
v_add_f32 v72, v72, v84
v_mfma_f32_16x16x32_bf16 v[172:175], a[216:219], a[64:67], v[172:175]
v_add_f32 v73, v73, v44
s_waitcnt vmcnt(6) lgkmcnt(0)
v_mfma_f32_16x16x32_bf16 v[156:159], v[176:179], a[248:251], v[156:159]
v_add_u32 v218, s40, v15
v_add_u32 v219, 0, v218
v_mfma_f32_16x16x32_bf16 v[156:159], v[180:183], a[252:255], v[156:159]
v_add_u32 v218, 73728, v218
v_mfma_f32_16x16x32_bf16 v[160:163], v[188:191], a[252:255], v[160:163]
s_add_u32 s46, s44, 3
s_and_b32 s46, s46, 3
v_mfma_f32_16x16x32_bf16 v[160:163], v[184:187], a[248:251], v[160:163]
s_lshl_b32 s46, s46, 13
v_mfma_f32_16x16x32_bf16 v[164:167], v[192:195], a[248:251], v[164:167]
s_add_u32 s46, s46, 0
v_add_u32 v5, s46, v15
v_mfma_f32_16x16x32_bf16 v[164:167], v[196:199], a[252:255], v[164:167]
s_add_u32 s46, s44, 2
v_mfma_f32_16x16x32_bf16 v[168:171], v[204:207], a[252:255], v[168:171]
s_and_b32 s46, s46, 3
s_lshl_b32 s46, s46, 13
v_mfma_f32_16x16x32_bf16 v[168:171], v[200:203], a[248:251], v[168:171]
s_add_u32 s46, s46, 110592
v_mfma_f32_16x16x32_bf16 v[172:175], v[208:211], a[248:251], v[172:175]
v_add_u32 v6, s46, v15
s_add_u32 s46, s44, 1
v_mfma_f32_16x16x32_bf16 v[172:175], v[212:215], a[252:255], v[172:175]
s_and_b32 s46, s46, 3
v_mfma_f32_16x16x32_bf16 v[136:139], v[180:183], a[244:247], v[136:139]
s_lshl_b32 s46, s46, 13
v_mfma_f32_16x16x32_bf16 v[136:139], v[176:179], a[240:243], v[136:139]
ds_write_b128 v218, v[156:159] offset:0
s_add_u32 s46, s46, 73728
v_add_u32 v7, s46, v15
v_mfma_f32_16x16x32_bf16 v[140:143], v[184:187], a[240:243], v[140:143]
v_lshlrev_b32 v84, 16, v45
v_mfma_f32_16x16x32_bf16 v[140:143], v[188:191], a[244:247], v[140:143]
ds_write_b128 v218, v[160:163] offset:1024
v_and_b32 v45, 0xffff0000, v45
v_add_f32 v74, v74, v84
v_mfma_f32_16x16x32_bf16 v[144:147], v[196:199], a[244:247], v[144:147]
v_add_f32 v75, v75, v45
v_mfma_f32_16x16x32_bf16 v[144:147], v[192:195], a[240:243], v[144:147]
ds_write_b128 v218, v[164:167] offset:2048
v_lshlrev_b32 v84, 16, v46
v_and_b32 v46, 0xffff0000, v46
v_mfma_f32_16x16x32_bf16 v[148:151], v[200:203], a[240:243], v[148:151]
v_add_f32 v76, v76, v84
v_mfma_f32_16x16x32_bf16 v[148:151], v[204:207], a[244:247], v[148:151]
ds_write_b128 v218, v[168:171] offset:3072
v_add_f32 v77, v77, v46
v_lshlrev_b32 v84, 16, v47
v_mfma_f32_16x16x32_bf16 v[152:155], v[212:215], a[244:247], v[152:155]
v_and_b32 v47, 0xffff0000, v47
v_mfma_f32_16x16x32_bf16 v[152:155], v[208:211], a[240:243], v[152:155]
ds_write_b128 v218, v[172:175] offset:4096
v_add_f32 v78, v78, v84
v_mfma_f32_16x16x32_bf16 v[116:119], v[176:179], a[232:235], v[116:119]
v_add_f32 v79, v79, v47
v_lshlrev_b32 v84, 16, v48
v_mfma_f32_16x16x32_bf16 v[116:119], v[180:183], a[236:239], v[116:119]
ds_write_b128 v218, v[136:139] offset:36864
v_and_b32 v48, 0xffff0000, v48
v_mfma_f32_16x16x32_bf16 v[120:123], v[188:191], a[236:239], v[120:123]
v_add_f32 v80, v80, v84
v_add_f32 v81, v81, v48
v_mfma_f32_16x16x32_bf16 v[120:123], v[184:187], a[232:235], v[120:123]
ds_write_b128 v218, v[140:143] offset:37888
v_lshlrev_b32 v84, 16, v49
v_mfma_f32_16x16x32_bf16 v[124:127], v[192:195], a[232:235], v[124:127]
v_and_b32 v49, 0xffff0000, v49
v_add_f32 v82, v82, v84
v_mfma_f32_16x16x32_bf16 v[124:127], v[196:199], a[236:239], v[124:127]
ds_write_b128 v218, v[144:147] offset:38912
v_add_f32 v83, v83, v49
v_mfma_f32_16x16x32_bf16 v[128:131], v[204:207], a[236:239], v[128:131]
v_lshlrev_b32 v84, 16, v52
v_and_b32 v52, 0xffff0000, v52
v_mfma_f32_16x16x32_bf16 v[128:131], v[200:203], a[232:235], v[128:131]
ds_write_b128 v218, v[148:151] offset:39936
v_add_f32 v64, v64, v84
v_mfma_f32_16x16x32_bf16 v[132:135], v[208:211], a[232:235], v[132:135]
v_add_f32 v65, v65, v52
v_lshlrev_b32 v84, 16, v53
v_mfma_f32_16x16x32_bf16 v[132:135], v[212:215], a[236:239], v[132:135]
ds_write_b128 v218, v[152:155] offset:40960
v_and_b32 v53, 0xffff0000, v53
v_mfma_f32_16x16x32_bf16 v[96:99], v[180:183], a[228:231], v[96:99]
v_add_f32 v66, v66, v84
v_mfma_f32_16x16x32_bf16 v[96:99], v[176:179], a[224:227], v[96:99]
ds_write_b128 v219, v[116:119] offset:0
v_add_f32 v67, v67, v53
v_lshlrev_b32 v84, 16, v54
v_mfma_f32_16x16x32_bf16 v[100:103], v[184:187], a[224:227], v[100:103]
v_and_b32 v54, 0xffff0000, v54
v_mfma_f32_16x16x32_bf16 v[100:103], v[188:191], a[228:231], v[100:103]
ds_write_b128 v219, v[120:123] offset:1024
v_add_f32 v68, v68, v84
v_add_f32 v69, v69, v54
v_mfma_f32_16x16x32_bf16 v[104:107], v[196:199], a[228:231], v[104:107]
v_lshlrev_b32 v84, 16, v55
v_mfma_f32_16x16x32_bf16 v[104:107], v[192:195], a[224:227], v[104:107]
ds_write_b128 v219, v[124:127] offset:2048
v_and_b32 v55, 0xffff0000, v55
v_add_f32 v70, v70, v84
v_mfma_f32_16x16x32_bf16 v[108:111], v[200:203], a[224:227], v[108:111]
v_add_f32 v71, v71, v55
v_mfma_f32_16x16x32_bf16 v[108:111], v[204:207], a[228:231], v[108:111]
ds_write_b128 v219, v[128:131] offset:3072
v_lshlrev_b32 v84, 16, v56
v_and_b32 v56, 0xffff0000, v56
v_mfma_f32_16x16x32_bf16 v[112:115], v[212:215], a[228:231], v[112:115]
v_add_f32 v72, v72, v84
v_mfma_f32_16x16x32_bf16 v[112:115], v[208:211], a[224:227], v[112:115]
ds_write_b128 v219, v[132:135] offset:4096
v_add_f32 v73, v73, v56
s_mov_b32 s46, 0xffff0000
v_lshlrev_b32 v84, 16, v57
v_and_b32 v57, 0xffff0000, v57
v_add_f32 v74, v74, v84
v_add_f32 v75, v75, v57
v_lshlrev_b32 v84, 16, v58
v_and_b32 v58, 0xffff0000, v58
v_add_f32 v76, v76, v84
v_add_f32 v77, v77, v58
v_lshlrev_b32 v84, 16, v59
v_and_b32 v59, 0xffff0000, v59
v_add_f32 v78, v78, v84
v_add_f32 v79, v79, v59
v_lshlrev_b32 v84, 16, v60
v_and_b32 v60, 0xffff0000, v60
v_add_f32 v80, v80, v84
v_add_f32 v81, v81, v60
v_lshlrev_b32 v84, 16, v61
v_and_b32 v61, 0xffff0000, v61
v_add_f32 v82, v82, v84
v_add_f32 v83, v83, v61
s_waitcnt lgkmcnt(0)
s_barrier
ds_read_b128 v[116:119], v5 offset:0
ds_read_b128 v[120:123], v5 offset:1024
ds_read_b128 v[124:127], v5 offset:2048
ds_read_b128 v[128:131], v5 offset:3072
ds_read_b128 v[132:135], v5 offset:4096
ds_read_b128 v[136:139], v6 offset:0
ds_read_b128 v[140:143], v6 offset:1024
ds_read_b128 v[144:147], v6 offset:2048
ds_read_b128 v[148:151], v6 offset:3072
ds_read_b128 v[152:155], v6 offset:4096
ds_read_b128 v[156:159], v7 offset:0
ds_read_b128 v[160:163], v7 offset:1024
ds_read_b128 v[164:167], v7 offset:2048
ds_read_b128 v[168:171], v7 offset:3072
ds_read_b128 v[172:175], v7 offset:4096
s_waitcnt vmcnt(0)
v_lshlrev_b32 v216, 16, v250
v_lshlrev_b32 v217, 16, v250
s_mov_b32 s77, s76
v_lshlrev_b32 v224, 16, v240
v_and_b32 v225, 0xffff0000, v240
v_lshlrev_b32 v226, 16, v241
v_and_b32 v227, 0xffff0000, v241
v_lshlrev_b32 v228, 16, v242
v_and_b32 v229, 0xffff0000, v242
v_lshlrev_b32 v230, 16, v243
v_and_b32 v231, 0xffff0000, v243
v_lshlrev_b32 v232, 16, v244
v_and_b32 v233, 0xffff0000, v244
v_lshlrev_b32 v234, 16, v245
v_and_b32 v235, 0xffff0000, v245
v_lshlrev_b32 v236, 16, v246
v_and_b32 v237, 0xffff0000, v246
v_lshlrev_b32 v238, 16, v247
v_and_b32 v239, 0xffff0000, v247
v_lshlrev_b32 v252, 16, v248
v_and_b32 v253, 0xffff0000, v248
v_lshlrev_b32 v254, 16, v249
v_and_b32 v255, 0xffff0000, v249
v_pk_add_f32 v[96:97], v[96:97], v[216:217]
v_pk_add_f32 v[98:99], v[98:99], v[216:217]
v_pk_add_f32 v[100:101], v[100:101], v[216:217]
v_pk_add_f32 v[102:103], v[102:103], v[216:217]
v_pk_add_f32 v[104:105], v[104:105], v[216:217]
v_pk_add_f32 v[106:107], v[106:107], v[216:217]
v_pk_add_f32 v[108:109], v[108:109], v[216:217]
v_pk_add_f32 v[110:111], v[110:111], v[216:217]
v_pk_add_f32 v[112:113], v[112:113], v[216:217]
v_pk_add_f32 v[114:115], v[114:115], v[216:217]
s_waitcnt lgkmcnt(10)
v_pk_add_f32 v[96:97], v[96:97], v[116:117]
v_pk_add_f32 v[98:99], v[98:99], v[118:119]
v_pk_add_f32 v[100:101], v[100:101], v[120:121]
v_pk_add_f32 v[102:103], v[102:103], v[122:123]
v_pk_add_f32 v[104:105], v[104:105], v[124:125]
v_pk_add_f32 v[106:107], v[106:107], v[126:127]
v_pk_add_f32 v[108:109], v[108:109], v[128:129]
v_pk_add_f32 v[110:111], v[110:111], v[130:131]
v_pk_add_f32 v[112:113], v[112:113], v[132:133]
v_pk_add_f32 v[114:115], v[114:115], v[134:135]
s_waitcnt lgkmcnt(5)
v_pk_add_f32 v[96:97], v[96:97], v[136:137]
v_pk_add_f32 v[98:99], v[98:99], v[138:139]
v_pk_add_f32 v[100:101], v[100:101], v[140:141]
v_pk_add_f32 v[102:103], v[102:103], v[142:143]
v_pk_add_f32 v[104:105], v[104:105], v[144:145]
v_pk_add_f32 v[106:107], v[106:107], v[146:147]
v_pk_add_f32 v[108:109], v[108:109], v[148:149]
v_pk_add_f32 v[110:111], v[110:111], v[150:151]
v_pk_add_f32 v[112:113], v[112:113], v[152:153]
v_pk_add_f32 v[114:115], v[114:115], v[154:155]
s_waitcnt lgkmcnt(0)
v_pk_add_f32 v[96:97], v[96:97], v[156:157]
v_pk_add_f32 v[98:99], v[98:99], v[158:159]
v_pk_add_f32 v[100:101], v[100:101], v[160:161]
v_pk_add_f32 v[102:103], v[102:103], v[162:163]
v_pk_add_f32 v[104:105], v[104:105], v[164:165]
v_pk_add_f32 v[106:107], v[106:107], v[166:167]
v_pk_add_f32 v[108:109], v[108:109], v[168:169]
v_pk_add_f32 v[110:111], v[110:111], v[170:171]
v_pk_add_f32 v[112:113], v[112:113], v[172:173]
v_pk_add_f32 v[114:115], v[114:115], v[174:175]
v_pk_mul_f32 v[116:117], v[96:97], s[76:77]
v_pk_mul_f32 v[118:119], v[98:99], s[76:77]
v_pk_mul_f32 v[120:121], v[100:101], s[76:77]
v_pk_mul_f32 v[122:123], v[102:103], s[76:77]
v_pk_mul_f32 v[124:125], v[104:105], s[76:77]
v_pk_mul_f32 v[126:127], v[106:107], s[76:77]
v_pk_mul_f32 v[128:129], v[108:109], s[76:77]
v_pk_mul_f32 v[130:131], v[110:111], s[76:77]
v_pk_mul_f32 v[132:133], v[112:113], s[76:77]
v_pk_mul_f32 v[134:135], v[114:115], s[76:77]
v_exp_f32 v116, v116
v_exp_f32 v117, v117
v_exp_f32 v118, v118
v_exp_f32 v119, v119
v_exp_f32 v120, v120
v_exp_f32 v121, v121
v_exp_f32 v122, v122
v_exp_f32 v123, v123
v_exp_f32 v124, v124
v_exp_f32 v125, v125
v_exp_f32 v126, v126
v_exp_f32 v127, v127
v_exp_f32 v128, v128
v_exp_f32 v129, v129
v_exp_f32 v130, v130
v_exp_f32 v131, v131
v_exp_f32 v132, v132
v_exp_f32 v133, v133
v_exp_f32 v134, v134
v_exp_f32 v135, v135
v_pk_mul_f32 v[96:97], v[96:97], v[64:65]
v_pk_mul_f32 v[98:99], v[98:99], v[66:67]
v_pk_mul_f32 v[100:101], v[100:101], v[68:69]
v_pk_mul_f32 v[102:103], v[102:103], v[70:71]
v_pk_mul_f32 v[104:105], v[104:105], v[72:73]
v_pk_mul_f32 v[106:107], v[106:107], v[74:75]
v_pk_mul_f32 v[108:109], v[108:109], v[76:77]
v_pk_mul_f32 v[110:111], v[110:111], v[78:79]
v_pk_mul_f32 v[112:113], v[112:113], v[80:81]
v_pk_mul_f32 v[114:115], v[114:115], v[82:83]
v_pk_add_f32 v[116:117], v[116:117], 1.0 op_sel_hi:[1,0]
v_pk_add_f32 v[118:119], v[118:119], 1.0 op_sel_hi:[1,0]
v_pk_add_f32 v[120:121], v[120:121], 1.0 op_sel_hi:[1,0]
v_pk_add_f32 v[122:123], v[122:123], 1.0 op_sel_hi:[1,0]
v_pk_add_f32 v[124:125], v[124:125], 1.0 op_sel_hi:[1,0]
v_pk_add_f32 v[126:127], v[126:127], 1.0 op_sel_hi:[1,0]
v_pk_add_f32 v[128:129], v[128:129], 1.0 op_sel_hi:[1,0]
v_pk_add_f32 v[130:131], v[130:131], 1.0 op_sel_hi:[1,0]
v_pk_add_f32 v[132:133], v[132:133], 1.0 op_sel_hi:[1,0]
v_pk_add_f32 v[134:135], v[134:135], 1.0 op_sel_hi:[1,0]
v_rcp_f32 v116, v116
v_rcp_f32 v117, v117
v_rcp_f32 v118, v118
v_rcp_f32 v119, v119
s_nop 0
v_pk_fma_f32 v[224:225], v[96:97], v[116:117], v[224:225]
v_pk_fma_f32 v[226:227], v[98:99], v[118:119], v[226:227]
v_rcp_f32 v120, v120
v_rcp_f32 v121, v121
v_rcp_f32 v122, v122
v_rcp_f32 v123, v123
v_cvt_pk_bf16_f32 v136, v224, v225
v_cvt_pk_bf16_f32 v137, v226, v227
buffer_store_dwordx2 v[136:137], v251, s[68:71], s43 offen offset:0
v_pk_fma_f32 v[228:229], v[100:101], v[120:121], v[228:229]
v_pk_fma_f32 v[230:231], v[102:103], v[122:123], v[230:231]
v_rcp_f32 v124, v124
v_rcp_f32 v125, v125
v_rcp_f32 v126, v126
v_rcp_f32 v127, v127
v_cvt_pk_bf16_f32 v138, v228, v229
v_cvt_pk_bf16_f32 v139, v230, v231
buffer_store_dwordx2 v[138:139], v251, s[68:71], s43 offen offset:32
v_pk_fma_f32 v[232:233], v[104:105], v[124:125], v[232:233]
v_pk_fma_f32 v[234:235], v[106:107], v[126:127], v[234:235]
v_rcp_f32 v128, v128
v_rcp_f32 v129, v129
v_rcp_f32 v130, v130
v_rcp_f32 v131, v131
v_cvt_pk_bf16_f32 v140, v232, v233
v_cvt_pk_bf16_f32 v141, v234, v235
buffer_store_dwordx2 v[140:141], v251, s[68:71], s43 offen offset:64
v_pk_fma_f32 v[236:237], v[108:109], v[128:129], v[236:237]
v_pk_fma_f32 v[238:239], v[110:111], v[130:131], v[238:239]
v_rcp_f32 v132, v132
v_rcp_f32 v133, v133
v_rcp_f32 v134, v134
v_rcp_f32 v135, v135
v_cvt_pk_bf16_f32 v142, v236, v237
v_cvt_pk_bf16_f32 v143, v238, v239
buffer_store_dwordx2 v[142:143], v251, s[68:71], s43 offen offset:96
K_pg14:
s_cbranch_execz K_back2
v_pk_fma_f32 v[252:253], v[112:113], v[132:133], v[252:253]
v_pk_fma_f32 v[254:255], v[114:115], v[134:135], v[254:255]
v_cvt_pk_bf16_f32 v144, v252, v253
v_cvt_pk_bf16_f32 v145, v254, v255
buffer_store_dwordx2 v[144:145], v251, s[68:71], s43 offen offset:128
K_end:
s_endpgm
K_plain:
v_mfma_f32_16x16x32_bf16 v[96:99], a[128:131], v[32:35], v[224:227]
v_exp_f32 v157, v157
v_mfma_f32_16x16x32_bf16 v[96:99], a[132:135], v[36:39], v[96:99]
ds_read_b64_tr_b16 a[192:193], v6 offset:32768
v_cvt_pk_bf16_f32 v190, v156, v157
v_mfma_f32_16x16x32_bf16 v[96:99], a[136:139], v[40:43], v[96:99]
v_exp_f32 v158, v158
v_mfma_f32_16x16x32_bf16 v[96:99], a[140:143], v[44:47], v[96:99]
ds_read_b64_tr_b16 a[194:195], v6 offset:36864
v_mfma_f32_16x16x32_bf16 v[100:103], a[140:143], v[60:63], v[228:231]
v_exp_f32 v159, v159
v_mfma_f32_16x16x32_bf16 v[100:103], a[136:139], v[56:59], v[100:103]
ds_read_b64_tr_b16 a[196:197], v6 offset:40960
v_cvt_pk_bf16_f32 v191, v158, v159
v_mfma_f32_16x16x32_bf16 v[100:103], a[132:135], v[52:55], v[100:103]
v_mfma_f32_16x16x32_bf16 v[100:103], a[128:131], v[48:51], v[100:103]
ds_read_b64_tr_b16 a[198:199], v6 offset:45056
v_mfma_f32_16x16x32_bf16 v[104:107], a[128:131], v[64:67], v[232:235]
v_mfma_f32_16x16x32_bf16 v[104:107], a[132:135], v[68:71], v[104:107]
ds_read_b64_tr_b16 a[200:201], v7 offset:32768
v_mfma_f32_16x16x32_bf16 v[104:107], a[136:139], v[72:75], v[104:107]
v_exp_f32 v96, v96
v_mfma_f32_16x16x32_bf16 v[104:107], a[140:143], v[76:79], v[104:107]
ds_read_b64_tr_b16 a[202:203], v7 offset:36864
v_mfma_f32_16x16x32_bf16 v[108:111], a[140:143], v[92:95], v[236:239]
v_exp_f32 v97, v97
v_mfma_f32_16x16x32_bf16 v[108:111], a[136:139], v[88:91], v[108:111]
ds_read_b64_tr_b16 a[204:205], v7 offset:40960
v_cvt_pk_bf16_f32 v192, v96, v97
v_mfma_f32_16x16x32_bf16 v[108:111], a[132:135], v[84:87], v[108:111]
v_exp_f32 v98, v98
v_mfma_f32_16x16x32_bf16 v[108:111], a[128:131], v[80:83], v[108:111]
ds_read_b64_tr_b16 a[206:207], v7 offset:45056
v_mfma_f32_16x16x32_bf16 v[112:115], a[144:147], v[32:35], v[224:227]
v_exp_f32 v99, v99
v_mfma_f32_16x16x32_bf16 v[112:115], a[148:151], v[36:39], v[112:115]
ds_read_b64_tr_b16 a[208:209], v8 offset:32768
v_cvt_pk_bf16_f32 v193, v98, v99
v_mfma_f32_16x16x32_bf16 v[112:115], a[152:155], v[40:43], v[112:115]
v_exp_f32 v100, v100
v_mfma_f32_16x16x32_bf16 v[112:115], a[156:159], v[44:47], v[112:115]
ds_read_b64_tr_b16 a[210:211], v8 offset:36864
v_mfma_f32_16x16x32_bf16 v[116:119], a[156:159], v[60:63], v[228:231]
v_exp_f32 v101, v101
v_mfma_f32_16x16x32_bf16 v[116:119], a[152:155], v[56:59], v[116:119]
ds_read_b64_tr_b16 a[212:213], v8 offset:40960
v_cvt_pk_bf16_f32 v200, v100, v101
v_mfma_f32_16x16x32_bf16 v[116:119], a[148:151], v[52:55], v[116:119]
v_exp_f32 v102, v102
v_mfma_f32_16x16x32_bf16 v[116:119], a[144:147], v[48:51], v[116:119]
ds_read_b64_tr_b16 a[214:215], v8 offset:45056
v_mfma_f32_16x16x32_bf16 v[120:123], a[144:147], v[64:67], v[232:235]
v_exp_f32 v103, v103
v_mfma_f32_16x16x32_bf16 v[120:123], a[148:151], v[68:71], v[120:123]
ds_read_b64_tr_b16 a[216:217], v9 offset:32768
v_cvt_pk_bf16_f32 v201, v102, v103
v_mfma_f32_16x16x32_bf16 v[120:123], a[152:155], v[72:75], v[120:123]
v_exp_f32 v104, v104
v_mfma_f32_16x16x32_bf16 v[120:123], a[156:159], v[76:79], v[120:123]
ds_read_b64_tr_b16 a[218:219], v9 offset:36864
v_mfma_f32_16x16x32_bf16 v[124:127], a[156:159], v[92:95], v[236:239]
v_exp_f32 v105, v105
v_mfma_f32_16x16x32_bf16 v[124:127], a[152:155], v[88:91], v[124:127]
ds_read_b64_tr_b16 a[220:221], v9 offset:40960
v_cvt_pk_bf16_f32 v208, v104, v105
v_mfma_f32_16x16x32_bf16 v[124:127], a[148:151], v[84:87], v[124:127]
v_exp_f32 v106, v106
v_mfma_f32_16x16x32_bf16 v[124:127], a[144:147], v[80:83], v[124:127]
ds_read_b64_tr_b16 a[222:223], v9 offset:45056
v_mfma_f32_16x16x32_bf16 v[128:131], a[160:163], v[32:35], v[224:227]
v_exp_f32 v107, v107
v_mfma_f32_16x16x32_bf16 v[128:131], a[164:167], v[36:39], v[128:131]
ds_read_b64_tr_b16 a[224:225], v10 offset:32768
v_cvt_pk_bf16_f32 v209, v106, v107
v_mfma_f32_16x16x32_bf16 v[128:131], a[168:171], v[40:43], v[128:131]
v_exp_f32 v108, v108
v_mfma_f32_16x16x32_bf16 v[128:131], a[172:175], v[44:47], v[128:131]
ds_read_b64_tr_b16 a[226:227], v10 offset:36864
v_mfma_f32_16x16x32_bf16 v[132:135], a[172:175], v[60:63], v[228:231]
v_exp_f32 v109, v109
v_mfma_f32_16x16x32_bf16 v[132:135], a[168:171], v[56:59], v[132:135]
ds_read_b64_tr_b16 a[228:229], v10 offset:40960
v_cvt_pk_bf16_f32 v216, v108, v109
v_mfma_f32_16x16x32_bf16 v[132:135], a[164:167], v[52:55], v[132:135]
v_exp_f32 v110, v110
v_mfma_f32_16x16x32_bf16 v[132:135], a[160:163], v[48:51], v[132:135]
ds_read_b64_tr_b16 a[230:231], v10 offset:45056
v_mfma_f32_16x16x32_bf16 v[136:139], a[160:163], v[64:67], v[232:235]
v_exp_f32 v111, v111
v_mfma_f32_16x16x32_bf16 v[136:139], a[164:167], v[68:71], v[136:139]
ds_read_b64_tr_b16 a[232:233], v11 offset:32768
v_cvt_pk_bf16_f32 v217, v110, v111
v_mfma_f32_16x16x32_bf16 v[136:139], a[168:171], v[72:75], v[136:139]
v_exp_f32 v112, v112
v_mfma_f32_16x16x32_bf16 v[136:139], a[172:175], v[76:79], v[136:139]
ds_read_b64_tr_b16 a[234:235], v11 offset:36864
v_mfma_f32_16x16x32_bf16 v[140:143], a[172:175], v[92:95], v[236:239]
v_exp_f32 v113, v113
v_mfma_f32_16x16x32_bf16 v[140:143], a[168:171], v[88:91], v[140:143]
ds_read_b64_tr_b16 a[236:237], v11 offset:40960
v_cvt_pk_bf16_f32 v194, v112, v113
v_mfma_f32_16x16x32_bf16 v[140:143], a[164:167], v[84:87], v[140:143]
v_exp_f32 v114, v114
v_mfma_f32_16x16x32_bf16 v[140:143], a[160:163], v[80:83], v[140:143]
ds_read_b64_tr_b16 a[238:239], v11 offset:45056
v_mfma_f32_16x16x32_bf16 v[144:147], a[176:179], v[32:35], v[224:227]
v_exp_f32 v115, v115
v_mfma_f32_16x16x32_bf16 v[144:147], a[180:183], v[36:39], v[144:147]
ds_read_b64_tr_b16 a[240:241], v12 offset:32768
v_cvt_pk_bf16_f32 v195, v114, v115
v_mfma_f32_16x16x32_bf16 v[144:147], a[184:187], v[40:43], v[144:147]
v_exp_f32 v116, v116
v_mfma_f32_16x16x32_bf16 v[144:147], a[188:191], v[44:47], v[144:147]
ds_read_b64_tr_b16 a[242:243], v12 offset:36864
v_mfma_f32_16x16x32_bf16 v[148:151], a[188:191], v[60:63], v[228:231]
v_exp_f32 v117, v117
v_mfma_f32_16x16x32_bf16 v[148:151], a[184:187], v[56:59], v[148:151]
ds_read_b64_tr_b16 a[244:245], v12 offset:40960
v_cvt_pk_bf16_f32 v202, v116, v117
v_mfma_f32_16x16x32_bf16 v[148:151], a[180:183], v[52:55], v[148:151]
v_exp_f32 v118, v118
v_mfma_f32_16x16x32_bf16 v[148:151], a[176:179], v[48:51], v[148:151]
ds_read_b64_tr_b16 a[246:247], v12 offset:45056
v_mfma_f32_16x16x32_bf16 v[152:155], a[176:179], v[64:67], v[232:235]
v_exp_f32 v119, v119
v_mfma_f32_16x16x32_bf16 v[152:155], a[180:183], v[68:71], v[152:155]
ds_read_b64_tr_b16 a[248:249], v13 offset:32768
v_cvt_pk_bf16_f32 v203, v118, v119
v_mfma_f32_16x16x32_bf16 v[152:155], a[184:187], v[72:75], v[152:155]
v_exp_f32 v120, v120
v_mfma_f32_16x16x32_bf16 v[152:155], a[188:191], v[76:79], v[152:155]
ds_read_b64_tr_b16 a[250:251], v13 offset:36864
v_mfma_f32_16x16x32_bf16 v[156:159], a[188:191], v[92:95], v[236:239]
v_exp_f32 v121, v121
v_mfma_f32_16x16x32_bf16 v[156:159], a[184:187], v[88:91], v[156:159]
ds_read_b64_tr_b16 a[252:253], v13 offset:40960
v_cvt_pk_bf16_f32 v210, v120, v121
v_mfma_f32_16x16x32_bf16 v[156:159], a[180:183], v[84:87], v[156:159]
v_exp_f32 v122, v122
v_mfma_f32_16x16x32_bf16 v[156:159], a[176:179], v[80:83], v[156:159]
ds_read_b64_tr_b16 a[254:255], v13 offset:45056
s_waitcnt lgkmcnt(8)
v_mfma_f32_16x16x32_bf16 a[0:3], v[160:163], a[192:195], a[0:3]
v_exp_f32 v123, v123
v_mfma_f32_16x16x32_bf16 a[0:3], v[164:167], a[196:199], a[0:3]
v_cvt_pk_bf16_f32 v211, v122, v123
v_mfma_f32_16x16x32_bf16 a[4:7], v[172:175], a[196:199], a[4:7]
v_exp_f32 v124, v124
v_mfma_f32_16x16x32_bf16 a[4:7], v[168:171], a[192:195], a[4:7]
v_mfma_f32_16x16x32_bf16 a[8:11], v[176:179], a[192:195], a[8:11]
v_exp_f32 v125, v125
v_mfma_f32_16x16x32_bf16 a[8:11], v[180:183], a[196:199], a[8:11]
v_cvt_pk_bf16_f32 v218, v124, v125
v_mfma_f32_16x16x32_bf16 a[12:15], v[188:191], a[196:199], a[12:15]
v_exp_f32 v126, v126
v_mfma_f32_16x16x32_bf16 a[12:15], v[184:187], a[192:195], a[12:15]
v_mfma_f32_16x16x32_bf16 a[28:31], v[184:187], a[200:203], a[28:31]
v_exp_f32 v127, v127
v_mfma_f32_16x16x32_bf16 a[28:31], v[188:191], a[204:207], a[28:31]
v_cvt_pk_bf16_f32 v219, v126, v127
v_mfma_f32_16x16x32_bf16 a[24:27], v[180:183], a[204:207], a[24:27]
v_exp_f32 v128, v128
v_mfma_f32_16x16x32_bf16 a[24:27], v[176:179], a[200:203], a[24:27]
s_waitcnt lgkmcnt(0)
v_mfma_f32_16x16x32_bf16 a[20:23], v[168:171], a[200:203], a[20:23]
v_exp_f32 v129, v129
v_mfma_f32_16x16x32_bf16 a[20:23], v[172:175], a[204:207], a[20:23]
v_cvt_pk_bf16_f32 v196, v128, v129
v_mfma_f32_16x16x32_bf16 a[16:19], v[164:167], a[204:207], a[16:19]
v_exp_f32 v130, v130
v_mfma_f32_16x16x32_bf16 a[16:19], v[160:163], a[200:203], a[16:19]
v_mfma_f32_16x16x32_bf16 a[32:35], v[160:163], a[208:211], a[32:35]
v_exp_f32 v131, v131
v_mfma_f32_16x16x32_bf16 a[32:35], v[164:167], a[212:215], a[32:35]
v_cvt_pk_bf16_f32 v197, v130, v131
v_mfma_f32_16x16x32_bf16 a[36:39], v[172:175], a[212:215], a[36:39]
v_exp_f32 v132, v132
v_mfma_f32_16x16x32_bf16 a[36:39], v[168:171], a[208:211], a[36:39]
v_mfma_f32_16x16x32_bf16 a[40:43], v[176:179], a[208:211], a[40:43]
v_exp_f32 v133, v133
v_mfma_f32_16x16x32_bf16 a[40:43], v[180:183], a[212:215], a[40:43]
v_cvt_pk_bf16_f32 v204, v132, v133
v_mfma_f32_16x16x32_bf16 a[44:47], v[188:191], a[212:215], a[44:47]
v_exp_f32 v134, v134
v_mfma_f32_16x16x32_bf16 a[44:47], v[184:187], a[208:211], a[44:47]
v_mfma_f32_16x16x32_bf16 a[60:63], v[184:187], a[216:219], a[60:63]
v_exp_f32 v135, v135
v_mfma_f32_16x16x32_bf16 a[60:63], v[188:191], a[220:223], a[60:63]
v_cvt_pk_bf16_f32 v205, v134, v135
v_mfma_f32_16x16x32_bf16 a[56:59], v[180:183], a[220:223], a[56:59]
v_exp_f32 v136, v136
v_mfma_f32_16x16x32_bf16 a[56:59], v[176:179], a[216:219], a[56:59]
v_mfma_f32_16x16x32_bf16 a[52:55], v[168:171], a[216:219], a[52:55]
v_exp_f32 v137, v137
v_mfma_f32_16x16x32_bf16 a[52:55], v[172:175], a[220:223], a[52:55]
v_cvt_pk_bf16_f32 v212, v136, v137
v_mfma_f32_16x16x32_bf16 a[48:51], v[164:167], a[220:223], a[48:51]
v_exp_f32 v138, v138
v_mfma_f32_16x16x32_bf16 a[48:51], v[160:163], a[216:219], a[48:51]
v_mfma_f32_16x16x32_bf16 a[64:67], v[160:163], a[224:227], a[64:67]
v_exp_f32 v139, v139
v_mfma_f32_16x16x32_bf16 a[64:67], v[164:167], a[228:231], a[64:67]
v_cvt_pk_bf16_f32 v213, v138, v139
v_mfma_f32_16x16x32_bf16 a[68:71], v[172:175], a[228:231], a[68:71]
v_exp_f32 v140, v140
v_mfma_f32_16x16x32_bf16 a[68:71], v[168:171], a[224:227], a[68:71]
v_mfma_f32_16x16x32_bf16 a[72:75], v[176:179], a[224:227], a[72:75]
v_exp_f32 v141, v141
v_mfma_f32_16x16x32_bf16 a[72:75], v[180:183], a[228:231], a[72:75]
v_cvt_pk_bf16_f32 v220, v140, v141
v_mfma_f32_16x16x32_bf16 a[76:79], v[188:191], a[228:231], a[76:79]
v_exp_f32 v142, v142
v_mfma_f32_16x16x32_bf16 a[76:79], v[184:187], a[224:227], a[76:79]
v_mfma_f32_16x16x32_bf16 a[92:95], v[184:187], a[232:235], a[92:95]
v_exp_f32 v143, v143
v_mfma_f32_16x16x32_bf16 a[92:95], v[188:191], a[236:239], a[92:95]
v_cvt_pk_bf16_f32 v221, v142, v143
v_mfma_f32_16x16x32_bf16 a[88:91], v[180:183], a[236:239], a[88:91]
v_exp_f32 v144, v144
v_mfma_f32_16x16x32_bf16 a[88:91], v[176:179], a[232:235], a[88:91]
v_mfma_f32_16x16x32_bf16 a[84:87], v[168:171], a[232:235], a[84:87]
v_exp_f32 v145, v145
v_mfma_f32_16x16x32_bf16 a[84:87], v[172:175], a[236:239], a[84:87]
v_cvt_pk_bf16_f32 v198, v144, v145
v_mfma_f32_16x16x32_bf16 a[80:83], v[164:167], a[236:239], a[80:83]
v_exp_f32 v146, v146
v_mfma_f32_16x16x32_bf16 a[80:83], v[160:163], a[232:235], a[80:83]
v_mfma_f32_16x16x32_bf16 a[96:99], v[160:163], a[240:243], a[96:99]
v_exp_f32 v147, v147
v_mfma_f32_16x16x32_bf16 a[96:99], v[164:167], a[244:247], a[96:99]
v_cvt_pk_bf16_f32 v199, v146, v147
v_mfma_f32_16x16x32_bf16 a[100:103], v[172:175], a[244:247], a[100:103]
v_exp_f32 v148, v148
v_mfma_f32_16x16x32_bf16 a[100:103], v[168:171], a[240:243], a[100:103]
v_mfma_f32_16x16x32_bf16 a[104:107], v[176:179], a[240:243], a[104:107]
v_exp_f32 v149, v149
v_mfma_f32_16x16x32_bf16 a[104:107], v[180:183], a[244:247], a[104:107]
v_cvt_pk_bf16_f32 v206, v148, v149
v_mfma_f32_16x16x32_bf16 a[108:111], v[188:191], a[244:247], a[108:111]
v_exp_f32 v150, v150
v_mfma_f32_16x16x32_bf16 a[108:111], v[184:187], a[240:243], a[108:111]
v_mfma_f32_16x16x32_bf16 a[124:127], v[184:187], a[248:251], a[124:127]
v_exp_f32 v151, v151
v_mfma_f32_16x16x32_bf16 a[124:127], v[188:191], a[252:255], a[124:127]
v_cvt_pk_bf16_f32 v207, v150, v151
v_mfma_f32_16x16x32_bf16 a[120:123], v[180:183], a[252:255], a[120:123]
v_exp_f32 v152, v152
v_mfma_f32_16x16x32_bf16 a[120:123], v[176:179], a[248:251], a[120:123]
v_mfma_f32_16x16x32_bf16 a[116:119], v[168:171], a[248:251], a[116:119]
v_exp_f32 v153, v153
v_mfma_f32_16x16x32_bf16 a[116:119], v[172:175], a[252:255], a[116:119]
v_cvt_pk_bf16_f32 v214, v152, v153
v_mfma_f32_16x16x32_bf16 a[112:115], v[164:167], a[252:255], a[112:115]
v_exp_f32 v154, v154
v_mfma_f32_16x16x32_bf16 a[112:115], v[160:163], a[248:251], a[112:115]
v_smfmac_f32_16x16x64_bf16 v[240:243], v[28:31], v[160:167], v16
v_exp_f32 v155, v155
v_smfmac_f32_16x16x64_bf16 v[244:247], v[28:31], v[168:175], v16
v_cvt_pk_bf16_f32 v215, v154, v155
v_smfmac_f32_16x16x64_bf16 v[248:251], v[28:31], v[176:183], v16
v_exp_f32 v156, v156
v_smfmac_f32_16x16x64_bf16 v[252:255], v[28:31], v[184:191], v16
s_barrier
s_nop 0
v_exp_f32 v157, v157
s_nop 0
ds_read_b64_tr_b16 a[192:193], v6 offset:49152
v_cvt_pk_bf16_f32 v222, v156, v157
s_nop 0
v_exp_f32 v158, v158
s_nop 0
ds_read_b64_tr_b16 a[194:195], v6 offset:53248
s_nop 0
v_exp_f32 v159, v159
s_nop 0
ds_read_b64_tr_b16 a[196:197], v6 offset:57344
v_cvt_pk_bf16_f32 v223, v158, v159
s_nop 0
ds_read_b64_tr_b16 a[198:199], v6 offset:61440
s_nop 0
ds_read_b64_tr_b16 a[200:201], v7 offset:49152
s_nop 0
ds_read_b64_tr_b16 a[202:203], v7 offset:53248
s_nop 0
ds_read_b64_tr_b16 a[204:205], v7 offset:57344
s_nop 0
ds_read_b64_tr_b16 a[206:207], v7 offset:61440
s_nop 0
ds_read_b64_tr_b16 a[208:209], v8 offset:49152
s_nop 0
ds_read_b64_tr_b16 a[210:211], v8 offset:53248
s_nop 0
ds_read_b64_tr_b16 a[212:213], v8 offset:57344
s_nop 0
ds_read_b64_tr_b16 a[214:215], v8 offset:61440
s_nop 0
ds_read_b64_tr_b16 a[216:217], v9 offset:49152
s_nop 0
ds_read_b64_tr_b16 a[218:219], v9 offset:53248
s_nop 0
ds_read_b64_tr_b16 a[220:221], v9 offset:57344
s_nop 0
ds_read_b64_tr_b16 a[222:223], v9 offset:61440
s_nop 0
ds_read_b64_tr_b16 a[224:225], v10 offset:49152
s_nop 0
ds_read_b64_tr_b16 a[226:227], v10 offset:53248
s_nop 0
ds_read_b64_tr_b16 a[228:229], v10 offset:57344
s_nop 0
ds_read_b64_tr_b16 a[230:231], v10 offset:61440
s_nop 0
ds_read_b64_tr_b16 a[232:233], v11 offset:49152
s_nop 0
ds_read_b64_tr_b16 a[234:235], v11 offset:53248
s_nop 0
ds_read_b64_tr_b16 a[236:237], v11 offset:57344
s_nop 0
ds_read_b64_tr_b16 a[238:239], v11 offset:61440
s_nop 0
ds_read_b64_tr_b16 a[240:241], v12 offset:49152
s_nop 0
ds_read_b64_tr_b16 a[242:243], v12 offset:53248
s_nop 0
ds_read_b64_tr_b16 a[244:245], v12 offset:57344
s_nop 0
ds_read_b64_tr_b16 a[246:247], v12 offset:61440
s_nop 0
ds_read_b64_tr_b16 a[248:249], v13 offset:49152
s_nop 0
ds_read_b64_tr_b16 a[250:251], v13 offset:53248
s_nop 0
ds_read_b64_tr_b16 a[252:253], v13 offset:57344
s_nop 0
ds_read_b64_tr_b16 a[254:255], v13 offset:61440
s_waitcnt lgkmcnt(8)
v_smfmac_f32_16x16x64_bf16 v[240:243], v[28:31], v[192:199], v16
v_smfmac_f32_16x16x64_bf16 v[244:247], v[28:31], v[200:207], v16
v_smfmac_f32_16x16x64_bf16 v[248:251], v[28:31], v[208:215], v16
v_smfmac_f32_16x16x64_bf16 v[252:255], v[28:31], v[216:223], v16
v_mfma_f32_16x16x32_bf16 a[0:3], v[192:195], a[192:195], a[0:3]
v_mfma_f32_16x16x32_bf16 a[0:3], v[196:199], a[196:199], a[0:3]
v_mfma_f32_16x16x32_bf16 a[4:7], v[204:207], a[196:199], a[4:7]
v_mfma_f32_16x16x32_bf16 a[4:7], v[200:203], a[192:195], a[4:7]
v_mfma_f32_16x16x32_bf16 a[8:11], v[208:211], a[192:195], a[8:11]
v_mfma_f32_16x16x32_bf16 a[8:11], v[212:215], a[196:199], a[8:11]
v_mfma_f32_16x16x32_bf16 a[12:15], v[220:223], a[196:199], a[12:15]
v_mfma_f32_16x16x32_bf16 a[12:15], v[216:219], a[192:195], a[12:15]
s_waitcnt lgkmcnt(0)
v_mfma_f32_16x16x32_bf16 a[28:31], v[216:219], a[200:203], a[28:31]
v_add_f32 v240, v240, v241
v_mfma_f32_16x16x32_bf16 a[28:31], v[220:223], a[204:207], a[28:31]
v_add_f32 v244, v244, v245
v_mfma_f32_16x16x32_bf16 a[24:27], v[212:215], a[204:207], a[24:27]
v_add_f32 v248, v248, v249
v_mfma_f32_16x16x32_bf16 a[24:27], v[208:211], a[200:203], a[24:27]
v_add_f32 v252, v252, v253
v_mfma_f32_16x16x32_bf16 a[20:23], v[200:203], a[200:203], a[20:23]
v_mov_b32 v241, v240
v_mfma_f32_16x16x32_bf16 a[20:23], v[204:207], a[204:207], a[20:23]
v_mov_b32 v245, v244
v_mfma_f32_16x16x32_bf16 a[16:19], v[196:199], a[204:207], a[16:19]
v_mov_b32 v249, v248
v_mfma_f32_16x16x32_bf16 a[16:19], v[192:195], a[200:203], a[16:19]
v_mov_b32 v253, v252
v_mfma_f32_16x16x32_bf16 a[32:35], v[192:195], a[208:211], a[32:35]
v_permlane16_swap_b32 v241, v240
v_mfma_f32_16x16x32_bf16 a[32:35], v[196:199], a[212:215], a[32:35]
v_permlane16_swap_b32 v245, v244
v_mfma_f32_16x16x32_bf16 a[36:39], v[204:207], a[212:215], a[36:39]
v_permlane16_swap_b32 v249, v248
v_mfma_f32_16x16x32_bf16 a[36:39], v[200:203], a[208:211], a[36:39]
v_permlane16_swap_b32 v253, v252
v_mfma_f32_16x16x32_bf16 a[40:43], v[208:211], a[208:211], a[40:43]
v_add_f32 v240, v240, v241
v_mfma_f32_16x16x32_bf16 a[40:43], v[212:215], a[212:215], a[40:43]
v_add_f32 v244, v244, v245
v_mfma_f32_16x16x32_bf16 a[44:47], v[220:223], a[212:215], a[44:47]
v_add_f32 v248, v248, v249
v_mfma_f32_16x16x32_bf16 a[44:47], v[216:219], a[208:211], a[44:47]
v_add_f32 v252, v252, v253
v_mfma_f32_16x16x32_bf16 a[60:63], v[216:219], a[216:219], a[60:63]
v_mov_b32 v241, v240
v_mfma_f32_16x16x32_bf16 a[60:63], v[220:223], a[220:223], a[60:63]
v_mov_b32 v245, v244
v_mfma_f32_16x16x32_bf16 a[56:59], v[212:215], a[220:223], a[56:59]
v_mov_b32 v249, v248
v_mfma_f32_16x16x32_bf16 a[56:59], v[208:211], a[216:219], a[56:59]
v_mov_b32 v253, v252
v_mfma_f32_16x16x32_bf16 a[52:55], v[200:203], a[216:219], a[52:55]
v_permlane32_swap_b32 v241, v240
v_mfma_f32_16x16x32_bf16 a[52:55], v[204:207], a[220:223], a[52:55]
v_permlane32_swap_b32 v245, v244
v_mfma_f32_16x16x32_bf16 a[48:51], v[196:199], a[220:223], a[48:51]
v_permlane32_swap_b32 v249, v248
v_mfma_f32_16x16x32_bf16 a[48:51], v[192:195], a[216:219], a[48:51]
v_permlane32_swap_b32 v253, v252
v_mfma_f32_16x16x32_bf16 a[64:67], v[192:195], a[224:227], a[64:67]
v_add_f32 v240, v240, v241
v_mfma_f32_16x16x32_bf16 a[64:67], v[196:199], a[228:231], a[64:67]
v_add_f32 v244, v244, v245
v_mfma_f32_16x16x32_bf16 a[68:71], v[204:207], a[228:231], a[68:71]
v_add_f32 v248, v248, v249
v_mfma_f32_16x16x32_bf16 a[68:71], v[200:203], a[224:227], a[68:71]
v_add_f32 v252, v252, v253
v_mfma_f32_16x16x32_bf16 a[72:75], v[208:211], a[224:227], a[72:75]
s_mov_b32 s56, 0x53800000
v_mfma_f32_16x16x32_bf16 a[72:75], v[212:215], a[228:231], a[72:75]
v_cmp_nge_f32 s[54:55], s56, v240
v_mfma_f32_16x16x32_bf16 a[76:79], v[220:223], a[228:231], a[76:79]
v_cmp_nge_f32 vcc, s56, v244
v_mfma_f32_16x16x32_bf16 a[76:79], v[216:219], a[224:227], a[76:79]
s_or_b64 s[54:55], s[54:55], vcc
v_mfma_f32_16x16x32_bf16 a[92:95], v[216:219], a[232:235], a[92:95]
v_cmp_nge_f32 vcc, s56, v248
v_mfma_f32_16x16x32_bf16 a[92:95], v[220:223], a[236:239], a[92:95]
s_or_b64 s[54:55], s[54:55], vcc
v_mfma_f32_16x16x32_bf16 a[88:91], v[212:215], a[236:239], a[88:91]
v_cmp_nge_f32 vcc, s56, v252
v_mfma_f32_16x16x32_bf16 a[88:91], v[208:211], a[232:235], a[88:91]
s_or_b64 s[54:55], s[54:55], vcc
v_mfma_f32_16x16x32_bf16 a[84:87], v[200:203], a[232:235], a[84:87]
v_rcp_f32 v240, v240
v_mfma_f32_16x16x32_bf16 a[84:87], v[204:207], a[236:239], a[84:87]
s_or_b32 s54, s54, s55
v_mfma_f32_16x16x32_bf16 a[80:83], v[196:199], a[236:239], a[80:83]
v_rcp_f32 v244, v244
v_mfma_f32_16x16x32_bf16 a[80:83], v[192:195], a[232:235], a[80:83]
s_lshl_b32 s55, s44, 2
v_mfma_f32_16x16x32_bf16 a[96:99], v[192:195], a[240:243], a[96:99]
v_rcp_f32 v248, v248
v_mfma_f32_16x16x32_bf16 a[96:99], v[196:199], a[244:247], a[96:99]
s_add_u32 s55, s55, 98304
v_mfma_f32_16x16x32_bf16 a[100:103], v[204:207], a[244:247], a[100:103]
v_rcp_f32 v252, v252
v_mfma_f32_16x16x32_bf16 a[100:103], v[200:203], a[240:243], a[100:103]
v_mov_b32 v241, s55
v_mfma_f32_16x16x32_bf16 a[104:107], v[208:211], a[240:243], a[104:107]
v_mov_b32 v242, s54
v_mfma_f32_16x16x32_bf16 a[104:107], v[212:215], a[244:247], a[104:107]
v_and_b32 v16, 48, v1
v_mfma_f32_16x16x32_bf16 a[108:111], v[220:223], a[244:247], a[108:111]
ds_write_b32 v241, v242
v_mfma_f32_16x16x32_bf16 a[108:111], v[216:219], a[240:243], a[108:111]
ds_bpermute_b32 v243, v16, v240 offset:12
ds_bpermute_b32 v242, v16, v240 offset:8
v_mfma_f32_16x16x32_bf16 a[124:127], v[216:219], a[248:251], a[124:127]
ds_bpermute_b32 v241, v16, v240 offset:4
ds_bpermute_b32 v240, v16, v240 offset:0
v_mfma_f32_16x16x32_bf16 a[124:127], v[220:223], a[252:255], a[124:127]
ds_bpermute_b32 v247, v16, v244 offset:12
ds_bpermute_b32 v246, v16, v244 offset:8
v_mfma_f32_16x16x32_bf16 a[120:123], v[212:215], a[252:255], a[120:123]
ds_bpermute_b32 v245, v16, v244 offset:4
ds_bpermute_b32 v244, v16, v244 offset:0
v_mfma_f32_16x16x32_bf16 a[120:123], v[208:211], a[248:251], a[120:123]
ds_bpermute_b32 v251, v16, v248 offset:12
ds_bpermute_b32 v250, v16, v248 offset:8
v_mfma_f32_16x16x32_bf16 a[116:119], v[200:203], a[248:251], a[116:119]
ds_bpermute_b32 v249, v16, v248 offset:4
ds_bpermute_b32 v248, v16, v248 offset:0
v_mfma_f32_16x16x32_bf16 a[116:119], v[204:207], a[252:255], a[116:119]
ds_bpermute_b32 v255, v16, v252 offset:12
ds_bpermute_b32 v254, v16, v252 offset:8
v_mfma_f32_16x16x32_bf16 a[112:115], v[196:199], a[252:255], a[112:115]
ds_bpermute_b32 v253, v16, v252 offset:4
ds_bpermute_b32 v252, v16, v252 offset:0
v_mfma_f32_16x16x32_bf16 a[112:115], v[192:195], a[248:251], a[112:115]
v_and_b32 v48, 15, v1
v_lshrrev_b32 v49, 4, v1
v_lshlrev_b32 v49, 2, v49
v_sub_u32 v48, v48, v49
v_mov_b32 v50, 0x3f80
v_mov_b32 v51, 0x3f800000
v_cmp_eq_u32 vcc, 0, v48
v_mov_b32 v18, 0
v_mov_b32 v19, 0
v_cndmask_b32 v20, 0, v50, vcc
v_cmp_eq_u32 vcc, 1, v48
v_mov_b32 v22, 0
v_mov_b32 v23, 0
v_cndmask_b32 v20, v20, v51, vcc
v_cmp_eq_u32 vcc, 2, v48
s_add_u32 s76, s57, 135424
s_add_u32 s77, s57, 270848
v_cndmask_b32 v21, 0, v50, vcc
v_cmp_eq_u32 vcc, 3, v48
s_add_u32 s59, s57, 406272
s_nop 0
v_cndmask_b32 v21, v21, v51, vcc
s_waitcnt lgkmcnt(0)
v_accvgpr_read_b32 v48, a0
v_accvgpr_read_b32 v49, a1
v_accvgpr_read_b32 v50, a2
v_accvgpr_read_b32 v51, a3
v_accvgpr_read_b32 v52, a4
v_accvgpr_read_b32 v53, a5
v_accvgpr_read_b32 v54, a6
v_accvgpr_read_b32 v55, a7
v_accvgpr_read_b32 v56, a16
v_accvgpr_read_b32 v57, a17
v_accvgpr_read_b32 v58, a18
v_accvgpr_read_b32 v59, a19
v_accvgpr_read_b32 v60, a20
v_accvgpr_read_b32 v61, a21
v_accvgpr_read_b32 v62, a22
v_accvgpr_read_b32 v63, a23
v_mul_f32 v48, v48, v240
v_mul_f32 v49, v49, v241
v_mul_f32 v50, v50, v242
v_mul_f32 v51, v51, v243
v_mul_f32 v52, v52, v244
v_mul_f32 v53, v53, v245
v_mul_f32 v54, v54, v246
v_mul_f32 v55, v55, v247
v_mul_f32 v56, v56, v240
v_mul_f32 v57, v57, v241
v_mul_f32 v58, v58, v242
v_mul_f32 v59, v59, v243
v_mul_f32 v60, v60, v244
v_mul_f32 v61, v61, v245
v_mul_f32 v62, v62, v246
v_mul_f32 v63, v63, v247
v_cvt_pk_bf16_f32 v24, v48, v49
v_cvt_pk_bf16_f32 v25, v50, v51
v_cvt_pk_bf16_f32 v26, v52, v53
v_cvt_pk_bf16_f32 v27, v54, v55
v_cvt_pk_bf16_f32 v28, v56, v57
v_cvt_pk_bf16_f32 v29, v58, v59
v_cvt_pk_bf16_f32 v30, v60, v61
v_cvt_pk_bf16_f32 v31, v62, v63
s_nop 0
v_mfma_f32_16x16x32_bf16 v[64:67], v[24:27], v[20:23], 0
v_mfma_f32_16x16x32_bf16 v[68:71], v[28:31], v[20:23], 0
v_mfma_f32_16x16x32_bf16 v[72:75], v[24:27], v[18:21], 0
v_mfma_f32_16x16x32_bf16 v[76:79], v[28:31], v[18:21], 0
v_accvgpr_read_b32 v48, a8
v_accvgpr_read_b32 v49, a9
v_accvgpr_read_b32 v50, a10
v_accvgpr_read_b32 v51, a11
v_accvgpr_read_b32 v52, a12
v_accvgpr_read_b32 v53, a13
v_accvgpr_read_b32 v54, a14
v_accvgpr_read_b32 v55, a15
v_accvgpr_read_b32 v56, a24
v_accvgpr_read_b32 v57, a25
v_accvgpr_read_b32 v58, a26
v_accvgpr_read_b32 v59, a27
v_accvgpr_read_b32 v60, a28
v_accvgpr_read_b32 v61, a29
v_accvgpr_read_b32 v62, a30
v_accvgpr_read_b32 v63, a31
v_cvt_pk_bf16_f32 v64, v64, v65
v_cvt_pk_bf16_f32 v65, v66, v67
v_cvt_pk_bf16_f32 v66, v68, v69
v_cvt_pk_bf16_f32 v67, v70, v71
buffer_store_dwordx4 v[64:67], v15, s[16:19], s57 offen offset:0 sc1
v_mul_f32 v48, v48, v248
v_mul_f32 v49, v49, v249
v_mul_f32 v50, v50, v250
v_mul_f32 v51, v51, v251
v_mul_f32 v52, v52, v252
v_mul_f32 v53, v53, v253
v_mul_f32 v54, v54, v254
v_mul_f32 v55, v55, v255
v_mul_f32 v56, v56, v248
v_mul_f32 v57, v57, v249
v_mul_f32 v58, v58, v250
v_mul_f32 v59, v59, v251
v_mul_f32 v60, v60, v252
v_mul_f32 v61, v61, v253
v_mul_f32 v62, v62, v254
v_mul_f32 v63, v63, v255
v_cvt_pk_bf16_f32 v24, v48, v49
v_cvt_pk_bf16_f32 v25, v50, v51
v_cvt_pk_bf16_f32 v26, v52, v53
v_cvt_pk_bf16_f32 v27, v54, v55
v_cvt_pk_bf16_f32 v28, v56, v57
v_cvt_pk_bf16_f32 v29, v58, v59
v_cvt_pk_bf16_f32 v30, v60, v61
v_cvt_pk_bf16_f32 v31, v62, v63
v_cvt_pk_bf16_f32 v72, v72, v73
v_cvt_pk_bf16_f32 v73, v74, v75
v_cvt_pk_bf16_f32 v74, v76, v77
v_cvt_pk_bf16_f32 v75, v78, v79
buffer_store_dwordx4 v[72:75], v15, s[16:19], s76 offen offset:0 sc1
v_mfma_f32_16x16x32_bf16 v[80:83], v[24:27], v[20:23], 0
v_mfma_f32_16x16x32_bf16 v[84:87], v[28:31], v[20:23], 0
v_mfma_f32_16x16x32_bf16 v[88:91], v[24:27], v[18:21], 0
v_mfma_f32_16x16x32_bf16 v[92:95], v[28:31], v[18:21], 0
v_accvgpr_read_b32 v48, a32
v_accvgpr_read_b32 v49, a33
v_accvgpr_read_b32 v50, a34
v_accvgpr_read_b32 v51, a35
v_accvgpr_read_b32 v52, a36
v_accvgpr_read_b32 v53, a37
v_accvgpr_read_b32 v54, a38
v_accvgpr_read_b32 v55, a39
v_accvgpr_read_b32 v56, a48
v_accvgpr_read_b32 v57, a49
v_accvgpr_read_b32 v58, a50
v_accvgpr_read_b32 v59, a51
v_accvgpr_read_b32 v60, a52
v_accvgpr_read_b32 v61, a53
v_accvgpr_read_b32 v62, a54
v_accvgpr_read_b32 v63, a55
v_cvt_pk_bf16_f32 v80, v80, v81
v_cvt_pk_bf16_f32 v81, v82, v83
v_cvt_pk_bf16_f32 v82, v84, v85
v_cvt_pk_bf16_f32 v83, v86, v87
buffer_store_dwordx4 v[80:83], v15, s[16:19], s77 offen offset:0 sc1
v_mul_f32 v48, v48, v240
v_mul_f32 v49, v49, v241
v_mul_f32 v50, v50, v242
v_mul_f32 v51, v51, v243
v_mul_f32 v52, v52, v244
v_mul_f32 v53, v53, v245
v_mul_f32 v54, v54, v246
v_mul_f32 v55, v55, v247
v_mul_f32 v56, v56, v240
v_mul_f32 v57, v57, v241
v_mul_f32 v58, v58, v242
v_mul_f32 v59, v59, v243
v_mul_f32 v60, v60, v244
v_mul_f32 v61, v61, v245
v_mul_f32 v62, v62, v246
v_mul_f32 v63, v63, v247
v_cvt_pk_bf16_f32 v24, v48, v49
v_cvt_pk_bf16_f32 v25, v50, v51
v_cvt_pk_bf16_f32 v26, v52, v53
v_cvt_pk_bf16_f32 v27, v54, v55
v_cvt_pk_bf16_f32 v28, v56, v57
v_cvt_pk_bf16_f32 v29, v58, v59
v_cvt_pk_bf16_f32 v30, v60, v61
v_cvt_pk_bf16_f32 v31, v62, v63
v_cvt_pk_bf16_f32 v88, v88, v89
v_cvt_pk_bf16_f32 v89, v90, v91
v_cvt_pk_bf16_f32 v90, v92, v93
v_cvt_pk_bf16_f32 v91, v94, v95
buffer_store_dwordx4 v[88:91], v15, s[16:19], s59 offen offset:0 sc1
v_mfma_f32_16x16x32_bf16 v[64:67], v[24:27], v[20:23], 0
v_mfma_f32_16x16x32_bf16 v[68:71], v[28:31], v[20:23], 0
v_mfma_f32_16x16x32_bf16 v[72:75], v[24:27], v[18:21], 0
v_mfma_f32_16x16x32_bf16 v[76:79], v[28:31], v[18:21], 0
v_accvgpr_read_b32 v48, a40
v_accvgpr_read_b32 v49, a41
v_accvgpr_read_b32 v50, a42
v_accvgpr_read_b32 v51, a43
v_accvgpr_read_b32 v52, a44
v_accvgpr_read_b32 v53, a45
v_accvgpr_read_b32 v54, a46
v_accvgpr_read_b32 v55, a47
v_accvgpr_read_b32 v56, a56
v_accvgpr_read_b32 v57, a57
v_accvgpr_read_b32 v58, a58
v_accvgpr_read_b32 v59, a59
v_accvgpr_read_b32 v60, a60
v_accvgpr_read_b32 v61, a61
v_accvgpr_read_b32 v62, a62
v_accvgpr_read_b32 v63, a63
v_cvt_pk_bf16_f32 v64, v64, v65
v_cvt_pk_bf16_f32 v65, v66, v67
v_cvt_pk_bf16_f32 v66, v68, v69
v_cvt_pk_bf16_f32 v67, v70, v71
buffer_store_dwordx4 v[64:67], v15, s[16:19], s57 offen offset:1024 sc1
v_mul_f32 v48, v48, v248
v_mul_f32 v49, v49, v249
v_mul_f32 v50, v50, v250
v_mul_f32 v51, v51, v251
v_mul_f32 v52, v52, v252
v_mul_f32 v53, v53, v253
v_mul_f32 v54, v54, v254
v_mul_f32 v55, v55, v255
v_mul_f32 v56, v56, v248
v_mul_f32 v57, v57, v249
v_mul_f32 v58, v58, v250
v_mul_f32 v59, v59, v251
v_mul_f32 v60, v60, v252
v_mul_f32 v61, v61, v253
v_mul_f32 v62, v62, v254
v_mul_f32 v63, v63, v255
v_cvt_pk_bf16_f32 v24, v48, v49
v_cvt_pk_bf16_f32 v25, v50, v51
v_cvt_pk_bf16_f32 v26, v52, v53
v_cvt_pk_bf16_f32 v27, v54, v55
v_cvt_pk_bf16_f32 v28, v56, v57
v_cvt_pk_bf16_f32 v29, v58, v59
v_cvt_pk_bf16_f32 v30, v60, v61
v_cvt_pk_bf16_f32 v31, v62, v63
v_cvt_pk_bf16_f32 v72, v72, v73
v_cvt_pk_bf16_f32 v73, v74, v75
v_cvt_pk_bf16_f32 v74, v76, v77
v_cvt_pk_bf16_f32 v75, v78, v79
buffer_store_dwordx4 v[72:75], v15, s[16:19], s76 offen offset:1024 sc1
v_mfma_f32_16x16x32_bf16 v[80:83], v[24:27], v[20:23], 0
v_mfma_f32_16x16x32_bf16 v[84:87], v[28:31], v[20:23], 0
v_mfma_f32_16x16x32_bf16 v[88:91], v[24:27], v[18:21], 0
v_mfma_f32_16x16x32_bf16 v[92:95], v[28:31], v[18:21], 0
v_accvgpr_read_b32 v48, a64
v_accvgpr_read_b32 v49, a65
v_accvgpr_read_b32 v50, a66
v_accvgpr_read_b32 v51, a67
v_accvgpr_read_b32 v52, a68
v_accvgpr_read_b32 v53, a69
v_accvgpr_read_b32 v54, a70
v_accvgpr_read_b32 v55, a71
v_accvgpr_read_b32 v56, a80
v_accvgpr_read_b32 v57, a81
v_accvgpr_read_b32 v58, a82
v_accvgpr_read_b32 v59, a83
v_accvgpr_read_b32 v60, a84
v_accvgpr_read_b32 v61, a85
v_accvgpr_read_b32 v62, a86
v_accvgpr_read_b32 v63, a87
v_cvt_pk_bf16_f32 v80, v80, v81
v_cvt_pk_bf16_f32 v81, v82, v83
v_cvt_pk_bf16_f32 v82, v84, v85
v_cvt_pk_bf16_f32 v83, v86, v87
buffer_store_dwordx4 v[80:83], v15, s[16:19], s77 offen offset:1024 sc1
v_mul_f32 v48, v48, v240
v_mul_f32 v49, v49, v241
v_mul_f32 v50, v50, v242
v_mul_f32 v51, v51, v243
v_mul_f32 v52, v52, v244
v_mul_f32 v53, v53, v245
v_mul_f32 v54, v54, v246
v_mul_f32 v55, v55, v247
v_mul_f32 v56, v56, v240
v_mul_f32 v57, v57, v241
v_mul_f32 v58, v58, v242
v_mul_f32 v59, v59, v243
v_mul_f32 v60, v60, v244
v_mul_f32 v61, v61, v245
v_mul_f32 v62, v62, v246
v_mul_f32 v63, v63, v247
v_cvt_pk_bf16_f32 v24, v48, v49
v_cvt_pk_bf16_f32 v25, v50, v51
v_cvt_pk_bf16_f32 v26, v52, v53
v_cvt_pk_bf16_f32 v27, v54, v55
v_cvt_pk_bf16_f32 v28, v56, v57
v_cvt_pk_bf16_f32 v29, v58, v59
v_cvt_pk_bf16_f32 v30, v60, v61
v_cvt_pk_bf16_f32 v31, v62, v63
v_cvt_pk_bf16_f32 v88, v88, v89
v_cvt_pk_bf16_f32 v89, v90, v91
v_cvt_pk_bf16_f32 v90, v92, v93
v_cvt_pk_bf16_f32 v91, v94, v95
buffer_store_dwordx4 v[88:91], v15, s[16:19], s59 offen offset:1024 sc1
v_mfma_f32_16x16x32_bf16 v[64:67], v[24:27], v[20:23], 0
v_mfma_f32_16x16x32_bf16 v[68:71], v[28:31], v[20:23], 0
v_mfma_f32_16x16x32_bf16 v[72:75], v[24:27], v[18:21], 0
v_mfma_f32_16x16x32_bf16 v[76:79], v[28:31], v[18:21], 0
v_accvgpr_read_b32 v48, a72
v_accvgpr_read_b32 v49, a73
v_accvgpr_read_b32 v50, a74
v_accvgpr_read_b32 v51, a75
v_accvgpr_read_b32 v52, a76
v_accvgpr_read_b32 v53, a77
v_accvgpr_read_b32 v54, a78
v_accvgpr_read_b32 v55, a79
v_accvgpr_read_b32 v56, a88
v_accvgpr_read_b32 v57, a89
v_accvgpr_read_b32 v58, a90
v_accvgpr_read_b32 v59, a91
v_accvgpr_read_b32 v60, a92
v_accvgpr_read_b32 v61, a93
v_accvgpr_read_b32 v62, a94
v_accvgpr_read_b32 v63, a95
v_cvt_pk_bf16_f32 v64, v64, v65
v_cvt_pk_bf16_f32 v65, v66, v67
v_cvt_pk_bf16_f32 v66, v68, v69
v_cvt_pk_bf16_f32 v67, v70, v71
buffer_store_dwordx4 v[64:67], v15, s[16:19], s57 offen offset:2048 sc1
v_mul_f32 v48, v48, v248
v_mul_f32 v49, v49, v249
v_mul_f32 v50, v50, v250
v_mul_f32 v51, v51, v251
v_mul_f32 v52, v52, v252
v_mul_f32 v53, v53, v253
v_mul_f32 v54, v54, v254
v_mul_f32 v55, v55, v255
v_mul_f32 v56, v56, v248
v_mul_f32 v57, v57, v249
v_mul_f32 v58, v58, v250
v_mul_f32 v59, v59, v251
v_mul_f32 v60, v60, v252
v_mul_f32 v61, v61, v253
v_mul_f32 v62, v62, v254
v_mul_f32 v63, v63, v255
v_cvt_pk_bf16_f32 v24, v48, v49
v_cvt_pk_bf16_f32 v25, v50, v51
v_cvt_pk_bf16_f32 v26, v52, v53
v_cvt_pk_bf16_f32 v27, v54, v55
v_cvt_pk_bf16_f32 v28, v56, v57
v_cvt_pk_bf16_f32 v29, v58, v59
v_cvt_pk_bf16_f32 v30, v60, v61
v_cvt_pk_bf16_f32 v31, v62, v63
v_cvt_pk_bf16_f32 v72, v72, v73
v_cvt_pk_bf16_f32 v73, v74, v75
v_cvt_pk_bf16_f32 v74, v76, v77
v_cvt_pk_bf16_f32 v75, v78, v79
buffer_store_dwordx4 v[72:75], v15, s[16:19], s76 offen offset:2048 sc1
v_mfma_f32_16x16x32_bf16 v[80:83], v[24:27], v[20:23], 0
v_mfma_f32_16x16x32_bf16 v[84:87], v[28:31], v[20:23], 0
v_mfma_f32_16x16x32_bf16 v[88:91], v[24:27], v[18:21], 0
v_mfma_f32_16x16x32_bf16 v[92:95], v[28:31], v[18:21], 0
v_accvgpr_read_b32 v48, a96
v_accvgpr_read_b32 v49, a97
v_accvgpr_read_b32 v50, a98
v_accvgpr_read_b32 v51, a99
v_accvgpr_read_b32 v52, a100
v_accvgpr_read_b32 v53, a101
v_accvgpr_read_b32 v54, a102
v_accvgpr_read_b32 v55, a103
v_accvgpr_read_b32 v56, a112
v_accvgpr_read_b32 v57, a113
v_accvgpr_read_b32 v58, a114
v_accvgpr_read_b32 v59, a115
v_accvgpr_read_b32 v60, a116
v_accvgpr_read_b32 v61, a117
v_accvgpr_read_b32 v62, a118
v_accvgpr_read_b32 v63, a119
v_cvt_pk_bf16_f32 v80, v80, v81
v_cvt_pk_bf16_f32 v81, v82, v83
v_cvt_pk_bf16_f32 v82, v84, v85
v_cvt_pk_bf16_f32 v83, v86, v87
buffer_store_dwordx4 v[80:83], v15, s[16:19], s77 offen offset:2048 sc1
v_mul_f32 v48, v48, v240
v_mul_f32 v49, v49, v241
v_mul_f32 v50, v50, v242
v_mul_f32 v51, v51, v243
v_mul_f32 v52, v52, v244
v_mul_f32 v53, v53, v245
v_mul_f32 v54, v54, v246
v_mul_f32 v55, v55, v247
v_mul_f32 v56, v56, v240
v_mul_f32 v57, v57, v241
v_mul_f32 v58, v58, v242
v_mul_f32 v59, v59, v243
v_mul_f32 v60, v60, v244
v_mul_f32 v61, v61, v245
v_mul_f32 v62, v62, v246
v_mul_f32 v63, v63, v247
v_cvt_pk_bf16_f32 v24, v48, v49
v_cvt_pk_bf16_f32 v25, v50, v51
v_cvt_pk_bf16_f32 v26, v52, v53
v_cvt_pk_bf16_f32 v27, v54, v55
v_cvt_pk_bf16_f32 v28, v56, v57
v_cvt_pk_bf16_f32 v29, v58, v59
v_cvt_pk_bf16_f32 v30, v60, v61
v_cvt_pk_bf16_f32 v31, v62, v63
v_cvt_pk_bf16_f32 v88, v88, v89
v_cvt_pk_bf16_f32 v89, v90, v91
v_cvt_pk_bf16_f32 v90, v92, v93
v_cvt_pk_bf16_f32 v91, v94, v95
buffer_store_dwordx4 v[88:91], v15, s[16:19], s59 offen offset:2048 sc1
v_mfma_f32_16x16x32_bf16 v[64:67], v[24:27], v[20:23], 0
v_mfma_f32_16x16x32_bf16 v[68:71], v[28:31], v[20:23], 0
v_mfma_f32_16x16x32_bf16 v[72:75], v[24:27], v[18:21], 0
v_mfma_f32_16x16x32_bf16 v[76:79], v[28:31], v[18:21], 0
v_accvgpr_read_b32 v48, a104
v_accvgpr_read_b32 v49, a105
v_accvgpr_read_b32 v50, a106
v_accvgpr_read_b32 v51, a107
v_accvgpr_read_b32 v52, a108
v_accvgpr_read_b32 v53, a109
v_accvgpr_read_b32 v54, a110
v_accvgpr_read_b32 v55, a111
v_accvgpr_read_b32 v56, a120
v_accvgpr_read_b32 v57, a121
v_accvgpr_read_b32 v58, a122
v_accvgpr_read_b32 v59, a123
v_accvgpr_read_b32 v60, a124
v_accvgpr_read_b32 v61, a125
v_accvgpr_read_b32 v62, a126
v_accvgpr_read_b32 v63, a127
v_cvt_pk_bf16_f32 v64, v64, v65
v_cvt_pk_bf16_f32 v65, v66, v67
v_cvt_pk_bf16_f32 v66, v68, v69
v_cvt_pk_bf16_f32 v67, v70, v71
buffer_store_dwordx4 v[64:67], v15, s[16:19], s57 offen offset:3072 sc1
v_mul_f32 v48, v48, v248
v_mul_f32 v49, v49, v249
v_mul_f32 v50, v50, v250
v_mul_f32 v51, v51, v251
v_mul_f32 v52, v52, v252
v_mul_f32 v53, v53, v253
v_mul_f32 v54, v54, v254
v_mul_f32 v55, v55, v255
v_mul_f32 v56, v56, v248
v_mul_f32 v57, v57, v249
v_mul_f32 v58, v58, v250
v_mul_f32 v59, v59, v251
v_mul_f32 v60, v60, v252
v_mul_f32 v61, v61, v253
v_mul_f32 v62, v62, v254
v_mul_f32 v63, v63, v255
v_cvt_pk_bf16_f32 v24, v48, v49
v_cvt_pk_bf16_f32 v25, v50, v51
v_cvt_pk_bf16_f32 v26, v52, v53
v_cvt_pk_bf16_f32 v27, v54, v55
v_cvt_pk_bf16_f32 v28, v56, v57
v_cvt_pk_bf16_f32 v29, v58, v59
v_cvt_pk_bf16_f32 v30, v60, v61
v_cvt_pk_bf16_f32 v31, v62, v63
v_cvt_pk_bf16_f32 v72, v72, v73
v_cvt_pk_bf16_f32 v73, v74, v75
v_cvt_pk_bf16_f32 v74, v76, v77
v_cvt_pk_bf16_f32 v75, v78, v79
buffer_store_dwordx4 v[72:75], v15, s[16:19], s76 offen offset:3072 sc1
v_mfma_f32_16x16x32_bf16 v[80:83], v[24:27], v[20:23], 0
v_mfma_f32_16x16x32_bf16 v[84:87], v[28:31], v[20:23], 0
v_mfma_f32_16x16x32_bf16 v[88:91], v[24:27], v[18:21], 0
v_mfma_f32_16x16x32_bf16 v[92:95], v[28:31], v[18:21], 0
s_nop 7
v_cvt_pk_bf16_f32 v80, v80, v81
v_cvt_pk_bf16_f32 v81, v82, v83
v_cvt_pk_bf16_f32 v82, v84, v85
v_cvt_pk_bf16_f32 v83, v86, v87
buffer_store_dwordx4 v[80:83], v15, s[16:19], s77 offen offset:3072 sc1
v_cvt_pk_bf16_f32 v88, v88, v89
v_cvt_pk_bf16_f32 v89, v90, v91
v_cvt_pk_bf16_f32 v90, v92, v93
v_cvt_pk_bf16_f32 v91, v94, v95
buffer_store_dwordx4 v[88:91], v15, s[16:19], s59 offen offset:3072 sc1
s_lshr_b32 s100, s81, 1
s_and_b32 s50, s81, 1
s_lshl_b32 s50, s50, 5
s_lshr_b32 s51, s2, 3
s_add_u32 s50, s50, s51
s_lshl_b32 s99, s50, 2
s_add_u32 s99, s99, s100
s_lshr_b32 s51, s50, 3
s_lshl_b32 s51, s51, 5
s_lshl_b32 s52, s100, 1
s_add_u32 s51, s51, s52
s_lshl_b32 s51, s51, 7
s_add_u32 s51, s51, 14745600
v_bfe_u32 v245, v1, 1, 2
v_and_b32 v244, 1, v1
v_lshl_add_u32 v245, v245, 3, v244
v_and_b32 v244, 0, v1
v_lshl_add_u32 v245, v244, 4, v245
v_lshlrev_b32 v245, 7, v245
v_add_u32 v245, s51, v245
v_lshlrev_b32 v244, 4, v1
s_lshr_b32 s41, s50, 2
s_lshl_b32 s41, s41, 1
s_lshr_b32 s52, s100, 1
s_lshl_b32 s52, s52, 0
s_add_u32 s41, s41, s52
s_and_b32 s42, s50, 3
s_and_b32 s52, s100, 1
s_lshl_b32 s52, s52, 2
s_add_u32 s42, s42, s52
v_and_b32 v250, 15, v1
v_lshrrev_b32 v252, 4, v1
v_mul_u32_u24 v251, 1280, v250
v_lshl_add_u32 v251, v252, 3, v251
s_lshl_b32 s43, s41, 2
s_add_u32 s43, s43, s44
s_lshl_b32 s52, s43, 4
v_add_lshl_u32 v252, v250, s52, 1
s_mul_i32 s43, s43, 20480
s_mul_i32 s52, s42, 160
s_add_u32 s43, s43, s52
s_lshl_b32 s52, s100, 15
s_and_b32 s51, s50, 3
s_mul_i32 s51, s51, 677120
s_add_u32 s51, s51, s52
s_add_u32 s51, s51, 7305216
s_lshr_b32 s50, s50, 2
s_mul_i32 s50, s50, 1083392
s_add_u32 s50, s50, s52
s_add_u32 s50, s50, 16777216
s_mul_i32 s98, s44, 9
s_add_u32 s52, s98, 0
s_cmp_lt_u32 s52, 16
s_cselect_b32 s89, s50, s51
s_cmp_ge_u32 s52, 8
s_cselect_b32 s101, 0, 0
s_add_u32 s89, s89, s101
s_cmp_ge_u32 s52, 26
s_cselect_b32 s101, 2031360, 0
s_add_u32 s89, s89, s101
s_and_b32 s101, s52, 1
s_lshl_b32 s101, s101, 10
s_add_u32 s89, s89, s101
s_sub_u32 s89, s89, 0
s_lshr_b32 s52, s52, 1
s_mul_i32 s52, s52, 135424
s_add_u32 s89, s89, s52
s_add_u32 s52, s98, 1
s_cmp_lt_u32 s52, 16
s_cselect_b32 s90, s50, s51
s_cmp_ge_u32 s52, 8
s_cselect_b32 s101, 0, 0
s_add_u32 s90, s90, s101
s_cmp_ge_u32 s52, 26
s_cselect_b32 s101, 2031360, 0
s_add_u32 s90, s90, s101
s_and_b32 s101, s52, 1
s_lshl_b32 s101, s101, 10
s_add_u32 s90, s90, s101
s_sub_u32 s90, s90, 1024
s_lshr_b32 s52, s52, 1
s_mul_i32 s52, s52, 135424
s_add_u32 s90, s90, s52
s_add_u32 s52, s98, 2
s_cmp_lt_u32 s52, 16
s_cselect_b32 s91, s50, s51
s_cmp_ge_u32 s52, 8
s_cselect_b32 s101, 0, 0
s_add_u32 s91, s91, s101
s_cmp_ge_u32 s52, 26
s_cselect_b32 s101, 2031360, 0
s_add_u32 s91, s91, s101
s_and_b32 s101, s52, 1
s_lshl_b32 s101, s101, 10
s_add_u32 s91, s91, s101
s_sub_u32 s91, s91, 2048
s_lshr_b32 s52, s52, 1
s_mul_i32 s52, s52, 135424
s_add_u32 s91, s91, s52
s_add_u32 s52, s98, 3
s_cmp_lt_u32 s52, 16
s_cselect_b32 s92, s50, s51
s_cmp_ge_u32 s52, 8
s_cselect_b32 s101, 0, 0
s_add_u32 s92, s92, s101
s_cmp_ge_u32 s52, 26
s_cselect_b32 s101, 2031360, 0
s_add_u32 s92, s92, s101
s_and_b32 s101, s52, 1
s_lshl_b32 s101, s101, 10
s_add_u32 s92, s92, s101
s_sub_u32 s92, s92, 3072
s_lshr_b32 s52, s52, 1
s_mul_i32 s52, s52, 135424
s_add_u32 s92, s92, s52
s_add_u32 s52, s98, 4
s_cmp_lt_u32 s52, 16
s_cselect_b32 s93, s50, s51
s_cmp_ge_u32 s52, 8
s_cselect_b32 s101, 0, 0
s_add_u32 s93, s93, s101
s_cmp_ge_u32 s52, 26
s_cselect_b32 s101, 2031360, 0
s_add_u32 s93, s93, s101
s_and_b32 s101, s52, 1
s_lshl_b32 s101, s101, 10
s_add_u32 s93, s93, s101
s_sub_u32 s93, s93, 0
s_lshr_b32 s52, s52, 1
s_mul_i32 s52, s52, 135424
s_add_u32 s93, s93, s52
s_add_u32 s52, s98, 5
s_cmp_lt_u32 s52, 16
s_cselect_b32 s94, s50, s51
s_cmp_ge_u32 s52, 8
s_cselect_b32 s101, 0, 0
s_add_u32 s94, s94, s101
s_cmp_ge_u32 s52, 26
s_cselect_b32 s101, 2031360, 0
s_add_u32 s94, s94, s101
s_and_b32 s101, s52, 1
s_lshl_b32 s101, s101, 10
s_add_u32 s94, s94, s101
s_sub_u32 s94, s94, 1024
s_lshr_b32 s52, s52, 1
s_mul_i32 s52, s52, 135424
s_add_u32 s94, s94, s52
s_add_u32 s52, s98, 6
s_cmp_lt_u32 s52, 16
s_cselect_b32 s95, s50, s51
s_cmp_ge_u32 s52, 8
s_cselect_b32 s101, 0, 0
s_add_u32 s95, s95, s101
s_cmp_ge_u32 s52, 26
s_cselect_b32 s101, 2031360, 0
s_add_u32 s95, s95, s101
s_and_b32 s101, s52, 1
s_lshl_b32 s101, s101, 10
s_add_u32 s95, s95, s101
s_sub_u32 s95, s95, 2048
s_lshr_b32 s52, s52, 1
s_mul_i32 s52, s52, 135424
s_add_u32 s95, s95, s52
s_add_u32 s52, s98, 7
s_cmp_lt_u32 s52, 16
s_cselect_b32 s96, s50, s51
s_cmp_ge_u32 s52, 8
s_cselect_b32 s101, 0, 0
s_add_u32 s96, s96, s101
s_cmp_ge_u32 s52, 26
s_cselect_b32 s101, 2031360, 0
s_add_u32 s96, s96, s101
s_and_b32 s101, s52, 1
s_lshl_b32 s101, s101, 10
s_add_u32 s96, s96, s101
s_sub_u32 s96, s96, 3072
s_lshr_b32 s52, s52, 1
s_mul_i32 s52, s52, 135424
s_add_u32 s96, s96, s52
s_add_u32 s52, s98, 8
s_cmp_lt_u32 s52, 16
s_cselect_b32 s97, s50, s51
s_cmp_ge_u32 s52, 8
s_cselect_b32 s101, 0, 0
s_add_u32 s97, s97, s101
s_cmp_ge_u32 s52, 26
s_cselect_b32 s101, 2031360, 0
s_add_u32 s97, s97, s101
s_and_b32 s101, s52, 1
s_lshl_b32 s101, s101, 10
s_add_u32 s97, s97, s101
s_sub_u32 s97, s97, 0
s_lshr_b32 s52, s52, 1
s_mul_i32 s52, s52, 135424
s_add_u32 s97, s97, s52
s_lshl_b32 s98, s98, 10
s_lshr_b32 s52, s44, 1
s_mul_i32 s101, s52, 541696
s_add_u32 s59, s50, s101
s_lshl_b32 s52, s52, 13
v_add_u32 v240, s52, v244
s_and_b32 s52, s44, 1
s_mul_i32 s101, s52, 2708480
s_add_u32 s101, s101, 1083392
s_add_u32 s77, s51, s101
s_mul_i32 s52, s52, 5
s_add_u32 s52, s52, 8
s_lshl_b32 s52, s52, 11
v_add_u32 v241, s52, v244
v_add_u32 v242, 73728, v240
v_add_u32 v243, 73728, v241
s_waitcnt vmcnt(0) lgkmcnt(0)
s_barrier
v_mov_b32 v19, 98304
ds_read_b128 v[20:23], v19
s_waitcnt lgkmcnt(0)
v_or3_b32 v20, v20, v21, v22
v_or_b32 v20, v20, v23
s_nop 0
v_readfirstlane_b32 s55, v20
s_nop 3
s_cmp_lg_u32 s45, 0
s_cbranch_scc1 K_plain_done
s_cmp_lg_u32 s55, 0
s_cbranch_scc1 K_redo
K_plain_done:
s_barrier
s_bitcmp1_b32 s58, 2
s_cbranch_scc1 Lsig_21
s_bitset1_b32 s58, 2
v_mov_b32 v19, s83
v_mov_b32 v18, s88
v_lshlrev_b32 v19, 7, v19
v_add_u32 v19, 14745600, v19
s_mov_b64 exec, 1
buffer_store_dword v18, v19, s[16:19], 0 offen sc1
s_mov_b64 exec, -1
Lsig_21:
s_mov_b32 s79, 67108864
v_mov_b32 v11, v15
v_mov_b32 v12, v15
v_mov_b32 v13, v15
s_cmp_lg_u32 s44, 0
s_cbranch_scc1 Lpark_22
s_mov_b32 s56, 0x40000
Lspin_23:
buffer_load_dword v246, v245, s[16:19], 0 offen sc1
s_waitcnt vmcnt(0)
v_cmp_ne_u32 vcc, s88, v246
s_cbranch_vccz Lspun_24
s_sleep 8
s_sub_u32 s56, s56, 1
s_cmp_lg_u32 s56, 0
s_cbranch_scc1 Lspin_23
Lspun_24:
Lpark_22:
s_barrier
K_late:
v_lshlrev_b32 v244, 4, v1
s_mov_b32 s56, 0x40000
Lspin_25:
buffer_load_dword v246, v245, s[16:19], 0 offen sc1
s_waitcnt vmcnt(0)
v_cmp_ne_u32 vcc, s88, v246
s_cbranch_vccz Lspun_26
s_sleep 4
s_sub_u32 s56, s56, 1
s_cmp_lg_u32 s56, 0
s_cbranch_scc1 Lspin_25
Lspun_26:
s_add_u32 s101, s59, 0
buffer_load_dwordx4 a[40:43], v244, s[16:19], s101 offen offset:0 sc1
buffer_load_dwordx4 a[44:47], v244, s[16:19], s101 offen offset:1024 sc1
s_add_u32 s101, s77, 0
buffer_load_dwordx4 a[0:3], v244, s[16:19], s101 offen offset:0 sc1
buffer_load_dwordx4 a[4:7], v244, s[16:19], s101 offen offset:1024 sc1
s_add_u32 s101, s77, 135424
buffer_load_dwordx4 a[8:11], v244, s[16:19], s101 offen offset:0 sc1
buffer_load_dwordx4 a[12:15], v244, s[16:19], s101 offen offset:1024 sc1
s_add_u32 s101, s77, 270848
buffer_load_dwordx4 a[16:19], v244, s[16:19], s101 offen offset:0 sc1
buffer_load_dwordx4 a[20:23], v244, s[16:19], s101 offen offset:1024 sc1
s_add_u32 s101, s77, 406272
buffer_load_dwordx4 a[24:27], v244, s[16:19], s101 offen offset:0 sc1
buffer_load_dwordx4 a[28:31], v244, s[16:19], s101 offen offset:1024 sc1
s_add_u32 s101, s77, 541696
buffer_load_dwordx4 a[32:35], v244, s[16:19], s101 offen offset:0 sc1
buffer_load_dwordx4 a[36:39], v244, s[16:19], s101 offen offset:1024 sc1
s_add_u32 s101, s59, 135424
buffer_load_dwordx4 a[48:51], v244, s[16:19], s101 offen offset:0 sc1
buffer_load_dwordx4 a[52:55], v244, s[16:19], s101 offen offset:1024 sc1
s_add_u32 s101, s59, 270848
buffer_load_dwordx4 a[56:59], v244, s[16:19], s101 offen offset:0 sc1
buffer_load_dwordx4 a[60:63], v244, s[16:19], s101 offen offset:1024 sc1
s_add_u32 s101, s59, 406272
buffer_load_dwordx4 a[64:67], v244, s[16:19], s101 offen offset:0 sc1
buffer_load_dwordx4 a[68:71], v244, s[16:19], s101 offen offset:1024 sc1
v_add_u32 v244, 2048, v244
s_add_u32 m0, s98, 110592
s_nop 0
buffer_load_dwordx4 v244, s[16:19], s89 offen offset:0 sc1 lds
buffer_load_dwordx4 v244, s[16:19], s90 offen offset:1024 sc1 lds
buffer_load_dwordx4 v244, s[16:19], s91 offen offset:2048 sc1 lds
buffer_load_dwordx4 v244, s[16:19], s92 offen offset:3072 sc1 lds
s_add_u32 m0, s98, 114688
s_nop 0
buffer_load_dwordx4 v244, s[16:19], s93 offen offset:0 sc1 lds
buffer_load_dwordx4 v244, s[16:19], s94 offen offset:1024 sc1 lds
buffer_load_dwordx4 v244, s[16:19], s95 offen offset:2048 sc1 lds
buffer_load_dwordx4 v244, s[16:19], s96 offen offset:3072 sc1 lds
s_add_u32 m0, s98, 118784
s_nop 0
buffer_load_dwordx4 v244, s[16:19], s97 offen offset:0 sc1 lds
v_add_u32 v244, 2048, v244
s_add_u32 m0, s98, 73728
s_nop 0
buffer_load_dwordx4 v244, s[16:19], s89 offen offset:0 sc1 lds
buffer_load_dwordx4 v244, s[16:19], s90 offen offset:1024 sc1 lds
buffer_load_dwordx4 v244, s[16:19], s91 offen offset:2048 sc1 lds
buffer_load_dwordx4 v244, s[16:19], s92 offen offset:3072 sc1 lds
s_add_u32 m0, s98, 77824
s_nop 0
buffer_load_dwordx4 v244, s[16:19], s93 offen offset:0 sc1 lds
buffer_load_dwordx4 v244, s[16:19], s94 offen offset:1024 sc1 lds
buffer_load_dwordx4 v244, s[16:19], s95 offen offset:2048 sc1 lds
buffer_load_dwordx4 v244, s[16:19], s96 offen offset:3072 sc1 lds
s_add_u32 m0, s98, 81920
s_nop 0
buffer_load_dwordx4 v244, s[16:19], s97 offen offset:0 sc1 lds
v_add_u32 v244, 2048, v244
s_branch K_final
K_redo_u:
s_waitcnt lgkmcnt(0)
s_barrier
ds_read_b128 v[116:119], v11 offset:0
ds_read_b128 v[120:123], v11 offset:1024
ds_read_b128 v[124:127], v11 offset:2048
ds_read_b128 v[128:131], v11 offset:3072
ds_read_b128 v[132:135], v11 offset:4096
ds_read_b128 v[136:139], v12 offset:5120
ds_read_b128 v[140:143], v12 offset:6144
ds_read_b128 v[144:147], v12 offset:7168
ds_read_b128 v[148:151], v12 offset:32768
ds_read_b128 v[152:155], v12 offset:33792
ds_read_b128 v[156:159], v13 offset:34816
ds_read_b128 v[160:163], v13 offset:35840
ds_read_b128 v[164:167], v13 offset:36864
ds_read_b128 v[168:171], v13 offset:37888
ds_read_b128 v[172:175], v13 offset:38912
s_waitcnt lgkmcnt(0)
v_add_f32 v96, v96, v116
v_add_f32 v97, v97, v117
v_add_f32 v98, v98, v118
v_add_f32 v99, v99, v119
v_add_f32 v100, v100, v120
v_add_f32 v101, v101, v121
v_add_f32 v102, v102, v122
v_add_f32 v103, v103, v123
v_add_f32 v104, v104, v124
v_add_f32 v105, v105, v125
v_add_f32 v106, v106, v126
v_add_f32 v107, v107, v127
v_add_f32 v108, v108, v128
v_add_f32 v109, v109, v129
v_add_f32 v110, v110, v130
v_add_f32 v111, v111, v131
v_add_f32 v112, v112, v132
v_add_f32 v113, v113, v133
v_add_f32 v114, v114, v134
v_add_f32 v115, v115, v135
v_add_f32 v96, v96, v136
v_add_f32 v97, v97, v137
v_add_f32 v98, v98, v138
v_add_f32 v99, v99, v139
v_add_f32 v100, v100, v140
v_add_f32 v101, v101, v141
v_add_f32 v102, v102, v142
v_add_f32 v103, v103, v143
v_add_f32 v104, v104, v144
v_add_f32 v105, v105, v145
v_add_f32 v106, v106, v146
v_add_f32 v107, v107, v147
v_add_f32 v108, v108, v148
v_add_f32 v109, v109, v149
v_add_f32 v110, v110, v150
v_add_f32 v111, v111, v151
v_add_f32 v112, v112, v152
v_add_f32 v113, v113, v153
v_add_f32 v114, v114, v154
v_add_f32 v115, v115, v155
v_add_f32 v96, v96, v156
v_add_f32 v97, v97, v157
v_add_f32 v98, v98, v158
v_add_f32 v99, v99, v159
v_add_f32 v100, v100, v160
v_add_f32 v101, v101, v161
v_add_f32 v102, v102, v162
v_add_f32 v103, v103, v163
v_add_f32 v104, v104, v164
v_add_f32 v105, v105, v165
v_add_f32 v106, v106, v166
v_add_f32 v107, v107, v167
v_add_f32 v108, v108, v168
v_add_f32 v109, v109, v169
v_add_f32 v110, v110, v170
v_add_f32 v111, v111, v171
v_add_f32 v112, v112, v172
v_add_f32 v113, v113, v173
v_add_f32 v114, v114, v174
v_add_f32 v115, v115, v175
v_mov_b32 v146, 0xc0135761
v_mov_b32 v147, 0xbdd2d3e8
s_lshr_b32 s50, s44, 1
s_lshl_b32 s50, s50, 10
v_add_u32 v148, s50, v15
s_and_b32 s50, s44, 1
s_lshl_b32 s50, s50, 3
s_add_u32 s50, s50, 147456
v_add_u32 v148, s50, v148
v_mul_f32 v116, v96, v96
v_fma_f32 v116, v116, v147, v146
v_mul_f32 v116, v116, v96
v_mul_f32 v117, v97, v97
v_fma_f32 v117, v117, v147, v146
v_mul_f32 v117, v117, v97
v_exp_f32 v116, v116
v_mul_f32 v118, v98, v98
v_fma_f32 v118, v118, v147, v146
v_mul_f32 v118, v118, v98
v_exp_f32 v117, v117
v_add_f32 v116, 1.0, v116
v_mul_f32 v119, v99, v99
v_fma_f32 v119, v119, v147, v146
v_mul_f32 v119, v119, v99
v_exp_f32 v118, v118
v_add_f32 v117, 1.0, v117
v_rcp_f32 v116, v116
v_mul_f32 v120, v100, v100
v_fma_f32 v120, v120, v147, v146
v_mul_f32 v120, v120, v100
v_exp_f32 v119, v119
v_mul_f32 v96, v96, v116
v_add_f32 v118, 1.0, v118
v_rcp_f32 v117, v117
v_mul_f32 v121, v101, v101
v_fma_f32 v121, v121, v147, v146
v_mul_f32 v121, v121, v101
v_exp_f32 v120, v120
v_mul_f32 v97, v97, v117
v_add_f32 v119, 1.0, v119
v_rcp_f32 v118, v118
v_mul_f32 v122, v102, v102
v_fma_f32 v122, v122, v147, v146
v_mul_f32 v122, v122, v102
v_exp_f32 v121, v121
v_mul_f32 v98, v98, v118
v_add_f32 v120, 1.0, v120
v_cvt_pk_bf16_f32 v136, v96, v97
v_rcp_f32 v119, v119
v_mul_f32 v123, v103, v103
v_fma_f32 v123, v123, v147, v146
v_mul_f32 v123, v123, v103
v_exp_f32 v122, v122
v_mul_f32 v99, v99, v119
v_add_f32 v121, 1.0, v121
v_rcp_f32 v120, v120
v_mul_f32 v124, v104, v104
v_fma_f32 v124, v124, v147, v146
v_mul_f32 v124, v124, v104
v_exp_f32 v123, v123
v_mul_f32 v100, v100, v120
v_add_f32 v122, 1.0, v122
v_cvt_pk_bf16_f32 v137, v98, v99
v_rcp_f32 v121, v121
v_mul_f32 v125, v105, v105
v_fma_f32 v125, v125, v147, v146
v_mul_f32 v125, v125, v105
v_exp_f32 v124, v124
v_mul_f32 v101, v101, v121
v_add_f32 v123, 1.0, v123
v_rcp_f32 v122, v122
v_mul_f32 v126, v106, v106
v_fma_f32 v126, v126, v147, v146
v_mul_f32 v126, v126, v106
v_exp_f32 v125, v125
v_mul_f32 v102, v102, v122
v_add_f32 v124, 1.0, v124
v_cvt_pk_bf16_f32 v138, v100, v101
v_rcp_f32 v123, v123
v_mul_f32 v127, v107, v107
v_fma_f32 v127, v127, v147, v146
v_mul_f32 v127, v127, v107
v_exp_f32 v126, v126
v_mul_f32 v103, v103, v123
v_add_f32 v125, 1.0, v125
v_rcp_f32 v124, v124
v_mul_f32 v128, v108, v108
v_fma_f32 v128, v128, v147, v146
v_mul_f32 v128, v128, v108
v_exp_f32 v127, v127
v_mul_f32 v104, v104, v124
v_add_f32 v126, 1.0, v126
v_cvt_pk_bf16_f32 v139, v102, v103
v_rcp_f32 v125, v125
v_mul_f32 v129, v109, v109
v_fma_f32 v129, v129, v147, v146
v_mul_f32 v129, v129, v109
v_exp_f32 v128, v128
v_mul_f32 v105, v105, v125
v_add_f32 v127, 1.0, v127
v_rcp_f32 v126, v126
v_mul_f32 v130, v110, v110
v_fma_f32 v130, v130, v147, v146
v_mul_f32 v130, v130, v110
v_exp_f32 v129, v129
v_mul_f32 v106, v106, v126
v_add_f32 v128, 1.0, v128
v_cvt_pk_bf16_f32 v140, v104, v105
v_rcp_f32 v127, v127
v_mul_f32 v131, v111, v111
v_fma_f32 v131, v131, v147, v146
v_mul_f32 v131, v131, v111
v_exp_f32 v130, v130
v_mul_f32 v107, v107, v127
v_add_f32 v129, 1.0, v129
v_rcp_f32 v128, v128
v_mul_f32 v132, v112, v112
v_fma_f32 v132, v132, v147, v146
v_mul_f32 v132, v132, v112
v_exp_f32 v131, v131
v_mul_f32 v108, v108, v128
v_add_f32 v130, 1.0, v130
v_cvt_pk_bf16_f32 v141, v106, v107
v_rcp_f32 v129, v129
v_mul_f32 v133, v113, v113
v_fma_f32 v133, v133, v147, v146
v_mul_f32 v133, v133, v113
v_exp_f32 v132, v132
v_mul_f32 v109, v109, v129
v_add_f32 v131, 1.0, v131
v_rcp_f32 v130, v130
v_mul_f32 v134, v114, v114
v_fma_f32 v134, v134, v147, v146
v_mul_f32 v134, v134, v114
v_exp_f32 v133, v133
v_mul_f32 v110, v110, v130
v_add_f32 v132, 1.0, v132
v_cvt_pk_bf16_f32 v142, v108, v109
v_rcp_f32 v131, v131
v_mul_f32 v135, v115, v115
v_fma_f32 v135, v135, v147, v146
v_mul_f32 v135, v135, v115
v_exp_f32 v134, v134
v_mul_f32 v111, v111, v131
v_add_f32 v133, 1.0, v133
v_rcp_f32 v132, v132
v_exp_f32 v135, v135
v_mul_f32 v112, v112, v132
v_add_f32 v134, 1.0, v134
v_cvt_pk_bf16_f32 v143, v110, v111
v_rcp_f32 v133, v133
s_nop 0
v_mul_f32 v113, v113, v133
v_add_f32 v135, 1.0, v135
v_rcp_f32 v134, v134
s_nop 0
v_mul_f32 v114, v114, v134
v_cvt_pk_bf16_f32 v144, v112, v113
v_rcp_f32 v135, v135
s_nop 0
v_mul_f32 v115, v115, v135
s_nop 0
v_cvt_pk_bf16_f32 v145, v114, v115
s_nop 0
ds_write_b64 v148, v[136:137] offset:0
ds_write_b64 v148, v[138:139] offset:2048
ds_write_b64 v148, v[140:141] offset:4096
ds_write_b64 v148, v[142:143] offset:6144
ds_write_b64 v148, v[144:145] offset:8192
s_waitcnt lgkmcnt(0)
s_barrier
s_lshl_b32 s50, s44, 10
s_add_u32 s50, s50, 147456
v_add_u32 v148, s50, v15
ds_read_b128 v[96:99], v148 offset:0
ds_read_b128 v[100:103], v148 offset:4096
ds_read_b128 v[104:107], v148 offset:8192
s_lshr_b32 s50, s44, 1
s_mul_i32 s50, s50, 55296
s_add_u32 s79, s79, s50
s_and_b32 s50, s44, 1
s_lshl_b32 s50, s50, 10
s_add_u32 s79, s79, s50
s_waitcnt lgkmcnt(0)
buffer_store_dwordx4 v[96:99], v15, s[16:19], s79 offen sc1
s_add_u32 s79, s79, 110592
buffer_store_dwordx4 v[100:103], v15, s[16:19], s79 offen sc1
s_add_u32 s79, s79, 110592
s_cmp_ge_u32 s44, 2
s_cselect_b32 s79, 67108864, s79
buffer_store_dwordx4 v[104:107], v15, s[16:19], s79 offen sc1
K_redo:
s_mov_b32 s45, 1
s_waitcnt vmcnt(0) lgkmcnt(0)
s_barrier
s_bitcmp1_b32 s58, 3
s_cbranch_scc1 Lsig_27
s_bitset1_b32 s58, 3
v_mov_b32 v26, s82
v_mov_b32 v25, s88
v_lshlrev_b32 v26, 7, v26
v_add_u32 v26, 14778368, v26
s_mov_b64 exec, 1
buffer_store_dword v25, v26, s[16:19], 0 offen sc1
s_mov_b64 exec, -1
Lsig_27:
v_lshrrev_b32 v40, 4, v1
v_and_b32 v41, 15, v1
v_lshlrev_b32 v42, 1, v40
v_xor_b32 v41, v41, v42
v_lshlrev_b32 v41, 4, v41
v_lshl_add_u32 v17, v40, 13, v41
v_xor_b32 v18, 128, v17
s_lshl_b32 s46, s44, 17
s_lshl_b32 s40, s44, 12
s_branch K_start
K_truemax:
s_waitcnt vmcnt(0)
s_barrier
s_mov_b32 s77, 67108864
s_mov_b32 s50, s40
s_mov_b32 s51, 33
v_add_u32 v192, 131072, v2
v_add_u32 v193, 131072, v3
v_add_u32 v194, 131072, v4
v_add_u32 v195, 131072, v5
v_mov_b32 v224, 0xff800000
v_mov_b32 v228, 0xff800000
v_mov_b32 v232, 0xff800000
v_mov_b32 v236, 0xff800000
K_mloop:
s_and_b32 s50, s50, 0x7ffff
s_add_u32 m0, s40, 131072
s_nop 0
buffer_load_dwordx4 v14, s[4:7], s50 offen offset:0 lds
buffer_load_dwordx4 v15, s[4:7], s50 offen offset:1024 lds
buffer_load_dwordx4 v14, s[4:7], s50 offen offset:2048 lds
buffer_load_dwordx4 v15, s[4:7], s50 offen offset:3072 lds
s_add_u32 s50, s50, 16384
s_waitcnt vmcnt(0)
s_barrier
ds_read_b128 a[128:131], v192 offset:0
ds_read_b128 a[132:135], v193 offset:0
ds_read_b128 a[136:139], v194 offset:0
ds_read_b128 a[140:143], v195 offset:0
ds_read_b128 a[144:147], v192 offset:4096
ds_read_b128 a[148:151], v193 offset:4096
ds_read_b128 a[152:155], v194 offset:4096
ds_read_b128 a[156:159], v195 offset:4096
ds_read_b128 a[160:163], v192 offset:8192
ds_read_b128 a[164:167], v193 offset:8192
ds_read_b128 a[168:171], v194 offset:8192
ds_read_b128 a[172:175], v195 offset:8192
ds_read_b128 a[176:179], v192 offset:12288
ds_read_b128 a[180:183], v193 offset:12288
ds_read_b128 a[184:187], v194 offset:12288
ds_read_b128 a[188:191], v195 offset:12288
s_waitcnt lgkmcnt(0)
s_barrier
v_mfma_f32_16x16x32_bf16 v[96:99], a[128:131], v[32:35], 0
v_mfma_f32_16x16x32_bf16 v[96:99], a[132:135], v[36:39], v[96:99]
v_mfma_f32_16x16x32_bf16 v[96:99], a[136:139], v[40:43], v[96:99]
v_mfma_f32_16x16x32_bf16 v[96:99], a[140:143], v[44:47], v[96:99]
v_mfma_f32_16x16x32_bf16 v[100:103], a[128:131], v[48:51], 0
v_mfma_f32_16x16x32_bf16 v[100:103], a[132:135], v[52:55], v[100:103]
v_mfma_f32_16x16x32_bf16 v[100:103], a[136:139], v[56:59], v[100:103]
v_mfma_f32_16x16x32_bf16 v[100:103], a[140:143], v[60:63], v[100:103]
v_mfma_f32_16x16x32_bf16 v[104:107], a[128:131], v[64:67], 0
v_mfma_f32_16x16x32_bf16 v[104:107], a[132:135], v[68:71], v[104:107]
v_mfma_f32_16x16x32_bf16 v[104:107], a[136:139], v[72:75], v[104:107]
v_mfma_f32_16x16x32_bf16 v[104:107], a[140:143], v[76:79], v[104:107]
v_mfma_f32_16x16x32_bf16 v[108:111], a[128:131], v[80:83], 0
v_mfma_f32_16x16x32_bf16 v[108:111], a[132:135], v[84:87], v[108:111]
v_mfma_f32_16x16x32_bf16 v[108:111], a[136:139], v[88:91], v[108:111]
v_mfma_f32_16x16x32_bf16 v[108:111], a[140:143], v[92:95], v[108:111]
v_mfma_f32_16x16x32_bf16 v[112:115], a[144:147], v[32:35], 0
v_mfma_f32_16x16x32_bf16 v[112:115], a[148:151], v[36:39], v[112:115]
v_mfma_f32_16x16x32_bf16 v[112:115], a[152:155], v[40:43], v[112:115]
v_mfma_f32_16x16x32_bf16 v[112:115], a[156:159], v[44:47], v[112:115]
v_mfma_f32_16x16x32_bf16 v[116:119], a[144:147], v[48:51], 0
v_mfma_f32_16x16x32_bf16 v[116:119], a[148:151], v[52:55], v[116:119]
v_mfma_f32_16x16x32_bf16 v[116:119], a[152:155], v[56:59], v[116:119]
v_mfma_f32_16x16x32_bf16 v[116:119], a[156:159], v[60:63], v[116:119]
v_mfma_f32_16x16x32_bf16 v[120:123], a[144:147], v[64:67], 0
v_mfma_f32_16x16x32_bf16 v[120:123], a[148:151], v[68:71], v[120:123]
v_mfma_f32_16x16x32_bf16 v[120:123], a[152:155], v[72:75], v[120:123]
v_mfma_f32_16x16x32_bf16 v[120:123], a[156:159], v[76:79], v[120:123]
v_mfma_f32_16x16x32_bf16 v[124:127], a[144:147], v[80:83], 0
v_mfma_f32_16x16x32_bf16 v[124:127], a[148:151], v[84:87], v[124:127]
v_mfma_f32_16x16x32_bf16 v[124:127], a[152:155], v[88:91], v[124:127]
v_mfma_f32_16x16x32_bf16 v[124:127], a[156:159], v[92:95], v[124:127]
v_mfma_f32_16x16x32_bf16 v[128:131], a[160:163], v[32:35], 0
v_mfma_f32_16x16x32_bf16 v[128:131], a[164:167], v[36:39], v[128:131]
v_mfma_f32_16x16x32_bf16 v[128:131], a[168:171], v[40:43], v[128:131]
v_mfma_f32_16x16x32_bf16 v[128:131], a[172:175], v[44:47], v[128:131]
v_mfma_f32_16x16x32_bf16 v[132:135], a[160:163], v[48:51], 0
v_mfma_f32_16x16x32_bf16 v[132:135], a[164:167], v[52:55], v[132:135]
v_mfma_f32_16x16x32_bf16 v[132:135], a[168:171], v[56:59], v[132:135]
v_mfma_f32_16x16x32_bf16 v[132:135], a[172:175], v[60:63], v[132:135]
v_mfma_f32_16x16x32_bf16 v[136:139], a[160:163], v[64:67], 0
v_mfma_f32_16x16x32_bf16 v[136:139], a[164:167], v[68:71], v[136:139]
v_mfma_f32_16x16x32_bf16 v[136:139], a[168:171], v[72:75], v[136:139]
v_mfma_f32_16x16x32_bf16 v[136:139], a[172:175], v[76:79], v[136:139]
v_mfma_f32_16x16x32_bf16 v[140:143], a[160:163], v[80:83], 0
v_mfma_f32_16x16x32_bf16 v[140:143], a[164:167], v[84:87], v[140:143]
v_mfma_f32_16x16x32_bf16 v[140:143], a[168:171], v[88:91], v[140:143]
v_mfma_f32_16x16x32_bf16 v[140:143], a[172:175], v[92:95], v[140:143]
v_mfma_f32_16x16x32_bf16 v[144:147], a[176:179], v[32:35], 0
v_mfma_f32_16x16x32_bf16 v[144:147], a[180:183], v[36:39], v[144:147]
v_mfma_f32_16x16x32_bf16 v[144:147], a[184:187], v[40:43], v[144:147]
v_mfma_f32_16x16x32_bf16 v[144:147], a[188:191], v[44:47], v[144:147]
v_mfma_f32_16x16x32_bf16 v[148:151], a[176:179], v[48:51], 0
v_mfma_f32_16x16x32_bf16 v[148:151], a[180:183], v[52:55], v[148:151]
v_mfma_f32_16x16x32_bf16 v[148:151], a[184:187], v[56:59], v[148:151]
v_mfma_f32_16x16x32_bf16 v[148:151], a[188:191], v[60:63], v[148:151]
v_mfma_f32_16x16x32_bf16 v[152:155], a[176:179], v[64:67], 0
v_mfma_f32_16x16x32_bf16 v[152:155], a[180:183], v[68:71], v[152:155]
v_mfma_f32_16x16x32_bf16 v[152:155], a[184:187], v[72:75], v[152:155]
v_mfma_f32_16x16x32_bf16 v[152:155], a[188:191], v[76:79], v[152:155]
v_mfma_f32_16x16x32_bf16 v[156:159], a[176:179], v[80:83], 0
v_mfma_f32_16x16x32_bf16 v[156:159], a[180:183], v[84:87], v[156:159]
v_mfma_f32_16x16x32_bf16 v[156:159], a[184:187], v[88:91], v[156:159]
v_mfma_f32_16x16x32_bf16 v[156:159], a[188:191], v[92:95], v[156:159]
s_nop 7
v_max3_f32 v224, v224, v96, v97
v_max3_f32 v224, v224, v98, v99
v_max3_f32 v228, v228, v100, v101
v_max3_f32 v228, v228, v102, v103
v_max3_f32 v232, v232, v104, v105
v_max3_f32 v232, v232, v106, v107
v_max3_f32 v236, v236, v108, v109
v_max3_f32 v236, v236, v110, v111
v_max3_f32 v224, v224, v112, v113
v_max3_f32 v224, v224, v114, v115
v_max3_f32 v228, v228, v116, v117
v_max3_f32 v228, v228, v118, v119
v_max3_f32 v232, v232, v120, v121
v_max3_f32 v232, v232, v122, v123
v_max3_f32 v236, v236, v124, v125
v_max3_f32 v236, v236, v126, v127
v_max3_f32 v224, v224, v128, v129
v_max3_f32 v224, v224, v130, v131
v_max3_f32 v228, v228, v132, v133
v_max3_f32 v228, v228, v134, v135
v_max3_f32 v232, v232, v136, v137
v_max3_f32 v232, v232, v138, v139
v_max3_f32 v236, v236, v140, v141
v_max3_f32 v236, v236, v142, v143
v_max3_f32 v224, v224, v144, v145
v_max3_f32 v224, v224, v146, v147
v_max3_f32 v228, v228, v148, v149
v_max3_f32 v228, v228, v150, v151
v_max3_f32 v232, v232, v152, v153
v_max3_f32 v232, v232, v154, v155
v_max3_f32 v236, v236, v156, v157
v_max3_f32 v236, v236, v158, v159
s_sub_u32 s51, s51, 1
s_cmp_lg_u32 s51, 0
s_cbranch_scc1 K_mloop
v_mov_b32 v225, v224
s_nop 1
v_permlane16_swap_b32 v225, v224
s_nop 1
v_max_f32 v224, v224, v225
v_mov_b32 v225, v224
s_nop 1
v_permlane32_swap_b32 v225, v224
s_nop 1
v_max_f32 v224, v224, v225
v_sub_f32 v224, 0, v224
v_mov_b32 v225, v224
v_mov_b32 v226, v224
v_mov_b32 v227, v224
v_mov_b32 v229, v228
s_nop 1
v_permlane16_swap_b32 v229, v228
s_nop 1
v_max_f32 v228, v228, v229
v_mov_b32 v229, v228
s_nop 1
v_permlane32_swap_b32 v229, v228
s_nop 1
v_max_f32 v228, v228, v229
v_sub_f32 v228, 0, v228
v_mov_b32 v229, v228
v_mov_b32 v230, v228
v_mov_b32 v231, v228
v_mov_b32 v233, v232
s_nop 1
v_permlane16_swap_b32 v233, v232
s_nop 1
v_max_f32 v232, v232, v233
v_mov_b32 v233, v232
s_nop 1
v_permlane32_swap_b32 v233, v232
s_nop 1
v_max_f32 v232, v232, v233
v_sub_f32 v232, 0, v232
v_mov_b32 v233, v232
v_mov_b32 v234, v232
v_mov_b32 v235, v232
v_mov_b32 v237, v236
s_nop 1
v_permlane16_swap_b32 v237, v236
s_nop 1
v_max_f32 v236, v236, v237
v_mov_b32 v237, v236
s_nop 1
v_permlane32_swap_b32 v237, v236
s_nop 1
v_max_f32 v236, v236, v237
v_sub_f32 v236, 0, v236
v_mov_b32 v237, v236
v_mov_b32 v238, v236
v_mov_b32 v239, v236
v_add_f32 v96, v96, v224
v_add_f32 v97, v97, v224
v_add_f32 v98, v98, v224
v_add_f32 v99, v99, v224
v_add_f32 v100, v100, v228
v_add_f32 v101, v101, v228
v_add_f32 v102, v102, v228
v_add_f32 v103, v103, v228
v_add_f32 v104, v104, v232
v_add_f32 v105, v105, v232
v_add_f32 v106, v106, v232
v_add_f32 v107, v107, v232
v_add_f32 v108, v108, v236
v_add_f32 v109, v109, v236
v_add_f32 v110, v110, v236
v_add_f32 v111, v111, v236
v_add_f32 v112, v112, v224
v_add_f32 v113, v113, v224
v_add_f32 v114, v114, v224
v_add_f32 v115, v115, v224
v_add_f32 v116, v116, v228
v_add_f32 v117, v117, v228
v_add_f32 v118, v118, v228
v_add_f32 v119, v119, v228
v_add_f32 v120, v120, v232
v_add_f32 v121, v121, v232
v_add_f32 v122, v122, v232
v_add_f32 v123, v123, v232
v_add_f32 v124, v124, v236
v_add_f32 v125, v125, v236
v_add_f32 v126, v126, v236
v_add_f32 v127, v127, v236
v_add_f32 v128, v128, v224
v_add_f32 v129, v129, v224
v_add_f32 v130, v130, v224
v_add_f32 v131, v131, v224
v_add_f32 v132, v132, v228
v_add_f32 v133, v133, v228
v_add_f32 v134, v134, v228
v_add_f32 v135, v135, v228
v_add_f32 v136, v136, v232
v_add_f32 v137, v137, v232
v_add_f32 v138, v138, v232
v_add_f32 v139, v139, v232
v_add_f32 v140, v140, v236
v_add_f32 v141, v141, v236
v_add_f32 v142, v142, v236
v_add_f32 v143, v143, v236
v_add_f32 v144, v144, v224
v_add_f32 v145, v145, v224
v_add_f32 v146, v146, v224
v_add_f32 v147, v147, v224
v_add_f32 v148, v148, v228
v_add_f32 v149, v149, v228
v_add_f32 v150, v150, v228
v_add_f32 v151, v151, v228
v_add_f32 v152, v152, v232
v_add_f32 v153, v153, v232
v_add_f32 v154, v154, v232
v_add_f32 v155, v155, v232
v_add_f32 v156, v156, v236
v_add_f32 v157, v157, v236
v_add_f32 v158, v158, v236
v_add_f32 v159, v159, v236
v_exp_f32 v96, v96
v_exp_f32 v97, v97
v_exp_f32 v98, v98
v_exp_f32 v99, v99
v_exp_f32 v100, v100
v_exp_f32 v101, v101
v_exp_f32 v102, v102
v_exp_f32 v103, v103
v_exp_f32 v104, v104
v_exp_f32 v105, v105
v_exp_f32 v106, v106
v_exp_f32 v107, v107
v_exp_f32 v108, v108
v_exp_f32 v109, v109
v_exp_f32 v110, v110
v_exp_f32 v111, v111
v_exp_f32 v112, v112
v_exp_f32 v113, v113
v_exp_f32 v114, v114
v_exp_f32 v115, v115
v_exp_f32 v116, v116
v_exp_f32 v117, v117
v_exp_f32 v118, v118
v_exp_f32 v119, v119
v_exp_f32 v120, v120
v_exp_f32 v121, v121
v_exp_f32 v122, v122
v_exp_f32 v123, v123
v_exp_f32 v124, v124
v_exp_f32 v125, v125
v_exp_f32 v126, v126
v_exp_f32 v127, v127
v_exp_f32 v128, v128
v_exp_f32 v129, v129
v_exp_f32 v130, v130
v_exp_f32 v131, v131
v_exp_f32 v132, v132
v_exp_f32 v133, v133
v_exp_f32 v134, v134
v_exp_f32 v135, v135
v_exp_f32 v136, v136
v_exp_f32 v137, v137
v_exp_f32 v138, v138
v_exp_f32 v139, v139
v_exp_f32 v140, v140
v_exp_f32 v141, v141
v_exp_f32 v142, v142
v_exp_f32 v143, v143
v_exp_f32 v144, v144
v_exp_f32 v145, v145
v_exp_f32 v146, v146
v_exp_f32 v147, v147
v_exp_f32 v148, v148
v_exp_f32 v149, v149
v_exp_f32 v150, v150
v_exp_f32 v151, v151
v_exp_f32 v152, v152
v_exp_f32 v153, v153
v_exp_f32 v154, v154
v_exp_f32 v155, v155
v_exp_f32 v156, v156
v_cvt_pk_bf16_f32 v160, v96, v97
v_cvt_pk_bf16_f32 v161, v98, v99
v_cvt_pk_bf16_f32 v168, v100, v101
v_cvt_pk_bf16_f32 v169, v102, v103
v_cvt_pk_bf16_f32 v176, v104, v105
v_cvt_pk_bf16_f32 v177, v106, v107
v_cvt_pk_bf16_f32 v184, v108, v109
v_cvt_pk_bf16_f32 v185, v110, v111
v_cvt_pk_bf16_f32 v162, v112, v113
v_cvt_pk_bf16_f32 v163, v114, v115
v_cvt_pk_bf16_f32 v170, v116, v117
v_cvt_pk_bf16_f32 v171, v118, v119
v_cvt_pk_bf16_f32 v178, v120, v121
v_cvt_pk_bf16_f32 v179, v122, v123
v_cvt_pk_bf16_f32 v186, v124, v125
v_cvt_pk_bf16_f32 v187, v126, v127
v_cvt_pk_bf16_f32 v164, v128, v129
v_cvt_pk_bf16_f32 v165, v130, v131
v_cvt_pk_bf16_f32 v172, v132, v133
v_cvt_pk_bf16_f32 v173, v134, v135
v_cvt_pk_bf16_f32 v180, v136, v137
v_cvt_pk_bf16_f32 v181, v138, v139
v_cvt_pk_bf16_f32 v188, v140, v141
v_cvt_pk_bf16_f32 v189, v142, v143
v_cvt_pk_bf16_f32 v166, v144, v145
v_cvt_pk_bf16_f32 v167, v146, v147
v_cvt_pk_bf16_f32 v174, v148, v149
v_cvt_pk_bf16_f32 v175, v150, v151
v_cvt_pk_bf16_f32 v182, v152, v153
v_cvt_pk_bf16_f32 v183, v154, v155
s_nop 1
s_branch K_it0
K_exit:
s_endpgm
K_last:
.section .rodata,"a"
.p2align 6
.amdhsa_kernel recurrent_scan__mha_block_cached__mixer_token_mlp__prompt_kernel
  .amdhsa_next_free_vgpr 512
  .amdhsa_next_free_sgpr 102
  .amdhsa_accum_offset 256
  .amdhsa_group_segment_fixed_size 0
  .amdhsa_kernarg_size 104
  .amdhsa_user_sgpr_count 2
  .amdhsa_user_sgpr_kernarg_segment_ptr 1
  .amdhsa_system_sgpr_workgroup_id_x 1
.end_amdhsa_kernel
```
